```python
import torch

def _softmax(x, axis=-1):
    return torch.softmax(x, dim=axis)
def _gelu(x):
    return torch.nn.functional.gelu(x, approximate="tanh")
def _silu(x):
    return torch.nn.functional.silu(x)
def _sigmoid(x):
    return torch.sigmoid(x)
def _layernorm(x, axis=-1, eps=1e-5):
    m = x.mean(dim=axis, keepdim=True)
    v = x.var(dim=axis, keepdim=True, unbiased=False)
    return (x - m) / torch.sqrt(v + eps)
def _scatter_add(tgt, idx, src, axis=0):
    return tgt.clone().index_add_(axis, idx, src)
def _segment_sum(src, seg, n):
    out = torch.zeros((n,) + src.shape[1:], dtype=src.dtype)
    return out.index_add_(0, seg, src)
def _pad(x, pw):
    flat = tuple(v for pair in reversed(pw) for v in pair)
    return torch.nn.functional.pad(x, flat)

kernel_name = 'interleave_layers__sliding_local_dilated__glu_gated_glu__prompt'

def setup_inputs():

    _w = (lambda a: (lambda t: t.to(torch.bfloat16) if t.is_floating_point() else t)(torch.as_tensor(a)))
    def _A_setup():
        B, S, D = 1, 2048, 640
        return {
            "x": _w((lambda *s: torch.randn(*s, dtype=torch.bfloat16) * 0.05)(B, S, D)),
            "wqkv": _w((lambda *s: torch.randn(*s, dtype=torch.bfloat16) * 0.05)(D, 3 * D)),
            "wo": _w((lambda *s: torch.randn(*s, dtype=torch.bfloat16) * 0.05)(D, D)),
        }
    _A_in = _A_setup()

    def _B_setup():
        B, S, D, F = 1, 2048, 640, 1536
        return {
            "x": _w((lambda *s: torch.randn(*s, dtype=torch.bfloat16) * 0.05)(B, S, D)),
            "w_gate": _w((lambda *s: torch.randn(*s, dtype=torch.bfloat16) * 0.05)(D, F)),
            "w_up": _w((lambda *s: torch.randn(*s, dtype=torch.bfloat16) * 0.05)(D, F)),
            "w_down": _w((lambda *s: torch.randn(*s, dtype=torch.bfloat16) * 0.05)(F, D)),
        }
    _B_in = _B_setup()

    return {
        "A_x": _A_in["x"],
        "A_wqkv": _A_in["wqkv"],
        "A_wo": _A_in["wo"],
        "B_x": _B_in["x"],
        "B_w_gate": _B_in["w_gate"],
        "B_w_up": _B_in["w_up"],
        "B_w_down": _B_in["w_down"],
    }

def reference(A_x, A_wqkv, A_wo, B_x, B_w_gate, B_w_up, B_w_down):
    def _A_ref(x, wqkv, wo):
        B, S, D = x.shape
        H = 32; Dh = D // H
        W, dil = 8, 2
        qkv = (lambda x, *d: x.permute(*d))((x @ wqkv).reshape(B, S, 3, H, Dh), 2, 0, 3, 1, 4)
        q, k, v = qkv[0], qkv[1], qkv[2]
        scale = Dh ** -0.5
        pos = torch.arange(S)
        off = torch.arange(W) * dil
        idx = pos[:, None] - off[None, :]
        mask = idx >= 0
        idx_c = torch.where(mask, idx, 0).reshape(-1)
        kg = k[:, :, idx_c, :].reshape(B, H, S, W, Dh)
        vg = v[:, :, idx_c, :].reshape(B, H, S, W, Dh)
        logits = torch.einsum("bhsd,bhswd->bhsw", q, kg) * scale
        logits = torch.where(mask[None, None, :, :], logits, -1e9)
        attn = _softmax(logits, axis=-1)
        o = torch.einsum("bhsw,bhswd->bhsd", attn, vg)
        return (lambda x, *d: x.permute(*d))(o, 0, 2, 1, 3).reshape(B, S, D) @ wo

    def _B_ref(x, w_gate, w_up, w_down):
        g = torch.einsum("bsd,df->bsf", x, w_gate)
        u = torch.einsum("bsd,df->bsf", x, w_up)
        h = _sigmoid(g) * u
        return torch.einsum("bsf,fd->bsd", h, w_down)

    x = A_x
    x = x + _A_ref(_layernorm(x, axis=-1), A_wqkv, A_wo)
    x = x + _B_ref(_layernorm(x, axis=-1), B_w_gate, B_w_up, B_w_down)
    x = x + _A_ref(_layernorm(x, axis=-1), A_wqkv, A_wo)
    x = x + _B_ref(_layernorm(x, axis=-1), B_w_gate, B_w_up, B_w_down)
    return x
```

```asm
; @launch kernel=prep_kernel grid=(256,1,1) block=(256,1,1) lds=45056
; @launch kernel=interleave_layers__sliding_local_dilated__glu_gated_glu__prompt_kernel grid=(256,1,1) block=(256,1,1) lds=163840
.amdgcn_target "amdgcn-amd-amdhsa--gfx950"
.text
.globl prep_kernel
.p2align 8
.type prep_kernel,@function
prep_kernel:
    s_cmp_ge_u32 s2, 256
    s_cbranch_scc1 L_prep_end
    s_getpc_b64 s[56:57]
    v_lshlrev_b32 v27, 4, v0
    global_load_dword v27, v27, s[56:57]
    s_load_dwordx2 s[92:93], s[0:1], 8
    s_load_dwordx2 s[4:5], s[0:1], 0
    s_load_dwordx2 s[8:9], s[0:1], 72
    s_load_dwordx2 s[88:89], s[0:1], 16
    s_load_dwordx4 s[84:87], s[0:1], 32
    s_load_dwordx2 s[90:91], s[0:1], 48
    v_lshrrev_b32 v178, 6, v0
    v_and_b32 v182, 63, v0
    v_readfirstlane_b32 s18, v178
    v_lshrrev_b32 v249, 3, v182
    v_and_b32 v250, 7, v182
    v_lshlrev_b32 v250, 4, v250
    v_and_b32 v176, 15, v182
    v_lshrrev_b32 v177, 4, v182
    v_mov_b32 v181, 0x80000000
    v_lshlrev_b32 v1, 4, v182
    v_mov_b32 v225, v181
    s_lshl_b32 s100, s18, 8
    s_add_u32 s100, s100, s2
    s_sub_u32 s100, 1023, s100
    s_mul_i32 s53, s18, 3072
    s_lshl_b32 s28, s18, 11
    s_and_b32 s56, s2, 7
    s_lshr_b32 s57, s2, 3
    s_lshr_b32 s16, s56, 1
    s_lshl_b32 s16, s16, 2
    s_lshr_b32 s58, s57, 3
    s_add_u32 s16, s16, s58
    s_and_b32 s17, s56, 1
    s_lshl_b32 s17, s17, 3
    s_and_b32 s58, s57, 7
    s_add_u32 s17, s17, s58
    s_lshr_b32 s19, s17, 3
    s_and_b32 s20, s17, 7
    s_mul_i32 s21, s16, 163840
    s_lshr_b32 s58, s18, 1
    s_and_b32 s59, s18, 1
    s_lshl_b32 s38, s16, 8
    s_add_u32 s38, s38, 35651584
    s_sub_u32 s39, s38, 256
    s_cmp_eq_u32 s16, 0
    s_cselect_b32 s39, s38, s39
    s_lshl_b32 s37, s17, 2
    s_add_u32 s37, s37, s38
    s_lshl_b32 s60, s16, 3
    s_lshl_b32 s61, s19, 1
    s_add_u32 s61, s61, s60
    s_lshl_b32 s62, s61, 4
    s_mul_i32 s34, s62, 1280
    s_mul_i32 s35, s61, 20480
    s_lshl_b32 s56, s59, 4
    s_add_u32 s56, s56, s58
    s_mul_i32 s56, s56, 1280
    s_mul_i32 s57, s20, 160
    s_add_u32 s56, s56, s57
    v_mul_u32_u24 v178, 160, v250
    v_lshl_add_u32 v178, v249, 4, v178
    v_add_u32 v15, s56, v178
    s_mov_b32 s46, 0xffff
    s_mov_b32 s47, 0
    v_cndmask_b32 v19, v181, v15, s[46:47]
    v_lshrrev_b32 v178, 2, v182
    v_mul_u32_u24 v178, 3840, v178
    v_and_b32 v179, 3, v182
    s_lshl_b32 s56, s18, 2
    v_add_u32 v179, s56, v179
    v_mul_u32_u24 v180, 52, v179
    v_lshrrev_b32 v180, 8, v180
    v_mul_u32_u24 v180, 1200, v180
    v_lshl_add_u32 v180, v179, 4, v180
    v_add_u32 v178, v178, v180
    v_cmp_gt_u32 vcc, 15, v179
    s_nop 1
    v_cndmask_b32 v251, v181, v178, vcc
    v_cmp_gt_u32 vcc, 32, v182
    s_nop 1
    v_cndmask_b32 v195, v181, v251, vcc
    s_mul_i32 s57, s16, 153600
    s_mul_i32 s56, s17, 80
    s_add_u32 s57, s57, s56
    s_mov_b32 s94, 2457600
    s_mov_b32 s95, 0x20000
    s_mov_b32 s6, 2621440
    s_mov_b32 s7, 0x20000
    s_mov_b32 s10, 39321600
    s_mov_b32 s11, 0x20000
    s_cmp_lt_u32 s100, 480
    s_cbranch_scc1 L_jc_g
    s_cmp_ge_u32 s100, 720
    s_cselect_b32 s80, 2, 1
    s_mov_b32 s98, 1966080
    s_cselect_b32 s98, 819200, s98
    s_mov_b32 s61, 480
    s_cselect_b32 s61, 720, s61
    s_mov_b32 s51, 7372800
    s_cselect_b32 s51, 2621440, s51
    s_mov_b32 s52, 240640
    s_cselect_b32 s52, 97280, s52
    s_cselect_b64 vcc, -1, 0
    s_sub_u32 s60, s100, s61
    s_cmp_lt_u32 s100, 820
    s_cselect_b32 s98, s98, 0
    s_cselect_b32 s60, s60, 0
    s_cselect_b32 s61, 0, 0x80000000
    v_or_b32 v225, s61, v1
    s_mul_hi_u32 s101, s60, 0x33333334
    s_mul_i32 s61, s101, 5
    s_sub_u32 s54, s60, s61
    s_lshl_b32 s54, s54, 1
    v_lshrrev_b32 v224, 1, v249
    v_lshl_add_u32 v224, v224, 1, v249
    v_lshrrev_b32 v226, 2, v249
    v_lshl_add_u32 v226, v226, 4, v249
    v_cndmask_b32 v224, v224, v226, vcc
    v_mul_u32_u24 v224, 1280, v224
    v_add_u32 v224, v224, v250
    s_lshl_b32 s62, s54, 7
    s_lshl_b32 s72, s101, 2
    s_add_u32 s72, s72, 0
    s_mul_hi_u32 s61, s72, 0x33333334
    s_mul_i32 s61, s61, 5
    s_add_u32 s72, s72, s61
    s_lshl_b32 s72, s72, 2
    s_lshl_b32 s61, s101, 5
    s_add_u32 s61, s61, 0
    s_cmp_eq_u32 s80, 2
    s_cselect_b32 s72, s72, s61
    s_mul_i32 s72, s72, 1280
    s_add_u32 s72, s72, s62
    s_add_u32 s76, s72, 128
    s_lshl_b32 s73, s101, 2
    s_add_u32 s73, s73, 1
    s_mul_hi_u32 s61, s73, 0x33333334
    s_mul_i32 s61, s61, 5
    s_add_u32 s73, s73, s61
    s_lshl_b32 s73, s73, 2
    s_lshl_b32 s61, s101, 5
    s_add_u32 s61, s61, 2
    s_cmp_eq_u32 s80, 2
    s_cselect_b32 s73, s73, s61
    s_mul_i32 s73, s73, 1280
    s_add_u32 s73, s73, s62
    s_add_u32 s77, s73, 128
    s_lshl_b32 s74, s101, 2
    s_add_u32 s74, s74, 2
    s_mul_hi_u32 s61, s74, 0x33333334
    s_mul_i32 s61, s61, 5
    s_add_u32 s74, s74, s61
    s_lshl_b32 s74, s74, 2
    s_lshl_b32 s61, s101, 5
    s_add_u32 s61, s61, 16
    s_cmp_eq_u32 s80, 2
    s_cselect_b32 s74, s74, s61
    s_mul_i32 s74, s74, 1280
    s_add_u32 s74, s74, s62
    s_add_u32 s78, s74, 128
    s_lshl_b32 s75, s101, 2
    s_add_u32 s75, s75, 3
    s_mul_hi_u32 s61, s75, 0x33333334
    s_mul_i32 s61, s61, 5
    s_add_u32 s75, s75, s61
    s_lshl_b32 s75, s75, 2
    s_lshl_b32 s61, s101, 5
    s_add_u32 s61, s61, 18
    s_cmp_eq_u32 s80, 2
    s_cselect_b32 s75, s75, s61
    s_mul_i32 s75, s75, 1280
    s_add_u32 s75, s75, s62
    s_add_u32 s79, s75, 128
    s_nop 1
    s_branch L_jc_j
L_jc_g:
    s_mov_b32 s80, 0
    s_mov_b32 s98, 1966080
    s_mul_hi_u32 s101, s100, 0xaaaaaab
    s_mul_i32 s60, s101, 24
    s_sub_u32 s54, s100, s60
    v_mul_u32_u24 v224, 3072, v249
    v_add_u32 v224, v224, v250
    s_mul_i32 s61, s101, 98304
    s_lshl_b32 s60, s54, 7
    s_add_u32 s61, s61, s60
    s_add_u32 s72, s61, 0
    s_add_u32 s73, s61, 24576
    s_add_u32 s74, s61, 49152
    s_add_u32 s75, s61, 73728
    s_add_u32 s76, s61, 0
    s_add_u32 s77, s61, 24576
    s_add_u32 s78, s61, 49152
    s_add_u32 s79, s61, 73728
    s_nop 1
L_jc_j:
    s_waitcnt lgkmcnt(0)
    s_and_b32 s93, s93, 0xffff
    s_add_u32 s56, s57, 0
    s_add_u32 m0, s53, 0
    s_nop 0
    buffer_load_dwordx4 v251, s[92:95], s56 offen nt lds
    s_add_u32 s56, s57, 61440
    s_add_u32 m0, s53, 1024
    s_nop 0
    buffer_load_dwordx4 v251, s[92:95], s56 offen nt lds
    s_add_u32 s56, s57, 122880
    s_add_u32 m0, s53, 2048
    s_nop 0
    buffer_load_dwordx4 v195, s[92:95], s56 offen nt lds
    s_and_b32 s5, s5, 0xffff
    s_and_b32 s9, s9, 0xffff
    s_cmp_eq_u32 s80, 2
    s_cselect_b32 s96, s88, s90
    s_cselect_b32 s97, s89, s91
    s_cmp_eq_u32 s80, 0
    s_cselect_b32 s60, s84, s96
    s_cselect_b32 s61, s85, s97
    s_cselect_b32 s96, s86, s96
    s_cselect_b32 s97, s87, s97
    s_and_b32 s61, s61, 0xffff
    s_and_b32 s97, s97, 0xffff
    s_mov_b32 s62, s98
    s_mov_b32 s63, 0x20000
    s_mov_b32 s99, 0x20000
    s_add_u32 m0, s28, 12288
    s_nop 0
    buffer_load_dwordx4 v224, s[60:63], s72 offen nt lds
    s_add_u32 m0, s28, 13312
    s_nop 0
    buffer_load_dwordx4 v224, s[60:63], s73 offen nt lds
    s_add_u32 m0, s28, 20480
    s_nop 0
    buffer_load_dwordx4 v224, s[60:63], s74 offen nt lds
    s_add_u32 m0, s28, 21504
    s_nop 0
    buffer_load_dwordx4 v224, s[60:63], s75 offen nt lds
    s_add_u32 m0, s28, 28672
    s_nop 0
    buffer_load_dwordx4 v224, s[96:99], s76 offen nt lds
    s_add_u32 m0, s28, 29696
    s_nop 0
    buffer_load_dwordx4 v224, s[96:99], s77 offen nt lds
    s_add_u32 m0, s28, 36864
    s_nop 0
    buffer_load_dwordx4 v224, s[96:99], s78 offen nt lds
    s_add_u32 m0, s28, 37888
    s_nop 0
    buffer_load_dwordx4 v224, s[96:99], s79 offen nt lds
    s_add_u32 s56, s34, 0
    buffer_load_dwordx4 v[64:67], v15, s[4:7], s56 offen offset:0 nt
    buffer_load_dwordx4 v[68:71], v19, s[4:7], s56 offen offset:128 nt
    s_add_u32 s56, s34, 81920
    buffer_load_dwordx4 v[72:75], v15, s[4:7], s56 offen offset:0 nt
    buffer_load_dwordx4 v[76:79], v19, s[4:7], s56 offen offset:128 nt
    s_mov_b32 s42, -1
    s_mov_b32 s43, 0
    s_lshl_b32 s56, s17, 2
    s_add_u32 s56, s56, s18
    s_mul_i32 s22, s56, 40960
    s_mul_i32 s24, s56, 61440
    s_add_u32 s24, s24, 3440640
    s_mul_i32 s33, s56, 768
    s_mul_i32 s56, s16, 393216
    s_add_u32 s33, s33, s56
    s_mul_i32 s48, s18, 20480
    s_add_u32 s48, s48, s21
    s_mul_i32 s56, s17, 1280
    s_add_u32 s32, s48, s56
    s_lshl_b32 s36, s16, 13
    v_lshlrev_b32 v0, 3, v182
    s_mul_i32 s60, s58, 20480
    s_lshl_b32 s61, s59, 7
    s_add_u32 s60, s60, s61
    s_mul_i32 s61, s20, 2560
    s_add_u32 s60, s60, s61
    v_lshlrev_b32 v178, 8, v249
    v_add3_u32 v8, v178, v250, s60
    v_cndmask_b32 v12, v181, v8, s[46:47]
    s_lshl_b32 s60, s20, 9
    s_lshl_b32 s61, s19, 8
    s_add_u32 s60, s60, s61
    s_lshl_b32 s61, s18, 6
    s_add_u32 s60, s60, s61
    v_add_u32 v178, s60, v0
    v_cmp_gt_u32 vcc, 8, v182
    s_nop 1
    v_cndmask_b32 v20, v181, v178, vcc
    v_cndmask_b32 v23, v181, v1, s[46:47]
    v_mul_u32_u24 v178, 49152, v177
    v_lshl_add_u32 v24, v176, 4, v178
    v_or_b32 v178, s18, v182
    v_cmp_eq_u32 vcc, 0, v178
    s_nop 1
    v_cndmask_b32_e64 v26, v181, 0, vcc
    v_lshrrev_b32 v178, 2, v176
    v_and_b32 v179, 3, v176
    v_lshlrev_b32 v179, 3, v179
    v_lshl_add_u32 v251, v178, 7, v179
    v_lshrrev_b32 v180, 1, v177
    v_lshl_add_u32 v251, v180, 13, v251
    v_and_b32 v180, 1, v177
    v_lshl_add_u32 v251, v180, 10, v251
    s_add_u32 s60, s28, 12288
    v_add_u32 v251, s60, v251
    v_lshrrev_b32 v180, 1, v177
    v_lshl_add_u32 v178, v180, 3, v178
    v_lshl_add_u32 v178, v178, 6, v179
    v_and_b32 v179, 1, v177
    v_lshl_add_u32 v178, v179, 5, v178
    v_add_u32 v195, s53, v178
    v_lshlrev_b32 v179, 10, v179
    v_lshl_add_u32 v179, v176, 4, v179
    s_mul_i32 s60, s16, 5
    v_add_u32 v178, s60, v180
    s_add_u32 s60, s60, 2
    v_lshrrev_b32 v184, 2, v178
    v_lshlrev_b32 v184, 11, v184
    v_and_b32 v178, 3, v178
    v_lshlrev_b32 v178, 8, v178
    v_add3_u32 v184, v184, v178, v179
    v_add_u32 v178, s60, v180
    s_add_u32 s60, s60, 2
    v_lshrrev_b32 v185, 2, v178
    v_lshlrev_b32 v185, 11, v185
    v_and_b32 v178, 3, v178
    v_lshlrev_b32 v178, 8, v178
    v_add3_u32 v185, v185, v178, v179
    v_add_u32 v178, s60, v180
    s_add_u32 s60, s60, 2
    v_lshrrev_b32 v186, 2, v178
    v_lshlrev_b32 v186, 11, v186
    v_and_b32 v178, 3, v178
    v_lshlrev_b32 v178, 8, v178
    v_add3_u32 v186, v186, v178, v179
    v_cndmask_b32 v186, v181, v186, s[42:43]
    v_and_b32 v178, 1, v177
    v_cmp_eq_u32 vcc, 0, v178
    v_mov_b32 v28, 0x3f803f80
    s_nop 0
    v_cndmask_b32 v32, 0, v28, vcc
    v_cndmask_b32_e64 v36, v28, 0, vcc
    v_mov_b32 v29, v28
    v_cndmask_b32 v33, 0, v28, vcc
    v_cndmask_b32_e64 v37, v28, 0, vcc
    v_mov_b32 v30, v28
    v_cndmask_b32 v34, 0, v28, vcc
    v_cndmask_b32_e64 v38, v28, 0, vcc
    v_mov_b32 v31, v28
    v_cndmask_b32 v35, 0, v28, vcc
    v_cndmask_b32_e64 v39, v28, 0, vcc
    v_lshlrev_b32 v178, 4, v177
    v_cmp_eq_u32 vcc, 0, v176
    s_nop 1
    v_cndmask_b32 v40, v181, v178, vcc
    s_getpc_b64 s[56:57]
L_pc_100001:
    s_add_u32 s56, s56, interleave_layers__sliding_local_dilated__glu_gated_glu__prompt_kernel-L_pc_100001
    s_addc_u32 s57, s57, 0
    s_lshr_b32 s62, s2, 3
    s_lshl_b32 s62, s62, 2
    s_add_u32 s62, s62, s18
    s_lshl_b32 s62, s62, 9
    v_and_b32 v178, 3, v182
    v_lshlrev_b32 v178, 7, v178
    v_add_u32 v178, s62, v178
    v_min_u32 v178, L_main_end-interleave_layers__sliding_local_dilated__glu_gated_glu__prompt_kernel, v178
    global_load_dword v27, v178, s[56:57]
    s_waitcnt vmcnt(13)
    ds_read_b64_tr_b16 v[96:97], v195 offset:0
    ds_read_b64_tr_b16 v[98:99], v195 offset:256
    ds_read_b64_tr_b16 v[100:101], v195 offset:1024
    ds_read_b64_tr_b16 v[102:103], v195 offset:1280
    ds_read_b64_tr_b16 v[104:105], v195 offset:2048
    ds_read_b64_tr_b16 v[106:107], v195 offset:2304
    s_mov_b32 s56, s22
    s_waitcnt lgkmcnt(4)
    buffer_store_dwordx4 v[96:99], v184, s[8:11], s56 offen
    s_waitcnt lgkmcnt(2)
    buffer_store_dwordx4 v[100:103], v185, s[8:11], s56 offen
    s_waitcnt lgkmcnt(0)
    buffer_store_dwordx4 v[104:107], v186, s[8:11], s56 offen
    s_waitcnt vmcnt(6)
    s_add_u32 s56, s35, 36175872
    buffer_store_dwordx4 v[64:67], v8, s[8:11], s56 offen offset:0
    buffer_store_dwordx4 v[68:71], v12, s[8:11], s56 offen offset:2048
    v_lshlrev_b32 v128, 16, v64
    v_and_b32 v129, 0xffff0000, v64
    v_lshlrev_b32 v130, 16, v65
    v_and_b32 v131, 0xffff0000, v65
    v_lshlrev_b32 v132, 16, v66
    v_and_b32 v133, 0xffff0000, v66
    v_lshlrev_b32 v134, 16, v67
    v_and_b32 v135, 0xffff0000, v67
    v_lshlrev_b32 v144, 16, v68
    v_and_b32 v145, 0xffff0000, v68
    v_lshlrev_b32 v146, 16, v69
    v_and_b32 v147, 0xffff0000, v69
    v_lshlrev_b32 v148, 16, v70
    v_and_b32 v149, 0xffff0000, v70
    v_lshlrev_b32 v150, 16, v71
    v_and_b32 v151, 0xffff0000, v71
    v_pk_add_f32 v[160:161], v[128:129], v[130:131]
    v_pk_mul_f32 v[164:165], v[128:129], v[128:129]
    v_pk_add_f32 v[162:163], v[144:145], v[146:147]
    v_pk_mul_f32 v[166:167], v[144:145], v[144:145]
    v_pk_fma_f32 v[164:165], v[130:131], v[130:131], v[164:165] op_sel:[0,0,0] op_sel_hi:[1,1,1]
    v_pk_fma_f32 v[166:167], v[146:147], v[146:147], v[166:167] op_sel:[0,0,0] op_sel_hi:[1,1,1]
    v_pk_add_f32 v[160:161], v[160:161], v[132:133]
    v_pk_fma_f32 v[164:165], v[132:133], v[132:133], v[164:165] op_sel:[0,0,0] op_sel_hi:[1,1,1]
    v_pk_add_f32 v[162:163], v[162:163], v[148:149]
    v_pk_fma_f32 v[166:167], v[148:149], v[148:149], v[166:167] op_sel:[0,0,0] op_sel_hi:[1,1,1]
    v_pk_add_f32 v[160:161], v[160:161], v[134:135]
    v_pk_fma_f32 v[164:165], v[134:135], v[134:135], v[164:165] op_sel:[0,0,0] op_sel_hi:[1,1,1]
    v_pk_add_f32 v[162:163], v[162:163], v[150:151]
    v_pk_fma_f32 v[166:167], v[150:151], v[150:151], v[166:167] op_sel:[0,0,0] op_sel_hi:[1,1,1]
    v_add_f32 v160, v160, v161
    v_add_f32 v162, v162, v163
    v_add_f32 v161, v164, v165
    v_add_f32 v163, v166, v167
    v_cndmask_b32 v162, 0, v162, s[46:47]
    v_cndmask_b32 v163, 0, v163, s[46:47]
    v_pk_add_f32 v[160:161], v[160:161], v[162:163]
    s_nop 1
    v_add_f32_dpp v160, v160, v160 row_ror:8 row_mask:0xf bank_mask:0xf
    v_add_f32_dpp v161, v161, v161 row_ror:8 row_mask:0xf bank_mask:0xf
    v_mov_b32 v162, v160
    v_mov_b32 v163, v161
    s_nop 0
    v_permlane16_swap_b32 v160, v162
    v_permlane16_swap_b32 v161, v163
    v_pk_add_f32 v[160:161], v[160:161], v[162:163]
    v_mov_b32 v162, v160
    v_mov_b32 v163, v161
    s_nop 0
    v_permlane32_swap_b32 v160, v162
    v_permlane32_swap_b32 v161, v163
    v_pk_add_f32 v[160:161], v[160:161], v[162:163]
    s_add_u32 s56, s36, 35127296
    buffer_store_dwordx2 v[160:161], v20, s[8:11], s56 offen
    s_waitcnt vmcnt(7)
    s_add_u32 s56, s35, 36257792
    buffer_store_dwordx4 v[72:75], v8, s[8:11], s56 offen offset:0
    buffer_store_dwordx4 v[76:79], v12, s[8:11], s56 offen offset:2048
    v_lshlrev_b32 v128, 16, v72
    v_and_b32 v129, 0xffff0000, v72
    v_lshlrev_b32 v130, 16, v73
    v_and_b32 v131, 0xffff0000, v73
    v_lshlrev_b32 v132, 16, v74
    v_and_b32 v133, 0xffff0000, v74
    v_lshlrev_b32 v134, 16, v75
    v_and_b32 v135, 0xffff0000, v75
    v_lshlrev_b32 v144, 16, v76
    v_and_b32 v145, 0xffff0000, v76
    v_lshlrev_b32 v146, 16, v77
    v_and_b32 v147, 0xffff0000, v77
    v_lshlrev_b32 v148, 16, v78
    v_and_b32 v149, 0xffff0000, v78
    v_lshlrev_b32 v150, 16, v79
    v_and_b32 v151, 0xffff0000, v79
    v_pk_add_f32 v[168:169], v[128:129], v[130:131]
    v_pk_mul_f32 v[172:173], v[128:129], v[128:129]
    v_pk_add_f32 v[170:171], v[144:145], v[146:147]
    v_pk_mul_f32 v[174:175], v[144:145], v[144:145]
    v_pk_fma_f32 v[172:173], v[130:131], v[130:131], v[172:173] op_sel:[0,0,0] op_sel_hi:[1,1,1]
    v_pk_fma_f32 v[174:175], v[146:147], v[146:147], v[174:175] op_sel:[0,0,0] op_sel_hi:[1,1,1]
    v_pk_add_f32 v[168:169], v[168:169], v[132:133]
    v_pk_fma_f32 v[172:173], v[132:133], v[132:133], v[172:173] op_sel:[0,0,0] op_sel_hi:[1,1,1]
    v_pk_add_f32 v[170:171], v[170:171], v[148:149]
    v_pk_fma_f32 v[174:175], v[148:149], v[148:149], v[174:175] op_sel:[0,0,0] op_sel_hi:[1,1,1]
    v_pk_add_f32 v[168:169], v[168:169], v[134:135]
    v_pk_fma_f32 v[172:173], v[134:135], v[134:135], v[172:173] op_sel:[0,0,0] op_sel_hi:[1,1,1]
    v_pk_add_f32 v[170:171], v[170:171], v[150:151]
    v_pk_fma_f32 v[174:175], v[150:151], v[150:151], v[174:175] op_sel:[0,0,0] op_sel_hi:[1,1,1]
    v_add_f32 v168, v168, v169
    v_add_f32 v170, v170, v171
    v_add_f32 v169, v172, v173
    v_add_f32 v171, v174, v175
    v_cndmask_b32 v170, 0, v170, s[46:47]
    v_cndmask_b32 v171, 0, v171, s[46:47]
    v_pk_add_f32 v[168:169], v[168:169], v[170:171]
    s_nop 1
    v_add_f32_dpp v168, v168, v168 row_ror:8 row_mask:0xf bank_mask:0xf
    v_add_f32_dpp v169, v169, v169 row_ror:8 row_mask:0xf bank_mask:0xf
    v_mov_b32 v170, v168
    v_mov_b32 v171, v169
    s_nop 0
    v_permlane16_swap_b32 v168, v170
    v_permlane16_swap_b32 v169, v171
    v_pk_add_f32 v[168:169], v[168:169], v[170:171]
    v_mov_b32 v170, v168
    v_mov_b32 v171, v169
    s_nop 0
    v_permlane32_swap_b32 v168, v170
    v_permlane32_swap_b32 v169, v171
    v_pk_add_f32 v[168:169], v[168:169], v[170:171]
    s_add_u32 s56, s36, 35131392
    buffer_store_dwordx2 v[168:169], v20, s[8:11], s56 offen
    s_cmp_lt_u32 s100, 480
    s_cbranch_scc1 L_jr_g
    s_mul_i32 s58, s101, 5
    ds_read_b64_tr_b16 v[228:229], v251 offset:0
    ds_read_b64_tr_b16 v[230:231], v251 offset:512
    ds_read_b64_tr_b16 v[232:233], v251 offset:32
    ds_read_b64_tr_b16 v[234:235], v251 offset:544
    ds_read_b64_tr_b16 v[236:237], v251 offset:64
    ds_read_b64_tr_b16 v[238:239], v251 offset:576
    ds_read_b64_tr_b16 v[240:241], v251 offset:96
    ds_read_b64_tr_b16 v[242:243], v251 offset:608
    s_lshl_b32 s56, s54, 2
    s_add_u32 s56, s56, 0
    s_mul_hi_u32 s57, s56, 0x33333334
    s_mul_i32 s57, s57, s52
    s_add_u32 s56, s56, s58
    s_lshl_b32 s56, s56, 10
    s_add_u32 s56, s56, s57
    s_add_u32 s56, s56, s51
    s_waitcnt lgkmcnt(6)
    buffer_store_dwordx4 v[228:231], v225, s[8:11], s56 offen
    s_lshl_b32 s56, s54, 2
    s_add_u32 s56, s56, 1
    s_mul_hi_u32 s57, s56, 0x33333334
    s_mul_i32 s57, s57, s52
    s_add_u32 s56, s56, s58
    s_lshl_b32 s56, s56, 10
    s_add_u32 s56, s56, s57
    s_add_u32 s56, s56, s51
    s_waitcnt lgkmcnt(4)
    buffer_store_dwordx4 v[232:235], v225, s[8:11], s56 offen
    s_lshl_b32 s56, s54, 2
    s_add_u32 s56, s56, 2
    s_mul_hi_u32 s57, s56, 0x33333334
    s_mul_i32 s57, s57, s52
    s_add_u32 s56, s56, s58
    s_lshl_b32 s56, s56, 10
    s_add_u32 s56, s56, s57
    s_add_u32 s56, s56, s51
    s_waitcnt lgkmcnt(2)
    buffer_store_dwordx4 v[236:239], v225, s[8:11], s56 offen
    s_lshl_b32 s56, s54, 2
    s_add_u32 s56, s56, 3
    s_mul_hi_u32 s57, s56, 0x33333334
    s_mul_i32 s57, s57, s52
    s_add_u32 s56, s56, s58
    s_lshl_b32 s56, s56, 10
    s_add_u32 s56, s56, s57
    s_add_u32 s56, s56, s51
    s_waitcnt lgkmcnt(0)
    buffer_store_dwordx4 v[240:243], v225, s[8:11], s56 offen
    ds_read_b64_tr_b16 v[228:229], v251 offset:16384
    ds_read_b64_tr_b16 v[230:231], v251 offset:16896
    ds_read_b64_tr_b16 v[232:233], v251 offset:16416
    ds_read_b64_tr_b16 v[234:235], v251 offset:16928
    ds_read_b64_tr_b16 v[236:237], v251 offset:16448
    ds_read_b64_tr_b16 v[238:239], v251 offset:16960
    ds_read_b64_tr_b16 v[240:241], v251 offset:16480
    ds_read_b64_tr_b16 v[242:243], v251 offset:16992
    s_lshl_b32 s56, s54, 2
    s_add_u32 s56, s56, 4
    s_mul_hi_u32 s57, s56, 0x33333334
    s_mul_i32 s57, s57, s52
    s_add_u32 s56, s56, s58
    s_lshl_b32 s56, s56, 10
    s_add_u32 s56, s56, s57
    s_add_u32 s56, s56, s51
    s_waitcnt lgkmcnt(6)
    buffer_store_dwordx4 v[228:231], v225, s[8:11], s56 offen
    s_lshl_b32 s56, s54, 2
    s_add_u32 s56, s56, 5
    s_mul_hi_u32 s57, s56, 0x33333334
    s_mul_i32 s57, s57, s52
    s_add_u32 s56, s56, s58
    s_lshl_b32 s56, s56, 10
    s_add_u32 s56, s56, s57
    s_add_u32 s56, s56, s51
    s_waitcnt lgkmcnt(4)
    buffer_store_dwordx4 v[232:235], v225, s[8:11], s56 offen
    s_lshl_b32 s56, s54, 2
    s_add_u32 s56, s56, 6
    s_mul_hi_u32 s57, s56, 0x33333334
    s_mul_i32 s57, s57, s52
    s_add_u32 s56, s56, s58
    s_lshl_b32 s56, s56, 10
    s_add_u32 s56, s56, s57
    s_add_u32 s56, s56, s51
    s_waitcnt lgkmcnt(2)
    buffer_store_dwordx4 v[236:239], v225, s[8:11], s56 offen
    s_lshl_b32 s56, s54, 2
    s_add_u32 s56, s56, 7
    s_mul_hi_u32 s57, s56, 0x33333334
    s_mul_i32 s57, s57, s52
    s_add_u32 s56, s56, s58
    s_lshl_b32 s56, s56, 10
    s_add_u32 s56, s56, s57
    s_add_u32 s56, s56, s51
    s_waitcnt lgkmcnt(0)
    buffer_store_dwordx4 v[240:243], v225, s[8:11], s56 offen
    s_nop 1
    s_branch L_jr_j
L_jr_g:
    ds_read_b64_tr_b16 v[228:229], v251 offset:0
    ds_read_b64_tr_b16 v[230:231], v251 offset:512
    ds_read_b64_tr_b16 v[232:233], v251 offset:16384
    ds_read_b64_tr_b16 v[234:235], v251 offset:16896
    ds_read_b64_tr_b16 v[236:237], v251 offset:32
    ds_read_b64_tr_b16 v[238:239], v251 offset:544
    ds_read_b64_tr_b16 v[240:241], v251 offset:16416
    ds_read_b64_tr_b16 v[242:243], v251 offset:16928
    s_waitcnt lgkmcnt(4)
    s_mov_b32 vcc_lo, 0x33333333
    s_mov_b32 vcc_hi, 0x33333333
    v_cndmask_b32_dpp v168, v232, v228, vcc quad_perm:[0,1,0,1] row_mask:0xf bank_mask:0xf
    v_cndmask_b32_dpp v169, v233, v229, vcc quad_perm:[0,1,0,1] row_mask:0xf bank_mask:0xf
    v_cndmask_b32_dpp v170, v234, v230, vcc quad_perm:[0,1,0,1] row_mask:0xf bank_mask:0xf
    v_cndmask_b32_dpp v171, v235, v231, vcc quad_perm:[0,1,0,1] row_mask:0xf bank_mask:0xf
    s_mov_b32 vcc_lo, 0xcccccccc
    s_mov_b32 vcc_hi, 0xcccccccc
    v_cndmask_b32_dpp v172, v228, v232, vcc quad_perm:[2,3,2,3] row_mask:0xf bank_mask:0xf
    v_cndmask_b32_dpp v173, v229, v233, vcc quad_perm:[2,3,2,3] row_mask:0xf bank_mask:0xf
    v_cndmask_b32_dpp v174, v230, v234, vcc quad_perm:[2,3,2,3] row_mask:0xf bank_mask:0xf
    v_cndmask_b32_dpp v175, v231, v235, vcc quad_perm:[2,3,2,3] row_mask:0xf bank_mask:0xf
    s_lshl_b32 s56, s54, 3
    s_add_u32 s56, s56, 0
    s_mul_hi_u32 s57, s56, 0x55555556
    s_mul_i32 s57, s57, 57
    s_add_u32 s56, s56, s57
    s_mul_i32 s57, s101, 3
    s_add_u32 s56, s56, s57
    s_lshl_b32 s56, s56, 10
    s_add_u32 s56, s56, 3440640
    buffer_store_dwordx4 v[168:171], v1, s[8:11], s56 offen
    s_lshl_b32 s56, s54, 3
    s_add_u32 s56, s56, 1
    s_mul_hi_u32 s57, s56, 0x55555556
    s_mul_i32 s57, s57, 57
    s_add_u32 s56, s56, s57
    s_mul_i32 s57, s101, 3
    s_add_u32 s56, s56, s57
    s_lshl_b32 s56, s56, 10
    s_add_u32 s56, s56, 3440640
    buffer_store_dwordx4 v[172:175], v1, s[8:11], s56 offen
    s_waitcnt lgkmcnt(0)
    s_mov_b32 vcc_lo, 0x33333333
    s_mov_b32 vcc_hi, 0x33333333
    v_cndmask_b32_dpp v168, v240, v236, vcc quad_perm:[0,1,0,1] row_mask:0xf bank_mask:0xf
    v_cndmask_b32_dpp v169, v241, v237, vcc quad_perm:[0,1,0,1] row_mask:0xf bank_mask:0xf
    v_cndmask_b32_dpp v170, v242, v238, vcc quad_perm:[0,1,0,1] row_mask:0xf bank_mask:0xf
    v_cndmask_b32_dpp v171, v243, v239, vcc quad_perm:[0,1,0,1] row_mask:0xf bank_mask:0xf
    s_mov_b32 vcc_lo, 0xcccccccc
    s_mov_b32 vcc_hi, 0xcccccccc
    v_cndmask_b32_dpp v172, v236, v240, vcc quad_perm:[2,3,2,3] row_mask:0xf bank_mask:0xf
    v_cndmask_b32_dpp v173, v237, v241, vcc quad_perm:[2,3,2,3] row_mask:0xf bank_mask:0xf
    v_cndmask_b32_dpp v174, v238, v242, vcc quad_perm:[2,3,2,3] row_mask:0xf bank_mask:0xf
    v_cndmask_b32_dpp v175, v239, v243, vcc quad_perm:[2,3,2,3] row_mask:0xf bank_mask:0xf
    s_lshl_b32 s56, s54, 3
    s_add_u32 s56, s56, 2
    s_mul_hi_u32 s57, s56, 0x55555556
    s_mul_i32 s57, s57, 57
    s_add_u32 s56, s56, s57
    s_mul_i32 s57, s101, 3
    s_add_u32 s56, s56, s57
    s_lshl_b32 s56, s56, 10
    s_add_u32 s56, s56, 3440640
    buffer_store_dwordx4 v[168:171], v1, s[8:11], s56 offen
    s_lshl_b32 s56, s54, 3
    s_add_u32 s56, s56, 3
    s_mul_hi_u32 s57, s56, 0x55555556
    s_mul_i32 s57, s57, 57
    s_add_u32 s56, s56, s57
    s_mul_i32 s57, s101, 3
    s_add_u32 s56, s56, s57
    s_lshl_b32 s56, s56, 10
    s_add_u32 s56, s56, 3440640
    buffer_store_dwordx4 v[172:175], v1, s[8:11], s56 offen
    ds_read_b64_tr_b16 v[228:229], v251 offset:64
    ds_read_b64_tr_b16 v[230:231], v251 offset:576
    ds_read_b64_tr_b16 v[232:233], v251 offset:16448
    ds_read_b64_tr_b16 v[234:235], v251 offset:16960
    ds_read_b64_tr_b16 v[236:237], v251 offset:96
    ds_read_b64_tr_b16 v[238:239], v251 offset:608
    ds_read_b64_tr_b16 v[240:241], v251 offset:16480
    ds_read_b64_tr_b16 v[242:243], v251 offset:16992
    s_waitcnt lgkmcnt(4)
    s_mov_b32 vcc_lo, 0x33333333
    s_mov_b32 vcc_hi, 0x33333333
    v_cndmask_b32_dpp v168, v232, v228, vcc quad_perm:[0,1,0,1] row_mask:0xf bank_mask:0xf
    v_cndmask_b32_dpp v169, v233, v229, vcc quad_perm:[0,1,0,1] row_mask:0xf bank_mask:0xf
    v_cndmask_b32_dpp v170, v234, v230, vcc quad_perm:[0,1,0,1] row_mask:0xf bank_mask:0xf
    v_cndmask_b32_dpp v171, v235, v231, vcc quad_perm:[0,1,0,1] row_mask:0xf bank_mask:0xf
    s_mov_b32 vcc_lo, 0xcccccccc
    s_mov_b32 vcc_hi, 0xcccccccc
    v_cndmask_b32_dpp v172, v228, v232, vcc quad_perm:[2,3,2,3] row_mask:0xf bank_mask:0xf
    v_cndmask_b32_dpp v173, v229, v233, vcc quad_perm:[2,3,2,3] row_mask:0xf bank_mask:0xf
    v_cndmask_b32_dpp v174, v230, v234, vcc quad_perm:[2,3,2,3] row_mask:0xf bank_mask:0xf
    v_cndmask_b32_dpp v175, v231, v235, vcc quad_perm:[2,3,2,3] row_mask:0xf bank_mask:0xf
    s_lshl_b32 s56, s54, 3
    s_add_u32 s56, s56, 4
    s_mul_hi_u32 s57, s56, 0x55555556
    s_mul_i32 s57, s57, 57
    s_add_u32 s56, s56, s57
    s_mul_i32 s57, s101, 3
    s_add_u32 s56, s56, s57
    s_lshl_b32 s56, s56, 10
    s_add_u32 s56, s56, 3440640
    buffer_store_dwordx4 v[168:171], v1, s[8:11], s56 offen
    s_lshl_b32 s56, s54, 3
    s_add_u32 s56, s56, 5
    s_mul_hi_u32 s57, s56, 0x55555556
    s_mul_i32 s57, s57, 57
    s_add_u32 s56, s56, s57
    s_mul_i32 s57, s101, 3
    s_add_u32 s56, s56, s57
    s_lshl_b32 s56, s56, 10
    s_add_u32 s56, s56, 3440640
    buffer_store_dwordx4 v[172:175], v1, s[8:11], s56 offen
    s_waitcnt lgkmcnt(0)
    s_mov_b32 vcc_lo, 0x33333333
    s_mov_b32 vcc_hi, 0x33333333
    v_cndmask_b32_dpp v168, v240, v236, vcc quad_perm:[0,1,0,1] row_mask:0xf bank_mask:0xf
    v_cndmask_b32_dpp v169, v241, v237, vcc quad_perm:[0,1,0,1] row_mask:0xf bank_mask:0xf
    v_cndmask_b32_dpp v170, v242, v238, vcc quad_perm:[0,1,0,1] row_mask:0xf bank_mask:0xf
    v_cndmask_b32_dpp v171, v243, v239, vcc quad_perm:[0,1,0,1] row_mask:0xf bank_mask:0xf
    s_mov_b32 vcc_lo, 0xcccccccc
    s_mov_b32 vcc_hi, 0xcccccccc
    v_cndmask_b32_dpp v172, v236, v240, vcc quad_perm:[2,3,2,3] row_mask:0xf bank_mask:0xf
    v_cndmask_b32_dpp v173, v237, v241, vcc quad_perm:[2,3,2,3] row_mask:0xf bank_mask:0xf
    v_cndmask_b32_dpp v174, v238, v242, vcc quad_perm:[2,3,2,3] row_mask:0xf bank_mask:0xf
    v_cndmask_b32_dpp v175, v239, v243, vcc quad_perm:[2,3,2,3] row_mask:0xf bank_mask:0xf
    s_lshl_b32 s56, s54, 3
    s_add_u32 s56, s56, 6
    s_mul_hi_u32 s57, s56, 0x55555556
    s_mul_i32 s57, s57, 57
    s_add_u32 s56, s56, s57
    s_mul_i32 s57, s101, 3
    s_add_u32 s56, s56, s57
    s_lshl_b32 s56, s56, 10
    s_add_u32 s56, s56, 3440640
    buffer_store_dwordx4 v[168:171], v1, s[8:11], s56 offen
    s_lshl_b32 s56, s54, 3
    s_add_u32 s56, s56, 7
    s_mul_hi_u32 s57, s56, 0x55555556
    s_mul_i32 s57, s57, 57
    s_add_u32 s56, s56, s57
    s_mul_i32 s57, s101, 3
    s_add_u32 s56, s56, s57
    s_lshl_b32 s56, s56, 10
    s_add_u32 s56, s56, 3440640
    buffer_store_dwordx4 v[172:175], v1, s[8:11], s56 offen
    s_nop 1
L_jr_j:
    v_mov_b32 v199, 0
    buffer_store_dword v199, v26, s[8:11], s37 offen
L_prep_end:
    s_endpgm
.globl interleave_layers__sliding_local_dilated__glu_gated_glu__prompt_kernel
.p2align 8
.type interleave_layers__sliding_local_dilated__glu_gated_glu__prompt_kernel,@function
interleave_layers__sliding_local_dilated__glu_gated_glu__prompt_kernel:
    s_cmp_ge_u32 s2, 256
    s_cbranch_scc1 L_main_end
    s_load_dwordx2 s[8:9], s[0:1], 72
    s_load_dwordx2 s[12:13], s[0:1], 56
    v_lshrrev_b32 v178, 6, v0
    v_and_b32 v182, 63, v0
    v_readfirstlane_b32 s18, v178
    v_lshrrev_b32 v249, 3, v182
    v_and_b32 v250, 7, v182
    v_lshlrev_b32 v250, 4, v250
    v_and_b32 v176, 15, v182
    v_lshrrev_b32 v177, 4, v182
    v_mov_b32 v181, 0x80000000
    v_lshlrev_b32 v1, 4, v182
    s_lshl_b32 s28, s18, 11
    s_and_b32 s56, s2, 7
    s_lshr_b32 s57, s2, 3
    s_lshr_b32 s16, s56, 1
    s_lshl_b32 s16, s16, 2
    s_lshr_b32 s58, s57, 3
    s_add_u32 s16, s16, s58
    s_and_b32 s17, s56, 1
    s_lshl_b32 s17, s17, 3
    s_and_b32 s58, s57, 7
    s_add_u32 s17, s17, s58
    s_lshr_b32 s19, s17, 3
    s_and_b32 s20, s17, 7
    s_mul_i32 s21, s16, 163840
    s_lshr_b32 s58, s18, 1
    s_and_b32 s59, s18, 1
    s_lshl_b32 s38, s16, 8
    s_add_u32 s38, s38, 35651584
    s_sub_u32 s39, s38, 256
    s_cmp_eq_u32 s16, 0
    s_cselect_b32 s39, s38, s39
    s_lshl_b32 s37, s17, 2
    s_add_u32 s37, s37, s38
    s_lshl_b32 s56, s17, 2
    s_add_u32 s56, s56, s18
    s_mul_i32 s22, s56, 40960
    s_mul_i32 s24, s56, 61440
    s_add_u32 s24, s24, 3440640
    s_mul_i32 s33, s56, 768
    s_mul_i32 s56, s16, 393216
    s_add_u32 s33, s33, s56
    s_mul_i32 s48, s18, 20480
    s_add_u32 s48, s48, s21
    s_mul_i32 s56, s17, 1280
    s_add_u32 s32, s48, s56
    s_lshl_b32 s36, s16, 13
    v_lshlrev_b32 v0, 3, v182
    s_mul_i32 s29, s18, 5120
    s_add_u32 s29, s29, 117760
    v_and_b32 v178, 7, v176
    v_lshrrev_b32 v179, 3, v176
    v_mul_u32_u24 v180, 20480, v179
    v_lshl_add_u32 v180, v178, 4, v180
    v_lshl_add_u32 v180, v177, 8, v180
    s_mul_i32 s62, s18, 5120
    s_add_u32 s62, s62, s21
    s_sub_u32 s62, s62, 40832
    s_cmp_eq_u32 s16, 0
    s_cselect_b32 s62, 0x80000000, s62
    v_add_u32 v5, s62, v180
    s_mov_b32 s10, 39321600
    s_mov_b32 s11, 0x20000
    s_waitcnt lgkmcnt(0)
    s_mov_b32 s52, s9
    s_and_b32 s9, s9, 0xffff
    s_add_u32 m0, s28, 3072
    s_add_u32 s49, s48, 36175872
    buffer_load_dwordx4 v1, s[8:11], s49 offen offset:0 sc1 lds
    s_add_u32 m0, s28, 3072
    s_nop 0
    buffer_load_dwordx4 v1, s[8:11], s49 offen offset:1024 sc1 lds
    s_add_u32 m0, s28, 9216
    s_nop 0
    buffer_load_dwordx4 v1, s[8:11], s49 offen offset:2048 sc1 lds
    s_add_u32 m0, s28, 9216
    s_nop 0
    buffer_load_dwordx4 v1, s[8:11], s49 offen offset:3072 sc1 lds
    s_add_u32 m0, s28, 19456
    s_add_u32 s49, s48, 36179968
    buffer_load_dwordx4 v1, s[8:11], s49 offen offset:0 sc1 lds
    s_add_u32 m0, s28, 19456
    s_nop 0
    buffer_load_dwordx4 v1, s[8:11], s49 offen offset:1024 sc1 lds
    s_add_u32 m0, s28, 25600
    s_nop 0
    buffer_load_dwordx4 v1, s[8:11], s49 offen offset:2048 sc1 lds
    s_add_u32 m0, s28, 25600
    s_nop 0
    buffer_load_dwordx4 v1, s[8:11], s49 offen offset:3072 sc1 lds
    s_add_u32 m0, s29, 0
    s_mov_b32 s49, 36175872
    buffer_load_dwordx4 v5, s[8:11], s49 offen offset:0 sc1 lds
    s_add_u32 m0, s29, 0
    s_nop 0
    buffer_load_dwordx4 v5, s[8:11], s49 offen offset:1024 sc1 lds
    s_add_u32 m0, s29, 0
    s_nop 0
    buffer_load_dwordx4 v5, s[8:11], s49 offen offset:2048 sc1 lds
    s_and_b32 s13, s13, 0xffff
    s_mov_b32 s14, 2621440
    s_mov_b32 s15, 0x20000
    v_lshl_add_u32 v180, v179, 3, v176
    v_lshlrev_b32 v180, 3, v180
    s_sub_u32 s62, s36, 3776
    s_cmp_eq_u32 s16, 0
    s_cselect_b32 s62, 0x80000000, s62
    v_add_u32 v22, s62, v180
    s_lshl_b32 s60, s16, 3
    s_lshl_b32 s61, s19, 1
    s_add_u32 s61, s61, s60
    s_lshl_b32 s62, s61, 4
    s_mul_i32 s34, s62, 1280
    s_mul_i32 s35, s61, 20480
    s_lshl_b32 s56, s59, 4
    s_add_u32 s56, s56, s58
    s_mul_i32 s56, s56, 1280
    s_mul_i32 s57, s20, 160
    s_add_u32 s56, s56, s57
    v_mul_u32_u24 v178, 160, v250
    v_lshl_add_u32 v178, v249, 4, v178
    v_add_u32 v15, s56, v178
    s_mov_b32 s46, 0xffff
    s_mov_b32 s47, 0
    v_cndmask_b32 v19, v181, v15, s[46:47]
    s_lshl_b32 s57, s20, 2
    s_add_u32 s57, s57, s18
    s_mul_i32 s23, s57, 25600
    s_add_u32 s23, s23, 2621440
    s_mul_i32 s25, s57, 61440
    s_add_u32 s25, s25, 7372800
    s_mul_i32 s62, s18, 5120
    s_add_u32 s30, s35, s62
    s_mul_i32 s31, s61, 49152
    s_mul_i32 s62, s18, 12288
    s_add_u32 s31, s31, s62
    s_mul_i32 s55, s18, 11520
    s_add_u32 s55, s55, 117760
    s_mov_b32 s40, 0xffffffff
    s_mov_b32 s41, 0xffff
    s_mov_b32 s42, 0xffffffff
    s_mov_b32 s43, 0x0
    s_mov_b32 s44, 0xffff0000
    s_mov_b32 s45, 0xffff
    s_mov_b32 s64, 0x3acccccd
    s_mov_b32 s65, 0x3727c5ac
    s_mov_b32 s66, 0xbfb8aa3b
    s_mov_b32 s67, 0x3ea52b5c
    v_add_u32 v2, 0x10000, v1
    v_lshlrev_b32 v25, 2, v176
    s_lshl_b32 s60, s18, 6
    s_add_u32 s60, s60, 138240
    v_lshlrev_b32 v178, 3, v177
    v_add_u32 v178, s60, v178
    v_mul_u32_u24 v180, 272, v176
    v_add_u32 v9, v178, v180
    v_lshl_add_u32 v179, v179, 5, v176
    v_mul_u32_u24 v179, 272, v179
    v_add_u32 v10, v178, v179
    s_lshl_b32 s61, s58, 4
    s_mul_i32 s62, s59, 10880
    s_add_u32 s62, s62, 138240
    v_min_u32 v178, 2, v177
    v_lshlrev_b32 v178, 4, v178
    v_add_u32 v178, s62, v178
    v_add_u32 v179, s61, v176
    v_mul_u32_u24 v180, 272, v179
    v_add_u32 v11, v178, v180
    v_cmp_gt_u32 vcc, 8, v179
    v_subrev_u32 v13, 2176, v11
    v_add_u32 v180, 10880, v13
    v_cndmask_b32 v13, v13, v180, vcc
    v_lshrrev_b32 v179, 2, v182
    v_add_u32 v179, s61, v179
    v_and_b32 v178, 3, v176
    v_lshlrev_b32 v178, 3, v178
    v_add_u32 v178, s62, v178
    v_mul_u32_u24 v180, 272, v179
    v_add_u32 v14, v178, v180
    v_cmp_gt_u32 vcc, 8, v179
    v_subrev_u32 v16, 2176, v14
    v_add_u32 v180, 10880, v16
    v_cndmask_b32 v16, v16, v180, vcc
    v_mul_u32_u24 v178, 576, v177
    v_lshl_add_u32 v178, v176, 4, v178
    v_add_u32 v17, s55, v178
    s_lshl_b32 s60, s18, 7
    s_add_u32 s60, s60, 117760
    v_mul_u32_u24 v178, 1152, v249
    v_add3_u32 v18, v178, v250, s60
    s_mul_i32 s60, s58, 20480
    s_lshl_b32 s61, s59, 7
    s_add_u32 s60, s60, s61
    s_mul_i32 s61, s20, 2560
    s_add_u32 s60, s60, s61
    v_lshlrev_b32 v178, 8, v249
    v_add3_u32 v8, v178, v250, s60
    v_cndmask_b32 v12, v181, v8, s[46:47]
    s_lshl_b32 s60, s20, 9
    s_lshl_b32 s61, s19, 8
    s_add_u32 s60, s60, s61
    s_lshl_b32 s61, s18, 6
    s_add_u32 s60, s60, s61
    v_add_u32 v178, s60, v0
    v_cmp_gt_u32 vcc, 8, v182
    s_nop 1
    v_cndmask_b32 v20, v181, v178, vcc
    v_add_u32 v94, s28, v1
    v_add_u32 v95, 0x10000, v94
    v_add_u32 v21, 0x20000, v94
    v_cndmask_b32 v23, v181, v1, s[46:47]
    v_mul_u32_u24 v178, 49152, v177
    v_lshl_add_u32 v24, v176, 4, v178
    v_or_b32 v178, s18, v182
    v_cmp_eq_u32 vcc, 0, v178
    s_nop 1
    v_cndmask_b32_e64 v26, v181, 0, vcc
    v_mov_b32 v28, 0x3f803f80
    v_mov_b32 v29, 0x3f803f80
    v_mov_b32 v30, 0x3f803f80
    v_mov_b32 v31, 0x3f803f80
    v_mov_b32 v180, 0xf149f2ca
    s_or_b32 s60, s16, s58
    s_cmp_eq_u32 s60, 0
    s_cselect_b32 s60, 0xf149f2ca, 0
    v_lshl_add_u32 v178, v177, 2, 0
    v_cmp_lt_u32 vcc, v176, v178
    s_nop 1
    v_cndmask_b32_e64 v32, v180, 0, vcc
    v_cmp_gt_u32 vcc, 8, v178
    s_nop 1
    v_cndmask_b32 v32, v180, v32, vcc
    v_min_f32 v40, s60, v32
    v_sub_u32 v179, v176, v178
    v_cmp_gt_u32 vcc, 8, v179
    s_nop 1
    v_cndmask_b32_e64 v36, v180, 0, vcc
    v_lshl_add_u32 v178, v177, 2, 1
    v_cmp_lt_u32 vcc, v176, v178
    s_nop 1
    v_cndmask_b32_e64 v33, v180, 0, vcc
    v_cmp_gt_u32 vcc, 8, v178
    s_nop 1
    v_cndmask_b32 v33, v180, v33, vcc
    v_min_f32 v41, s60, v33
    v_sub_u32 v179, v176, v178
    v_cmp_gt_u32 vcc, 8, v179
    s_nop 1
    v_cndmask_b32_e64 v37, v180, 0, vcc
    v_lshl_add_u32 v178, v177, 2, 2
    s_add_u32 m0, s29, 0
    s_nop 0
    buffer_load_dwordx4 v5, s[8:11], s49 offen offset:3072 sc1 lds
    v_cmp_lt_u32 vcc, v176, v178
    s_add_u32 m0, s29, 4096
    s_mov_b32 s49, 36179968
    buffer_load_dwordx4 v5, s[8:11], s49 offen offset:0 sc1 lds
    v_cndmask_b32_e64 v34, v180, 0, vcc
    s_add_u32 s26, s22, 0
    buffer_load_dwordx4 a[0:3], v1, s[8:11], s26 offen offset:0 sc1
    v_cmp_gt_u32 vcc, 8, v178
    buffer_load_dwordx4 a[4:7], v1, s[8:11], s26 offen offset:1024 sc1
    s_nop 0
    v_cndmask_b32 v34, v180, v34, vcc
    buffer_load_dwordx4 a[8:11], v1, s[8:11], s26 offen offset:2048 sc1
    v_min_f32 v42, s60, v34
    v_sub_u32 v179, v176, v178
    v_cmp_gt_u32 vcc, 8, v179
    s_nop 1
    v_cndmask_b32_e64 v38, v180, 0, vcc
    buffer_load_dwordx4 a[12:15], v1, s[8:11], s26 offen offset:3072 sc1
    v_lshl_add_u32 v178, v177, 2, 3
    v_cmp_lt_u32 vcc, v176, v178
    s_nop 1
    v_cndmask_b32_e64 v35, v180, 0, vcc
    v_cmp_gt_u32 vcc, 8, v178
    s_nop 1
    v_cndmask_b32 v35, v180, v35, vcc
    s_add_u32 s26, s22, 4096
    buffer_load_dwordx4 a[16:19], v1, s[8:11], s26 offen offset:0 sc1
    v_min_f32 v43, s60, v35
    v_sub_u32 v179, v176, v178
    v_cmp_gt_u32 vcc, 8, v179
    s_nop 1
    v_cndmask_b32_e64 v39, v180, 0, vcc
    buffer_load_dwordx4 a[20:23], v1, s[8:11], s26 offen offset:1024 sc1
    buffer_load_dwordx4 a[24:27], v1, s[8:11], s26 offen offset:2048 sc1
    buffer_load_dwordx4 a[28:31], v1, s[8:11], s26 offen offset:3072 sc1
    s_add_u32 s26, s22, 8192
    buffer_load_dwordx4 a[32:35], v1, s[8:11], s26 offen offset:0 sc1
    buffer_load_dwordx4 a[36:39], v1, s[8:11], s26 offen offset:1024 sc1
    buffer_load_dwordx4 a[40:43], v1, s[8:11], s26 offen offset:2048 sc1
    buffer_load_dwordx4 a[44:47], v1, s[8:11], s26 offen offset:3072 sc1
    s_add_u32 s26, s22, 12288
    buffer_load_dwordx4 a[48:51], v1, s[8:11], s26 offen offset:0 sc1
    buffer_load_dwordx4 a[52:55], v1, s[8:11], s26 offen offset:1024 sc1
    s_waitcnt vmcnt(14)
    v_add_u32 v222, 117760, v1
    s_barrier
    ds_read_b128 v[96:99], v1 offset:3072
    s_add_u32 m0, s28, 35840
    s_add_u32 s49, s48, 36184064
    buffer_load_dwordx4 v1, s[8:11], s49 offen offset:0 sc1 lds
    ds_read_b128 v[100:103], v1 offset:5120
    ds_read_b128 v[104:107], v1 offset:7168
    ds_read_b128 v[108:111], v1 offset:9216
    ds_read_b128 v[240:243], v222 offset:0
    s_waitcnt vmcnt(13)
    s_waitcnt lgkmcnt(3)
    v_mfma_f32_16x16x32_bf16 v[128:131], a[0:3], v[96:99], 0
    ds_read_b128 v[112:115], v1 offset:4096
    v_mfma_f32_16x16x32_bf16 v[136:139], a[0:3], v[100:103], 0
    ds_read_b128 v[116:119], v1 offset:6144
    v_mfma_f32_16x16x32_bf16 v[132:135], a[4:7], v[96:99], 0
    ds_read_b128 v[120:123], v1 offset:8192
    s_add_u32 m0, s28, 35840
    v_mfma_f32_16x16x32_bf16 v[140:143], a[4:7], v[100:103], 0
    ds_read_b128 v[124:127], v1 offset:10240
    s_waitcnt lgkmcnt(5)
    v_mfma_f32_16x16x32_bf16 v[148:151], a[4:7], v[104:107], 0
    buffer_load_dwordx4 v1, s[8:11], s49 offen offset:1024 sc1 lds
    v_mfma_f32_16x16x32_bf16 v[156:159], a[4:7], v[108:111], 0
    v_mfma_f32_16x16x32_bf16 v[144:147], a[0:3], v[104:107], 0
    v_mfma_f32_16x16x32_bf16 v[152:155], a[0:3], v[108:111], 0
    s_add_u32 m0, s28, 41984
    s_waitcnt lgkmcnt(4)
    v_mfma_f32_16x16x32_bf16 v[160:163], a[0:3], v[240:243], 0
    ds_read_b128 v[244:247], v222 offset:1024
    v_mfma_f32_16x16x32_bf16 v[164:167], a[4:7], v[240:243], 0
    buffer_load_dwordx4 v1, s[8:11], s49 offen offset:2048 sc1 lds
    v_mfma_f32_16x16x32_bf16 v[44:47], a[0:3], v[28:31], 0
    v_mfma_f32_16x16x32_bf16 v[48:51], a[4:7], v[28:31], 0
    s_add_u32 m0, s28, 41984
    s_waitcnt vmcnt(13)
    s_waitcnt lgkmcnt(3)
    v_mfma_f32_16x16x32_bf16 v[128:131], a[8:11], v[112:115], v[128:131]
    ds_read_b128 v[96:99], v1 offset:11264
    v_mfma_f32_16x16x32_bf16 v[136:139], a[8:11], v[116:119], v[136:139]
    ds_read_b128 v[100:103], v1 offset:13312
    v_mfma_f32_16x16x32_bf16 v[132:135], a[12:15], v[112:115], v[132:135]
    ds_read_b128 v[104:107], v1 offset:15360
    v_mfma_f32_16x16x32_bf16 v[140:143], a[12:15], v[116:119], v[140:143]
    ds_read_b128 v[108:111], v1 offset:17408
    s_waitcnt lgkmcnt(5)
    v_mfma_f32_16x16x32_bf16 v[148:151], a[12:15], v[120:123], v[148:151]
    buffer_load_dwordx4 v1, s[8:11], s49 offen offset:3072 sc1 lds
    v_mfma_f32_16x16x32_bf16 v[156:159], a[12:15], v[124:127], v[156:159]
    s_add_u32 m0, s28, 52224
    s_add_u32 s49, s48, 36188160
    v_mfma_f32_16x16x32_bf16 v[144:147], a[8:11], v[120:123], v[144:147]
    buffer_load_dwordx4 v1, s[8:11], s49 offen offset:0 sc1 lds
    v_mfma_f32_16x16x32_bf16 v[152:155], a[8:11], v[124:127], v[152:155]
    s_waitcnt lgkmcnt(4)
    v_mfma_f32_16x16x32_bf16 v[160:163], a[8:11], v[244:247], v[160:163]
    ds_read_b128 v[240:243], v222 offset:2048
    v_mfma_f32_16x16x32_bf16 v[164:167], a[12:15], v[244:247], v[164:167]
    s_add_u32 m0, s28, 52224
    v_mfma_f32_16x16x32_bf16 v[44:47], a[8:11], v[28:31], v[44:47]
    buffer_load_dwordx4 v1, s[8:11], s49 offen offset:1024 sc1 lds
    v_mfma_f32_16x16x32_bf16 v[48:51], a[12:15], v[28:31], v[48:51]
    s_waitcnt vmcnt(14)
    s_waitcnt lgkmcnt(3)
    v_mfma_f32_16x16x32_bf16 v[128:131], a[16:19], v[96:99], v[128:131]
    ds_read_b128 v[112:115], v1 offset:12288
    v_mfma_f32_16x16x32_bf16 v[136:139], a[16:19], v[100:103], v[136:139]
    ds_read_b128 v[116:119], v1 offset:14336
    v_mfma_f32_16x16x32_bf16 v[132:135], a[20:23], v[96:99], v[132:135]
    ds_read_b128 v[120:123], v1 offset:16384
    v_mfma_f32_16x16x32_bf16 v[140:143], a[20:23], v[100:103], v[140:143]
    ds_read_b128 v[124:127], v1 offset:18432
    s_waitcnt lgkmcnt(5)
    v_mfma_f32_16x16x32_bf16 v[148:151], a[20:23], v[104:107], v[148:151]
    buffer_load_dwordx4 a[56:59], v1, s[8:11], s26 offen offset:2048 sc1
    v_mfma_f32_16x16x32_bf16 v[156:159], a[20:23], v[108:111], v[156:159]
    buffer_load_dwordx4 a[60:63], v1, s[8:11], s26 offen offset:3072 sc1
    v_mfma_f32_16x16x32_bf16 v[144:147], a[16:19], v[104:107], v[144:147]
    v_mfma_f32_16x16x32_bf16 v[152:155], a[16:19], v[108:111], v[152:155]
    s_waitcnt lgkmcnt(4)
    v_mfma_f32_16x16x32_bf16 v[160:163], a[16:19], v[240:243], v[160:163]
    ds_read_b128 v[244:247], v222 offset:3072
    v_mfma_f32_16x16x32_bf16 v[164:167], a[20:23], v[240:243], v[164:167]
    s_add_u32 s26, s22, 16384
    v_mfma_f32_16x16x32_bf16 v[44:47], a[16:19], v[28:31], v[44:47]
    buffer_load_dwordx4 a[64:67], v1, s[8:11], s26 offen offset:0 sc1
    v_mfma_f32_16x16x32_bf16 v[48:51], a[20:23], v[28:31], v[48:51]
    s_waitcnt vmcnt(15)
    s_waitcnt lgkmcnt(3)
    v_mfma_f32_16x16x32_bf16 v[128:131], a[24:27], v[112:115], v[128:131]
    ds_read_b128 v[96:99], v1 offset:19456
    v_mfma_f32_16x16x32_bf16 v[136:139], a[24:27], v[116:119], v[136:139]
    ds_read_b128 v[100:103], v1 offset:21504
    v_mfma_f32_16x16x32_bf16 v[132:135], a[28:31], v[112:115], v[132:135]
    ds_read_b128 v[104:107], v1 offset:23552
    v_mfma_f32_16x16x32_bf16 v[140:143], a[28:31], v[116:119], v[140:143]
    ds_read_b128 v[108:111], v1 offset:25600
    s_waitcnt lgkmcnt(5)
    v_mfma_f32_16x16x32_bf16 v[148:151], a[28:31], v[120:123], v[148:151]
    buffer_load_dwordx4 a[68:71], v1, s[8:11], s26 offen offset:1024 sc1
    v_mfma_f32_16x16x32_bf16 v[156:159], a[28:31], v[124:127], v[156:159]
    v_mfma_f32_16x16x32_bf16 v[144:147], a[24:27], v[120:123], v[144:147]
    v_mfma_f32_16x16x32_bf16 v[152:155], a[24:27], v[124:127], v[152:155]
    s_waitcnt lgkmcnt(4)
    v_mfma_f32_16x16x32_bf16 v[160:163], a[24:27], v[244:247], v[160:163]
    ds_read_b128 v[240:243], v222 offset:4096
    v_mfma_f32_16x16x32_bf16 v[164:167], a[28:31], v[244:247], v[164:167]
    s_add_u32 s53, s36, 35127296
    v_mfma_f32_16x16x32_bf16 v[44:47], a[24:27], v[28:31], v[44:47]
    buffer_load_dwordx2 v[200:201], v0, s[8:11], s53 offen offset:0 sc1
    v_mfma_f32_16x16x32_bf16 v[48:51], a[28:31], v[28:31], v[48:51]
    s_waitcnt vmcnt(15)
    s_waitcnt lgkmcnt(3)
    v_mfma_f32_16x16x32_bf16 v[128:131], a[32:35], v[96:99], v[128:131]
    ds_read_b128 v[112:115], v1 offset:20480
    v_mfma_f32_16x16x32_bf16 v[136:139], a[32:35], v[100:103], v[136:139]
    ds_read_b128 v[116:119], v1 offset:22528
    v_mfma_f32_16x16x32_bf16 v[132:135], a[36:39], v[96:99], v[132:135]
    ds_read_b128 v[120:123], v1 offset:24576
    v_mfma_f32_16x16x32_bf16 v[140:143], a[36:39], v[100:103], v[140:143]
    ds_read_b128 v[124:127], v1 offset:26624
    s_waitcnt lgkmcnt(5)
    v_mfma_f32_16x16x32_bf16 v[148:151], a[36:39], v[104:107], v[148:151]
    buffer_load_dwordx2 v[202:203], v0, s[8:11], s53 offen offset:512 sc1
    v_mfma_f32_16x16x32_bf16 v[156:159], a[36:39], v[108:111], v[156:159]
    buffer_load_dwordx2 v[204:205], v0, s[8:11], s53 offen offset:1024 sc1
    v_mfma_f32_16x16x32_bf16 v[144:147], a[32:35], v[104:107], v[144:147]
    buffer_load_dwordx2 v[206:207], v0, s[8:11], s53 offen offset:1536 sc1
    v_mfma_f32_16x16x32_bf16 v[152:155], a[32:35], v[108:111], v[152:155]
    s_waitcnt lgkmcnt(4)
    v_mfma_f32_16x16x32_bf16 v[160:163], a[32:35], v[240:243], v[160:163]
    ds_read_b128 v[244:247], v222 offset:5120
    v_mfma_f32_16x16x32_bf16 v[164:167], a[36:39], v[240:243], v[164:167]
    buffer_load_dwordx2 v[208:209], v0, s[8:11], s53 offen offset:2048 sc1
    v_mfma_f32_16x16x32_bf16 v[44:47], a[32:35], v[28:31], v[44:47]
    buffer_load_dwordx2 v[210:211], v0, s[8:11], s53 offen offset:2560 sc1
    v_mfma_f32_16x16x32_bf16 v[48:51], a[36:39], v[28:31], v[48:51]
    s_waitcnt vmcnt(18)
    s_waitcnt lgkmcnt(3)
    v_mfma_f32_16x16x32_bf16 v[128:131], a[40:43], v[112:115], v[128:131]
    ds_read_b128 v[96:99], v1 offset:27648
    v_mfma_f32_16x16x32_bf16 v[136:139], a[40:43], v[116:119], v[136:139]
    ds_read_b128 v[100:103], v1 offset:29696
    v_mfma_f32_16x16x32_bf16 v[132:135], a[44:47], v[112:115], v[132:135]
    ds_read_b128 v[104:107], v1 offset:31744
    v_mfma_f32_16x16x32_bf16 v[140:143], a[44:47], v[116:119], v[140:143]
    ds_read_b128 v[108:111], v1 offset:33792
    s_waitcnt lgkmcnt(5)
    v_mfma_f32_16x16x32_bf16 v[148:151], a[44:47], v[120:123], v[148:151]
    buffer_load_dwordx2 v[212:213], v0, s[8:11], s53 offen offset:3072 sc1
    v_mfma_f32_16x16x32_bf16 v[156:159], a[44:47], v[124:127], v[156:159]
    buffer_load_dwordx2 v[214:215], v0, s[8:11], s53 offen offset:3584 sc1
    v_mfma_f32_16x16x32_bf16 v[144:147], a[40:43], v[120:123], v[144:147]
    buffer_load_dwordx4 a[72:75], v1, s[8:11], s26 offen offset:2048 sc1
    v_mfma_f32_16x16x32_bf16 v[152:155], a[40:43], v[124:127], v[152:155]
    s_waitcnt lgkmcnt(4)
    v_mfma_f32_16x16x32_bf16 v[160:163], a[40:43], v[244:247], v[160:163]
    ds_read_b128 v[240:243], v222 offset:6144
    v_mfma_f32_16x16x32_bf16 v[164:167], a[44:47], v[244:247], v[164:167]
    buffer_load_dwordx4 a[76:79], v1, s[8:11], s26 offen offset:3072 sc1
    v_mfma_f32_16x16x32_bf16 v[44:47], a[40:43], v[28:31], v[44:47]
    s_add_u32 s26, s22, 20480
    v_mfma_f32_16x16x32_bf16 v[48:51], a[44:47], v[28:31], v[48:51]
    s_waitcnt vmcnt(20)
    s_waitcnt lgkmcnt(3)
    v_mfma_f32_16x16x32_bf16 v[128:131], a[48:51], v[96:99], v[128:131]
    ds_read_b128 v[112:115], v1 offset:28672
    v_mfma_f32_16x16x32_bf16 v[136:139], a[48:51], v[100:103], v[136:139]
    ds_read_b128 v[116:119], v1 offset:30720
    v_mfma_f32_16x16x32_bf16 v[132:135], a[52:55], v[96:99], v[132:135]
    ds_read_b128 v[120:123], v1 offset:32768
    v_mfma_f32_16x16x32_bf16 v[140:143], a[52:55], v[100:103], v[140:143]
    ds_read_b128 v[124:127], v1 offset:34816
    s_waitcnt lgkmcnt(5)
    v_mfma_f32_16x16x32_bf16 v[148:151], a[52:55], v[104:107], v[148:151]
    buffer_load_dwordx4 a[80:83], v1, s[8:11], s26 offen offset:0 sc1
    v_mfma_f32_16x16x32_bf16 v[156:159], a[52:55], v[108:111], v[156:159]
    buffer_load_dwordx4 a[84:87], v1, s[8:11], s26 offen offset:1024 sc1
    v_mfma_f32_16x16x32_bf16 v[144:147], a[48:51], v[104:107], v[144:147]
    buffer_load_dwordx4 a[88:91], v1, s[8:11], s26 offen offset:2048 sc1
    v_mfma_f32_16x16x32_bf16 v[152:155], a[48:51], v[108:111], v[152:155]
    s_waitcnt lgkmcnt(4)
    v_mfma_f32_16x16x32_bf16 v[160:163], a[48:51], v[240:243], v[160:163]
    ds_read_b128 v[244:247], v222 offset:7168
    v_mfma_f32_16x16x32_bf16 v[164:167], a[52:55], v[240:243], v[164:167]
    v_mfma_f32_16x16x32_bf16 v[44:47], a[48:51], v[28:31], v[44:47]
    v_mfma_f32_16x16x32_bf16 v[48:51], a[52:55], v[28:31], v[48:51]
    s_waitcnt vmcnt(17)
    s_waitcnt lgkmcnt(0)
    s_barrier
    s_waitcnt vmcnt(15)
    v_mfma_f32_16x16x32_bf16 v[128:131], a[56:59], v[112:115], v[128:131]
    ds_read_b128 v[96:99], v1 offset:35840
    v_mfma_f32_16x16x32_bf16 v[136:139], a[56:59], v[116:119], v[136:139]
    ds_read_b128 v[100:103], v1 offset:37888
    v_mfma_f32_16x16x32_bf16 v[132:135], a[60:63], v[112:115], v[132:135]
    ds_read_b128 v[104:107], v1 offset:39936
    v_mfma_f32_16x16x32_bf16 v[140:143], a[60:63], v[116:119], v[140:143]
    ds_read_b128 v[108:111], v1 offset:41984
    v_mfma_f32_16x16x32_bf16 v[148:151], a[60:63], v[120:123], v[148:151]
    buffer_load_dwordx4 a[92:95], v1, s[8:11], s26 offen offset:3072 sc1
    v_mfma_f32_16x16x32_bf16 v[156:159], a[60:63], v[124:127], v[156:159]
    v_mfma_f32_16x16x32_bf16 v[144:147], a[56:59], v[120:123], v[144:147]
    v_mfma_f32_16x16x32_bf16 v[152:155], a[56:59], v[124:127], v[152:155]
    v_mfma_f32_16x16x32_bf16 v[160:163], a[56:59], v[244:247], v[160:163]
    ds_read_b128 v[240:243], v222 offset:8192
    v_mfma_f32_16x16x32_bf16 v[164:167], a[60:63], v[244:247], v[164:167]
    s_add_u32 s26, s22, 24576
    v_mfma_f32_16x16x32_bf16 v[44:47], a[56:59], v[28:31], v[44:47]
    buffer_load_dwordx4 a[96:99], v1, s[8:11], s26 offen offset:0 sc1
    v_mfma_f32_16x16x32_bf16 v[48:51], a[60:63], v[28:31], v[48:51]
    buffer_load_dwordx4 a[100:103], v1, s[8:11], s26 offen offset:1024 sc1
    s_add_u32 m0, s28, 58368
    s_nop 0
    buffer_load_dwordx4 v1, s[8:11], s49 offen offset:2048 sc1 lds
    s_add_u32 m0, s28, 58368
    s_nop 0
    buffer_load_dwordx4 v1, s[8:11], s49 offen offset:3072 sc1 lds
    s_add_u32 m0, s28, 68608
    s_add_u32 s49, s48, 36192256
    buffer_load_dwordx4 v1, s[8:11], s49 offen offset:0 sc1 lds
    s_add_u32 m0, s28, 68608
    s_nop 0
    buffer_load_dwordx4 v1, s[8:11], s49 offen offset:1024 sc1 lds
    s_waitcnt vmcnt(12)
    s_waitcnt lgkmcnt(3)
    v_mfma_f32_16x16x32_bf16 v[128:131], a[64:67], v[96:99], v[128:131]
    ds_read_b128 v[112:115], v1 offset:36864
    v_add_f32 v200, v200, v208
    v_mfma_f32_16x16x32_bf16 v[136:139], a[64:67], v[100:103], v[136:139]
    ds_read_b128 v[116:119], v1 offset:38912
    v_add_f32 v201, v201, v209
    v_mfma_f32_16x16x32_bf16 v[132:135], a[68:71], v[96:99], v[132:135]
    ds_read_b128 v[120:123], v1 offset:40960
    s_add_u32 m0, s28, 74752
    v_mfma_f32_16x16x32_bf16 v[140:143], a[68:71], v[100:103], v[140:143]
    ds_read_b128 v[124:127], v1 offset:43008
    s_waitcnt lgkmcnt(5)
    v_mfma_f32_16x16x32_bf16 v[148:151], a[68:71], v[104:107], v[148:151]
    buffer_load_dwordx4 v1, s[8:11], s49 offen offset:2048 sc1 lds
    v_mfma_f32_16x16x32_bf16 v[156:159], a[68:71], v[108:111], v[156:159]
    v_add_f32 v202, v202, v210
    v_add_f32 v203, v203, v211
    v_mfma_f32_16x16x32_bf16 v[144:147], a[64:67], v[104:107], v[144:147]
    s_add_u32 m0, s28, 74752
    v_add_f32 v204, v204, v212
    v_mfma_f32_16x16x32_bf16 v[152:155], a[64:67], v[108:111], v[152:155]
    v_add_f32 v205, v205, v213
    s_waitcnt lgkmcnt(4)
    v_mfma_f32_16x16x32_bf16 v[160:163], a[64:67], v[240:243], v[160:163]
    ds_read_b128 v[244:247], v222 offset:9216
    v_mfma_f32_16x16x32_bf16 v[164:167], a[68:71], v[240:243], v[164:167]
    buffer_load_dwordx4 v1, s[8:11], s49 offen offset:3072 sc1 lds
    v_mfma_f32_16x16x32_bf16 v[44:47], a[64:67], v[28:31], v[44:47]
    v_add_f32 v206, v206, v214
    v_add_f32 v207, v207, v215
    v_mfma_f32_16x16x32_bf16 v[48:51], a[68:71], v[28:31], v[48:51]
    v_add_f32 v200, v200, v204
    s_waitcnt vmcnt(12)
    s_waitcnt lgkmcnt(3)
    v_mfma_f32_16x16x32_bf16 v[128:131], a[72:75], v[112:115], v[128:131]
    ds_read_b128 v[96:99], v1 offset:44032
    v_add_f32 v201, v201, v205
    v_mfma_f32_16x16x32_bf16 v[136:139], a[72:75], v[116:119], v[136:139]
    ds_read_b128 v[100:103], v1 offset:46080
    v_add_f32 v202, v202, v206
    v_mfma_f32_16x16x32_bf16 v[132:135], a[76:79], v[112:115], v[132:135]
    ds_read_b128 v[104:107], v1 offset:48128
    v_add_f32 v203, v203, v207
    v_mfma_f32_16x16x32_bf16 v[140:143], a[76:79], v[116:119], v[140:143]
    ds_read_b128 v[108:111], v1 offset:50176
    s_waitcnt lgkmcnt(5)
    v_mfma_f32_16x16x32_bf16 v[148:151], a[76:79], v[120:123], v[148:151]
    buffer_load_dwordx4 a[104:107], v1, s[8:11], s26 offen offset:2048 sc1
    v_mfma_f32_16x16x32_bf16 v[156:159], a[76:79], v[124:127], v[156:159]
    buffer_load_dwordx4 a[108:111], v1, s[8:11], s26 offen offset:3072 sc1
    v_mfma_f32_16x16x32_bf16 v[144:147], a[72:75], v[120:123], v[144:147]
    v_add_f32 v200, v200, v202
    v_add_f32 v201, v201, v203
    v_mfma_f32_16x16x32_bf16 v[152:155], a[72:75], v[124:127], v[152:155]
    v_mul_f32 v80, s64, v200
    s_waitcnt lgkmcnt(4)
    v_mfma_f32_16x16x32_bf16 v[160:163], a[72:75], v[244:247], v[160:163]
    ds_read_b128 v[240:243], v222 offset:10240
    v_mfma_f32_16x16x32_bf16 v[164:167], a[76:79], v[244:247], v[164:167]
    s_add_u32 s26, s22, 28672
    v_mul_f32 v201, s64, v201
    v_mfma_f32_16x16x32_bf16 v[44:47], a[72:75], v[28:31], v[44:47]
    buffer_load_dwordx4 a[112:115], v1, s[8:11], s26 offen offset:0 sc1
    v_mfma_f32_16x16x32_bf16 v[48:51], a[76:79], v[28:31], v[48:51]
    v_fma_f32 v201, -v80, v80, v201
    s_waitcnt vmcnt(13)
    s_waitcnt lgkmcnt(3)
    v_mfma_f32_16x16x32_bf16 v[128:131], a[80:83], v[96:99], v[128:131]
    ds_read_b128 v[112:115], v1 offset:45056
    v_max_f32 v201, 0, v201
    v_mfma_f32_16x16x32_bf16 v[136:139], a[80:83], v[100:103], v[136:139]
    ds_read_b128 v[116:119], v1 offset:47104
    v_add_f32 v201, s65, v201
    v_mfma_f32_16x16x32_bf16 v[132:135], a[84:87], v[96:99], v[132:135]
    ds_read_b128 v[120:123], v1 offset:49152
    v_mfma_f32_16x16x32_bf16 v[140:143], a[84:87], v[100:103], v[140:143]
    ds_read_b128 v[124:127], v1 offset:51200
    s_waitcnt lgkmcnt(5)
    v_mfma_f32_16x16x32_bf16 v[148:151], a[84:87], v[104:107], v[148:151]
    buffer_load_dwordx4 a[116:119], v1, s[8:11], s26 offen offset:1024 sc1
    v_mfma_f32_16x16x32_bf16 v[156:159], a[84:87], v[108:111], v[156:159]
    v_rsq_f32 v84, v201
    v_mfma_f32_16x16x32_bf16 v[144:147], a[80:83], v[104:107], v[144:147]
    v_mov_b32 v82, v80
    v_mov_b32 v86, v84
    v_mfma_f32_16x16x32_bf16 v[152:155], a[80:83], v[108:111], v[152:155]
    s_waitcnt lgkmcnt(4)
    v_mfma_f32_16x16x32_bf16 v[160:163], a[80:83], v[240:243], v[160:163]
    ds_read_b128 v[244:247], v222 offset:11264
    v_mfma_f32_16x16x32_bf16 v[164:167], a[84:87], v[240:243], v[164:167]
    buffer_load_dwordx4 a[120:123], v1, s[8:11], s26 offen offset:2048 sc1
    v_mfma_f32_16x16x32_bf16 v[44:47], a[80:83], v[28:31], v[44:47]
    v_permlane32_swap_b32 v80, v82
    v_mfma_f32_16x16x32_bf16 v[48:51], a[84:87], v[28:31], v[48:51]
    s_waitcnt vmcnt(13)
    s_waitcnt lgkmcnt(3)
    v_mfma_f32_16x16x32_bf16 v[128:131], a[88:91], v[112:115], v[128:131]
    ds_read_b128 v[96:99], v1 offset:52224
    v_mfma_f32_16x16x32_bf16 v[136:139], a[88:91], v[116:119], v[136:139]
    ds_read_b128 v[100:103], v1 offset:54272
    v_mfma_f32_16x16x32_bf16 v[132:135], a[92:95], v[112:115], v[132:135]
    ds_read_b128 v[104:107], v1 offset:56320
    v_mfma_f32_16x16x32_bf16 v[140:143], a[92:95], v[116:119], v[140:143]
    ds_read_b128 v[108:111], v1 offset:58368
    s_waitcnt lgkmcnt(5)
    v_mfma_f32_16x16x32_bf16 v[148:151], a[92:95], v[120:123], v[148:151]
    buffer_load_dwordx4 a[124:127], v1, s[8:11], s26 offen offset:3072 sc1
    v_mfma_f32_16x16x32_bf16 v[156:159], a[92:95], v[124:127], v[156:159]
    s_add_u32 s26, s22, 32768
    v_mfma_f32_16x16x32_bf16 v[144:147], a[88:91], v[120:123], v[144:147]
    buffer_load_dwordx4 a[128:131], v1, s[8:11], s26 offen offset:0 sc1
    v_mfma_f32_16x16x32_bf16 v[152:155], a[88:91], v[124:127], v[152:155]
    s_waitcnt lgkmcnt(4)
    v_mfma_f32_16x16x32_bf16 v[160:163], a[88:91], v[244:247], v[160:163]
    ds_read_b128 v[240:243], v222 offset:12288
    v_mfma_f32_16x16x32_bf16 v[164:167], a[92:95], v[244:247], v[164:167]
    buffer_load_dwordx4 a[132:135], v1, s[8:11], s26 offen offset:1024 sc1
    v_mfma_f32_16x16x32_bf16 v[44:47], a[88:91], v[28:31], v[44:47]
    v_permlane32_swap_b32 v84, v86
    v_mfma_f32_16x16x32_bf16 v[48:51], a[92:95], v[28:31], v[48:51]
    v_mov_b32 v81, v80
    s_waitcnt vmcnt(14)
    s_waitcnt lgkmcnt(3)
    v_mfma_f32_16x16x32_bf16 v[128:131], a[96:99], v[96:99], v[128:131]
    ds_read_b128 v[112:115], v1 offset:53248
    v_mov_b32 v83, v82
    v_mfma_f32_16x16x32_bf16 v[136:139], a[96:99], v[100:103], v[136:139]
    ds_read_b128 v[116:119], v1 offset:55296
    v_mov_b32 v85, v84
    v_mfma_f32_16x16x32_bf16 v[132:135], a[100:103], v[96:99], v[132:135]
    ds_read_b128 v[120:123], v1 offset:57344
    v_mov_b32 v87, v86
    v_mfma_f32_16x16x32_bf16 v[140:143], a[100:103], v[100:103], v[140:143]
    ds_read_b128 v[124:127], v1 offset:59392
    s_waitcnt lgkmcnt(5)
    v_mfma_f32_16x16x32_bf16 v[148:151], a[100:103], v[104:107], v[148:151]
    buffer_load_dwordx4 a[136:139], v1, s[8:11], s26 offen offset:2048 sc1
    v_mfma_f32_16x16x32_bf16 v[156:159], a[100:103], v[108:111], v[156:159]
    v_permlane16_swap_b32 v80, v81
    v_mfma_f32_16x16x32_bf16 v[144:147], a[96:99], v[104:107], v[144:147]
    v_permlane16_swap_b32 v82, v83
    v_mfma_f32_16x16x32_bf16 v[152:155], a[96:99], v[108:111], v[152:155]
    s_waitcnt lgkmcnt(4)
    v_mfma_f32_16x16x32_bf16 v[160:163], a[96:99], v[240:243], v[160:163]
    ds_read_b128 v[244:247], v222 offset:13312
    v_mfma_f32_16x16x32_bf16 v[164:167], a[100:103], v[240:243], v[164:167]
    buffer_load_dwordx4 a[140:143], v1, s[8:11], s26 offen offset:3072 sc1
    v_mfma_f32_16x16x32_bf16 v[44:47], a[96:99], v[28:31], v[44:47]
    s_add_u32 s26, s22, 36864
    v_mfma_f32_16x16x32_bf16 v[48:51], a[100:103], v[28:31], v[48:51]
    s_waitcnt vmcnt(10)
    s_waitcnt lgkmcnt(0)
    s_barrier
    s_waitcnt vmcnt(8)
    v_mfma_f32_16x16x32_bf16 v[128:131], a[104:107], v[112:115], v[128:131]
    ds_read_b128 v[96:99], v1 offset:60416
    v_mfma_f32_16x16x32_bf16 v[136:139], a[104:107], v[116:119], v[136:139]
    ds_read_b128 v[100:103], v1 offset:62464
    v_mfma_f32_16x16x32_bf16 v[132:135], a[108:111], v[112:115], v[132:135]
    ds_read_b128 v[104:107], v1 offset:64512
    v_mfma_f32_16x16x32_bf16 v[140:143], a[108:111], v[116:119], v[140:143]
    ds_read_b128 v[108:111], v2 offset:1024
    v_mfma_f32_16x16x32_bf16 v[148:151], a[108:111], v[120:123], v[148:151]
    buffer_load_dwordx4 a[144:147], v1, s[8:11], s26 offen offset:0 sc1
    v_mfma_f32_16x16x32_bf16 v[156:159], a[108:111], v[124:127], v[156:159]
    buffer_load_dwordx4 a[148:151], v1, s[8:11], s26 offen offset:1024 sc1
    v_mfma_f32_16x16x32_bf16 v[144:147], a[104:107], v[120:123], v[144:147]
    buffer_load_dwordx4 a[152:155], v1, s[8:11], s26 offen offset:2048 sc1
    v_mfma_f32_16x16x32_bf16 v[152:155], a[104:107], v[124:127], v[152:155]
    v_mfma_f32_16x16x32_bf16 v[160:163], a[104:107], v[244:247], v[160:163]
    ds_read_b128 v[240:243], v222 offset:14336
    v_mfma_f32_16x16x32_bf16 v[164:167], a[108:111], v[244:247], v[164:167]
    buffer_load_dwordx4 a[156:159], v1, s[8:11], s26 offen offset:3072 sc1
    v_mfma_f32_16x16x32_bf16 v[44:47], a[104:107], v[28:31], v[44:47]
    v_permlane16_swap_b32 v84, v85
    v_mfma_f32_16x16x32_bf16 v[48:51], a[108:111], v[28:31], v[48:51]
    s_waitcnt vmcnt(10)
    s_waitcnt lgkmcnt(3)
    v_mfma_f32_16x16x32_bf16 v[128:131], a[112:115], v[96:99], v[128:131]
    ds_read_b128 v[112:115], v1 offset:61440
    s_mov_b32 s53, 35127296
    v_mfma_f32_16x16x32_bf16 v[136:139], a[112:115], v[100:103], v[136:139]
    ds_read_b128 v[116:119], v1 offset:63488
    v_mfma_f32_16x16x32_bf16 v[132:135], a[116:119], v[96:99], v[132:135]
    ds_read_b128 v[120:123], v2 offset:0
    v_mfma_f32_16x16x32_bf16 v[140:143], a[116:119], v[100:103], v[140:143]
    ds_read_b128 v[124:127], v2 offset:2048
    s_waitcnt lgkmcnt(5)
    v_mfma_f32_16x16x32_bf16 v[148:151], a[116:119], v[104:107], v[148:151]
    buffer_load_dwordx2 v[176:177], v22, s[8:11], s53 offen offset:0 sc1
    v_mfma_f32_16x16x32_bf16 v[156:159], a[116:119], v[108:111], v[156:159]
    buffer_load_dwordx2 v[178:179], v22, s[8:11], s53 offen offset:512 sc1
    v_mfma_f32_16x16x32_bf16 v[144:147], a[112:115], v[104:107], v[144:147]
    buffer_load_dwordx2 v[180:181], v22, s[8:11], s53 offen offset:1024 sc1
    v_mfma_f32_16x16x32_bf16 v[152:155], a[112:115], v[108:111], v[152:155]
    s_waitcnt lgkmcnt(4)
    v_mfma_f32_16x16x32_bf16 v[160:163], a[112:115], v[240:243], v[160:163]
    ds_read_b128 v[244:247], v222 offset:15360
    v_mfma_f32_16x16x32_bf16 v[164:167], a[116:119], v[240:243], v[164:167]
    buffer_load_dwordx2 v[182:183], v22, s[8:11], s53 offen offset:1536 sc1
    v_mfma_f32_16x16x32_bf16 v[44:47], a[112:115], v[28:31], v[44:47]
    buffer_load_dwordx2 v[184:185], v22, s[8:11], s53 offen offset:2048 sc1
    v_mfma_f32_16x16x32_bf16 v[48:51], a[116:119], v[28:31], v[48:51]
    v_permlane16_swap_b32 v86, v87
    buffer_load_dwordx2 v[186:187], v22, s[8:11], s53 offen offset:2560 sc1
    v_mov_b32 v168, -1
    buffer_load_dwordx2 v[188:189], v22, s[8:11], s53 offen offset:3072 sc1
    v_mov_b32 v169, -1
    v_mov_b32 v170, -1
    v_mov_b32 v171, -1
    buffer_load_dwordx2 v[190:191], v22, s[8:11], s53 offen offset:3584 sc1
    s_waitcnt vmcnt(16)
    s_waitcnt lgkmcnt(3)
    v_mfma_f32_16x16x32_bf16 v[128:131], a[120:123], v[112:115], v[128:131]
    ds_read_b128 v[96:99], v2 offset:3072
    v_mfma_f32_16x16x32_bf16 v[136:139], a[120:123], v[116:119], v[136:139]
    ds_read_b128 v[100:103], v2 offset:5120
    s_add_u32 m0, s28, 84992
    s_add_u32 s49, s48, 36257792
    v_mfma_f32_16x16x32_bf16 v[132:135], a[124:127], v[112:115], v[132:135]
    ds_read_b128 v[104:107], v2 offset:7168
    v_mfma_f32_16x16x32_bf16 v[140:143], a[124:127], v[116:119], v[140:143]
    ds_read_b128 v[108:111], v2 offset:9216
    s_waitcnt lgkmcnt(5)
    v_mfma_f32_16x16x32_bf16 v[148:151], a[124:127], v[120:123], v[148:151]
    buffer_load_dwordx4 v1, s[8:11], s49 offen offset:0 sc1 lds
    v_mfma_f32_16x16x32_bf16 v[156:159], a[124:127], v[124:127], v[156:159]
    s_add_u32 m0, s28, 84992
    v_mfma_f32_16x16x32_bf16 v[144:147], a[120:123], v[120:123], v[144:147]
    buffer_load_dwordx4 v1, s[8:11], s49 offen offset:1024 sc1 lds
    v_mfma_f32_16x16x32_bf16 v[152:155], a[120:123], v[124:127], v[152:155]
    s_add_u32 m0, s28, 91136
    s_waitcnt lgkmcnt(4)
    v_mfma_f32_16x16x32_bf16 v[160:163], a[120:123], v[244:247], v[160:163]
    ds_read_b128 v[240:243], v222 offset:16384
    v_mfma_f32_16x16x32_bf16 v[164:167], a[124:127], v[244:247], v[164:167]
    buffer_load_dwordx4 v1, s[8:11], s49 offen offset:2048 sc1 lds
    v_mfma_f32_16x16x32_bf16 v[44:47], a[120:123], v[28:31], v[44:47]
    s_add_u32 m0, s28, 91136
    v_mfma_f32_16x16x32_bf16 v[48:51], a[124:127], v[28:31], v[48:51]
    s_waitcnt vmcnt(17)
    s_waitcnt lgkmcnt(3)
    v_mfma_f32_16x16x32_bf16 v[128:131], a[128:131], v[96:99], v[128:131]
    ds_read_b128 v[112:115], v2 offset:4096
    v_mfma_f32_16x16x32_bf16 v[136:139], a[128:131], v[100:103], v[136:139]
    ds_read_b128 v[116:119], v2 offset:6144
    v_mfma_f32_16x16x32_bf16 v[132:135], a[132:135], v[96:99], v[132:135]
    ds_read_b128 v[120:123], v2 offset:8192
    v_mfma_f32_16x16x32_bf16 v[140:143], a[132:135], v[100:103], v[140:143]
    ds_read_b128 v[124:127], v2 offset:10240
    s_waitcnt lgkmcnt(5)
    v_mfma_f32_16x16x32_bf16 v[148:151], a[132:135], v[104:107], v[148:151]
    buffer_load_dwordx4 v1, s[8:11], s49 offen offset:3072 sc1 lds
    v_mfma_f32_16x16x32_bf16 v[156:159], a[132:135], v[108:111], v[156:159]
    s_add_u32 m0, s28, 101376
    s_add_u32 s49, s48, 36261888
    v_mfma_f32_16x16x32_bf16 v[144:147], a[128:131], v[104:107], v[144:147]
    buffer_load_dwordx4 v1, s[8:11], s49 offen offset:0 sc1 lds
    v_mfma_f32_16x16x32_bf16 v[152:155], a[128:131], v[108:111], v[152:155]
    s_add_u32 m0, s28, 101376
    s_waitcnt lgkmcnt(4)
    v_mfma_f32_16x16x32_bf16 v[160:163], a[128:131], v[240:243], v[160:163]
    ds_read_b128 v[244:247], v222 offset:17408
    v_mfma_f32_16x16x32_bf16 v[164:167], a[132:135], v[240:243], v[164:167]
    buffer_load_dwordx4 v1, s[8:11], s49 offen offset:1024 sc1 lds
    v_mfma_f32_16x16x32_bf16 v[44:47], a[128:131], v[28:31], v[44:47]
    s_add_u32 m0, s28, 107520
    v_mfma_f32_16x16x32_bf16 v[48:51], a[132:135], v[28:31], v[48:51]
    s_waitcnt vmcnt(18)
    s_waitcnt lgkmcnt(3)
    v_mfma_f32_16x16x32_bf16 v[128:131], a[136:139], v[112:115], v[128:131]
    ds_read_b128 v[96:99], v2 offset:11264
    v_mfma_f32_16x16x32_bf16 v[136:139], a[136:139], v[116:119], v[136:139]
    ds_read_b128 v[100:103], v2 offset:13312
    v_mfma_f32_16x16x32_bf16 v[132:135], a[140:143], v[112:115], v[132:135]
    ds_read_b128 v[104:107], v2 offset:15360
    v_mfma_f32_16x16x32_bf16 v[140:143], a[140:143], v[116:119], v[140:143]
    ds_read_b128 v[108:111], v2 offset:17408
    s_waitcnt lgkmcnt(5)
    v_mfma_f32_16x16x32_bf16 v[148:151], a[140:143], v[120:123], v[148:151]
    buffer_load_dwordx4 v1, s[8:11], s49 offen offset:2048 sc1 lds
    v_mfma_f32_16x16x32_bf16 v[156:159], a[140:143], v[124:127], v[156:159]
    s_add_u32 m0, s28, 107520
    v_mfma_f32_16x16x32_bf16 v[144:147], a[136:139], v[120:123], v[144:147]
    buffer_load_dwordx4 v1, s[8:11], s49 offen offset:3072 sc1 lds
    v_mfma_f32_16x16x32_bf16 v[152:155], a[136:139], v[124:127], v[152:155]
    s_waitcnt lgkmcnt(4)
    v_mfma_f32_16x16x32_bf16 v[160:163], a[136:139], v[244:247], v[160:163]
    ds_read_b128 v[240:243], v222 offset:18432
    v_mfma_f32_16x16x32_bf16 v[164:167], a[140:143], v[244:247], v[164:167]
    v_mfma_f32_16x16x32_bf16 v[44:47], a[136:139], v[28:31], v[44:47]
    v_mfma_f32_16x16x32_bf16 v[48:51], a[140:143], v[28:31], v[48:51]
    s_waitcnt vmcnt(18)
    s_waitcnt lgkmcnt(3)
    v_mfma_f32_16x16x32_bf16 v[128:131], a[144:147], v[96:99], v[128:131]
    ds_read_b128 v[112:115], v2 offset:12288
    v_mfma_f32_16x16x32_bf16 v[136:139], a[144:147], v[100:103], v[136:139]
    ds_read_b128 v[116:119], v2 offset:14336
    v_mfma_f32_16x16x32_bf16 v[132:135], a[148:151], v[96:99], v[132:135]
    ds_read_b128 v[120:123], v2 offset:16384
    s_add_u32 s55, s32, 9519104
    v_mfma_f32_16x16x32_bf16 v[140:143], a[148:151], v[100:103], v[140:143]
    ds_read_b128 v[124:127], v2 offset:18432
    s_waitcnt lgkmcnt(5)
    v_mfma_f32_16x16x32_bf16 v[148:151], a[148:151], v[104:107], v[148:151]
    buffer_store_dwordx4 v[168:171], v1, s[8:11], s55 offen offset:0 sc1
    v_mfma_f32_16x16x32_bf16 v[156:159], a[148:151], v[108:111], v[156:159]
    v_mfma_f32_16x16x32_bf16 v[144:147], a[144:147], v[104:107], v[144:147]
    v_mfma_f32_16x16x32_bf16 v[152:155], a[144:147], v[108:111], v[152:155]
    s_waitcnt lgkmcnt(4)
    v_mfma_f32_16x16x32_bf16 v[160:163], a[144:147], v[240:243], v[160:163]
    ds_read_b128 v[244:247], v222 offset:19456
    v_mfma_f32_16x16x32_bf16 v[164:167], a[148:151], v[240:243], v[164:167]
    s_add_u32 s55, s32, 9519104
    v_mfma_f32_16x16x32_bf16 v[44:47], a[144:147], v[28:31], v[44:47]
    buffer_store_dwordx4 v[168:171], v23, s[8:11], s55 offen offset:1024 sc1
    v_mfma_f32_16x16x32_bf16 v[48:51], a[148:151], v[28:31], v[48:51]
    s_add_u32 s55, s35, 27262976
    s_waitcnt vmcnt(18)
    s_waitcnt lgkmcnt(3)
    v_mfma_f32_16x16x32_bf16 v[128:131], a[152:155], v[112:115], v[128:131]
    buffer_store_dwordx4 v[168:171], v8, s[8:11], s55 offen offset:0 sc1
    v_mfma_f32_16x16x32_bf16 v[136:139], a[152:155], v[116:119], v[136:139]
    v_mfma_f32_16x16x32_bf16 v[132:135], a[156:159], v[112:115], v[132:135]
    v_mfma_f32_16x16x32_bf16 v[140:143], a[156:159], v[116:119], v[140:143]
    s_add_u32 s55, s35, 27262976
    s_waitcnt lgkmcnt(1)
    v_mfma_f32_16x16x32_bf16 v[148:151], a[156:159], v[120:123], v[148:151]
    buffer_store_dwordx4 v[168:171], v12, s[8:11], s55 offen offset:2048 sc1
    v_mfma_f32_16x16x32_bf16 v[156:159], a[156:159], v[124:127], v[156:159]
    s_add_u32 s53, s36, 35131392
    v_mfma_f32_16x16x32_bf16 v[144:147], a[152:155], v[120:123], v[144:147]
    buffer_load_dwordx2 v[200:201], v0, s[8:11], s53 offen offset:0 sc1
    v_mfma_f32_16x16x32_bf16 v[152:155], a[152:155], v[124:127], v[152:155]
    s_waitcnt lgkmcnt(0)
    v_mfma_f32_16x16x32_bf16 v[160:163], a[152:155], v[244:247], v[160:163]
    buffer_load_dwordx2 v[202:203], v0, s[8:11], s53 offen offset:512 sc1
    v_mfma_f32_16x16x32_bf16 v[164:167], a[156:159], v[244:247], v[164:167]
    buffer_load_dwordx2 v[204:205], v0, s[8:11], s53 offen offset:1024 sc1
    v_mfma_f32_16x16x32_bf16 v[44:47], a[152:155], v[28:31], v[44:47]
    buffer_load_dwordx2 v[206:207], v0, s[8:11], s53 offen offset:1536 sc1
    v_mfma_f32_16x16x32_bf16 v[48:51], a[156:159], v[28:31], v[48:51]
    buffer_load_dwordx2 v[208:209], v0, s[8:11], s53 offen offset:2048 sc1
    s_nop 4
    v_pk_fma_f32 v[128:129], v[80:81], v[44:45], v[128:129] op_sel:[0,0,0] op_sel_hi:[0,1,1] neg_lo:[1,0,0] neg_hi:[1,0,0]
    v_pk_fma_f32 v[130:131], v[80:81], v[46:47], v[130:131] op_sel:[0,0,0] op_sel_hi:[0,1,1] neg_lo:[1,0,0] neg_hi:[1,0,0]
    v_pk_mul_f32 v[128:129], v[84:85], v[128:129] op_sel:[0,0] op_sel_hi:[0,1]
    v_pk_mul_f32 v[130:131], v[84:85], v[130:131] op_sel:[0,0] op_sel_hi:[0,1]
    v_cvt_pk_bf16_f32 v128, v128, v129
    v_cvt_pk_bf16_f32 v129, v130, v131
    ds_write_b64 v9, v[128:129] offset:2176
    v_pk_fma_f32 v[132:133], v[80:81], v[48:49], v[132:133] op_sel:[0,0,0] op_sel_hi:[0,1,1] neg_lo:[1,0,0] neg_hi:[1,0,0]
    v_pk_fma_f32 v[134:135], v[80:81], v[50:51], v[134:135] op_sel:[0,0,0] op_sel_hi:[0,1,1] neg_lo:[1,0,0] neg_hi:[1,0,0]
    buffer_load_dwordx2 v[210:211], v0, s[8:11], s53 offen offset:2560 sc1
    v_pk_mul_f32 v[132:133], v[84:85], v[132:133] op_sel:[0,0] op_sel_hi:[0,1]
    buffer_load_dwordx2 v[212:213], v0, s[8:11], s53 offen offset:3072 sc1
    v_pk_mul_f32 v[134:135], v[84:85], v[134:135] op_sel:[0,0] op_sel_hi:[0,1]
    v_cvt_pk_bf16_f32 v132, v132, v133
    v_cvt_pk_bf16_f32 v133, v134, v135
    ds_write_b64 v9, v[132:133] offset:2208
    v_pk_fma_f32 v[136:137], v[80:81], v[44:45], v[136:137] op_sel:[1,0,0] op_sel_hi:[1,1,1] neg_lo:[1,0,0] neg_hi:[1,0,0]
    buffer_load_dwordx2 v[214:215], v0, s[8:11], s53 offen offset:3584 sc1
    v_pk_fma_f32 v[138:139], v[80:81], v[46:47], v[138:139] op_sel:[1,0,0] op_sel_hi:[1,1,1] neg_lo:[1,0,0] neg_hi:[1,0,0]
    v_pk_mul_f32 v[136:137], v[84:85], v[136:137] op_sel:[1,0] op_sel_hi:[1,1]
    v_pk_mul_f32 v[138:139], v[84:85], v[138:139] op_sel:[1,0] op_sel_hi:[1,1]
    v_cvt_pk_bf16_f32 v136, v136, v137
    s_add_u32 m0, s28, 3072
    s_add_u32 s49, s48, 36265984
    buffer_load_dwordx4 v1, s[8:11], s49 offen offset:0 sc1 lds
    v_cvt_pk_bf16_f32 v137, v138, v139
    ds_write_b64 v9, v[136:137] offset:13056
    v_pk_fma_f32 v[140:141], v[80:81], v[48:49], v[140:141] op_sel:[1,0,0] op_sel_hi:[1,1,1] neg_lo:[1,0,0] neg_hi:[1,0,0]
    v_pk_fma_f32 v[142:143], v[80:81], v[50:51], v[142:143] op_sel:[1,0,0] op_sel_hi:[1,1,1] neg_lo:[1,0,0] neg_hi:[1,0,0]
    v_pk_mul_f32 v[140:141], v[84:85], v[140:141] op_sel:[1,0] op_sel_hi:[1,1]
    v_pk_mul_f32 v[142:143], v[84:85], v[142:143] op_sel:[1,0] op_sel_hi:[1,1]
    v_cvt_pk_bf16_f32 v140, v140, v141
    s_add_u32 m0, s28, 3072
    s_nop 0
    buffer_load_dwordx4 v1, s[8:11], s49 offen offset:1024 sc1 lds
    v_cvt_pk_bf16_f32 v141, v142, v143
    ds_write_b64 v9, v[140:141] offset:13088
    v_pk_fma_f32 v[144:145], v[82:83], v[44:45], v[144:145] op_sel:[0,0,0] op_sel_hi:[0,1,1] neg_lo:[1,0,0] neg_hi:[1,0,0]
    v_pk_fma_f32 v[146:147], v[82:83], v[46:47], v[146:147] op_sel:[0,0,0] op_sel_hi:[0,1,1] neg_lo:[1,0,0] neg_hi:[1,0,0]
    v_pk_mul_f32 v[144:145], v[86:87], v[144:145] op_sel:[0,0] op_sel_hi:[0,1]
    v_pk_mul_f32 v[146:147], v[86:87], v[146:147] op_sel:[0,0] op_sel_hi:[0,1]
    v_cvt_pk_bf16_f32 v144, v144, v145
    v_cvt_pk_bf16_f32 v145, v146, v147
    ds_write_b64 v9, v[144:145] offset:6528
    v_pk_fma_f32 v[148:149], v[82:83], v[48:49], v[148:149] op_sel:[0,0,0] op_sel_hi:[0,1,1] neg_lo:[1,0,0] neg_hi:[1,0,0]
    v_pk_fma_f32 v[150:151], v[82:83], v[50:51], v[150:151] op_sel:[0,0,0] op_sel_hi:[0,1,1] neg_lo:[1,0,0] neg_hi:[1,0,0]
    v_pk_mul_f32 v[148:149], v[86:87], v[148:149] op_sel:[0,0] op_sel_hi:[0,1]
    v_pk_mul_f32 v[150:151], v[86:87], v[150:151] op_sel:[0,0] op_sel_hi:[0,1]
    v_cvt_pk_bf16_f32 v148, v148, v149
    v_cvt_pk_bf16_f32 v149, v150, v151
    ds_write_b64 v9, v[148:149] offset:6560
    v_pk_fma_f32 v[152:153], v[82:83], v[44:45], v[152:153] op_sel:[1,0,0] op_sel_hi:[1,1,1] neg_lo:[1,0,0] neg_hi:[1,0,0]
    v_pk_fma_f32 v[154:155], v[82:83], v[46:47], v[154:155] op_sel:[1,0,0] op_sel_hi:[1,1,1] neg_lo:[1,0,0] neg_hi:[1,0,0]
    v_pk_mul_f32 v[152:153], v[86:87], v[152:153] op_sel:[1,0] op_sel_hi:[1,1]
    v_pk_mul_f32 v[154:155], v[86:87], v[154:155] op_sel:[1,0] op_sel_hi:[1,1]
    v_cvt_pk_bf16_f32 v152, v152, v153
    v_cvt_pk_bf16_f32 v153, v154, v155
    s_add_u32 m0, s28, 9216
    s_nop 0
    buffer_load_dwordx4 v1, s[8:11], s49 offen offset:2048 sc1 lds
    ds_write_b64 v9, v[152:153] offset:17408
    v_pk_fma_f32 v[156:157], v[82:83], v[48:49], v[156:157] op_sel:[1,0,0] op_sel_hi:[1,1,1] neg_lo:[1,0,0] neg_hi:[1,0,0]
    v_pk_fma_f32 v[158:159], v[82:83], v[50:51], v[158:159] op_sel:[1,0,0] op_sel_hi:[1,1,1] neg_lo:[1,0,0] neg_hi:[1,0,0]
    v_pk_mul_f32 v[156:157], v[86:87], v[156:157] op_sel:[1,0] op_sel_hi:[1,1]
    v_pk_mul_f32 v[158:159], v[86:87], v[158:159] op_sel:[1,0] op_sel_hi:[1,1]
    s_add_u32 m0, s28, 9216
    s_nop 0
    buffer_load_dwordx4 v1, s[8:11], s49 offen offset:3072 sc1 lds
    v_cvt_pk_bf16_f32 v156, v156, v157
    v_cvt_pk_bf16_f32 v157, v158, v159
    ds_write_b64 v9, v[156:157] offset:17440
    s_waitcnt vmcnt(24)
    v_pk_add_f32 v[176:177], v[176:177], v[184:185]
    v_pk_add_f32 v[178:179], v[178:179], v[186:187]
    v_pk_add_f32 v[180:181], v[180:181], v[188:189]
    v_pk_add_f32 v[182:183], v[182:183], v[190:191]
    v_pk_add_f32 v[176:177], v[176:177], v[180:181]
    v_pk_add_f32 v[178:179], v[178:179], v[182:183]
    v_pk_add_f32 v[176:177], v[176:177], v[178:179]
    v_mul_f32 v92, s64, v176
    v_mul_f32 v177, s64, v177
    v_fma_f32 v177, -v92, v92, v177
    v_max_f32 v177, 0, v177
    v_add_f32 v177, s65, v177
    v_rsq_f32 v93, v177
    s_nop 0
    v_pk_fma_f32 v[160:161], v[92:93], v[44:45], v[160:161] op_sel:[0,0,0] op_sel_hi:[0,1,1] neg_lo:[1,0,0] neg_hi:[1,0,0]
    v_pk_fma_f32 v[162:163], v[92:93], v[46:47], v[162:163] op_sel:[0,0,0] op_sel_hi:[0,1,1] neg_lo:[1,0,0] neg_hi:[1,0,0]
    v_pk_mul_f32 v[160:161], v[92:93], v[160:161] op_sel:[1,0] op_sel_hi:[1,1]
    v_pk_mul_f32 v[162:163], v[92:93], v[162:163] op_sel:[1,0] op_sel_hi:[1,1]
    v_cvt_pk_bf16_f32 v160, v160, v161
    v_cvt_pk_bf16_f32 v161, v162, v163
    ds_write_b64 v10, v[160:161] offset:0
    v_pk_fma_f32 v[164:165], v[92:93], v[48:49], v[164:165] op_sel:[0,0,0] op_sel_hi:[0,1,1] neg_lo:[1,0,0] neg_hi:[1,0,0]
    v_pk_fma_f32 v[166:167], v[92:93], v[50:51], v[166:167] op_sel:[0,0,0] op_sel_hi:[0,1,1] neg_lo:[1,0,0] neg_hi:[1,0,0]
    v_pk_mul_f32 v[164:165], v[92:93], v[164:165] op_sel:[1,0] op_sel_hi:[1,1]
    v_pk_mul_f32 v[166:167], v[92:93], v[166:167] op_sel:[1,0] op_sel_hi:[1,1]
    v_cvt_pk_bf16_f32 v164, v164, v165
    v_cvt_pk_bf16_f32 v165, v166, v167
    ds_write_b64 v10, v[164:165] offset:32
    s_waitcnt vmcnt(16)
    s_waitcnt lgkmcnt(0)
    s_barrier
    ds_read_b128 v[128:131], v11 offset:2176
    ds_read_b128 v[132:135], v11 offset:80
    ds_read_b128 v[136:139], v11 offset:2256
    ds_read_b128 v[140:143], v11 offset:2208
    ds_read_b128 v[144:147], v11 offset:112
    ds_read_b128 v[148:151], v11 offset:2288
    s_waitcnt lgkmcnt(5)
    v_cndmask_b32 v128, 0, v128, s[40:41]
    v_cndmask_b32 v129, 0, v129, s[40:41]
    v_cndmask_b32 v130, 0, v130, s[42:43]
    v_cndmask_b32 v131, 0, v131, s[42:43]
    s_waitcnt lgkmcnt(3)
    s_nop 0
    v_mfma_f32_16x16x32_bf16 v[96:99], v[132:135], v[128:131], v[40:43]
    v_mfma_f32_16x16x32_bf16 v[100:103], v[136:139], v[128:131], v[36:39]
    s_waitcnt lgkmcnt(2)
    v_cndmask_b32 v140, 0, v140, s[44:45]
    v_cndmask_b32 v141, 0, v141, s[44:45]
    v_cndmask_b32 v142, 0, v142, s[40:41]
    v_cndmask_b32 v143, 0, v143, s[40:41]
    s_waitcnt lgkmcnt(0)
    s_nop 0
    v_mfma_f32_16x16x32_bf16 v[104:107], v[144:147], v[140:143], v[40:43]
    v_mfma_f32_16x16x32_bf16 v[108:111], v[148:151], v[140:143], v[36:39]
    ds_read_b64_tr_b16 v[152:153], v14 offset:160
    ds_read_b64_tr_b16 v[154:155], v14 offset:2336
    ds_read_b64_tr_b16 v[156:157], v14 offset:192
    ds_read_b64_tr_b16 v[158:159], v14 offset:2368
    v_max3_f32 v120, v96, v97, v98
    v_max3_f32 v121, v100, v101, v102
    v_max3_f32 v120, v120, v99, v103
    v_max_f32 v120, v120, v121
    v_mov_b32 v121, v120
    v_max3_f32 v122, v104, v105, v106
    v_max3_f32 v123, v108, v109, v110
    v_max3_f32 v122, v122, v107, v111
    v_max_f32 v122, v122, v123
    v_mov_b32 v123, v122
    v_permlane32_swap_b32 v120, v121
    s_nop 0
    v_permlane32_swap_b32 v122, v123
    v_max_f32 v120, v120, v121
    v_mov_b32 v121, v120
    v_max_f32 v122, v122, v123
    v_mov_b32 v123, v122
    v_permlane16_swap_b32 v120, v121
    s_nop 0
    v_permlane16_swap_b32 v122, v123
    v_max_f32 v120, v120, v121
    v_max_f32 v122, v122, v123
    ds_read_b64_tr_b16 v[160:161], v14 offset:200
    ds_read_b64_tr_b16 v[162:163], v14 offset:2376
    ds_read_b64_tr_b16 v[164:165], v14 offset:232
    ds_read_b64_tr_b16 v[166:167], v14 offset:2408
    v_mov_b32 v124, s67
    v_mul_f32 v120, v124, v120
    v_mul_f32 v122, v124, v122
    v_pk_fma_f32 v[96:97], v[96:97], v[124:125], v[120:121] op_sel:[0,0,0] op_sel_hi:[1,0,0] neg_lo:[0,0,1] neg_hi:[0,0,1]
    s_add_u32 m0, s28, 19456
    s_add_u32 s49, s48, 36270080
    buffer_load_dwordx4 v1, s[8:11], s49 offen offset:0 sc1 lds
    v_pk_fma_f32 v[98:99], v[98:99], v[124:125], v[120:121] op_sel:[0,0,0] op_sel_hi:[1,0,0] neg_lo:[0,0,1] neg_hi:[0,0,1]
    v_pk_fma_f32 v[100:101], v[100:101], v[124:125], v[120:121] op_sel:[0,0,0] op_sel_hi:[1,0,0] neg_lo:[0,0,1] neg_hi:[0,0,1]
    v_pk_fma_f32 v[102:103], v[102:103], v[124:125], v[120:121] op_sel:[0,0,0] op_sel_hi:[1,0,0] neg_lo:[0,0,1] neg_hi:[0,0,1]
    v_pk_fma_f32 v[104:105], v[104:105], v[124:125], v[122:123] op_sel:[0,0,0] op_sel_hi:[1,0,0] neg_lo:[0,0,1] neg_hi:[0,0,1]
    v_pk_fma_f32 v[106:107], v[106:107], v[124:125], v[122:123] op_sel:[0,0,0] op_sel_hi:[1,0,0] neg_lo:[0,0,1] neg_hi:[0,0,1]
    s_add_u32 m0, s28, 19456
    s_nop 0
    buffer_load_dwordx4 v1, s[8:11], s49 offen offset:1024 sc1 lds
    v_pk_fma_f32 v[108:109], v[108:109], v[124:125], v[122:123] op_sel:[0,0,0] op_sel_hi:[1,0,0] neg_lo:[0,0,1] neg_hi:[0,0,1]
    v_pk_fma_f32 v[110:111], v[110:111], v[124:125], v[122:123] op_sel:[0,0,0] op_sel_hi:[1,0,0] neg_lo:[0,0,1] neg_hi:[0,0,1]
    v_exp_f32 v96, v96
    v_exp_f32 v97, v97
    v_exp_f32 v98, v98
    v_exp_f32 v99, v99
    v_exp_f32 v100, v100
    v_exp_f32 v101, v101
    v_exp_f32 v102, v102
    s_add_u32 m0, s28, 25600
    s_nop 0
    buffer_load_dwordx4 v1, s[8:11], s49 offen offset:2048 sc1 lds
    v_exp_f32 v103, v103
    v_cvt_pk_bf16_f32 v112, v96, v97
    v_cvt_pk_bf16_f32 v113, v98, v99
    v_cvt_pk_bf16_f32 v114, v100, v101
    s_add_u32 m0, s28, 25600
    s_nop 0
    buffer_load_dwordx4 v1, s[8:11], s49 offen offset:3072 sc1 lds
    v_cvt_pk_bf16_f32 v115, v102, v103
    s_waitcnt lgkmcnt(4)
    v_exp_f32 v104, v104
    s_add_u32 m0, s28, 35840
    s_add_u32 s49, s48, 36274176
    buffer_load_dwordx4 v1, s[8:11], s49 offen offset:0 sc1 lds
    v_exp_f32 v105, v105
    s_add_u32 m0, s28, 35840
    s_nop 0
    buffer_load_dwordx4 v1, s[8:11], s49 offen offset:1024 sc1 lds
    v_mfma_f32_16x16x32_bf16 v[184:187], v[28:31], v[112:115], 0
    s_add_u32 m0, s28, 41984
    s_nop 0
    buffer_load_dwordx4 v1, s[8:11], s49 offen offset:2048 sc1 lds
    v_exp_f32 v106, v106
    v_exp_f32 v107, v107
    v_mfma_f32_16x16x32_bf16 v[176:179], v[152:155], v[112:115], 0
    v_exp_f32 v108, v108
    v_exp_f32 v109, v109
    v_mfma_f32_16x16x32_bf16 v[180:183], v[156:159], v[112:115], 0
    v_exp_f32 v110, v110
    v_exp_f32 v111, v111
    v_cvt_pk_bf16_f32 v116, v104, v105
    v_cvt_pk_bf16_f32 v117, v106, v107
    v_cvt_pk_bf16_f32 v118, v108, v109
    v_cvt_pk_bf16_f32 v119, v110, v111
    v_rcp_f32 v184, v184
    s_add_u32 m0, s28, 41984
    s_nop 0
    buffer_load_dwordx4 v1, s[8:11], s49 offen offset:3072 sc1 lds
    s_waitcnt lgkmcnt(0)
    v_mfma_f32_16x16x32_bf16 v[196:199], v[28:31], v[116:119], 0
    s_add_u32 s55, s35, 36175872
    buffer_load_dwordx4 v[64:67], v8, s[8:11], s55 offen offset:0
    v_mul_f32 v176, v184, v176
    v_mul_f32 v177, v184, v177
    v_mul_f32 v178, v184, v178
    v_mfma_f32_16x16x32_bf16 v[188:191], v[160:163], v[116:119], 0
    v_mul_f32 v179, v184, v179
    v_mul_f32 v180, v184, v180
    v_mul_f32 v181, v184, v181
    v_mfma_f32_16x16x32_bf16 v[192:195], v[164:167], v[116:119], 0
    v_mul_f32 v182, v184, v182
    s_add_u32 s55, s35, 36175872
    buffer_load_dwordx4 v[68:71], v12, s[8:11], s55 offen offset:2048
    v_mul_f32 v183, v184, v183
    ds_read_b128 v[96:99], v2 offset:19456
    ds_read_b128 v[100:103], v2 offset:21504
    ds_read_b128 v[104:107], v2 offset:23552
    ds_read_b128 v[108:111], v2 offset:25600
    v_cvt_pk_bf16_f32 v168, v176, v177
    v_cvt_pk_bf16_f32 v172, v180, v181
    v_cvt_pk_bf16_f32 v169, v178, v179
    v_cvt_pk_bf16_f32 v173, v182, v183
    v_rcp_f32 v196, v196
    s_nop 0
    v_pk_mul_f32 v[188:189], v[196:197], v[188:189] op_sel:[0,0] op_sel_hi:[0,1]
    v_pk_mul_f32 v[192:193], v[196:197], v[192:193] op_sel:[0,0] op_sel_hi:[0,1]
    v_pk_mul_f32 v[190:191], v[196:197], v[190:191] op_sel:[0,0] op_sel_hi:[0,1]
    v_pk_mul_f32 v[194:195], v[196:197], v[194:195] op_sel:[0,0] op_sel_hi:[0,1]
    v_cvt_pk_bf16_f32 v170, v188, v189
    v_cvt_pk_bf16_f32 v174, v192, v193
    v_cvt_pk_bf16_f32 v171, v190, v191
    v_cvt_pk_bf16_f32 v175, v194, v195
    s_add_u32 s56, s32, 9437184
    buffer_store_dwordx4 v[168:171], v1, s[8:11], s56 offen sc1
    buffer_store_dwordx4 v[172:175], v23, s[8:11], s56 offen offset:1024 sc1
    s_waitcnt lgkmcnt(2)
    v_mfma_f32_16x16x32_bf16 v[128:131], a[0:3], v[96:99], 0
    ds_read_b128 v[112:115], v2 offset:20480
    v_mfma_f32_16x16x32_bf16 v[136:139], a[0:3], v[100:103], 0
    ds_read_b128 v[116:119], v2 offset:22528
    v_mfma_f32_16x16x32_bf16 v[132:135], a[4:7], v[96:99], 0
    ds_read_b128 v[120:123], v2 offset:24576
    v_mfma_f32_16x16x32_bf16 v[140:143], a[4:7], v[100:103], 0
    ds_read_b128 v[124:127], v2 offset:26624
    s_waitcnt lgkmcnt(4)
    v_mfma_f32_16x16x32_bf16 v[148:151], a[4:7], v[104:107], 0
    v_mfma_f32_16x16x32_bf16 v[156:159], a[4:7], v[108:111], 0
    v_mfma_f32_16x16x32_bf16 v[144:147], a[0:3], v[104:107], 0
    v_mfma_f32_16x16x32_bf16 v[152:155], a[0:3], v[108:111], 0
    s_waitcnt lgkmcnt(2)
    v_mfma_f32_16x16x32_bf16 v[128:131], a[8:11], v[112:115], v[128:131]
    ds_read_b128 v[96:99], v2 offset:27648
    v_mfma_f32_16x16x32_bf16 v[136:139], a[8:11], v[116:119], v[136:139]
    ds_read_b128 v[100:103], v2 offset:29696
    v_mfma_f32_16x16x32_bf16 v[132:135], a[12:15], v[112:115], v[132:135]
    ds_read_b128 v[104:107], v2 offset:31744
    v_mfma_f32_16x16x32_bf16 v[140:143], a[12:15], v[116:119], v[140:143]
    ds_read_b128 v[108:111], v2 offset:33792
    s_waitcnt lgkmcnt(4)
    v_mfma_f32_16x16x32_bf16 v[148:151], a[12:15], v[120:123], v[148:151]
    v_mfma_f32_16x16x32_bf16 v[156:159], a[12:15], v[124:127], v[156:159]
    v_mfma_f32_16x16x32_bf16 v[144:147], a[8:11], v[120:123], v[144:147]
    v_mfma_f32_16x16x32_bf16 v[152:155], a[8:11], v[124:127], v[152:155]
    s_waitcnt vmcnt(16)
    s_waitcnt lgkmcnt(2)
    v_mfma_f32_16x16x32_bf16 v[128:131], a[16:19], v[96:99], v[128:131]
    ds_read_b128 v[112:115], v2 offset:28672
    v_add_f32 v200, v200, v208
    v_mfma_f32_16x16x32_bf16 v[136:139], a[16:19], v[100:103], v[136:139]
    ds_read_b128 v[116:119], v2 offset:30720
    v_add_f32 v201, v201, v209
    v_mfma_f32_16x16x32_bf16 v[132:135], a[20:23], v[96:99], v[132:135]
    ds_read_b128 v[120:123], v2 offset:32768
    s_add_u32 s55, s35, 36257792
    v_mfma_f32_16x16x32_bf16 v[140:143], a[20:23], v[100:103], v[140:143]
    ds_read_b128 v[124:127], v2 offset:34816
    s_waitcnt lgkmcnt(4)
    v_mfma_f32_16x16x32_bf16 v[148:151], a[20:23], v[104:107], v[148:151]
    buffer_load_dwordx4 v[72:75], v8, s[8:11], s55 offen offset:0
    v_mfma_f32_16x16x32_bf16 v[156:159], a[20:23], v[108:111], v[156:159]
    v_add_f32 v202, v202, v210
    v_add_f32 v203, v203, v211
    v_mfma_f32_16x16x32_bf16 v[144:147], a[16:19], v[104:107], v[144:147]
    v_add_f32 v204, v204, v212
    v_add_f32 v205, v205, v213
    v_mfma_f32_16x16x32_bf16 v[152:155], a[16:19], v[108:111], v[152:155]
    v_add_f32 v206, v206, v214
    s_waitcnt lgkmcnt(2)
    v_mfma_f32_16x16x32_bf16 v[128:131], a[24:27], v[112:115], v[128:131]
    ds_read_b128 v[96:99], v2 offset:35840
    v_add_f32 v207, v207, v215
    v_mfma_f32_16x16x32_bf16 v[136:139], a[24:27], v[116:119], v[136:139]
    ds_read_b128 v[100:103], v2 offset:37888
    s_add_u32 s55, s35, 36257792
    v_mfma_f32_16x16x32_bf16 v[132:135], a[28:31], v[112:115], v[132:135]
    ds_read_b128 v[104:107], v2 offset:39936
    v_add_f32 v200, v200, v204
    v_mfma_f32_16x16x32_bf16 v[140:143], a[28:31], v[116:119], v[140:143]
    ds_read_b128 v[108:111], v2 offset:41984
    s_waitcnt lgkmcnt(4)
    v_mfma_f32_16x16x32_bf16 v[148:151], a[28:31], v[120:123], v[148:151]
    buffer_load_dwordx4 v[76:79], v12, s[8:11], s55 offen offset:2048
    v_mfma_f32_16x16x32_bf16 v[156:159], a[28:31], v[124:127], v[156:159]
    s_add_u32 s26, s23, 0
    v_add_f32 v201, v201, v205
    v_mfma_f32_16x16x32_bf16 v[144:147], a[24:27], v[120:123], v[144:147]
    buffer_load_dwordx4 a[160:163], v1, s[8:11], s26 offen offset:0 sc1
    v_mfma_f32_16x16x32_bf16 v[152:155], a[24:27], v[124:127], v[152:155]
    v_add_f32 v202, v202, v206
    s_waitcnt lgkmcnt(2)
    v_mfma_f32_16x16x32_bf16 v[128:131], a[32:35], v[96:99], v[128:131]
    ds_read_b128 v[112:115], v2 offset:36864
    v_add_f32 v203, v203, v207
    v_mfma_f32_16x16x32_bf16 v[136:139], a[32:35], v[100:103], v[136:139]
    ds_read_b128 v[116:119], v2 offset:38912
    v_add_f32 v200, v200, v202
    v_mfma_f32_16x16x32_bf16 v[132:135], a[36:39], v[96:99], v[132:135]
    ds_read_b128 v[120:123], v2 offset:40960
    v_add_f32 v201, v201, v203
    v_mfma_f32_16x16x32_bf16 v[140:143], a[36:39], v[100:103], v[140:143]
    ds_read_b128 v[124:127], v2 offset:43008
    s_waitcnt lgkmcnt(4)
    v_mfma_f32_16x16x32_bf16 v[148:151], a[36:39], v[104:107], v[148:151]
    buffer_load_dwordx4 a[164:167], v1, s[8:11], s26 offen offset:1024 sc1
    v_mfma_f32_16x16x32_bf16 v[156:159], a[36:39], v[108:111], v[156:159]
    buffer_load_dwordx4 a[168:171], v1, s[8:11], s26 offen offset:2048 sc1
    v_mfma_f32_16x16x32_bf16 v[144:147], a[32:35], v[104:107], v[144:147]
    buffer_load_dwordx4 a[172:175], v1, s[8:11], s26 offen offset:3072 sc1
    v_mfma_f32_16x16x32_bf16 v[152:155], a[32:35], v[108:111], v[152:155]
    s_add_u32 s26, s23, 4096
    s_waitcnt lgkmcnt(2)
    v_mfma_f32_16x16x32_bf16 v[128:131], a[40:43], v[112:115], v[128:131]
    ds_read_b128 v[96:99], v2 offset:44032
    v_mul_f32 v80, s64, v200
    v_mfma_f32_16x16x32_bf16 v[136:139], a[40:43], v[116:119], v[136:139]
    ds_read_b128 v[100:103], v2 offset:46080
    v_mul_f32 v201, s64, v201
    v_mfma_f32_16x16x32_bf16 v[132:135], a[44:47], v[112:115], v[132:135]
    ds_read_b128 v[104:107], v2 offset:48128
    v_fma_f32 v201, -v80, v80, v201
    v_mfma_f32_16x16x32_bf16 v[140:143], a[44:47], v[116:119], v[140:143]
    ds_read_b128 v[108:111], v2 offset:50176
    s_waitcnt lgkmcnt(4)
    v_mfma_f32_16x16x32_bf16 v[148:151], a[44:47], v[120:123], v[148:151]
    buffer_load_dwordx4 a[176:179], v1, s[8:11], s26 offen offset:0 sc1
    v_mfma_f32_16x16x32_bf16 v[156:159], a[44:47], v[124:127], v[156:159]
    buffer_load_dwordx4 a[180:183], v1, s[8:11], s26 offen offset:1024 sc1
    v_mfma_f32_16x16x32_bf16 v[144:147], a[40:43], v[120:123], v[144:147]
    buffer_load_dwordx4 a[184:187], v1, s[8:11], s26 offen offset:2048 sc1
    v_mfma_f32_16x16x32_bf16 v[152:155], a[40:43], v[124:127], v[152:155]
    v_max_f32 v201, 0, v201
    s_waitcnt lgkmcnt(2)
    v_mfma_f32_16x16x32_bf16 v[128:131], a[48:51], v[96:99], v[128:131]
    ds_read_b128 v[112:115], v2 offset:45056
    v_add_f32 v201, s65, v201
    v_mfma_f32_16x16x32_bf16 v[136:139], a[48:51], v[100:103], v[136:139]
    ds_read_b128 v[116:119], v2 offset:47104
    v_mfma_f32_16x16x32_bf16 v[132:135], a[52:55], v[96:99], v[132:135]
    ds_read_b128 v[120:123], v2 offset:49152
    v_mfma_f32_16x16x32_bf16 v[140:143], a[52:55], v[100:103], v[140:143]
    ds_read_b128 v[124:127], v2 offset:51200
    s_waitcnt lgkmcnt(4)
    v_mfma_f32_16x16x32_bf16 v[148:151], a[52:55], v[104:107], v[148:151]
    v_rsq_f32 v84, v201
    v_mfma_f32_16x16x32_bf16 v[156:159], a[52:55], v[108:111], v[156:159]
    v_mov_b32 v82, v80
    v_mov_b32 v86, v84
    v_mfma_f32_16x16x32_bf16 v[144:147], a[48:51], v[104:107], v[144:147]
    v_permlane32_swap_b32 v80, v82
    v_mfma_f32_16x16x32_bf16 v[152:155], a[48:51], v[108:111], v[152:155]
    s_waitcnt vmcnt(19)
    s_waitcnt lgkmcnt(0)
    buffer_load_dwordx4 a[188:191], v1, s[8:11], s26 offen offset:3072 sc1
    s_add_u32 s26, s23, 8192
    buffer_load_dwordx4 a[192:195], v1, s[8:11], s26 offen offset:0 sc1
    buffer_load_dwordx4 a[196:199], v1, s[8:11], s26 offen offset:1024 sc1
    buffer_load_dwordx4 a[200:203], v1, s[8:11], s26 offen offset:2048 sc1
    s_waitcnt vmcnt(13)
    s_barrier
    v_mov_b32 v199, 3
    buffer_load_dwordx4 a[204:207], v1, s[8:11], s26 offen offset:3072 sc1
    buffer_store_dword v199, v26, s[8:11], s37 offen sc1
    s_add_u32 s26, s23, 12288
    buffer_load_dwordx4 a[208:211], v1, s[8:11], s26 offen offset:0 sc1
    v_mfma_f32_16x16x32_bf16 v[128:131], a[56:59], v[112:115], v[128:131]
    ds_read_b128 v[96:99], v1 offset:3072
    v_mfma_f32_16x16x32_bf16 v[136:139], a[56:59], v[116:119], v[136:139]
    ds_read_b128 v[100:103], v1 offset:5120
    v_mfma_f32_16x16x32_bf16 v[132:135], a[60:63], v[112:115], v[132:135]
    ds_read_b128 v[104:107], v1 offset:7168
    v_mfma_f32_16x16x32_bf16 v[140:143], a[60:63], v[116:119], v[140:143]
    ds_read_b128 v[108:111], v1 offset:9216
    v_mfma_f32_16x16x32_bf16 v[148:151], a[60:63], v[120:123], v[148:151]
    buffer_load_dwordx4 a[212:215], v1, s[8:11], s26 offen offset:1024 sc1
    v_mfma_f32_16x16x32_bf16 v[156:159], a[60:63], v[124:127], v[156:159]
    v_permlane32_swap_b32 v84, v86
    v_mfma_f32_16x16x32_bf16 v[144:147], a[56:59], v[120:123], v[144:147]
    buffer_load_dwordx4 a[216:219], v1, s[8:11], s26 offen offset:2048 sc1
    v_mfma_f32_16x16x32_bf16 v[152:155], a[56:59], v[124:127], v[152:155]
    v_mov_b32 v81, v80
    s_waitcnt lgkmcnt(2)
    v_mfma_f32_16x16x32_bf16 v[128:131], a[64:67], v[96:99], v[128:131]
    ds_read_b128 v[112:115], v1 offset:4096
    v_mov_b32 v83, v82
    v_mfma_f32_16x16x32_bf16 v[136:139], a[64:67], v[100:103], v[136:139]
    ds_read_b128 v[116:119], v1 offset:6144
    v_mov_b32 v85, v84
    v_mfma_f32_16x16x32_bf16 v[132:135], a[68:71], v[96:99], v[132:135]
    ds_read_b128 v[120:123], v1 offset:8192
    v_mov_b32 v87, v86
    v_mfma_f32_16x16x32_bf16 v[140:143], a[68:71], v[100:103], v[140:143]
    ds_read_b128 v[124:127], v1 offset:10240
    s_waitcnt lgkmcnt(4)
    v_mfma_f32_16x16x32_bf16 v[148:151], a[68:71], v[104:107], v[148:151]
    buffer_load_dwordx4 a[220:223], v1, s[8:11], s26 offen offset:3072 sc1
    v_mfma_f32_16x16x32_bf16 v[156:159], a[68:71], v[108:111], v[156:159]
    s_add_u32 s26, s23, 16384
    v_mfma_f32_16x16x32_bf16 v[144:147], a[64:67], v[104:107], v[144:147]
    buffer_load_dwordx4 a[224:227], v1, s[8:11], s26 offen offset:0 sc1
    v_mfma_f32_16x16x32_bf16 v[152:155], a[64:67], v[108:111], v[152:155]
    s_waitcnt lgkmcnt(2)
    v_mfma_f32_16x16x32_bf16 v[128:131], a[72:75], v[112:115], v[128:131]
    ds_read_b128 v[96:99], v1 offset:11264
    v_mfma_f32_16x16x32_bf16 v[136:139], a[72:75], v[116:119], v[136:139]
    ds_read_b128 v[100:103], v1 offset:13312
    v_mfma_f32_16x16x32_bf16 v[132:135], a[76:79], v[112:115], v[132:135]
    ds_read_b128 v[104:107], v1 offset:15360
    v_mfma_f32_16x16x32_bf16 v[140:143], a[76:79], v[116:119], v[140:143]
    ds_read_b128 v[108:111], v1 offset:17408
    s_waitcnt lgkmcnt(4)
    v_mfma_f32_16x16x32_bf16 v[148:151], a[76:79], v[120:123], v[148:151]
    buffer_load_dwordx4 a[228:231], v1, s[8:11], s26 offen offset:1024 sc1
    v_mfma_f32_16x16x32_bf16 v[156:159], a[76:79], v[124:127], v[156:159]
    v_permlane16_swap_b32 v80, v81
    v_mfma_f32_16x16x32_bf16 v[144:147], a[72:75], v[120:123], v[144:147]
    v_permlane16_swap_b32 v82, v83
    v_mfma_f32_16x16x32_bf16 v[152:155], a[72:75], v[124:127], v[152:155]
    s_waitcnt lgkmcnt(2)
    v_mfma_f32_16x16x32_bf16 v[128:131], a[80:83], v[96:99], v[128:131]
    ds_read_b128 v[112:115], v1 offset:12288
    v_mfma_f32_16x16x32_bf16 v[136:139], a[80:83], v[100:103], v[136:139]
    ds_read_b128 v[116:119], v1 offset:14336
    v_mfma_f32_16x16x32_bf16 v[132:135], a[84:87], v[96:99], v[132:135]
    ds_read_b128 v[120:123], v1 offset:16384
    v_mfma_f32_16x16x32_bf16 v[140:143], a[84:87], v[100:103], v[140:143]
    ds_read_b128 v[124:127], v1 offset:18432
    s_waitcnt lgkmcnt(4)
    v_mfma_f32_16x16x32_bf16 v[148:151], a[84:87], v[104:107], v[148:151]
    v_permlane16_swap_b32 v84, v85
    v_mfma_f32_16x16x32_bf16 v[156:159], a[84:87], v[108:111], v[156:159]
    buffer_load_dwordx4 a[232:235], v1, s[8:11], s26 offen offset:2048 sc1
    v_mfma_f32_16x16x32_bf16 v[144:147], a[80:83], v[104:107], v[144:147]
    buffer_load_dwordx4 a[236:239], v1, s[8:11], s26 offen offset:3072 sc1
    v_mfma_f32_16x16x32_bf16 v[152:155], a[80:83], v[108:111], v[152:155]
    s_add_u32 s26, s23, 20480
    s_waitcnt lgkmcnt(2)
    v_mfma_f32_16x16x32_bf16 v[128:131], a[88:91], v[112:115], v[128:131]
    ds_read_b128 v[96:99], v1 offset:19456
    v_mfma_f32_16x16x32_bf16 v[136:139], a[88:91], v[116:119], v[136:139]
    ds_read_b128 v[100:103], v1 offset:21504
    v_mfma_f32_16x16x32_bf16 v[132:135], a[92:95], v[112:115], v[132:135]
    ds_read_b128 v[104:107], v1 offset:23552
    v_mfma_f32_16x16x32_bf16 v[140:143], a[92:95], v[116:119], v[140:143]
    ds_read_b128 v[108:111], v1 offset:25600
    s_waitcnt lgkmcnt(4)
    v_mfma_f32_16x16x32_bf16 v[148:151], a[92:95], v[120:123], v[148:151]
    buffer_load_dwordx4 a[240:243], v1, s[8:11], s26 offen offset:0 sc1
    v_mfma_f32_16x16x32_bf16 v[156:159], a[92:95], v[124:127], v[156:159]
    buffer_load_dwordx4 a[244:247], v1, s[8:11], s26 offen offset:1024 sc1
    v_mfma_f32_16x16x32_bf16 v[144:147], a[88:91], v[120:123], v[144:147]
    buffer_load_dwordx4 a[248:251], v1, s[8:11], s26 offen offset:2048 sc1
    v_mfma_f32_16x16x32_bf16 v[152:155], a[88:91], v[124:127], v[152:155]
    s_waitcnt lgkmcnt(2)
    v_mfma_f32_16x16x32_bf16 v[128:131], a[96:99], v[96:99], v[128:131]
    ds_read_b128 v[112:115], v1 offset:20480
    v_mfma_f32_16x16x32_bf16 v[136:139], a[96:99], v[100:103], v[136:139]
    ds_read_b128 v[116:119], v1 offset:22528
    v_mfma_f32_16x16x32_bf16 v[132:135], a[100:103], v[96:99], v[132:135]
    ds_read_b128 v[120:123], v1 offset:24576
    v_mfma_f32_16x16x32_bf16 v[140:143], a[100:103], v[100:103], v[140:143]
    ds_read_b128 v[124:127], v1 offset:26624
    s_waitcnt lgkmcnt(4)
    v_mfma_f32_16x16x32_bf16 v[148:151], a[100:103], v[104:107], v[148:151]
    buffer_load_dwordx4 a[252:255], v1, s[8:11], s26 offen offset:3072 sc1
    v_mfma_f32_16x16x32_bf16 v[156:159], a[100:103], v[108:111], v[156:159]
    s_add_u32 s26, s23, 24576
    v_mfma_f32_16x16x32_bf16 v[144:147], a[96:99], v[104:107], v[144:147]
    buffer_load_dwordx4 a[0:3], v1, s[8:11], s26 offen offset:0 sc1
    v_mfma_f32_16x16x32_bf16 v[152:155], a[96:99], v[108:111], v[152:155]
    s_waitcnt lgkmcnt(0)
    s_barrier
    v_mfma_f32_16x16x32_bf16 v[128:131], a[104:107], v[112:115], v[128:131]
    ds_read_b128 v[96:99], v1 offset:27648
    v_mfma_f32_16x16x32_bf16 v[136:139], a[104:107], v[116:119], v[136:139]
    ds_read_b128 v[100:103], v1 offset:29696
    v_mfma_f32_16x16x32_bf16 v[132:135], a[108:111], v[112:115], v[132:135]
    ds_read_b128 v[104:107], v1 offset:31744
    s_add_u32 s26, s24, 0
    v_mfma_f32_16x16x32_bf16 v[140:143], a[108:111], v[116:119], v[140:143]
    ds_read_b128 v[108:111], v1 offset:33792
    v_mfma_f32_16x16x32_bf16 v[148:151], a[108:111], v[120:123], v[148:151]
    buffer_load_dwordx4 a[4:7], v1, s[8:11], s26 offen offset:0 sc1
    v_mfma_f32_16x16x32_bf16 v[156:159], a[108:111], v[124:127], v[156:159]
    buffer_load_dwordx4 a[8:11], v1, s[8:11], s26 offen offset:1024 sc1
    v_mfma_f32_16x16x32_bf16 v[144:147], a[104:107], v[120:123], v[144:147]
    v_permlane16_swap_b32 v86, v87
    v_mfma_f32_16x16x32_bf16 v[152:155], a[104:107], v[124:127], v[152:155]
    s_waitcnt lgkmcnt(2)
    v_mfma_f32_16x16x32_bf16 v[128:131], a[112:115], v[96:99], v[128:131]
    ds_read_b128 v[112:115], v1 offset:28672
    v_mfma_f32_16x16x32_bf16 v[136:139], a[112:115], v[100:103], v[136:139]
    ds_read_b128 v[116:119], v1 offset:30720
    v_mfma_f32_16x16x32_bf16 v[132:135], a[116:119], v[96:99], v[132:135]
    ds_read_b128 v[120:123], v1 offset:32768
    v_mfma_f32_16x16x32_bf16 v[140:143], a[116:119], v[100:103], v[140:143]
    ds_read_b128 v[124:127], v1 offset:34816
    s_waitcnt lgkmcnt(4)
    v_mfma_f32_16x16x32_bf16 v[148:151], a[116:119], v[104:107], v[148:151]
    buffer_load_dwordx4 a[12:15], v1, s[8:11], s26 offen offset:2048 sc1
    v_mfma_f32_16x16x32_bf16 v[156:159], a[116:119], v[108:111], v[156:159]
    v_mfma_f32_16x16x32_bf16 v[144:147], a[112:115], v[104:107], v[144:147]
    v_mfma_f32_16x16x32_bf16 v[152:155], a[112:115], v[108:111], v[152:155]
    buffer_load_dword v27, v25, s[8:11], s38 offen sc1
    s_waitcnt lgkmcnt(2)
    v_mfma_f32_16x16x32_bf16 v[128:131], a[120:123], v[112:115], v[128:131]
    ds_read_b128 v[96:99], v1 offset:35840
    v_mfma_f32_16x16x32_bf16 v[136:139], a[120:123], v[116:119], v[136:139]
    ds_read_b128 v[100:103], v1 offset:37888
    v_mfma_f32_16x16x32_bf16 v[132:135], a[124:127], v[112:115], v[132:135]
    ds_read_b128 v[104:107], v1 offset:39936
    v_mfma_f32_16x16x32_bf16 v[140:143], a[124:127], v[116:119], v[140:143]
    ds_read_b128 v[108:111], v1 offset:41984
    s_waitcnt lgkmcnt(4)
    v_mfma_f32_16x16x32_bf16 v[148:151], a[124:127], v[120:123], v[148:151]
    buffer_load_dwordx4 a[16:19], v1, s[8:11], s26 offen offset:3072 sc1
    v_mfma_f32_16x16x32_bf16 v[156:159], a[124:127], v[124:127], v[156:159]
    s_add_u32 s26, s24, 4096
    v_mfma_f32_16x16x32_bf16 v[144:147], a[120:123], v[120:123], v[144:147]
    buffer_load_dwordx4 a[20:23], v1, s[8:11], s26 offen offset:0 sc1
    v_mfma_f32_16x16x32_bf16 v[152:155], a[120:123], v[124:127], v[152:155]
    s_waitcnt lgkmcnt(2)
    v_mfma_f32_16x16x32_bf16 v[128:131], a[128:131], v[96:99], v[128:131]
    ds_read_b128 v[112:115], v1 offset:36864
    v_mfma_f32_16x16x32_bf16 v[136:139], a[128:131], v[100:103], v[136:139]
    ds_read_b128 v[116:119], v1 offset:38912
    v_mfma_f32_16x16x32_bf16 v[132:135], a[132:135], v[96:99], v[132:135]
    ds_read_b128 v[120:123], v1 offset:40960
    v_mfma_f32_16x16x32_bf16 v[140:143], a[132:135], v[100:103], v[140:143]
    ds_read_b128 v[124:127], v1 offset:43008
    s_waitcnt lgkmcnt(4)
    v_mfma_f32_16x16x32_bf16 v[148:151], a[132:135], v[104:107], v[148:151]
    buffer_load_dwordx4 a[24:27], v1, s[8:11], s26 offen offset:1024 sc1
    v_mfma_f32_16x16x32_bf16 v[156:159], a[132:135], v[108:111], v[156:159]
    buffer_load_dwordx4 a[28:31], v1, s[8:11], s26 offen offset:2048 sc1
    v_mfma_f32_16x16x32_bf16 v[144:147], a[128:131], v[104:107], v[144:147]
    buffer_load_dwordx4 a[32:35], v1, s[8:11], s26 offen offset:3072 sc1
    v_mfma_f32_16x16x32_bf16 v[152:155], a[128:131], v[108:111], v[152:155]
    s_waitcnt lgkmcnt(2)
    v_mfma_f32_16x16x32_bf16 v[128:131], a[136:139], v[112:115], v[128:131]
    ds_read_b128 v[96:99], v1 offset:44032
    v_mfma_f32_16x16x32_bf16 v[136:139], a[136:139], v[116:119], v[136:139]
    ds_read_b128 v[100:103], v1 offset:46080
    v_mfma_f32_16x16x32_bf16 v[132:135], a[140:143], v[112:115], v[132:135]
    ds_read_b128 v[104:107], v1 offset:48128
    s_add_u32 s26, s24, 8192
    v_mfma_f32_16x16x32_bf16 v[140:143], a[140:143], v[116:119], v[140:143]
    ds_read_b128 v[108:111], v1 offset:50176
    s_waitcnt lgkmcnt(4)
    v_mfma_f32_16x16x32_bf16 v[148:151], a[140:143], v[120:123], v[148:151]
    buffer_load_dwordx4 a[36:39], v1, s[8:11], s26 offen offset:0 sc1
    v_mfma_f32_16x16x32_bf16 v[156:159], a[140:143], v[124:127], v[156:159]
    buffer_load_dwordx4 a[40:43], v1, s[8:11], s26 offen offset:1024 sc1
    v_mfma_f32_16x16x32_bf16 v[144:147], a[136:139], v[120:123], v[144:147]
    v_mfma_f32_16x16x32_bf16 v[152:155], a[136:139], v[124:127], v[152:155]
    s_waitcnt lgkmcnt(2)
    v_mfma_f32_16x16x32_bf16 v[128:131], a[144:147], v[96:99], v[128:131]
    ds_read_b128 v[112:115], v1 offset:45056
    v_mfma_f32_16x16x32_bf16 v[136:139], a[144:147], v[100:103], v[136:139]
    ds_read_b128 v[116:119], v1 offset:47104
    v_mfma_f32_16x16x32_bf16 v[132:135], a[148:151], v[96:99], v[132:135]
    ds_read_b128 v[120:123], v1 offset:49152
    v_mfma_f32_16x16x32_bf16 v[140:143], a[148:151], v[100:103], v[140:143]
    ds_read_b128 v[124:127], v1 offset:51200
    s_waitcnt lgkmcnt(4)
    v_mfma_f32_16x16x32_bf16 v[148:151], a[148:151], v[104:107], v[148:151]
    buffer_load_dwordx4 a[44:47], v1, s[8:11], s26 offen offset:2048 sc1
    v_mfma_f32_16x16x32_bf16 v[156:159], a[148:151], v[108:111], v[156:159]
    v_mfma_f32_16x16x32_bf16 v[144:147], a[144:147], v[104:107], v[144:147]
    buffer_load_dwordx4 a[48:51], v1, s[8:11], s26 offen offset:3072 sc1
    v_mfma_f32_16x16x32_bf16 v[152:155], a[144:147], v[108:111], v[152:155]
    s_waitcnt lgkmcnt(2)
    v_mfma_f32_16x16x32_bf16 v[128:131], a[152:155], v[112:115], v[128:131]
    v_mfma_f32_16x16x32_bf16 v[136:139], a[152:155], v[116:119], v[136:139]
    v_mfma_f32_16x16x32_bf16 v[132:135], a[156:159], v[112:115], v[132:135]
    s_add_u32 s26, s24, 12288
    v_mfma_f32_16x16x32_bf16 v[140:143], a[156:159], v[116:119], v[140:143]
    s_waitcnt lgkmcnt(0)
    v_mfma_f32_16x16x32_bf16 v[148:151], a[156:159], v[120:123], v[148:151]
    buffer_load_dwordx4 a[52:55], v1, s[8:11], s26 offen offset:0 sc1
    v_mfma_f32_16x16x32_bf16 v[156:159], a[156:159], v[124:127], v[156:159]
    v_mfma_f32_16x16x32_bf16 v[144:147], a[152:155], v[120:123], v[144:147]
    v_mfma_f32_16x16x32_bf16 v[152:155], a[152:155], v[124:127], v[152:155]
    s_waitcnt vmcnt(10)
    v_cmp_le_u32 vcc, 3, v27
    s_nop 3
    s_cmp_eq_u64 vcc, -1
    s_cbranch_scc1 L_pdone_2
    s_mov_b32 s68, 0x80000
L_poll_1:
    buffer_load_dword v27, v25, s[8:11], s38 offen sc1
    s_waitcnt vmcnt(0)
    v_cmp_le_u32 vcc, 3, v27
    s_nop 3
    s_cmp_eq_u64 vcc, -1
    s_cbranch_scc1 L_pdone_2
    s_sub_u32 s68, s68, 1
    s_cmp_lg_u32 s68, 0
    s_cbranch_scc1 L_poll_1
L_pdone_2:
    v_pk_fma_f32 v[128:129], v[80:81], v[44:45], v[128:129] op_sel:[0,0,0] op_sel_hi:[0,1,1] neg_lo:[1,0,0] neg_hi:[1,0,0]
    s_add_u32 s88, s30, 9441280
    s_add_u32 s88, s88, s8
    s_addc_u32 s89, s52, 0
    global_load_dwordx4 v[216:219], v1, s[88:89] offset:-4096 sc1
    v_pk_fma_f32 v[130:131], v[80:81], v[46:47], v[130:131] op_sel:[0,0,0] op_sel_hi:[0,1,1] neg_lo:[1,0,0] neg_hi:[1,0,0]
    s_add_u32 s90, s30, 9461760
    s_add_u32 s90, s90, s8
    s_addc_u32 s91, s52, 0
    global_load_dwordx4 v[220:223], v1, s[90:91] offset:-4096 sc1
    v_pk_mul_f32 v[128:129], v[84:85], v[128:129] op_sel:[0,0] op_sel_hi:[0,1]
    global_load_dwordx4 v[224:227], v1, s[88:89] offset:-3072 sc1
    v_pk_mul_f32 v[130:131], v[84:85], v[130:131] op_sel:[0,0] op_sel_hi:[0,1]
    global_load_dwordx4 v[228:231], v1, s[90:91] offset:-3072 sc1
    v_cvt_pk_bf16_f32 v128, v128, v129
    v_cvt_pk_bf16_f32 v129, v130, v131
    ds_write_b64 v9, v[128:129] offset:0
    v_pk_fma_f32 v[132:133], v[80:81], v[48:49], v[132:133] op_sel:[0,0,0] op_sel_hi:[0,1,1] neg_lo:[1,0,0] neg_hi:[1,0,0]
    v_pk_fma_f32 v[134:135], v[80:81], v[50:51], v[134:135] op_sel:[0,0,0] op_sel_hi:[0,1,1] neg_lo:[1,0,0] neg_hi:[1,0,0]
    v_pk_mul_f32 v[132:133], v[84:85], v[132:133] op_sel:[0,0] op_sel_hi:[0,1]
    v_pk_mul_f32 v[134:135], v[84:85], v[134:135] op_sel:[0,0] op_sel_hi:[0,1]
    v_cvt_pk_bf16_f32 v132, v132, v133
    v_cvt_pk_bf16_f32 v133, v134, v135
    ds_write_b64 v9, v[132:133] offset:32
    global_load_dwordx4 v[232:235], v1, s[88:89] offset:-2048 sc1
    v_pk_fma_f32 v[136:137], v[80:81], v[44:45], v[136:137] op_sel:[1,0,0] op_sel_hi:[1,1,1] neg_lo:[1,0,0] neg_hi:[1,0,0]
    v_pk_fma_f32 v[138:139], v[80:81], v[46:47], v[138:139] op_sel:[1,0,0] op_sel_hi:[1,1,1] neg_lo:[1,0,0] neg_hi:[1,0,0]
    v_pk_mul_f32 v[136:137], v[84:85], v[136:137] op_sel:[1,0] op_sel_hi:[1,1]
    v_pk_mul_f32 v[138:139], v[84:85], v[138:139] op_sel:[1,0] op_sel_hi:[1,1]
    v_cvt_pk_bf16_f32 v136, v136, v137
    v_cvt_pk_bf16_f32 v137, v138, v139
    ds_write_b64 v9, v[136:137] offset:10880
    v_pk_fma_f32 v[140:141], v[80:81], v[48:49], v[140:141] op_sel:[1,0,0] op_sel_hi:[1,1,1] neg_lo:[1,0,0] neg_hi:[1,0,0]
    v_pk_fma_f32 v[142:143], v[80:81], v[50:51], v[142:143] op_sel:[1,0,0] op_sel_hi:[1,1,1] neg_lo:[1,0,0] neg_hi:[1,0,0]
    v_pk_mul_f32 v[140:141], v[84:85], v[140:141] op_sel:[1,0] op_sel_hi:[1,1]
    v_pk_mul_f32 v[142:143], v[84:85], v[142:143] op_sel:[1,0] op_sel_hi:[1,1]
    v_cvt_pk_bf16_f32 v140, v140, v141
    v_cvt_pk_bf16_f32 v141, v142, v143
    ds_write_b64 v9, v[140:141] offset:10912
    v_pk_fma_f32 v[144:145], v[82:83], v[44:45], v[144:145] op_sel:[0,0,0] op_sel_hi:[0,1,1] neg_lo:[1,0,0] neg_hi:[1,0,0]
    v_pk_fma_f32 v[146:147], v[82:83], v[46:47], v[146:147] op_sel:[0,0,0] op_sel_hi:[0,1,1] neg_lo:[1,0,0] neg_hi:[1,0,0]
    v_pk_mul_f32 v[144:145], v[86:87], v[144:145] op_sel:[0,0] op_sel_hi:[0,1]
    global_load_dwordx4 v[236:239], v1, s[90:91] offset:-2048 sc1
    v_pk_mul_f32 v[146:147], v[86:87], v[146:147] op_sel:[0,0] op_sel_hi:[0,1]
    v_cvt_pk_bf16_f32 v144, v144, v145
    v_cvt_pk_bf16_f32 v145, v146, v147
    ds_write_b64 v9, v[144:145] offset:4352
    v_pk_fma_f32 v[148:149], v[82:83], v[48:49], v[148:149] op_sel:[0,0,0] op_sel_hi:[0,1,1] neg_lo:[1,0,0] neg_hi:[1,0,0]
    v_pk_fma_f32 v[150:151], v[82:83], v[50:51], v[150:151] op_sel:[0,0,0] op_sel_hi:[0,1,1] neg_lo:[1,0,0] neg_hi:[1,0,0]
    v_pk_mul_f32 v[148:149], v[86:87], v[148:149] op_sel:[0,0] op_sel_hi:[0,1]
    v_pk_mul_f32 v[150:151], v[86:87], v[150:151] op_sel:[0,0] op_sel_hi:[0,1]
    v_cvt_pk_bf16_f32 v148, v148, v149
    v_cvt_pk_bf16_f32 v149, v150, v151
    ds_write_b64 v9, v[148:149] offset:4384
    v_pk_fma_f32 v[152:153], v[82:83], v[44:45], v[152:153] op_sel:[1,0,0] op_sel_hi:[1,1,1] neg_lo:[1,0,0] neg_hi:[1,0,0]
    v_pk_fma_f32 v[154:155], v[82:83], v[46:47], v[154:155] op_sel:[1,0,0] op_sel_hi:[1,1,1] neg_lo:[1,0,0] neg_hi:[1,0,0]
    v_pk_mul_f32 v[152:153], v[86:87], v[152:153] op_sel:[1,0] op_sel_hi:[1,1]
    v_pk_mul_f32 v[154:155], v[86:87], v[154:155] op_sel:[1,0] op_sel_hi:[1,1]
    v_cvt_pk_bf16_f32 v152, v152, v153
    v_cvt_pk_bf16_f32 v153, v154, v155
    global_load_dwordx4 v[240:243], v1, s[88:89] offset:-1024 sc1
    ds_write_b64 v9, v[152:153] offset:15232
    v_pk_fma_f32 v[156:157], v[82:83], v[48:49], v[156:157] op_sel:[1,0,0] op_sel_hi:[1,1,1] neg_lo:[1,0,0] neg_hi:[1,0,0]
    v_pk_fma_f32 v[158:159], v[82:83], v[50:51], v[158:159] op_sel:[1,0,0] op_sel_hi:[1,1,1] neg_lo:[1,0,0] neg_hi:[1,0,0]
    v_pk_mul_f32 v[156:157], v[86:87], v[156:157] op_sel:[1,0] op_sel_hi:[1,1]
    v_pk_mul_f32 v[158:159], v[86:87], v[158:159] op_sel:[1,0] op_sel_hi:[1,1]
    v_cvt_pk_bf16_f32 v156, v156, v157
    v_cvt_pk_bf16_f32 v157, v158, v159
    ds_write_b64 v9, v[156:157] offset:15264
    s_waitcnt lgkmcnt(0)
    s_barrier
    ds_read_b128 v[128:131], v11 offset:0
    ds_read_b128 v[132:135], v13 offset:80
    ds_read_b128 v[136:139], v11 offset:80
    ds_read_b128 v[140:143], v11 offset:32
    ds_read_b128 v[144:147], v13 offset:112
    ds_read_b128 v[148:151], v11 offset:112
    s_waitcnt lgkmcnt(5)
    v_cndmask_b32 v128, 0, v128, s[40:41]
    global_load_dwordx4 v[244:247], v1, s[90:91] offset:-1024 sc1
    v_cndmask_b32 v129, 0, v129, s[40:41]
    v_cndmask_b32 v130, 0, v130, s[42:43]
    v_cndmask_b32 v131, 0, v131, s[42:43]
    s_waitcnt lgkmcnt(3)
    s_nop 0
    v_mfma_f32_16x16x32_bf16 v[96:99], v[132:135], v[128:131], v[32:35]
    v_mfma_f32_16x16x32_bf16 v[100:103], v[136:139], v[128:131], v[36:39]
    s_waitcnt lgkmcnt(2)
    v_cndmask_b32 v140, 0, v140, s[44:45]
    v_cndmask_b32 v141, 0, v141, s[44:45]
    v_cndmask_b32 v142, 0, v142, s[40:41]
    v_cndmask_b32 v143, 0, v143, s[40:41]
    global_load_dwordx4 v[248:251], v1, s[88:89] offset:0 sc1
    s_waitcnt lgkmcnt(0)
    v_mfma_f32_16x16x32_bf16 v[104:107], v[144:147], v[140:143], v[32:35]
    v_mfma_f32_16x16x32_bf16 v[108:111], v[148:151], v[140:143], v[36:39]
    ds_read_b64_tr_b16 v[152:153], v16 offset:160
    ds_read_b64_tr_b16 v[154:155], v14 offset:160
    ds_read_b64_tr_b16 v[156:157], v16 offset:192
    ds_read_b64_tr_b16 v[158:159], v14 offset:192
    v_max3_f32 v120, v96, v97, v98
    v_max3_f32 v121, v100, v101, v102
    v_max3_f32 v120, v120, v99, v103
    v_max_f32 v120, v120, v121
    v_mov_b32 v121, v120
    v_max3_f32 v122, v104, v105, v106
    global_load_dwordx4 v[252:255], v1, s[90:91] offset:0 sc1
    v_max3_f32 v123, v108, v109, v110
    v_max3_f32 v122, v122, v107, v111
    v_max_f32 v122, v122, v123
    v_mov_b32 v123, v122
    v_permlane32_swap_b32 v120, v121
    s_nop 0
    v_permlane32_swap_b32 v122, v123
    v_max_f32 v120, v120, v121
    v_mov_b32 v121, v120
    v_max_f32 v122, v122, v123
    v_mov_b32 v123, v122
    v_permlane16_swap_b32 v120, v121
    s_nop 0
    v_permlane16_swap_b32 v122, v123
    v_max_f32 v120, v120, v121
    v_max_f32 v122, v122, v123
    ds_read_b64_tr_b16 v[160:161], v16 offset:200
    ds_read_b64_tr_b16 v[162:163], v14 offset:200
    ds_read_b64_tr_b16 v[164:165], v16 offset:232
    ds_read_b64_tr_b16 v[166:167], v14 offset:232
    v_mov_b32 v124, s67
    v_mul_f32 v120, v124, v120
    v_mul_f32 v122, v124, v122
    v_pk_fma_f32 v[96:97], v[96:97], v[124:125], v[120:121] op_sel:[0,0,0] op_sel_hi:[1,0,0] neg_lo:[0,0,1] neg_hi:[0,0,1]
    v_pk_fma_f32 v[98:99], v[98:99], v[124:125], v[120:121] op_sel:[0,0,0] op_sel_hi:[1,0,0] neg_lo:[0,0,1] neg_hi:[0,0,1]
    v_pk_fma_f32 v[100:101], v[100:101], v[124:125], v[120:121] op_sel:[0,0,0] op_sel_hi:[1,0,0] neg_lo:[0,0,1] neg_hi:[0,0,1]
    v_pk_fma_f32 v[102:103], v[102:103], v[124:125], v[120:121] op_sel:[0,0,0] op_sel_hi:[1,0,0] neg_lo:[0,0,1] neg_hi:[0,0,1]
    v_pk_fma_f32 v[104:105], v[104:105], v[124:125], v[122:123] op_sel:[0,0,0] op_sel_hi:[1,0,0] neg_lo:[0,0,1] neg_hi:[0,0,1]
    v_pk_fma_f32 v[106:107], v[106:107], v[124:125], v[122:123] op_sel:[0,0,0] op_sel_hi:[1,0,0] neg_lo:[0,0,1] neg_hi:[0,0,1]
    v_pk_fma_f32 v[108:109], v[108:109], v[124:125], v[122:123] op_sel:[0,0,0] op_sel_hi:[1,0,0] neg_lo:[0,0,1] neg_hi:[0,0,1]
    v_pk_fma_f32 v[110:111], v[110:111], v[124:125], v[122:123] op_sel:[0,0,0] op_sel_hi:[1,0,0] neg_lo:[0,0,1] neg_hi:[0,0,1]
    v_exp_f32 v96, v96
    v_exp_f32 v97, v97
    v_exp_f32 v98, v98
    v_exp_f32 v99, v99
    v_exp_f32 v100, v100
    v_exp_f32 v101, v101
    v_exp_f32 v102, v102
    v_exp_f32 v103, v103
    v_cvt_pk_bf16_f32 v112, v96, v97
    v_cvt_pk_bf16_f32 v113, v98, v99
    v_cvt_pk_bf16_f32 v114, v100, v101
    v_cvt_pk_bf16_f32 v115, v102, v103
    s_waitcnt lgkmcnt(4)
    v_exp_f32 v104, v104
    v_exp_f32 v105, v105
    v_mfma_f32_16x16x32_bf16 v[184:187], v[28:31], v[112:115], 0
    v_exp_f32 v106, v106
    v_exp_f32 v107, v107
    v_mfma_f32_16x16x32_bf16 v[176:179], v[152:155], v[112:115], 0
    v_exp_f32 v108, v108
    v_exp_f32 v109, v109
    v_mfma_f32_16x16x32_bf16 v[180:183], v[156:159], v[112:115], 0
    v_exp_f32 v110, v110
    v_exp_f32 v111, v111
    v_cvt_pk_bf16_f32 v116, v104, v105
    v_cvt_pk_bf16_f32 v117, v106, v107
    v_cvt_pk_bf16_f32 v118, v108, v109
    buffer_load_dwordx4 a[56:59], v1, s[8:11], s26 offen offset:1024 sc1
    v_cvt_pk_bf16_f32 v119, v110, v111
    v_rcp_f32 v184, v184
    s_waitcnt lgkmcnt(0)
    v_mfma_f32_16x16x32_bf16 v[196:199], v[28:31], v[116:119], 0
    buffer_load_dwordx4 a[60:63], v1, s[8:11], s26 offen offset:2048 sc1
    v_mul_f32 v176, v184, v176
    buffer_load_dwordx4 a[64:67], v1, s[8:11], s26 offen offset:3072 sc1
    v_mul_f32 v177, v184, v177
    s_add_u32 s26, s24, 16384
    buffer_load_dwordx4 a[68:71], v1, s[8:11], s26 offen offset:0 sc1
    v_mul_f32 v178, v184, v178
    v_mfma_f32_16x16x32_bf16 v[188:191], v[160:163], v[116:119], 0
    v_mul_f32 v179, v184, v179
    v_mul_f32 v180, v184, v180
    v_mul_f32 v181, v184, v181
    v_mfma_f32_16x16x32_bf16 v[192:195], v[164:167], v[116:119], 0
    buffer_load_dwordx4 a[72:75], v1, s[8:11], s26 offen offset:1024 sc1
    v_mul_f32 v182, v184, v182
    v_mul_f32 v183, v184, v183
    v_cvt_pk_bf16_f32 v96, v176, v177
    v_cvt_pk_bf16_f32 v100, v180, v181
    v_cvt_pk_bf16_f32 v97, v178, v179
    v_cvt_pk_bf16_f32 v101, v182, v183
    v_rcp_f32 v196, v196
    s_nop 0
    v_pk_mul_f32 v[188:189], v[196:197], v[188:189] op_sel:[0,0] op_sel_hi:[0,1]
    v_pk_mul_f32 v[192:193], v[196:197], v[192:193] op_sel:[0,0] op_sel_hi:[0,1]
    v_pk_mul_f32 v[190:191], v[196:197], v[190:191] op_sel:[0,0] op_sel_hi:[0,1]
    v_pk_mul_f32 v[194:195], v[196:197], v[194:195] op_sel:[0,0] op_sel_hi:[0,1]
    v_cvt_pk_bf16_f32 v98, v188, v189
    v_cvt_pk_bf16_f32 v102, v192, v193
    v_cvt_pk_bf16_f32 v99, v190, v191
    buffer_load_dwordx4 a[76:79], v1, s[8:11], s26 offen offset:2048 sc1
    v_cvt_pk_bf16_f32 v103, v194, v195
    s_add_u32 s56, s32, 9519104
    buffer_store_dwordx4 v[96:99], v1, s[8:11], s56 offen sc1
    buffer_store_dwordx4 v[100:103], v23, s[8:11], s56 offen offset:1024 sc1
    s_barrier
    s_waitcnt vmcnt(16)
    v_mfma_f32_16x16x32_bf16 v[128:131], a[160:163], v[216:219], 0
    v_mfma_f32_16x16x32_bf16 v[132:135], a[164:167], v[216:219], 0
    v_mfma_f32_16x16x32_bf16 v[136:139], a[168:171], v[216:219], 0
    v_mfma_f32_16x16x32_bf16 v[140:143], a[172:175], v[216:219], 0
    v_mfma_f32_16x16x32_bf16 v[144:147], a[176:179], v[216:219], 0
    v_mfma_f32_16x16x32_bf16 v[148:151], a[160:163], v[220:223], 0
    v_mfma_f32_16x16x32_bf16 v[152:155], a[164:167], v[220:223], 0
    v_mfma_f32_16x16x32_bf16 v[156:159], a[168:171], v[220:223], 0
    buffer_load_dwordx4 a[80:83], v1, s[8:11], s26 offen offset:3072 sc1
    v_mfma_f32_16x16x32_bf16 v[160:163], a[172:175], v[220:223], 0
    v_mfma_f32_16x16x32_bf16 v[164:167], a[176:179], v[220:223], 0
    s_waitcnt vmcnt(15)
    v_mfma_f32_16x16x32_bf16 v[128:131], a[180:183], v[224:227], v[128:131]
    v_mfma_f32_16x16x32_bf16 v[132:135], a[184:187], v[224:227], v[132:135]
    v_mfma_f32_16x16x32_bf16 v[136:139], a[188:191], v[224:227], v[136:139]
    s_add_u32 s26, s24, 20480
    v_mfma_f32_16x16x32_bf16 v[140:143], a[192:195], v[224:227], v[140:143]
    buffer_load_dwordx4 a[84:87], v1, s[8:11], s26 offen offset:0 sc1
    v_mfma_f32_16x16x32_bf16 v[144:147], a[196:199], v[224:227], v[144:147]
    v_mfma_f32_16x16x32_bf16 v[148:151], a[180:183], v[228:231], v[148:151]
    v_mfma_f32_16x16x32_bf16 v[152:155], a[184:187], v[228:231], v[152:155]
    buffer_load_dwordx4 a[88:91], v1, s[8:11], s26 offen offset:1024 sc1
    v_mfma_f32_16x16x32_bf16 v[156:159], a[188:191], v[228:231], v[156:159]
    v_mfma_f32_16x16x32_bf16 v[160:163], a[192:195], v[228:231], v[160:163]
    v_mfma_f32_16x16x32_bf16 v[164:167], a[196:199], v[228:231], v[164:167]
    s_waitcnt vmcnt(16)
    v_mfma_f32_16x16x32_bf16 v[128:131], a[200:203], v[232:235], v[128:131]
    s_waitcnt vmcnt(14)
    v_mfma_f32_16x16x32_bf16 v[128:131], a[220:223], v[240:243], v[128:131]
    s_waitcnt vmcnt(12)
    v_mfma_f32_16x16x32_bf16 v[128:131], a[240:243], v[248:251], v[128:131]
    v_mfma_f32_16x16x32_bf16 v[148:151], a[200:203], v[236:239], v[148:151]
    v_mfma_f32_16x16x32_bf16 v[148:151], a[220:223], v[244:247], v[148:151]
    s_waitcnt vmcnt(11)
    v_mfma_f32_16x16x32_bf16 v[148:151], a[240:243], v[252:255], v[148:151]
    v_mfma_f32_16x16x32_bf16 v[132:135], a[204:207], v[232:235], v[132:135]
    buffer_load_dwordx4 a[92:95], v1, s[8:11], s26 offen offset:2048 sc1
    v_mfma_f32_16x16x32_bf16 v[132:135], a[224:227], v[240:243], v[132:135]
    v_mfma_f32_16x16x32_bf16 v[132:135], a[244:247], v[248:251], v[132:135]
    ds_write_b128 v17, v[128:131] offset:0
    v_mfma_f32_16x16x32_bf16 v[152:155], a[204:207], v[236:239], v[152:155]
    buffer_load_dwordx4 a[96:99], v1, s[8:11], s26 offen offset:3072 sc1
    v_mfma_f32_16x16x32_bf16 v[152:155], a[224:227], v[244:247], v[152:155]
    s_add_u32 s26, s24, 24576
    v_mfma_f32_16x16x32_bf16 v[152:155], a[244:247], v[252:255], v[152:155]
    ds_write_b128 v17, v[148:151] offset:256
    v_mfma_f32_16x16x32_bf16 v[136:139], a[208:211], v[232:235], v[136:139]
    buffer_load_dwordx4 a[100:103], v1, s[8:11], s26 offen offset:0 sc1
    v_mfma_f32_16x16x32_bf16 v[136:139], a[228:231], v[240:243], v[136:139]
    buffer_load_dwordx4 a[104:107], v1, s[8:11], s26 offen offset:1024 sc1
    v_mfma_f32_16x16x32_bf16 v[136:139], a[248:251], v[248:251], v[136:139]
    ds_write_b128 v17, v[132:135] offset:2304
    v_mfma_f32_16x16x32_bf16 v[156:159], a[208:211], v[236:239], v[156:159]
    v_mfma_f32_16x16x32_bf16 v[156:159], a[228:231], v[244:247], v[156:159]
    v_mfma_f32_16x16x32_bf16 v[156:159], a[248:251], v[252:255], v[156:159]
    ds_write_b128 v17, v[152:155] offset:2560
    v_mfma_f32_16x16x32_bf16 v[140:143], a[212:215], v[232:235], v[140:143]
    buffer_load_dwordx4 a[108:111], v1, s[8:11], s26 offen offset:2048 sc1
    v_mfma_f32_16x16x32_bf16 v[140:143], a[232:235], v[240:243], v[140:143]
    v_mfma_f32_16x16x32_bf16 v[140:143], a[252:255], v[248:251], v[140:143]
    ds_write_b128 v17, v[136:139] offset:4608
    v_mfma_f32_16x16x32_bf16 v[160:163], a[212:215], v[236:239], v[160:163]
    buffer_load_dwordx4 a[112:115], v1, s[8:11], s26 offen offset:3072 sc1
    v_mfma_f32_16x16x32_bf16 v[160:163], a[232:235], v[244:247], v[160:163]
    v_mfma_f32_16x16x32_bf16 v[160:163], a[252:255], v[252:255], v[160:163]
    ds_write_b128 v17, v[156:159] offset:4864
    v_mfma_f32_16x16x32_bf16 v[144:147], a[216:219], v[232:235], v[144:147]
    v_mfma_f32_16x16x32_bf16 v[144:147], a[236:239], v[240:243], v[144:147]
    v_mfma_f32_16x16x32_bf16 v[144:147], a[0:3], v[248:251], v[144:147]
    ds_write_b128 v17, v[140:143] offset:6912
    v_mfma_f32_16x16x32_bf16 v[164:167], a[216:219], v[236:239], v[164:167]
    v_mfma_f32_16x16x32_bf16 v[164:167], a[236:239], v[244:247], v[164:167]
    v_mfma_f32_16x16x32_bf16 v[164:167], a[0:3], v[252:255], v[164:167]
    ds_write_b128 v17, v[160:163] offset:7168
    s_nop 2
    ds_write_b128 v17, v[144:147] offset:9216
    s_nop 2
    ds_write_b128 v17, v[164:167] offset:9472
    s_add_u32 s26, s24, 28672
    buffer_load_dwordx4 a[116:119], v1, s[8:11], s26 offen offset:0 sc1
    s_waitcnt lgkmcnt(0)
    buffer_load_dwordx4 a[120:123], v1, s[8:11], s26 offen offset:1024 sc1
    buffer_load_dwordx4 a[124:127], v1, s[8:11], s26 offen offset:2048 sc1
    buffer_load_dwordx4 a[128:131], v1, s[8:11], s26 offen offset:3072 sc1
    s_add_u32 s26, s24, 32768
    buffer_load_dwordx4 a[132:135], v1, s[8:11], s26 offen offset:0 sc1
    buffer_load_dwordx4 a[136:139], v1, s[8:11], s26 offen offset:1024 sc1
    s_waitcnt vmcnt(15)
    s_barrier
    v_mov_b32 v199, 4
    buffer_load_dwordx4 a[140:143], v1, s[8:11], s26 offen offset:2048 sc1
    buffer_store_dword v199, v26, s[8:11], s37 offen sc1
    ds_read_b128 v[128:131], v18 offset:0
    ds_read_b128 v[132:135], v18 offset:576
    ds_read_b128 v[136:139], v18 offset:11520
    ds_read_b128 v[140:143], v18 offset:12096
    ds_read_b128 v[144:147], v18 offset:23040
    ds_read_b128 v[148:151], v18 offset:23616
    ds_read_b128 v[152:155], v18 offset:34560
    ds_read_b128 v[156:159], v18 offset:35136
    s_waitcnt lgkmcnt(4)
    v_pk_add_f32 v[128:129], v[128:129], v[136:137]
    v_pk_add_f32 v[130:131], v[130:131], v[138:139]
    v_pk_add_f32 v[132:133], v[132:133], v[140:141]
    buffer_load_dwordx4 a[144:147], v1, s[8:11], s26 offen offset:3072 sc1
    v_pk_add_f32 v[134:135], v[134:135], v[142:143]
    ds_read_b128 v[160:163], v18 offset:9216
    ds_read_b128 v[164:167], v18 offset:9792
    ds_read_b128 v[176:179], v18 offset:20736
    ds_read_b128 v[180:183], v18 offset:21312
    v_lshlrev_b32 v136, 16, v64
    v_and_b32 v137, 0xffff0000, v64
    v_lshlrev_b32 v138, 16, v65
    v_and_b32 v139, 0xffff0000, v65
    v_lshlrev_b32 v140, 16, v66
    v_and_b32 v141, 0xffff0000, v66
    v_lshlrev_b32 v142, 16, v67
    v_and_b32 v143, 0xffff0000, v67
    s_waitcnt lgkmcnt(4)
    v_pk_add_f32 v[128:129], v[128:129], v[136:137]
    v_pk_add_f32 v[130:131], v[130:131], v[138:139]
    v_pk_add_f32 v[132:133], v[132:133], v[140:141]
    s_add_u32 s26, s24, 36864
    buffer_load_dwordx4 a[148:151], v1, s[8:11], s26 offen offset:0 sc1
    v_pk_add_f32 v[134:135], v[134:135], v[142:143]
    ds_read_b128 v[184:187], v18 offset:32256
    ds_read_b128 v[188:191], v18 offset:32832
    ds_read_b128 v[192:195], v18 offset:43776
    ds_read_b128 v[196:199], v18 offset:44352
    v_pk_add_f32 v[144:145], v[144:145], v[152:153]
    v_pk_add_f32 v[146:147], v[146:147], v[154:155]
    v_pk_add_f32 v[148:149], v[148:149], v[156:157]
    v_pk_add_f32 v[150:151], v[150:151], v[158:159]
    v_pk_add_f32 v[128:129], v[128:129], v[144:145]
    v_pk_add_f32 v[130:131], v[130:131], v[146:147]
    v_pk_add_f32 v[132:133], v[132:133], v[148:149]
    v_pk_add_f32 v[134:135], v[134:135], v[150:151]
    v_cvt_pk_bf16_f32 v64, v128, v129
    v_cvt_pk_bf16_f32 v65, v130, v131
    v_cvt_pk_bf16_f32 v66, v132, v133
    buffer_load_dwordx4 a[152:155], v1, s[8:11], s26 offen offset:1024 sc1
    v_cvt_pk_bf16_f32 v67, v134, v135
    s_add_u32 s56, s35, 27262976
    buffer_store_dwordx4 v[64:67], v8, s[8:11], s56 offen offset:0 sc1
    s_waitcnt lgkmcnt(4)
    v_pk_add_f32 v[160:161], v[160:161], v[176:177]
    v_pk_add_f32 v[162:163], v[162:163], v[178:179]
    v_pk_add_f32 v[164:165], v[164:165], v[180:181]
    v_pk_add_f32 v[166:167], v[166:167], v[182:183]
    v_lshlrev_b32 v176, 16, v68
    v_and_b32 v177, 0xffff0000, v68
    v_lshlrev_b32 v178, 16, v69
    v_and_b32 v179, 0xffff0000, v69
    v_lshlrev_b32 v180, 16, v70
    v_and_b32 v181, 0xffff0000, v70
    v_lshlrev_b32 v182, 16, v71
    v_and_b32 v183, 0xffff0000, v71
    s_waitcnt lgkmcnt(0)
    v_pk_add_f32 v[160:161], v[160:161], v[176:177]
    v_pk_add_f32 v[162:163], v[162:163], v[178:179]
    v_pk_add_f32 v[164:165], v[164:165], v[180:181]
    v_pk_add_f32 v[166:167], v[166:167], v[182:183]
    v_pk_add_f32 v[184:185], v[184:185], v[192:193]
    v_pk_add_f32 v[186:187], v[186:187], v[194:195]
    v_pk_add_f32 v[188:189], v[188:189], v[196:197]
    v_pk_add_f32 v[190:191], v[190:191], v[198:199]
    v_pk_add_f32 v[160:161], v[160:161], v[184:185]
    v_pk_add_f32 v[162:163], v[162:163], v[186:187]
    v_pk_add_f32 v[164:165], v[164:165], v[188:189]
    v_pk_add_f32 v[166:167], v[166:167], v[190:191]
    v_cvt_pk_bf16_f32 v68, v160, v161
    v_cvt_pk_bf16_f32 v69, v162, v163
    v_cvt_pk_bf16_f32 v70, v164, v165
    v_cvt_pk_bf16_f32 v71, v166, v167
    buffer_store_dwordx4 v[68:71], v12, s[8:11], s56 offen offset:2048 sc1
    v_pk_add_f32 v[136:137], v[128:129], v[130:131]
    buffer_load_dwordx4 a[156:159], v1, s[8:11], s26 offen offset:2048 sc1
    v_pk_mul_f32 v[140:141], v[128:129], v[128:129]
    v_pk_add_f32 v[138:139], v[160:161], v[162:163]
    v_pk_mul_f32 v[142:143], v[160:161], v[160:161]
    v_pk_fma_f32 v[140:141], v[130:131], v[130:131], v[140:141] op_sel:[0,0,0] op_sel_hi:[1,1,1]
    v_pk_fma_f32 v[142:143], v[162:163], v[162:163], v[142:143] op_sel:[0,0,0] op_sel_hi:[1,1,1]
    v_pk_add_f32 v[136:137], v[136:137], v[132:133]
    v_pk_fma_f32 v[140:141], v[132:133], v[132:133], v[140:141] op_sel:[0,0,0] op_sel_hi:[1,1,1]
    v_pk_add_f32 v[138:139], v[138:139], v[164:165]
    v_pk_fma_f32 v[142:143], v[164:165], v[164:165], v[142:143] op_sel:[0,0,0] op_sel_hi:[1,1,1]
    v_pk_add_f32 v[136:137], v[136:137], v[134:135]
    v_pk_fma_f32 v[140:141], v[134:135], v[134:135], v[140:141] op_sel:[0,0,0] op_sel_hi:[1,1,1]
    v_pk_add_f32 v[138:139], v[138:139], v[166:167]
    v_pk_fma_f32 v[142:143], v[166:167], v[166:167], v[142:143] op_sel:[0,0,0] op_sel_hi:[1,1,1]
    v_add_f32 v136, v136, v137
    v_add_f32 v138, v138, v139
    v_add_f32 v137, v140, v141
    v_add_f32 v139, v142, v143
    v_cndmask_b32 v138, 0, v138, s[46:47]
    v_cndmask_b32 v139, 0, v139, s[46:47]
    v_pk_add_f32 v[136:137], v[136:137], v[138:139]
    s_nop 1
    v_add_f32_dpp v136, v136, v136 row_ror:8 row_mask:0xf bank_mask:0xf
    v_add_f32_dpp v137, v137, v137 row_ror:8 row_mask:0xf bank_mask:0xf
    v_mov_b32 v138, v136
    v_mov_b32 v139, v137
    s_nop 0
    v_permlane16_swap_b32 v136, v138
    v_permlane16_swap_b32 v137, v139
    v_pk_add_f32 v[136:137], v[136:137], v[138:139]
    v_mov_b32 v138, v136
    v_mov_b32 v139, v137
    s_nop 0
    v_permlane32_swap_b32 v136, v138
    v_permlane32_swap_b32 v137, v139
    v_pk_add_f32 v[136:137], v[136:137], v[138:139]
    s_add_u32 s56, s36, 35258368
    buffer_store_dwordx2 v[136:137], v20, s[8:11], s56 offen sc1
    s_add_u32 s88, s30, 9523200
    s_add_u32 s88, s88, s8
    s_addc_u32 s89, s52, 0
    global_load_dwordx4 v[96:99], v1, s[88:89] offset:-4096 sc1
    s_add_u32 s90, s30, 9543680
    s_add_u32 s90, s90, s8
    s_addc_u32 s91, s52, 0
    global_load_dwordx4 v[100:103], v1, s[90:91] offset:-4096 sc1
    global_load_dwordx4 v[104:107], v1, s[88:89] offset:-3072 sc1
    global_load_dwordx4 v[108:111], v1, s[90:91] offset:-3072 sc1
    global_load_dwordx4 v[112:115], v1, s[88:89] offset:-2048 sc1
    global_load_dwordx4 v[116:119], v1, s[90:91] offset:-2048 sc1
    global_load_dwordx4 v[120:123], v1, s[88:89] offset:-1024 sc1
    global_load_dwordx4 v[124:127], v1, s[90:91] offset:-1024 sc1
    global_load_dwordx4 v[168:171], v1, s[88:89] offset:0 sc1
    global_load_dwordx4 v[172:175], v1, s[90:91] offset:0 sc1
    v_mov_b32 v200, -1
    v_mov_b32 v201, -1
    v_mov_b32 v202, -1
    v_mov_b32 v203, -1
    s_add_u32 s55, s33, 14876672
    buffer_store_dwordx4 v[200:203], v24, s[8:11], s55 offen offset:0 sc1
    s_add_u32 s55, s33, 14876672
    buffer_store_dwordx4 v[200:203], v24, s[8:11], s55 offen offset:256 sc1
    s_add_u32 s55, s33, 14876672
    buffer_store_dwordx4 v[200:203], v24, s[8:11], s55 offen offset:512 sc1
    s_add_u32 s55, s35, 32505856
    buffer_store_dwordx4 v[200:203], v8, s[8:11], s55 offen offset:0 sc1
    s_add_u32 s55, s35, 32505856
    buffer_store_dwordx4 v[200:203], v12, s[8:11], s55 offen offset:2048 sc1
    v_mfma_f32_16x16x32_bf16 v[52:55], a[4:7], v[28:31], 0
    v_mfma_f32_16x16x32_bf16 v[56:59], a[8:11], v[28:31], 0
    v_mfma_f32_16x16x32_bf16 v[60:63], a[12:15], v[28:31], 0
    v_mfma_f32_16x16x32_bf16 v[52:55], a[16:19], v[28:31], v[52:55]
    v_mfma_f32_16x16x32_bf16 v[56:59], a[20:23], v[28:31], v[56:59]
    v_mfma_f32_16x16x32_bf16 v[60:63], a[24:27], v[28:31], v[60:63]
    v_mfma_f32_16x16x32_bf16 v[52:55], a[28:31], v[28:31], v[52:55]
    v_mfma_f32_16x16x32_bf16 v[56:59], a[32:35], v[28:31], v[56:59]
    v_mfma_f32_16x16x32_bf16 v[60:63], a[36:39], v[28:31], v[60:63]
    v_mfma_f32_16x16x32_bf16 v[52:55], a[40:43], v[28:31], v[52:55]
    v_mfma_f32_16x16x32_bf16 v[56:59], a[44:47], v[28:31], v[56:59]
    v_mfma_f32_16x16x32_bf16 v[60:63], a[48:51], v[28:31], v[60:63]
    v_mfma_f32_16x16x32_bf16 v[52:55], a[52:55], v[28:31], v[52:55]
    v_mfma_f32_16x16x32_bf16 v[56:59], a[56:59], v[28:31], v[56:59]
    v_mfma_f32_16x16x32_bf16 v[60:63], a[60:63], v[28:31], v[60:63]
    s_waitcnt vmcnt(15)
    s_barrier
    v_mov_b32 v199, 5
    buffer_store_dword v199, v26, s[8:11], s37 offen sc1
    s_waitcnt vmcnt(14)
    v_max_u32 v3, v96, v100
    v_cmp_eq_u32 vcc, -1, v3
    s_nop 3
    s_cbranch_vccnz L_fix_3
L_fixed_4:
    v_mfma_f32_16x16x32_bf16 v[128:131], a[160:163], v[96:99], 0
    v_mfma_f32_16x16x32_bf16 v[132:135], a[164:167], v[96:99], 0
    v_mfma_f32_16x16x32_bf16 v[136:139], a[168:171], v[96:99], 0
    v_mfma_f32_16x16x32_bf16 v[140:143], a[172:175], v[96:99], 0
    v_mfma_f32_16x16x32_bf16 v[144:147], a[176:179], v[96:99], 0
    s_waitcnt vmcnt(12)
    v_max_u32 v3, v104, v108
    v_cmp_eq_u32 vcc, -1, v3
    v_mfma_f32_16x16x32_bf16 v[148:151], a[160:163], v[100:103], 0
    v_mfma_f32_16x16x32_bf16 v[152:155], a[164:167], v[100:103], 0
    v_mfma_f32_16x16x32_bf16 v[156:159], a[168:171], v[100:103], 0
    v_mfma_f32_16x16x32_bf16 v[160:163], a[172:175], v[100:103], 0
    s_cbranch_vccnz L_fix_7
L_fixed_8:
    v_mfma_f32_16x16x32_bf16 v[164:167], a[176:179], v[100:103], 0
    v_mfma_f32_16x16x32_bf16 v[128:131], a[180:183], v[104:107], v[128:131]
    buffer_load_dwordx4 a[160:163], v1, s[8:11], s26 offen offset:3072 sc1
    v_mfma_f32_16x16x32_bf16 v[132:135], a[184:187], v[104:107], v[132:135]
    s_add_u32 s26, s24, 40960
    v_mfma_f32_16x16x32_bf16 v[136:139], a[188:191], v[104:107], v[136:139]
    buffer_load_dwordx4 a[164:167], v1, s[8:11], s26 offen offset:0 sc1
    v_mfma_f32_16x16x32_bf16 v[140:143], a[192:195], v[104:107], v[140:143]
    buffer_load_dwordx4 a[168:171], v1, s[8:11], s26 offen offset:1024 sc1
    v_mfma_f32_16x16x32_bf16 v[144:147], a[196:199], v[104:107], v[144:147]
    s_waitcnt vmcnt(9)
    v_max3_u32 v3, v112, v116, v120
    v_max3_u32 v3, v3, v124, v168
    v_max_u32 v3, v3, v172
    v_cmp_eq_u32 vcc, -1, v3
    v_mfma_f32_16x16x32_bf16 v[148:151], a[180:183], v[108:111], v[148:151]
    buffer_load_dwordx4 a[172:175], v1, s[8:11], s26 offen offset:2048 sc1
    v_mfma_f32_16x16x32_bf16 v[152:155], a[184:187], v[108:111], v[152:155]
    buffer_load_dwordx4 a[176:179], v1, s[8:11], s26 offen offset:3072 sc1
    v_mfma_f32_16x16x32_bf16 v[156:159], a[188:191], v[108:111], v[156:159]
    v_mfma_f32_16x16x32_bf16 v[160:163], a[192:195], v[108:111], v[160:163]
    s_cbranch_vccnz L_fix_11
L_fixed_12:
    v_mfma_f32_16x16x32_bf16 v[164:167], a[196:199], v[108:111], v[164:167]
    v_mfma_f32_16x16x32_bf16 v[128:131], a[200:203], v[112:115], v[128:131]
    s_add_u32 m0, s28, 52224
    s_add_u32 s49, s48, 27262976
    v_mfma_f32_16x16x32_bf16 v[128:131], a[220:223], v[120:123], v[128:131]
    buffer_load_dwordx4 v1, s[8:11], s49 offen offset:0 sc1 lds
    v_mfma_f32_16x16x32_bf16 v[128:131], a[240:243], v[168:171], v[128:131]
    v_mfma_f32_16x16x32_bf16 v[148:151], a[200:203], v[116:119], v[148:151]
    v_mfma_f32_16x16x32_bf16 v[148:151], a[220:223], v[124:127], v[148:151]
    v_mfma_f32_16x16x32_bf16 v[148:151], a[240:243], v[172:175], v[148:151]
    v_mfma_f32_16x16x32_bf16 v[132:135], a[204:207], v[112:115], v[132:135]
    v_mfma_f32_16x16x32_bf16 v[132:135], a[224:227], v[120:123], v[132:135]
    v_mfma_f32_16x16x32_bf16 v[132:135], a[244:247], v[168:171], v[132:135]
    s_nop 1
    ds_write_b128 v17, v[128:131] offset:0
    v_mfma_f32_16x16x32_bf16 v[152:155], a[204:207], v[116:119], v[152:155]
    v_mfma_f32_16x16x32_bf16 v[152:155], a[224:227], v[124:127], v[152:155]
    v_mfma_f32_16x16x32_bf16 v[152:155], a[244:247], v[172:175], v[152:155]
    ds_write_b128 v17, v[148:151] offset:256
    v_mfma_f32_16x16x32_bf16 v[136:139], a[208:211], v[112:115], v[136:139]
    v_mfma_f32_16x16x32_bf16 v[136:139], a[228:231], v[120:123], v[136:139]
    v_mfma_f32_16x16x32_bf16 v[136:139], a[248:251], v[168:171], v[136:139]
    ds_write_b128 v17, v[132:135] offset:2304
    v_mfma_f32_16x16x32_bf16 v[156:159], a[208:211], v[116:119], v[156:159]
    v_mfma_f32_16x16x32_bf16 v[156:159], a[228:231], v[124:127], v[156:159]
    v_mfma_f32_16x16x32_bf16 v[156:159], a[248:251], v[172:175], v[156:159]
    ds_write_b128 v17, v[152:155] offset:2560
    v_mfma_f32_16x16x32_bf16 v[140:143], a[212:215], v[112:115], v[140:143]
    v_mfma_f32_16x16x32_bf16 v[140:143], a[232:235], v[120:123], v[140:143]
    v_mfma_f32_16x16x32_bf16 v[140:143], a[252:255], v[168:171], v[140:143]
    ds_write_b128 v17, v[136:139] offset:4608
    v_mfma_f32_16x16x32_bf16 v[160:163], a[212:215], v[116:119], v[160:163]
    v_mfma_f32_16x16x32_bf16 v[160:163], a[232:235], v[124:127], v[160:163]
    v_mfma_f32_16x16x32_bf16 v[160:163], a[252:255], v[172:175], v[160:163]
    ds_write_b128 v17, v[156:159] offset:4864
    v_mfma_f32_16x16x32_bf16 v[144:147], a[216:219], v[112:115], v[144:147]
    s_add_u32 m0, s28, 52224
    v_mfma_f32_16x16x32_bf16 v[144:147], a[236:239], v[120:123], v[144:147]
    buffer_load_dwordx4 v1, s[8:11], s49 offen offset:1024 sc1 lds
    v_mfma_f32_16x16x32_bf16 v[144:147], a[0:3], v[168:171], v[144:147]
    ds_write_b128 v17, v[140:143] offset:6912
    s_add_u32 m0, s28, 58368
    v_mfma_f32_16x16x32_bf16 v[164:167], a[216:219], v[116:119], v[164:167]
    buffer_load_dwordx4 v1, s[8:11], s49 offen offset:2048 sc1 lds
    v_mfma_f32_16x16x32_bf16 v[164:167], a[236:239], v[124:127], v[164:167]
    s_add_u32 m0, s28, 58368
    v_mfma_f32_16x16x32_bf16 v[164:167], a[0:3], v[172:175], v[164:167]
    ds_write_b128 v17, v[160:163] offset:7168
    ds_write_b128 v17, v[144:147] offset:9216
    buffer_load_dwordx4 v1, s[8:11], s49 offen offset:3072 sc1 lds
    s_nop 4
    ds_write_b128 v17, v[164:167] offset:9472
    s_add_u32 m0, s28, 68608
    s_add_u32 s49, s48, 27267072
    buffer_load_dwordx4 v1, s[8:11], s49 offen offset:0 sc1 lds
    buffer_load_dword v27, v25, s[8:11], s38 offen sc1
    s_add_u32 m0, s28, 68608
    s_nop 0
    buffer_load_dwordx4 v1, s[8:11], s49 offen offset:1024 sc1 lds
    s_waitcnt lgkmcnt(0)
    s_barrier
    ds_read_b128 v[128:131], v18 offset:0
    s_add_u32 m0, s28, 74752
    s_nop 0
    buffer_load_dwordx4 v1, s[8:11], s49 offen offset:2048 sc1 lds
    ds_read_b128 v[132:135], v18 offset:576
    s_add_u32 m0, s28, 74752
    s_nop 0
    buffer_load_dwordx4 v1, s[8:11], s49 offen offset:3072 sc1 lds
    ds_read_b128 v[136:139], v18 offset:11520
    s_add_u32 s26, s24, 45056
    buffer_load_dwordx4 a[180:183], v1, s[8:11], s26 offen offset:0 sc1
    ds_read_b128 v[140:143], v18 offset:12096
    ds_read_b128 v[144:147], v18 offset:23040
    buffer_load_dwordx4 a[184:187], v1, s[8:11], s26 offen offset:1024 sc1
    ds_read_b128 v[148:151], v18 offset:23616
    ds_read_b128 v[152:155], v18 offset:34560
    ds_read_b128 v[156:159], v18 offset:35136
    s_waitcnt lgkmcnt(4)
    v_pk_add_f32 v[128:129], v[128:129], v[136:137]
    v_pk_add_f32 v[130:131], v[130:131], v[138:139]
    v_pk_add_f32 v[132:133], v[132:133], v[140:141]
    v_pk_add_f32 v[134:135], v[134:135], v[142:143]
    ds_read_b128 v[160:163], v18 offset:9216
    ds_read_b128 v[164:167], v18 offset:9792
    ds_read_b128 v[176:179], v18 offset:20736
    ds_read_b128 v[180:183], v18 offset:21312
    v_lshlrev_b32 v136, 16, v72
    v_and_b32 v137, 0xffff0000, v72
    v_lshlrev_b32 v138, 16, v73
    v_and_b32 v139, 0xffff0000, v73
    v_lshlrev_b32 v140, 16, v74
    v_and_b32 v141, 0xffff0000, v74
    v_lshlrev_b32 v142, 16, v75
    v_and_b32 v143, 0xffff0000, v75
    s_waitcnt lgkmcnt(4)
    v_pk_add_f32 v[128:129], v[128:129], v[136:137]
    v_pk_add_f32 v[130:131], v[130:131], v[138:139]
    v_pk_add_f32 v[132:133], v[132:133], v[140:141]
    v_pk_add_f32 v[134:135], v[134:135], v[142:143]
    ds_read_b128 v[184:187], v18 offset:32256
    ds_read_b128 v[188:191], v18 offset:32832
    ds_read_b128 v[192:195], v18 offset:43776
    ds_read_b128 v[196:199], v18 offset:44352
    v_pk_add_f32 v[144:145], v[144:145], v[152:153]
    v_pk_add_f32 v[146:147], v[146:147], v[154:155]
    v_pk_add_f32 v[148:149], v[148:149], v[156:157]
    v_pk_add_f32 v[150:151], v[150:151], v[158:159]
    v_pk_add_f32 v[128:129], v[128:129], v[144:145]
    v_pk_add_f32 v[130:131], v[130:131], v[146:147]
    v_pk_add_f32 v[132:133], v[132:133], v[148:149]
    v_pk_add_f32 v[134:135], v[134:135], v[150:151]
    v_cvt_pk_bf16_f32 v72, v128, v129
    v_cvt_pk_bf16_f32 v73, v130, v131
    v_cvt_pk_bf16_f32 v74, v132, v133
    v_cvt_pk_bf16_f32 v75, v134, v135
    s_add_u32 s56, s35, 27344896
    buffer_store_dwordx4 v[72:75], v8, s[8:11], s56 offen offset:0 sc1
    s_waitcnt lgkmcnt(4)
    v_pk_add_f32 v[160:161], v[160:161], v[176:177]
    v_pk_add_f32 v[162:163], v[162:163], v[178:179]
    v_pk_add_f32 v[164:165], v[164:165], v[180:181]
    v_pk_add_f32 v[166:167], v[166:167], v[182:183]
    v_lshlrev_b32 v176, 16, v76
    v_and_b32 v177, 0xffff0000, v76
    v_lshlrev_b32 v178, 16, v77
    v_and_b32 v179, 0xffff0000, v77
    v_lshlrev_b32 v180, 16, v78
    v_and_b32 v181, 0xffff0000, v78
    v_lshlrev_b32 v182, 16, v79
    v_and_b32 v183, 0xffff0000, v79
    s_waitcnt lgkmcnt(0)
    v_pk_add_f32 v[160:161], v[160:161], v[176:177]
    v_pk_add_f32 v[162:163], v[162:163], v[178:179]
    v_pk_add_f32 v[164:165], v[164:165], v[180:181]
    v_pk_add_f32 v[166:167], v[166:167], v[182:183]
    v_pk_add_f32 v[184:185], v[184:185], v[192:193]
    v_pk_add_f32 v[186:187], v[186:187], v[194:195]
    v_pk_add_f32 v[188:189], v[188:189], v[196:197]
    v_pk_add_f32 v[190:191], v[190:191], v[198:199]
    v_pk_add_f32 v[160:161], v[160:161], v[184:185]
    v_pk_add_f32 v[162:163], v[162:163], v[186:187]
    v_pk_add_f32 v[164:165], v[164:165], v[188:189]
    v_pk_add_f32 v[166:167], v[166:167], v[190:191]
    v_cvt_pk_bf16_f32 v76, v160, v161
    v_cvt_pk_bf16_f32 v77, v162, v163
    v_cvt_pk_bf16_f32 v78, v164, v165
    v_cvt_pk_bf16_f32 v79, v166, v167
    buffer_store_dwordx4 v[76:79], v12, s[8:11], s56 offen offset:2048 sc1
    v_pk_add_f32 v[136:137], v[128:129], v[130:131]
    v_pk_mul_f32 v[140:141], v[128:129], v[128:129]
    v_pk_add_f32 v[138:139], v[160:161], v[162:163]
    v_pk_mul_f32 v[142:143], v[160:161], v[160:161]
    v_pk_fma_f32 v[140:141], v[130:131], v[130:131], v[140:141] op_sel:[0,0,0] op_sel_hi:[1,1,1]
    v_pk_fma_f32 v[142:143], v[162:163], v[162:163], v[142:143] op_sel:[0,0,0] op_sel_hi:[1,1,1]
    v_pk_add_f32 v[136:137], v[136:137], v[132:133]
    v_pk_fma_f32 v[140:141], v[132:133], v[132:133], v[140:141] op_sel:[0,0,0] op_sel_hi:[1,1,1]
    v_pk_add_f32 v[138:139], v[138:139], v[164:165]
    v_pk_fma_f32 v[142:143], v[164:165], v[164:165], v[142:143] op_sel:[0,0,0] op_sel_hi:[1,1,1]
    v_pk_add_f32 v[136:137], v[136:137], v[134:135]
    v_pk_fma_f32 v[140:141], v[134:135], v[134:135], v[140:141] op_sel:[0,0,0] op_sel_hi:[1,1,1]
    v_pk_add_f32 v[138:139], v[138:139], v[166:167]
    v_pk_fma_f32 v[142:143], v[166:167], v[166:167], v[142:143] op_sel:[0,0,0] op_sel_hi:[1,1,1]
    v_add_f32 v136, v136, v137
    v_add_f32 v138, v138, v139
    v_add_f32 v137, v140, v141
    v_add_f32 v139, v142, v143
    v_cndmask_b32 v138, 0, v138, s[46:47]
    v_cndmask_b32 v139, 0, v139, s[46:47]
    v_pk_add_f32 v[136:137], v[136:137], v[138:139]
    s_nop 1
    v_add_f32_dpp v136, v136, v136 row_ror:8 row_mask:0xf bank_mask:0xf
    v_add_f32_dpp v137, v137, v137 row_ror:8 row_mask:0xf bank_mask:0xf
    v_mov_b32 v138, v136
    v_mov_b32 v139, v137
    s_nop 0
    v_permlane16_swap_b32 v136, v138
    v_permlane16_swap_b32 v137, v139
    v_pk_add_f32 v[136:137], v[136:137], v[138:139]
    v_mov_b32 v138, v136
    v_mov_b32 v139, v137
    s_nop 0
    v_permlane32_swap_b32 v136, v138
    v_permlane32_swap_b32 v137, v139
    v_pk_add_f32 v[136:137], v[136:137], v[138:139]
    s_add_u32 s56, s36, 35262464
    buffer_store_dwordx2 v[136:137], v20, s[8:11], s56 offen sc1
    s_waitcnt vmcnt(8)
    v_cmp_le_u32 vcc, 5, v27
    s_nop 3
    s_cmp_eq_u64 vcc, -1
    s_cbranch_scc1 L_pdone_16
    s_mov_b32 s68, 0x80000
L_poll_15:
    buffer_load_dword v27, v25, s[8:11], s38 offen sc1
    s_waitcnt vmcnt(0)
    v_cmp_le_u32 vcc, 5, v27
    s_nop 3
    s_cmp_eq_u64 vcc, -1
    s_cbranch_scc1 L_pdone_16
    s_sub_u32 s68, s68, 1
    s_cmp_lg_u32 s68, 0
    s_cbranch_scc1 L_poll_15
L_pdone_16:
    s_waitcnt vmcnt(5)
    ds_read_b32 v96, v94 offset:52224
    s_add_u32 m0, s28, 84992
    s_add_u32 s49, s48, 27271168
    buffer_load_dwordx4 v1, s[8:11], s49 offen offset:0 sc1 lds
    ds_read_b32 v97, v94 offset:53248
    s_add_u32 m0, s28, 84992
    s_nop 0
    buffer_load_dwordx4 v1, s[8:11], s49 offen offset:1024 sc1 lds
    ds_read_b32 v98, v94 offset:60416
    s_add_u32 m0, s28, 91136
    s_nop 0
    buffer_load_dwordx4 v1, s[8:11], s49 offen offset:2048 sc1 lds
    ds_read_b32 v99, v94 offset:61440
    s_add_u32 m0, s28, 91136
    s_nop 0
    buffer_load_dwordx4 v1, s[8:11], s49 offen offset:3072 sc1 lds
    ds_read_b32 v100, v95 offset:3072
    s_add_u32 m0, s28, 101376
    s_add_u32 s49, s48, 27275264
    buffer_load_dwordx4 v1, s[8:11], s49 offen offset:0 sc1 lds
    ds_read_b32 v101, v95 offset:4096
    ds_read_b32 v102, v95 offset:11264
    s_add_u32 m0, s28, 101376
    s_nop 0
    buffer_load_dwordx4 v1, s[8:11], s49 offen offset:1024 sc1 lds
    ds_read_b32 v103, v95 offset:12288
    s_waitcnt lgkmcnt(0)
    v_max3_u32 v3, v96, v97, v98
    v_max3_u32 v3, v3, v99, v100
    v_max3_u32 v3, v3, v101, v102
    v_max_u32 v3, v3, v103
    v_cmp_eq_u32 vcc, -1, v3
    s_nop 3
    s_cbranch_vccnz L_fix_17
L_fixed_18:
    s_barrier
    ds_read_b128 v[96:99], v1 offset:52224
    s_add_u32 s53, s36, 35258368
    buffer_load_dwordx2 v[200:201], v0, s[8:11], s53 offen offset:0 sc1
    ds_read_b128 v[100:103], v1 offset:54272
    buffer_load_dwordx2 v[202:203], v0, s[8:11], s53 offen offset:512 sc1
    ds_read_b128 v[104:107], v1 offset:56320
    ds_read_b128 v[108:111], v1 offset:58368
    s_waitcnt lgkmcnt(2)
    v_mfma_f32_16x16x32_bf16 v[128:131], a[4:7], v[96:99], 0
    ds_read_b128 v[112:115], v1 offset:53248
    v_mfma_f32_16x16x32_bf16 v[140:143], a[4:7], v[100:103], 0
    ds_read_b128 v[116:119], v1 offset:55296
    v_mfma_f32_16x16x32_bf16 v[132:135], a[8:11], v[96:99], 0
    ds_read_b128 v[120:123], v1 offset:57344
    v_mfma_f32_16x16x32_bf16 v[144:147], a[8:11], v[100:103], 0
    ds_read_b128 v[124:127], v1 offset:59392
    v_mfma_f32_16x16x32_bf16 v[136:139], a[12:15], v[96:99], 0
    buffer_load_dwordx2 v[204:205], v0, s[8:11], s53 offen offset:1024 sc1
    v_mfma_f32_16x16x32_bf16 v[148:151], a[12:15], v[100:103], 0
    s_waitcnt lgkmcnt(4)
    v_mfma_f32_16x16x32_bf16 v[160:163], a[12:15], v[104:107], 0
    buffer_load_dwordx2 v[206:207], v0, s[8:11], s53 offen offset:1536 sc1
    v_mfma_f32_16x16x32_bf16 v[172:175], a[12:15], v[108:111], 0
    buffer_load_dwordx2 v[208:209], v0, s[8:11], s53 offen offset:2048 sc1
    v_mfma_f32_16x16x32_bf16 v[156:159], a[8:11], v[104:107], 0
    v_mfma_f32_16x16x32_bf16 v[168:171], a[8:11], v[108:111], 0
    v_mfma_f32_16x16x32_bf16 v[152:155], a[4:7], v[104:107], 0
    v_mfma_f32_16x16x32_bf16 v[164:167], a[4:7], v[108:111], 0
    s_waitcnt lgkmcnt(2)
    v_mfma_f32_16x16x32_bf16 v[128:131], a[16:19], v[112:115], v[128:131]
    ds_read_b128 v[96:99], v1 offset:60416
    v_mfma_f32_16x16x32_bf16 v[140:143], a[16:19], v[116:119], v[140:143]
    ds_read_b128 v[100:103], v1 offset:62464
    v_mfma_f32_16x16x32_bf16 v[132:135], a[20:23], v[112:115], v[132:135]
    ds_read_b128 v[104:107], v1 offset:64512
    v_mfma_f32_16x16x32_bf16 v[144:147], a[20:23], v[116:119], v[144:147]
    ds_read_b128 v[108:111], v2 offset:1024
    v_mfma_f32_16x16x32_bf16 v[136:139], a[24:27], v[112:115], v[136:139]
    v_mfma_f32_16x16x32_bf16 v[148:151], a[24:27], v[116:119], v[148:151]
    s_waitcnt lgkmcnt(4)
    v_mfma_f32_16x16x32_bf16 v[160:163], a[24:27], v[120:123], v[160:163]
    v_mfma_f32_16x16x32_bf16 v[172:175], a[24:27], v[124:127], v[172:175]
    v_mfma_f32_16x16x32_bf16 v[156:159], a[20:23], v[120:123], v[156:159]
    v_mfma_f32_16x16x32_bf16 v[168:171], a[20:23], v[124:127], v[168:171]
    v_mfma_f32_16x16x32_bf16 v[152:155], a[16:19], v[120:123], v[152:155]
    v_mfma_f32_16x16x32_bf16 v[164:167], a[16:19], v[124:127], v[164:167]
    s_waitcnt lgkmcnt(2)
    v_mfma_f32_16x16x32_bf16 v[128:131], a[28:31], v[96:99], v[128:131]
    ds_read_b128 v[112:115], v1 offset:61440
    v_mfma_f32_16x16x32_bf16 v[140:143], a[28:31], v[100:103], v[140:143]
    ds_read_b128 v[116:119], v1 offset:63488
    v_mfma_f32_16x16x32_bf16 v[132:135], a[32:35], v[96:99], v[132:135]
    ds_read_b128 v[120:123], v2 offset:0
    v_mfma_f32_16x16x32_bf16 v[144:147], a[32:35], v[100:103], v[144:147]
    ds_read_b128 v[124:127], v2 offset:2048
    v_mfma_f32_16x16x32_bf16 v[136:139], a[36:39], v[96:99], v[136:139]
    buffer_load_dwordx2 v[210:211], v0, s[8:11], s53 offen offset:2560 sc1
    v_mfma_f32_16x16x32_bf16 v[148:151], a[36:39], v[100:103], v[148:151]
    s_waitcnt lgkmcnt(4)
    v_mfma_f32_16x16x32_bf16 v[160:163], a[36:39], v[104:107], v[160:163]
    buffer_load_dwordx2 v[212:213], v0, s[8:11], s53 offen offset:3072 sc1
    v_mfma_f32_16x16x32_bf16 v[172:175], a[36:39], v[108:111], v[172:175]
    v_mfma_f32_16x16x32_bf16 v[156:159], a[32:35], v[104:107], v[156:159]
    v_mfma_f32_16x16x32_bf16 v[168:171], a[32:35], v[108:111], v[168:171]
    v_mfma_f32_16x16x32_bf16 v[152:155], a[28:31], v[104:107], v[152:155]
    v_mfma_f32_16x16x32_bf16 v[164:167], a[28:31], v[108:111], v[164:167]
    s_waitcnt lgkmcnt(2)
    v_mfma_f32_16x16x32_bf16 v[128:131], a[40:43], v[112:115], v[128:131]
    ds_read_b128 v[96:99], v2 offset:3072
    v_mfma_f32_16x16x32_bf16 v[140:143], a[40:43], v[116:119], v[140:143]
    ds_read_b128 v[100:103], v2 offset:5120
    v_mfma_f32_16x16x32_bf16 v[132:135], a[44:47], v[112:115], v[132:135]
    ds_read_b128 v[104:107], v2 offset:7168
    v_mfma_f32_16x16x32_bf16 v[144:147], a[44:47], v[116:119], v[144:147]
    ds_read_b128 v[108:111], v2 offset:9216
    v_mfma_f32_16x16x32_bf16 v[136:139], a[48:51], v[112:115], v[136:139]
    buffer_load_dwordx2 v[214:215], v0, s[8:11], s53 offen offset:3584 sc1
    v_mfma_f32_16x16x32_bf16 v[148:151], a[48:51], v[116:119], v[148:151]
    s_add_u32 m0, s28, 107520
    s_waitcnt lgkmcnt(4)
    v_mfma_f32_16x16x32_bf16 v[160:163], a[48:51], v[120:123], v[160:163]
    buffer_load_dwordx4 v1, s[8:11], s49 offen offset:2048 sc1 lds
    v_mfma_f32_16x16x32_bf16 v[172:175], a[48:51], v[124:127], v[172:175]
    s_add_u32 m0, s28, 107520
    v_mfma_f32_16x16x32_bf16 v[156:159], a[44:47], v[120:123], v[156:159]
    buffer_load_dwordx4 v1, s[8:11], s49 offen offset:3072 sc1 lds
    v_mfma_f32_16x16x32_bf16 v[168:171], a[44:47], v[124:127], v[168:171]
    s_add_u32 m0, s28, 3072
    s_add_u32 s49, s48, 27279360
    v_mfma_f32_16x16x32_bf16 v[152:155], a[40:43], v[120:123], v[152:155]
    buffer_load_dwordx4 v1, s[8:11], s49 offen offset:0 sc1 lds
    v_mfma_f32_16x16x32_bf16 v[164:167], a[40:43], v[124:127], v[164:167]
    s_add_u32 m0, s28, 3072
    s_waitcnt lgkmcnt(2)
    v_mfma_f32_16x16x32_bf16 v[128:131], a[52:55], v[96:99], v[128:131]
    ds_read_b128 v[112:115], v2 offset:4096
    v_mfma_f32_16x16x32_bf16 v[140:143], a[52:55], v[100:103], v[140:143]
    ds_read_b128 v[116:119], v2 offset:6144
    v_mfma_f32_16x16x32_bf16 v[132:135], a[56:59], v[96:99], v[132:135]
    ds_read_b128 v[120:123], v2 offset:8192
    v_mfma_f32_16x16x32_bf16 v[144:147], a[56:59], v[100:103], v[144:147]
    ds_read_b128 v[124:127], v2 offset:10240
    v_mfma_f32_16x16x32_bf16 v[136:139], a[60:63], v[96:99], v[136:139]
    buffer_load_dwordx4 v1, s[8:11], s49 offen offset:1024 sc1 lds
    v_mfma_f32_16x16x32_bf16 v[148:151], a[60:63], v[100:103], v[148:151]
    s_add_u32 m0, s28, 9216
    s_waitcnt lgkmcnt(4)
    v_mfma_f32_16x16x32_bf16 v[160:163], a[60:63], v[104:107], v[160:163]
    buffer_load_dwordx4 v1, s[8:11], s49 offen offset:2048 sc1 lds
    v_mfma_f32_16x16x32_bf16 v[172:175], a[60:63], v[108:111], v[172:175]
    s_add_u32 m0, s28, 9216
    v_mfma_f32_16x16x32_bf16 v[156:159], a[56:59], v[104:107], v[156:159]
    buffer_load_dwordx4 v1, s[8:11], s49 offen offset:3072 sc1 lds
    v_mfma_f32_16x16x32_bf16 v[168:171], a[56:59], v[108:111], v[168:171]
    buffer_load_dwordx4 a[188:191], v1, s[8:11], s26 offen offset:2048 sc1
    v_mfma_f32_16x16x32_bf16 v[152:155], a[52:55], v[104:107], v[152:155]
    buffer_load_dwordx4 a[192:195], v1, s[8:11], s26 offen offset:3072 sc1
    v_mfma_f32_16x16x32_bf16 v[164:167], a[52:55], v[108:111], v[164:167]
    s_add_u32 s26, s24, 49152
    s_waitcnt lgkmcnt(2)
    v_mfma_f32_16x16x32_bf16 v[128:131], a[64:67], v[112:115], v[128:131]
    ds_read_b128 v[96:99], v2 offset:11264
    v_mfma_f32_16x16x32_bf16 v[140:143], a[64:67], v[116:119], v[140:143]
    ds_read_b128 v[100:103], v2 offset:13312
    v_mfma_f32_16x16x32_bf16 v[132:135], a[68:71], v[112:115], v[132:135]
    ds_read_b128 v[104:107], v2 offset:15360
    v_mfma_f32_16x16x32_bf16 v[144:147], a[68:71], v[116:119], v[144:147]
    ds_read_b128 v[108:111], v2 offset:17408
    v_mfma_f32_16x16x32_bf16 v[136:139], a[72:75], v[112:115], v[136:139]
    buffer_load_dwordx4 a[196:199], v1, s[8:11], s26 offen offset:0 sc1
    v_mfma_f32_16x16x32_bf16 v[148:151], a[72:75], v[116:119], v[148:151]
    s_waitcnt lgkmcnt(4)
    v_mfma_f32_16x16x32_bf16 v[160:163], a[72:75], v[120:123], v[160:163]
    v_mfma_f32_16x16x32_bf16 v[172:175], a[72:75], v[124:127], v[172:175]
    v_mfma_f32_16x16x32_bf16 v[156:159], a[68:71], v[120:123], v[156:159]
    v_mfma_f32_16x16x32_bf16 v[168:171], a[68:71], v[124:127], v[168:171]
    v_mfma_f32_16x16x32_bf16 v[152:155], a[64:67], v[120:123], v[152:155]
    v_mfma_f32_16x16x32_bf16 v[164:167], a[64:67], v[124:127], v[164:167]
    v_mfma_f32_16x16x32_bf16 v[52:55], a[64:67], v[28:31], v[52:55]
    v_mfma_f32_16x16x32_bf16 v[56:59], a[68:71], v[28:31], v[56:59]
    v_mfma_f32_16x16x32_bf16 v[60:63], a[72:75], v[28:31], v[60:63]
    v_mov_b32 v216, -1
    v_mov_b32 v217, -1
    v_mov_b32 v218, -1
    v_mov_b32 v219, -1
    s_waitcnt lgkmcnt(2)
    v_mfma_f32_16x16x32_bf16 v[128:131], a[76:79], v[96:99], v[128:131]
    ds_read_b128 v[112:115], v2 offset:12288
    v_mfma_f32_16x16x32_bf16 v[140:143], a[76:79], v[100:103], v[140:143]
    ds_read_b128 v[116:119], v2 offset:14336
    s_add_u32 s55, s32, 12140544
    v_mfma_f32_16x16x32_bf16 v[132:135], a[80:83], v[96:99], v[132:135]
    ds_read_b128 v[120:123], v2 offset:16384
    v_mfma_f32_16x16x32_bf16 v[144:147], a[80:83], v[100:103], v[144:147]
    ds_read_b128 v[124:127], v2 offset:18432
    v_mfma_f32_16x16x32_bf16 v[136:139], a[84:87], v[96:99], v[136:139]
    buffer_store_dwordx4 v[216:219], v1, s[8:11], s55 offen offset:0 sc1
    v_mfma_f32_16x16x32_bf16 v[148:151], a[84:87], v[100:103], v[148:151]
    s_waitcnt lgkmcnt(4)
    v_mfma_f32_16x16x32_bf16 v[160:163], a[84:87], v[104:107], v[160:163]
    v_mfma_f32_16x16x32_bf16 v[172:175], a[84:87], v[108:111], v[172:175]
    v_mfma_f32_16x16x32_bf16 v[156:159], a[80:83], v[104:107], v[156:159]
    v_mfma_f32_16x16x32_bf16 v[168:171], a[80:83], v[108:111], v[168:171]
    v_mfma_f32_16x16x32_bf16 v[152:155], a[76:79], v[104:107], v[152:155]
    v_mfma_f32_16x16x32_bf16 v[164:167], a[76:79], v[108:111], v[164:167]
    v_mfma_f32_16x16x32_bf16 v[52:55], a[76:79], v[28:31], v[52:55]
    v_mfma_f32_16x16x32_bf16 v[56:59], a[80:83], v[28:31], v[56:59]
    v_mfma_f32_16x16x32_bf16 v[60:63], a[84:87], v[28:31], v[60:63]
    s_add_u32 s55, s32, 12140544
    s_waitcnt vmcnt(18)
    s_waitcnt lgkmcnt(0)
    s_barrier
    v_mov_b32 v199, 6
    buffer_store_dwordx4 v[216:219], v23, s[8:11], s55 offen offset:1024 sc1
    buffer_store_dword v199, v26, s[8:11], s37 offen sc1
    s_add_u32 s55, s33, 21168128
    buffer_store_dwordx4 v[216:219], v24, s[8:11], s55 offen offset:0 sc1
    v_mfma_f32_16x16x32_bf16 v[128:131], a[88:91], v[112:115], v[128:131]
    ds_read_b128 v[96:99], v2 offset:19456
    s_add_u32 s55, s33, 21168128
    v_mfma_f32_16x16x32_bf16 v[140:143], a[88:91], v[116:119], v[140:143]
    ds_read_b128 v[100:103], v2 offset:21504
    v_mfma_f32_16x16x32_bf16 v[132:135], a[92:95], v[112:115], v[132:135]
    ds_read_b128 v[104:107], v2 offset:23552
    v_mfma_f32_16x16x32_bf16 v[144:147], a[92:95], v[116:119], v[144:147]
    ds_read_b128 v[108:111], v2 offset:25600
    v_mfma_f32_16x16x32_bf16 v[136:139], a[96:99], v[112:115], v[136:139]
    buffer_store_dwordx4 v[216:219], v24, s[8:11], s55 offen offset:256 sc1
    v_mfma_f32_16x16x32_bf16 v[148:151], a[96:99], v[116:119], v[148:151]
    s_add_u32 s55, s33, 21168128
    v_mfma_f32_16x16x32_bf16 v[160:163], a[96:99], v[120:123], v[160:163]
    buffer_store_dwordx4 v[216:219], v24, s[8:11], s55 offen offset:512 sc1
    v_mfma_f32_16x16x32_bf16 v[172:175], a[96:99], v[124:127], v[172:175]
    s_add_u32 s55, s35, 29884416
    v_mfma_f32_16x16x32_bf16 v[156:159], a[92:95], v[120:123], v[156:159]
    buffer_store_dwordx4 v[216:219], v8, s[8:11], s55 offen offset:0 sc1
    v_mfma_f32_16x16x32_bf16 v[168:171], a[92:95], v[124:127], v[168:171]
    s_add_u32 s55, s35, 29884416
    v_mfma_f32_16x16x32_bf16 v[152:155], a[88:91], v[120:123], v[152:155]
    buffer_store_dwordx4 v[216:219], v12, s[8:11], s55 offen offset:2048 sc1
    v_mfma_f32_16x16x32_bf16 v[164:167], a[88:91], v[124:127], v[164:167]
    v_mfma_f32_16x16x32_bf16 v[52:55], a[88:91], v[28:31], v[52:55]
    buffer_load_dwordx4 a[200:203], v1, s[8:11], s26 offen offset:1024 sc1
    v_mfma_f32_16x16x32_bf16 v[56:59], a[92:95], v[28:31], v[56:59]
    buffer_load_dwordx4 a[220:223], v1, s[8:11], s26 offen offset:2048 sc1
    v_mfma_f32_16x16x32_bf16 v[60:63], a[96:99], v[28:31], v[60:63]
    s_waitcnt vmcnt(19)
    s_waitcnt lgkmcnt(2)
    v_mfma_f32_16x16x32_bf16 v[128:131], a[100:103], v[96:99], v[128:131]
    ds_read_b128 v[112:115], v2 offset:20480
    v_add_f32 v200, v200, v208
    v_mfma_f32_16x16x32_bf16 v[140:143], a[100:103], v[100:103], v[140:143]
    ds_read_b128 v[116:119], v2 offset:22528
    v_add_f32 v201, v201, v209
    v_mfma_f32_16x16x32_bf16 v[132:135], a[104:107], v[96:99], v[132:135]
    ds_read_b128 v[120:123], v2 offset:24576
    v_add_f32 v202, v202, v210
    v_mfma_f32_16x16x32_bf16 v[144:147], a[104:107], v[100:103], v[144:147]
    ds_read_b128 v[124:127], v2 offset:26624
    v_add_f32 v203, v203, v211
    v_mfma_f32_16x16x32_bf16 v[136:139], a[108:111], v[96:99], v[136:139]
    buffer_load_dwordx4 a[240:243], v1, s[8:11], s26 offen offset:3072 sc1
    v_mfma_f32_16x16x32_bf16 v[148:151], a[108:111], v[100:103], v[148:151]
    s_add_u32 s26, s24, 53248
    s_waitcnt lgkmcnt(4)
    v_mfma_f32_16x16x32_bf16 v[160:163], a[108:111], v[104:107], v[160:163]
    buffer_load_dwordx4 a[204:207], v1, s[8:11], s26 offen offset:0 sc1
    v_mfma_f32_16x16x32_bf16 v[172:175], a[108:111], v[108:111], v[172:175]
    buffer_load_dwordx4 a[224:227], v1, s[8:11], s26 offen offset:1024 sc1
    v_mfma_f32_16x16x32_bf16 v[156:159], a[104:107], v[104:107], v[156:159]
    v_add_f32 v204, v204, v212
    v_add_f32 v205, v205, v213
    v_mfma_f32_16x16x32_bf16 v[168:171], a[104:107], v[108:111], v[168:171]
    v_add_f32 v206, v206, v214
    v_add_f32 v207, v207, v215
    v_mfma_f32_16x16x32_bf16 v[152:155], a[100:103], v[104:107], v[152:155]
    v_add_f32 v200, v200, v204
    v_add_f32 v201, v201, v205
    v_mfma_f32_16x16x32_bf16 v[164:167], a[100:103], v[108:111], v[164:167]
    v_add_f32 v202, v202, v206
    v_mfma_f32_16x16x32_bf16 v[52:55], a[100:103], v[28:31], v[52:55]
    v_add_f32 v203, v203, v207
    v_add_f32 v200, v200, v202
    v_mfma_f32_16x16x32_bf16 v[56:59], a[104:107], v[28:31], v[56:59]
    v_add_f32 v201, v201, v203
    v_mul_f32 v80, s64, v200
    v_mfma_f32_16x16x32_bf16 v[60:63], a[108:111], v[28:31], v[60:63]
    v_mul_f32 v201, s64, v201
    s_waitcnt lgkmcnt(2)
    v_mfma_f32_16x16x32_bf16 v[128:131], a[112:115], v[112:115], v[128:131]
    ds_read_b128 v[96:99], v2 offset:27648
    v_fma_f32 v201, -v80, v80, v201
    v_mfma_f32_16x16x32_bf16 v[140:143], a[112:115], v[116:119], v[140:143]
    ds_read_b128 v[100:103], v2 offset:29696
    v_max_f32 v201, 0, v201
    v_mfma_f32_16x16x32_bf16 v[132:135], a[116:119], v[112:115], v[132:135]
    ds_read_b128 v[104:107], v2 offset:31744
    v_add_f32 v201, s65, v201
    v_mfma_f32_16x16x32_bf16 v[144:147], a[116:119], v[116:119], v[144:147]
    ds_read_b128 v[108:111], v2 offset:33792
    v_mfma_f32_16x16x32_bf16 v[136:139], a[120:123], v[112:115], v[136:139]
    v_rsq_f32 v84, v201
    v_mfma_f32_16x16x32_bf16 v[148:151], a[120:123], v[116:119], v[148:151]
    v_mul_f32 v88, v201, v84
    s_waitcnt lgkmcnt(4)
    v_mfma_f32_16x16x32_bf16 v[160:163], a[120:123], v[120:123], v[160:163]
    v_mul_f32 v84, s66, v84
    v_mov_b32 v82, v80
    v_mfma_f32_16x16x32_bf16 v[172:175], a[120:123], v[124:127], v[172:175]
    v_mov_b32 v86, v84
    v_mov_b32 v90, v88
    v_mfma_f32_16x16x32_bf16 v[156:159], a[116:119], v[120:123], v[156:159]
    v_permlane32_swap_b32 v80, v82
    v_mfma_f32_16x16x32_bf16 v[168:171], a[116:119], v[124:127], v[168:171]
    v_permlane32_swap_b32 v84, v86
    v_mfma_f32_16x16x32_bf16 v[152:155], a[112:115], v[120:123], v[152:155]
    v_permlane32_swap_b32 v88, v90
    v_mfma_f32_16x16x32_bf16 v[164:167], a[112:115], v[124:127], v[164:167]
    v_mov_b32 v81, v80
    v_mfma_f32_16x16x32_bf16 v[52:55], a[112:115], v[28:31], v[52:55]
    v_mov_b32 v83, v82
    v_mov_b32 v85, v84
    v_mfma_f32_16x16x32_bf16 v[56:59], a[116:119], v[28:31], v[56:59]
    v_mov_b32 v87, v86
    v_mov_b32 v89, v88
    v_mfma_f32_16x16x32_bf16 v[60:63], a[120:123], v[28:31], v[60:63]
    v_mov_b32 v91, v90
    s_waitcnt lgkmcnt(2)
    v_mfma_f32_16x16x32_bf16 v[128:131], a[124:127], v[96:99], v[128:131]
    ds_read_b128 v[112:115], v2 offset:28672
    v_mfma_f32_16x16x32_bf16 v[140:143], a[124:127], v[100:103], v[140:143]
    ds_read_b128 v[116:119], v2 offset:30720
    v_mfma_f32_16x16x32_bf16 v[132:135], a[128:131], v[96:99], v[132:135]
    ds_read_b128 v[120:123], v2 offset:32768
    v_mfma_f32_16x16x32_bf16 v[144:147], a[128:131], v[100:103], v[144:147]
    ds_read_b128 v[124:127], v2 offset:34816
    v_mfma_f32_16x16x32_bf16 v[136:139], a[132:135], v[96:99], v[136:139]
    v_permlane16_swap_b32 v80, v81
    v_mfma_f32_16x16x32_bf16 v[148:151], a[132:135], v[100:103], v[148:151]
    s_waitcnt lgkmcnt(4)
    v_mfma_f32_16x16x32_bf16 v[160:163], a[132:135], v[104:107], v[160:163]
    buffer_load_dwordx4 a[244:247], v1, s[8:11], s26 offen offset:2048 sc1
    v_mfma_f32_16x16x32_bf16 v[172:175], a[132:135], v[108:111], v[172:175]
    buffer_load_dwordx4 a[208:211], v1, s[8:11], s26 offen offset:3072 sc1
    v_mfma_f32_16x16x32_bf16 v[156:159], a[128:131], v[104:107], v[156:159]
    v_permlane16_swap_b32 v82, v83
    v_mfma_f32_16x16x32_bf16 v[168:171], a[128:131], v[108:111], v[168:171]
    v_permlane16_swap_b32 v84, v85
    v_mfma_f32_16x16x32_bf16 v[152:155], a[124:127], v[104:107], v[152:155]
    v_permlane16_swap_b32 v86, v87
    v_mfma_f32_16x16x32_bf16 v[164:167], a[124:127], v[108:111], v[164:167]
    v_mfma_f32_16x16x32_bf16 v[52:55], a[124:127], v[28:31], v[52:55]
    s_add_u32 s26, s24, 57344
    v_mfma_f32_16x16x32_bf16 v[56:59], a[128:131], v[28:31], v[56:59]
    buffer_load_dwordx4 a[228:231], v1, s[8:11], s26 offen offset:0 sc1
    v_mfma_f32_16x16x32_bf16 v[60:63], a[132:135], v[28:31], v[60:63]
    s_waitcnt lgkmcnt(2)
    v_mfma_f32_16x16x32_bf16 v[128:131], a[136:139], v[112:115], v[128:131]
    ds_read_b128 v[96:99], v2 offset:35840
    v_mfma_f32_16x16x32_bf16 v[140:143], a[136:139], v[116:119], v[140:143]
    ds_read_b128 v[100:103], v2 offset:37888
    v_mfma_f32_16x16x32_bf16 v[132:135], a[140:143], v[112:115], v[132:135]
    ds_read_b128 v[104:107], v2 offset:39936
    v_mfma_f32_16x16x32_bf16 v[144:147], a[140:143], v[116:119], v[144:147]
    ds_read_b128 v[108:111], v2 offset:41984
    v_mfma_f32_16x16x32_bf16 v[136:139], a[144:147], v[112:115], v[136:139]
    buffer_load_dwordx4 a[248:251], v1, s[8:11], s26 offen offset:1024 sc1
    v_mfma_f32_16x16x32_bf16 v[148:151], a[144:147], v[116:119], v[148:151]
    s_waitcnt lgkmcnt(4)
    v_mfma_f32_16x16x32_bf16 v[160:163], a[144:147], v[120:123], v[160:163]
    buffer_load_dwordx4 a[212:215], v1, s[8:11], s26 offen offset:2048 sc1
    v_mfma_f32_16x16x32_bf16 v[172:175], a[144:147], v[124:127], v[172:175]
    buffer_load_dwordx4 a[232:235], v1, s[8:11], s26 offen offset:3072 sc1
    v_mfma_f32_16x16x32_bf16 v[156:159], a[140:143], v[120:123], v[156:159]
    v_permlane16_swap_b32 v88, v89
    v_mfma_f32_16x16x32_bf16 v[168:171], a[140:143], v[124:127], v[168:171]
    v_permlane16_swap_b32 v90, v91
    v_mfma_f32_16x16x32_bf16 v[152:155], a[136:139], v[120:123], v[152:155]
    v_mfma_f32_16x16x32_bf16 v[164:167], a[136:139], v[124:127], v[164:167]
    v_mfma_f32_16x16x32_bf16 v[52:55], a[136:139], v[28:31], v[52:55]
    v_mfma_f32_16x16x32_bf16 v[56:59], a[140:143], v[28:31], v[56:59]
    v_mfma_f32_16x16x32_bf16 v[60:63], a[144:147], v[28:31], v[60:63]
    buffer_load_dword v27, v25, s[8:11], s38 offen sc1
    s_add_u32 s26, s25, 0
    buffer_load_dwordx4 a[252:255], v1, s[8:11], s26 offen offset:0 sc1
    s_waitcnt lgkmcnt(2)
    v_mfma_f32_16x16x32_bf16 v[128:131], a[148:151], v[96:99], v[128:131]
    ds_read_b128 v[112:115], v2 offset:36864
    v_mfma_f32_16x16x32_bf16 v[140:143], a[148:151], v[100:103], v[140:143]
    ds_read_b128 v[116:119], v2 offset:38912
    v_mfma_f32_16x16x32_bf16 v[132:135], a[152:155], v[96:99], v[132:135]
    ds_read_b128 v[120:123], v2 offset:40960
    v_mfma_f32_16x16x32_bf16 v[144:147], a[152:155], v[100:103], v[144:147]
    ds_read_b128 v[124:127], v2 offset:43008
    v_mfma_f32_16x16x32_bf16 v[136:139], a[156:159], v[96:99], v[136:139]
    buffer_load_dwordx4 a[216:219], v1, s[8:11], s26 offen offset:1024 sc1
    v_mfma_f32_16x16x32_bf16 v[148:151], a[156:159], v[100:103], v[148:151]
    s_waitcnt lgkmcnt(4)
    v_mfma_f32_16x16x32_bf16 v[160:163], a[156:159], v[104:107], v[160:163]
    buffer_load_dwordx4 a[236:239], v1, s[8:11], s26 offen offset:2048 sc1
    v_mfma_f32_16x16x32_bf16 v[172:175], a[156:159], v[108:111], v[172:175]
    v_mfma_f32_16x16x32_bf16 v[156:159], a[152:155], v[104:107], v[156:159]
    buffer_load_dwordx4 a[0:3], v1, s[8:11], s26 offen offset:3072 sc1
    v_mfma_f32_16x16x32_bf16 v[168:171], a[152:155], v[108:111], v[168:171]
    v_mfma_f32_16x16x32_bf16 v[152:155], a[148:151], v[104:107], v[152:155]
    v_mfma_f32_16x16x32_bf16 v[164:167], a[148:151], v[108:111], v[164:167]
    v_mfma_f32_16x16x32_bf16 v[52:55], a[148:151], v[28:31], v[52:55]
    v_mfma_f32_16x16x32_bf16 v[56:59], a[152:155], v[28:31], v[56:59]
    s_add_u32 m0, s28, 117760
    s_add_u32 s26, s25, 4096
    v_mfma_f32_16x16x32_bf16 v[60:63], a[156:159], v[28:31], v[60:63]
    s_waitcnt vmcnt(27)
    s_waitcnt lgkmcnt(0)
    s_barrier
    v_mfma_f32_16x16x32_bf16 v[128:131], a[160:163], v[112:115], v[128:131]
    ds_read_b128 v[96:99], v2 offset:44032
    v_mfma_f32_16x16x32_bf16 v[140:143], a[160:163], v[116:119], v[140:143]
    ds_read_b128 v[100:103], v2 offset:46080
    v_mfma_f32_16x16x32_bf16 v[132:135], a[164:167], v[112:115], v[132:135]
    ds_read_b128 v[104:107], v2 offset:48128
    v_mfma_f32_16x16x32_bf16 v[144:147], a[164:167], v[116:119], v[144:147]
    ds_read_b128 v[108:111], v2 offset:50176
    v_mfma_f32_16x16x32_bf16 v[136:139], a[168:171], v[112:115], v[136:139]
    buffer_load_dwordx4 v1, s[8:11], s26 offen offset:0 sc1 lds
    v_mfma_f32_16x16x32_bf16 v[148:151], a[168:171], v[116:119], v[148:151]
    s_add_u32 m0, s28, 117760
    v_mfma_f32_16x16x32_bf16 v[160:163], a[168:171], v[120:123], v[160:163]
    buffer_load_dwordx4 v1, s[8:11], s26 offen offset:1024 sc1 lds
    v_mfma_f32_16x16x32_bf16 v[172:175], a[168:171], v[124:127], v[172:175]
    s_add_u32 m0, s28, 123904
    v_mfma_f32_16x16x32_bf16 v[156:159], a[164:167], v[120:123], v[156:159]
    buffer_load_dwordx4 v1, s[8:11], s26 offen offset:2048 sc1 lds
    v_mfma_f32_16x16x32_bf16 v[168:171], a[164:167], v[124:127], v[168:171]
    v_mfma_f32_16x16x32_bf16 v[152:155], a[160:163], v[120:123], v[152:155]
    v_mfma_f32_16x16x32_bf16 v[164:167], a[160:163], v[124:127], v[164:167]
    s_add_u32 m0, s28, 123904
    v_mfma_f32_16x16x32_bf16 v[52:55], a[160:163], v[28:31], v[52:55]
    buffer_load_dwordx4 v1, s[8:11], s26 offen offset:3072 sc1 lds
    v_mfma_f32_16x16x32_bf16 v[56:59], a[164:167], v[28:31], v[56:59]
    s_add_u32 m0, s28, 134144
    s_add_u32 s26, s25, 8192
    v_mfma_f32_16x16x32_bf16 v[60:63], a[168:171], v[28:31], v[60:63]
    s_waitcnt lgkmcnt(2)
    v_mfma_f32_16x16x32_bf16 v[128:131], a[172:175], v[96:99], v[128:131]
    ds_read_b128 v[112:115], v2 offset:45056
    v_mfma_f32_16x16x32_bf16 v[140:143], a[172:175], v[100:103], v[140:143]
    ds_read_b128 v[116:119], v2 offset:47104
    v_mfma_f32_16x16x32_bf16 v[132:135], a[176:179], v[96:99], v[132:135]
    ds_read_b128 v[120:123], v2 offset:49152
    v_mfma_f32_16x16x32_bf16 v[144:147], a[176:179], v[100:103], v[144:147]
    ds_read_b128 v[124:127], v2 offset:51200
    v_mfma_f32_16x16x32_bf16 v[136:139], a[180:183], v[96:99], v[136:139]
    buffer_load_dwordx4 v1, s[8:11], s26 offen offset:0 sc1 lds
    v_mfma_f32_16x16x32_bf16 v[148:151], a[180:183], v[100:103], v[148:151]
    s_add_u32 m0, s28, 134144
    s_waitcnt lgkmcnt(4)
    v_mfma_f32_16x16x32_bf16 v[160:163], a[180:183], v[104:107], v[160:163]
    buffer_load_dwordx4 v1, s[8:11], s26 offen offset:1024 sc1 lds
    v_mfma_f32_16x16x32_bf16 v[172:175], a[180:183], v[108:111], v[172:175]
    s_add_u32 m0, s28, 140288
    v_mfma_f32_16x16x32_bf16 v[156:159], a[176:179], v[104:107], v[156:159]
    buffer_load_dwordx4 v1, s[8:11], s26 offen offset:2048 sc1 lds
    v_mfma_f32_16x16x32_bf16 v[168:171], a[176:179], v[108:111], v[168:171]
    v_mfma_f32_16x16x32_bf16 v[152:155], a[172:175], v[104:107], v[152:155]
    v_mfma_f32_16x16x32_bf16 v[164:167], a[172:175], v[108:111], v[164:167]
    v_mfma_f32_16x16x32_bf16 v[52:55], a[172:175], v[28:31], v[52:55]
    s_add_u32 m0, s28, 140288
    v_mfma_f32_16x16x32_bf16 v[56:59], a[176:179], v[28:31], v[56:59]
    buffer_load_dwordx4 v1, s[8:11], s26 offen offset:3072 sc1 lds
    v_mfma_f32_16x16x32_bf16 v[60:63], a[180:183], v[28:31], v[60:63]
    s_add_u32 m0, s28, 150528
    s_add_u32 s26, s25, 12288
    s_waitcnt vmcnt(33)
    s_waitcnt lgkmcnt(2)
    v_mfma_f32_16x16x32_bf16 v[128:131], a[184:187], v[112:115], v[128:131]
    ds_read_b128 v[96:99], v1 offset:3072
    v_mfma_f32_16x16x32_bf16 v[140:143], a[184:187], v[116:119], v[140:143]
    ds_read_b128 v[100:103], v1 offset:5120
    v_mfma_f32_16x16x32_bf16 v[132:135], a[188:191], v[112:115], v[132:135]
    ds_read_b128 v[104:107], v1 offset:7168
    v_mfma_f32_16x16x32_bf16 v[144:147], a[188:191], v[116:119], v[144:147]
    ds_read_b128 v[108:111], v1 offset:9216
    v_mfma_f32_16x16x32_bf16 v[136:139], a[192:195], v[112:115], v[136:139]
    buffer_load_dwordx4 v1, s[8:11], s26 offen offset:0 sc1 lds
    v_mfma_f32_16x16x32_bf16 v[148:151], a[192:195], v[116:119], v[148:151]
    s_add_u32 m0, s28, 150528
    s_waitcnt lgkmcnt(4)
    v_mfma_f32_16x16x32_bf16 v[160:163], a[192:195], v[120:123], v[160:163]
    buffer_load_dwordx4 v1, s[8:11], s26 offen offset:1024 sc1 lds
    v_mfma_f32_16x16x32_bf16 v[172:175], a[192:195], v[124:127], v[172:175]
    v_mfma_f32_16x16x32_bf16 v[156:159], a[188:191], v[120:123], v[156:159]
    v_mfma_f32_16x16x32_bf16 v[168:171], a[188:191], v[124:127], v[168:171]
    v_mfma_f32_16x16x32_bf16 v[152:155], a[184:187], v[120:123], v[152:155]
    v_mfma_f32_16x16x32_bf16 v[164:167], a[184:187], v[124:127], v[164:167]
    s_add_u32 m0, s28, 17408
    v_mfma_f32_16x16x32_bf16 v[52:55], a[184:187], v[28:31], v[52:55]
    buffer_load_dwordx4 v1, s[8:11], s26 offen offset:2048 sc1 lds
    v_mfma_f32_16x16x32_bf16 v[56:59], a[188:191], v[28:31], v[56:59]
    s_add_u32 m0, s28, 17408
    v_mfma_f32_16x16x32_bf16 v[60:63], a[192:195], v[28:31], v[60:63]
    s_waitcnt vmcnt(15)
    v_cmp_le_u32 vcc, 6, v27
    s_nop 3
    s_cmp_eq_u64 vcc, -1
    s_cbranch_scc1 L_pdone_22
    s_mov_b32 s68, 0x80000
L_poll_21:
    buffer_load_dword v27, v25, s[8:11], s38 offen sc1
    s_waitcnt vmcnt(0)
    v_cmp_le_u32 vcc, 6, v27
    s_nop 3
    s_cmp_eq_u64 vcc, -1
    s_cbranch_scc1 L_pdone_22
    s_sub_u32 s68, s68, 1
    s_cmp_lg_u32 s68, 0
    s_cbranch_scc1 L_poll_21
L_pdone_22:
    s_waitcnt lgkmcnt(2)
    v_mfma_f32_16x16x32_bf16 v[128:131], a[196:199], v[96:99], v[128:131]
    ds_read_b128 v[112:115], v1 offset:4096
    v_mfma_f32_16x16x32_bf16 v[140:143], a[196:199], v[100:103], v[140:143]
    ds_read_b128 v[116:119], v1 offset:6144
    v_mfma_f32_16x16x32_bf16 v[132:135], a[200:203], v[96:99], v[132:135]
    ds_read_b128 v[120:123], v1 offset:8192
    v_mfma_f32_16x16x32_bf16 v[144:147], a[200:203], v[100:103], v[144:147]
    ds_read_b128 v[124:127], v1 offset:10240
    v_mfma_f32_16x16x32_bf16 v[136:139], a[220:223], v[96:99], v[136:139]
    buffer_load_dwordx4 v1, s[8:11], s26 offen offset:3072 sc1 lds
    v_mfma_f32_16x16x32_bf16 v[148:151], a[220:223], v[100:103], v[148:151]
    s_add_u32 m0, s28, 27648
    s_add_u32 s49, s48, 27344896
    s_waitcnt lgkmcnt(4)
    v_mfma_f32_16x16x32_bf16 v[160:163], a[220:223], v[104:107], v[160:163]
    buffer_load_dwordx4 v1, s[8:11], s49 offen offset:0 sc1 lds
    v_mfma_f32_16x16x32_bf16 v[172:175], a[220:223], v[108:111], v[172:175]
    s_add_u32 m0, s28, 27648
    v_mfma_f32_16x16x32_bf16 v[156:159], a[200:203], v[104:107], v[156:159]
    buffer_load_dwordx4 v1, s[8:11], s49 offen offset:1024 sc1 lds
    v_mfma_f32_16x16x32_bf16 v[168:171], a[200:203], v[108:111], v[168:171]
    s_add_u32 m0, s28, 33792
    v_mfma_f32_16x16x32_bf16 v[152:155], a[196:199], v[104:107], v[152:155]
    buffer_load_dwordx4 v1, s[8:11], s49 offen offset:2048 sc1 lds
    v_mfma_f32_16x16x32_bf16 v[164:167], a[196:199], v[108:111], v[164:167]
    s_add_u32 m0, s28, 33792
    v_mfma_f32_16x16x32_bf16 v[52:55], a[196:199], v[28:31], v[52:55]
    buffer_load_dwordx4 v1, s[8:11], s49 offen offset:3072 sc1 lds
    v_mfma_f32_16x16x32_bf16 v[56:59], a[200:203], v[28:31], v[56:59]
    s_add_u32 m0, s28, 44032
    s_add_u32 s49, s48, 27348992
    v_mfma_f32_16x16x32_bf16 v[60:63], a[220:223], v[28:31], v[60:63]
    s_waitcnt lgkmcnt(2)
    v_mfma_f32_16x16x32_bf16 v[128:131], a[240:243], v[112:115], v[128:131]
    ds_read_b128 v[96:99], v1 offset:11264
    v_mfma_f32_16x16x32_bf16 v[140:143], a[240:243], v[116:119], v[140:143]
    ds_read_b128 v[100:103], v1 offset:13312
    v_mfma_f32_16x16x32_bf16 v[132:135], a[204:207], v[112:115], v[132:135]
    ds_read_b128 v[104:107], v1 offset:15360
    v_mfma_f32_16x16x32_bf16 v[144:147], a[204:207], v[116:119], v[144:147]
    ds_read_b128 v[108:111], v1 offset:17408
    v_mfma_f32_16x16x32_bf16 v[136:139], a[224:227], v[112:115], v[136:139]
    buffer_load_dwordx4 v1, s[8:11], s49 offen offset:0 sc1 lds
    v_mfma_f32_16x16x32_bf16 v[148:151], a[224:227], v[116:119], v[148:151]
    s_add_u32 m0, s28, 44032
    s_waitcnt lgkmcnt(4)
    v_mfma_f32_16x16x32_bf16 v[160:163], a[224:227], v[120:123], v[160:163]
    buffer_load_dwordx4 v1, s[8:11], s49 offen offset:1024 sc1 lds
    v_mfma_f32_16x16x32_bf16 v[172:175], a[224:227], v[124:127], v[172:175]
    s_add_u32 m0, s28, 50176
    v_mfma_f32_16x16x32_bf16 v[156:159], a[204:207], v[120:123], v[156:159]
    buffer_load_dwordx4 v1, s[8:11], s49 offen offset:2048 sc1 lds
    v_mfma_f32_16x16x32_bf16 v[168:171], a[204:207], v[124:127], v[168:171]
    s_add_u32 m0, s28, 50176
    v_mfma_f32_16x16x32_bf16 v[152:155], a[240:243], v[120:123], v[152:155]
    buffer_load_dwordx4 v1, s[8:11], s49 offen offset:3072 sc1 lds
    v_mfma_f32_16x16x32_bf16 v[164:167], a[240:243], v[124:127], v[164:167]
    v_mfma_f32_16x16x32_bf16 v[52:55], a[240:243], v[28:31], v[52:55]
    v_mfma_f32_16x16x32_bf16 v[56:59], a[204:207], v[28:31], v[56:59]
    v_mfma_f32_16x16x32_bf16 v[60:63], a[224:227], v[28:31], v[60:63]
    s_waitcnt lgkmcnt(2)
    v_mfma_f32_16x16x32_bf16 v[128:131], a[244:247], v[96:99], v[128:131]
    ds_read_b128 v[112:115], v1 offset:12288
    s_add_u32 s53, s36, 35262464
    v_mfma_f32_16x16x32_bf16 v[140:143], a[244:247], v[100:103], v[140:143]
    ds_read_b128 v[116:119], v1 offset:14336
    v_mfma_f32_16x16x32_bf16 v[132:135], a[208:211], v[96:99], v[132:135]
    ds_read_b128 v[120:123], v1 offset:16384
    v_mfma_f32_16x16x32_bf16 v[144:147], a[208:211], v[100:103], v[144:147]
    ds_read_b128 v[124:127], v1 offset:18432
    v_mfma_f32_16x16x32_bf16 v[136:139], a[228:231], v[96:99], v[136:139]
    buffer_load_dwordx2 v[200:201], v0, s[8:11], s53 offen offset:0 sc1
    v_mfma_f32_16x16x32_bf16 v[148:151], a[228:231], v[100:103], v[148:151]
    s_waitcnt lgkmcnt(4)
    v_mfma_f32_16x16x32_bf16 v[160:163], a[228:231], v[104:107], v[160:163]
    buffer_load_dwordx2 v[202:203], v0, s[8:11], s53 offen offset:512 sc1
    v_mfma_f32_16x16x32_bf16 v[172:175], a[228:231], v[108:111], v[172:175]
    v_mfma_f32_16x16x32_bf16 v[156:159], a[208:211], v[104:107], v[156:159]
    v_mfma_f32_16x16x32_bf16 v[168:171], a[208:211], v[108:111], v[168:171]
    v_mfma_f32_16x16x32_bf16 v[152:155], a[244:247], v[104:107], v[152:155]
    v_mfma_f32_16x16x32_bf16 v[164:167], a[244:247], v[108:111], v[164:167]
    v_mfma_f32_16x16x32_bf16 v[52:55], a[244:247], v[28:31], v[52:55]
    buffer_load_dwordx2 v[204:205], v0, s[8:11], s53 offen offset:1024 sc1
    v_mfma_f32_16x16x32_bf16 v[56:59], a[208:211], v[28:31], v[56:59]
    buffer_load_dwordx2 v[206:207], v0, s[8:11], s53 offen offset:1536 sc1
    v_mfma_f32_16x16x32_bf16 v[60:63], a[228:231], v[28:31], v[60:63]
    s_waitcnt lgkmcnt(2)
    v_mfma_f32_16x16x32_bf16 v[128:131], a[248:251], v[112:115], v[128:131]
    v_mfma_f32_16x16x32_bf16 v[140:143], a[248:251], v[116:119], v[140:143]
    v_mfma_f32_16x16x32_bf16 v[132:135], a[212:215], v[112:115], v[132:135]
    v_mfma_f32_16x16x32_bf16 v[144:147], a[212:215], v[116:119], v[144:147]
    v_mfma_f32_16x16x32_bf16 v[136:139], a[232:235], v[112:115], v[136:139]
    v_mfma_f32_16x16x32_bf16 v[148:151], a[232:235], v[116:119], v[148:151]
    s_waitcnt lgkmcnt(0)
    v_mfma_f32_16x16x32_bf16 v[160:163], a[232:235], v[120:123], v[160:163]
    v_mfma_f32_16x16x32_bf16 v[172:175], a[232:235], v[124:127], v[172:175]
    v_mfma_f32_16x16x32_bf16 v[156:159], a[212:215], v[120:123], v[156:159]
    buffer_load_dwordx2 v[208:209], v0, s[8:11], s53 offen offset:2048 sc1
    v_mfma_f32_16x16x32_bf16 v[168:171], a[212:215], v[124:127], v[168:171]
    buffer_load_dwordx2 v[210:211], v0, s[8:11], s53 offen offset:2560 sc1
    v_mfma_f32_16x16x32_bf16 v[152:155], a[248:251], v[120:123], v[152:155]
    buffer_load_dwordx2 v[212:213], v0, s[8:11], s53 offen offset:3072 sc1
    v_mfma_f32_16x16x32_bf16 v[164:167], a[248:251], v[124:127], v[164:167]
    v_mfma_f32_16x16x32_bf16 v[52:55], a[248:251], v[28:31], v[52:55]
    buffer_load_dwordx2 v[214:215], v0, s[8:11], s53 offen offset:3584 sc1
    v_mfma_f32_16x16x32_bf16 v[56:59], a[212:215], v[28:31], v[56:59]
    s_add_u32 m0, s28, 60416
    s_add_u32 s49, s48, 27353088
    v_mfma_f32_16x16x32_bf16 v[60:63], a[232:235], v[28:31], v[60:63]
    buffer_load_dwordx4 v1, s[8:11], s49 offen offset:0 sc1 lds
    s_add_u32 m0, s28, 60416
    s_nop 0
    buffer_load_dwordx4 v1, s[8:11], s49 offen offset:1024 sc1 lds
    s_add_u32 s56, s33, 14680064
    v_pk_fma_f32 v[128:129], v[80:81], v[52:53], v[128:129] op_sel:[0,0,0] op_sel_hi:[0,1,1] neg_lo:[1,0,0] neg_hi:[1,0,0]
    v_pk_fma_f32 v[130:131], v[80:81], v[54:55], v[130:131] op_sel:[0,0,0] op_sel_hi:[0,1,1] neg_lo:[1,0,0] neg_hi:[1,0,0]
    v_pk_fma_f32 v[140:141], v[80:81], v[52:53], v[140:141] op_sel:[1,0,0] op_sel_hi:[1,1,1] neg_lo:[1,0,0] neg_hi:[1,0,0]
    v_pk_fma_f32 v[142:143], v[80:81], v[54:55], v[142:143] op_sel:[1,0,0] op_sel_hi:[1,1,1] neg_lo:[1,0,0] neg_hi:[1,0,0]
    v_pk_fma_f32 v[152:153], v[82:83], v[52:53], v[152:153] op_sel:[0,0,0] op_sel_hi:[0,1,1] neg_lo:[1,0,0] neg_hi:[1,0,0]
    v_pk_fma_f32 v[154:155], v[82:83], v[54:55], v[154:155] op_sel:[0,0,0] op_sel_hi:[0,1,1] neg_lo:[1,0,0] neg_hi:[1,0,0]
    v_pk_fma_f32 v[164:165], v[82:83], v[52:53], v[164:165] op_sel:[1,0,0] op_sel_hi:[1,1,1] neg_lo:[1,0,0] neg_hi:[1,0,0]
    v_pk_fma_f32 v[166:167], v[82:83], v[54:55], v[166:167] op_sel:[1,0,0] op_sel_hi:[1,1,1] neg_lo:[1,0,0] neg_hi:[1,0,0]
    v_pk_mul_f32 v[128:129], v[84:85], v[128:129] op_sel:[0,0] op_sel_hi:[0,1]
    v_pk_mul_f32 v[140:141], v[84:85], v[140:141] op_sel:[1,0] op_sel_hi:[1,1]
    v_pk_mul_f32 v[152:153], v[86:87], v[152:153] op_sel:[0,0] op_sel_hi:[0,1]
    v_pk_mul_f32 v[164:165], v[86:87], v[164:165] op_sel:[1,0] op_sel_hi:[1,1]
    v_exp_f32 v128, v128
    v_exp_f32 v129, v129
    v_exp_f32 v140, v140
    v_exp_f32 v141, v141
    v_exp_f32 v152, v152
    v_exp_f32 v153, v153
    s_add_u32 m0, s28, 66560
    s_nop 0
    buffer_load_dwordx4 v1, s[8:11], s49 offen offset:2048 sc1 lds
    v_exp_f32 v164, v164
    v_exp_f32 v165, v165
    s_add_u32 m0, s28, 66560
    s_nop 0
    buffer_load_dwordx4 v1, s[8:11], s49 offen offset:3072 sc1 lds
    v_pk_fma_f32 v[128:129], v[128:129], v[88:89], v[88:89] op_sel:[0,0,0] op_sel_hi:[1,0,0]
    v_pk_fma_f32 v[140:141], v[140:141], v[88:89], v[88:89] op_sel:[0,1,1] op_sel_hi:[1,1,1]
    v_pk_fma_f32 v[152:153], v[152:153], v[90:91], v[90:91] op_sel:[0,0,0] op_sel_hi:[1,0,0]
    v_pk_fma_f32 v[164:165], v[164:165], v[90:91], v[90:91] op_sel:[0,1,1] op_sel_hi:[1,1,1]
    v_rcp_f32 v128, v128
    s_add_u32 m0, s28, 76800
    s_add_u32 s49, s48, 27357184
    buffer_load_dwordx4 v1, s[8:11], s49 offen offset:0 sc1 lds
    v_rcp_f32 v129, v129
    v_rcp_f32 v140, v140
    s_add_u32 m0, s28, 76800
    s_nop 0
    buffer_load_dwordx4 v1, s[8:11], s49 offen offset:1024 sc1 lds
    v_rcp_f32 v141, v141
    v_rcp_f32 v152, v152
    v_rcp_f32 v153, v153
    v_rcp_f32 v164, v164
    v_rcp_f32 v165, v165
    v_pk_mul_f32 v[128:129], v[128:129], v[130:131]
    v_pk_mul_f32 v[140:141], v[140:141], v[142:143]
    v_pk_mul_f32 v[152:153], v[152:153], v[154:155]
    v_pk_mul_f32 v[164:165], v[164:165], v[166:167]
    v_cvt_pk_bf16_f32 v176, v128, v129
    v_cvt_pk_bf16_f32 v177, v140, v141
    v_cvt_pk_bf16_f32 v178, v152, v153
    v_cvt_pk_bf16_f32 v179, v164, v165
    s_nop 0
    v_permlane32_swap_b32 v176, v178
    v_permlane32_swap_b32 v177, v179
    s_nop 1
    v_permlane16_swap_b32 v176, v177
    v_permlane16_swap_b32 v178, v179
    buffer_store_dwordx4 v[176:179], v24, s[8:11], s56 offen offset:0 sc1
    v_pk_fma_f32 v[132:133], v[80:81], v[56:57], v[132:133] op_sel:[0,0,0] op_sel_hi:[0,1,1] neg_lo:[1,0,0] neg_hi:[1,0,0]
    v_pk_fma_f32 v[134:135], v[80:81], v[58:59], v[134:135] op_sel:[0,0,0] op_sel_hi:[0,1,1] neg_lo:[1,0,0] neg_hi:[1,0,0]
    v_pk_fma_f32 v[144:145], v[80:81], v[56:57], v[144:145] op_sel:[1,0,0] op_sel_hi:[1,1,1] neg_lo:[1,0,0] neg_hi:[1,0,0]
    v_pk_fma_f32 v[146:147], v[80:81], v[58:59], v[146:147] op_sel:[1,0,0] op_sel_hi:[1,1,1] neg_lo:[1,0,0] neg_hi:[1,0,0]
    v_pk_fma_f32 v[156:157], v[82:83], v[56:57], v[156:157] op_sel:[0,0,0] op_sel_hi:[0,1,1] neg_lo:[1,0,0] neg_hi:[1,0,0]
    v_pk_fma_f32 v[158:159], v[82:83], v[58:59], v[158:159] op_sel:[0,0,0] op_sel_hi:[0,1,1] neg_lo:[1,0,0] neg_hi:[1,0,0]
    v_pk_fma_f32 v[168:169], v[82:83], v[56:57], v[168:169] op_sel:[1,0,0] op_sel_hi:[1,1,1] neg_lo:[1,0,0] neg_hi:[1,0,0]
    v_pk_fma_f32 v[170:171], v[82:83], v[58:59], v[170:171] op_sel:[1,0,0] op_sel_hi:[1,1,1] neg_lo:[1,0,0] neg_hi:[1,0,0]
    v_pk_mul_f32 v[132:133], v[84:85], v[132:133] op_sel:[0,0] op_sel_hi:[0,1]
    v_pk_mul_f32 v[144:145], v[84:85], v[144:145] op_sel:[1,0] op_sel_hi:[1,1]
    v_pk_mul_f32 v[156:157], v[86:87], v[156:157] op_sel:[0,0] op_sel_hi:[0,1]
    v_pk_mul_f32 v[168:169], v[86:87], v[168:169] op_sel:[1,0] op_sel_hi:[1,1]
    v_exp_f32 v132, v132
    v_exp_f32 v133, v133
    v_exp_f32 v144, v144
    v_exp_f32 v145, v145
    v_exp_f32 v156, v156
    v_exp_f32 v157, v157
    v_exp_f32 v168, v168
    v_exp_f32 v169, v169
    v_pk_fma_f32 v[132:133], v[132:133], v[88:89], v[88:89] op_sel:[0,0,0] op_sel_hi:[1,0,0]
    v_pk_fma_f32 v[144:145], v[144:145], v[88:89], v[88:89] op_sel:[0,1,1] op_sel_hi:[1,1,1]
    v_pk_fma_f32 v[156:157], v[156:157], v[90:91], v[90:91] op_sel:[0,0,0] op_sel_hi:[1,0,0]
    v_pk_fma_f32 v[168:169], v[168:169], v[90:91], v[90:91] op_sel:[0,1,1] op_sel_hi:[1,1,1]
    v_rcp_f32 v132, v132
    v_rcp_f32 v133, v133
    v_rcp_f32 v144, v144
    v_rcp_f32 v145, v145
    s_add_u32 m0, s28, 82944
    s_nop 0
    buffer_load_dwordx4 v1, s[8:11], s49 offen offset:2048 sc1 lds
    v_rcp_f32 v156, v156
    v_rcp_f32 v157, v157
    v_rcp_f32 v168, v168
    v_rcp_f32 v169, v169
    v_pk_mul_f32 v[132:133], v[132:133], v[134:135]
    v_pk_mul_f32 v[144:145], v[144:145], v[146:147]
    v_pk_mul_f32 v[156:157], v[156:157], v[158:159]
    v_pk_mul_f32 v[168:169], v[168:169], v[170:171]
    v_cvt_pk_bf16_f32 v180, v132, v133
    v_cvt_pk_bf16_f32 v181, v144, v145
    v_cvt_pk_bf16_f32 v182, v156, v157
    v_cvt_pk_bf16_f32 v183, v168, v169
    s_nop 0
    v_permlane32_swap_b32 v180, v182
    v_permlane32_swap_b32 v181, v183
    s_nop 1
    v_permlane16_swap_b32 v180, v181
    v_permlane16_swap_b32 v182, v183
    buffer_store_dwordx4 v[180:183], v24, s[8:11], s56 offen offset:256 sc1
    v_pk_fma_f32 v[136:137], v[80:81], v[60:61], v[136:137] op_sel:[0,0,0] op_sel_hi:[0,1,1] neg_lo:[1,0,0] neg_hi:[1,0,0]
    v_pk_fma_f32 v[138:139], v[80:81], v[62:63], v[138:139] op_sel:[0,0,0] op_sel_hi:[0,1,1] neg_lo:[1,0,0] neg_hi:[1,0,0]
    v_pk_fma_f32 v[148:149], v[80:81], v[60:61], v[148:149] op_sel:[1,0,0] op_sel_hi:[1,1,1] neg_lo:[1,0,0] neg_hi:[1,0,0]
    v_pk_fma_f32 v[150:151], v[80:81], v[62:63], v[150:151] op_sel:[1,0,0] op_sel_hi:[1,1,1] neg_lo:[1,0,0] neg_hi:[1,0,0]
    v_pk_fma_f32 v[160:161], v[82:83], v[60:61], v[160:161] op_sel:[0,0,0] op_sel_hi:[0,1,1] neg_lo:[1,0,0] neg_hi:[1,0,0]
    v_pk_fma_f32 v[162:163], v[82:83], v[62:63], v[162:163] op_sel:[0,0,0] op_sel_hi:[0,1,1] neg_lo:[1,0,0] neg_hi:[1,0,0]
    v_pk_fma_f32 v[172:173], v[82:83], v[60:61], v[172:173] op_sel:[1,0,0] op_sel_hi:[1,1,1] neg_lo:[1,0,0] neg_hi:[1,0,0]
    v_pk_fma_f32 v[174:175], v[82:83], v[62:63], v[174:175] op_sel:[1,0,0] op_sel_hi:[1,1,1] neg_lo:[1,0,0] neg_hi:[1,0,0]
    v_pk_mul_f32 v[136:137], v[84:85], v[136:137] op_sel:[0,0] op_sel_hi:[0,1]
    v_pk_mul_f32 v[148:149], v[84:85], v[148:149] op_sel:[1,0] op_sel_hi:[1,1]
    v_pk_mul_f32 v[160:161], v[86:87], v[160:161] op_sel:[0,0] op_sel_hi:[0,1]
    v_pk_mul_f32 v[172:173], v[86:87], v[172:173] op_sel:[1,0] op_sel_hi:[1,1]
    v_exp_f32 v136, v136
    v_exp_f32 v137, v137
    v_exp_f32 v148, v148
    v_exp_f32 v149, v149
    v_exp_f32 v160, v160
    v_exp_f32 v161, v161
    s_add_u32 m0, s28, 82944
    s_nop 0
    buffer_load_dwordx4 v1, s[8:11], s49 offen offset:3072 sc1 lds
    v_exp_f32 v172, v172
    v_exp_f32 v173, v173
    v_pk_fma_f32 v[136:137], v[136:137], v[88:89], v[88:89] op_sel:[0,0,0] op_sel_hi:[1,0,0]
    v_pk_fma_f32 v[148:149], v[148:149], v[88:89], v[88:89] op_sel:[0,1,1] op_sel_hi:[1,1,1]
    v_pk_fma_f32 v[160:161], v[160:161], v[90:91], v[90:91] op_sel:[0,0,0] op_sel_hi:[1,0,0]
    v_pk_fma_f32 v[172:173], v[172:173], v[90:91], v[90:91] op_sel:[0,1,1] op_sel_hi:[1,1,1]
    v_rcp_f32 v136, v136
    v_rcp_f32 v137, v137
    v_rcp_f32 v148, v148
    s_add_u32 m0, s28, 93184
    s_add_u32 s49, s48, 27361280
    buffer_load_dwordx4 v1, s[8:11], s49 offen offset:0 sc1 lds
    v_rcp_f32 v149, v149
    s_add_u32 m0, s28, 93184
    s_nop 0
    buffer_load_dwordx4 v1, s[8:11], s49 offen offset:1024 sc1 lds
    v_rcp_f32 v160, v160
    v_rcp_f32 v161, v161
    v_rcp_f32 v172, v172
    v_rcp_f32 v173, v173
    v_pk_mul_f32 v[136:137], v[136:137], v[138:139]
    v_pk_mul_f32 v[148:149], v[148:149], v[150:151]
    v_pk_mul_f32 v[160:161], v[160:161], v[162:163]
    v_pk_mul_f32 v[172:173], v[172:173], v[174:175]
    s_waitcnt vmcnt(20)
    s_barrier
    ds_read_b128 v[96:99], v1 offset:27648
    ds_read_b128 v[100:103], v1 offset:29696
    ds_read_b128 v[104:107], v1 offset:31744
    ds_read_b128 v[108:111], v1 offset:33792
    v_cvt_pk_bf16_f32 v184, v136, v137
    v_cvt_pk_bf16_f32 v185, v148, v149
    v_cvt_pk_bf16_f32 v186, v160, v161
    s_add_u32 m0, s28, 99328
    s_nop 0
    buffer_load_dwordx4 v1, s[8:11], s49 offen offset:2048 sc1 lds
    v_cvt_pk_bf16_f32 v187, v172, v173
    v_permlane32_swap_b32 v184, v186
    s_nop 0
    v_permlane32_swap_b32 v185, v187
    s_add_u32 m0, s28, 99328
    s_nop 0
    buffer_load_dwordx4 v1, s[8:11], s49 offen offset:3072 sc1 lds
    v_permlane16_swap_b32 v184, v185
    v_permlane16_swap_b32 v186, v187
    buffer_store_dwordx4 v[184:187], v24, s[8:11], s56 offen offset:512 sc1
    s_waitcnt lgkmcnt(2)
    v_mfma_f32_16x16x32_bf16 v[128:131], a[4:7], v[96:99], 0
    ds_read_b128 v[112:115], v1 offset:28672
    v_mfma_f32_16x16x32_bf16 v[140:143], a[4:7], v[100:103], 0
    ds_read_b128 v[116:119], v1 offset:30720
    v_mfma_f32_16x16x32_bf16 v[132:135], a[8:11], v[96:99], 0
    ds_read_b128 v[120:123], v1 offset:32768
    v_mfma_f32_16x16x32_bf16 v[144:147], a[8:11], v[100:103], 0
    ds_read_b128 v[124:127], v1 offset:34816
    v_mfma_f32_16x16x32_bf16 v[136:139], a[12:15], v[96:99], 0
    v_mfma_f32_16x16x32_bf16 v[148:151], a[12:15], v[100:103], 0
    s_waitcnt lgkmcnt(4)
    v_mfma_f32_16x16x32_bf16 v[160:163], a[12:15], v[104:107], 0
    v_mfma_f32_16x16x32_bf16 v[172:175], a[12:15], v[108:111], 0
    v_mfma_f32_16x16x32_bf16 v[156:159], a[8:11], v[104:107], 0
    v_mfma_f32_16x16x32_bf16 v[168:171], a[8:11], v[108:111], 0
    v_mfma_f32_16x16x32_bf16 v[152:155], a[4:7], v[104:107], 0
    v_mfma_f32_16x16x32_bf16 v[164:167], a[4:7], v[108:111], 0
    s_waitcnt lgkmcnt(2)
    v_mfma_f32_16x16x32_bf16 v[128:131], a[16:19], v[112:115], v[128:131]
    ds_read_b128 v[96:99], v1 offset:35840
    ds_read_b128 a[4:7], v95 offset:52224
    v_mfma_f32_16x16x32_bf16 v[140:143], a[16:19], v[116:119], v[140:143]
    ds_read_b128 v[100:103], v1 offset:37888
    ds_read_b128 a[8:11], v95 offset:53248
    v_mfma_f32_16x16x32_bf16 v[132:135], a[20:23], v[112:115], v[132:135]
    ds_read_b128 v[104:107], v1 offset:39936
    ds_read_b128 a[12:15], v95 offset:60416
    v_mfma_f32_16x16x32_bf16 v[144:147], a[20:23], v[116:119], v[144:147]
    ds_read_b128 v[108:111], v1 offset:41984
    v_mfma_f32_16x16x32_bf16 v[136:139], a[24:27], v[112:115], v[136:139]
    v_mfma_f32_16x16x32_bf16 v[148:151], a[24:27], v[116:119], v[148:151]
    s_waitcnt lgkmcnt(7)
    v_mfma_f32_16x16x32_bf16 v[160:163], a[24:27], v[120:123], v[160:163]
    v_mfma_f32_16x16x32_bf16 v[172:175], a[24:27], v[124:127], v[172:175]
    v_mfma_f32_16x16x32_bf16 v[156:159], a[20:23], v[120:123], v[156:159]
    v_mfma_f32_16x16x32_bf16 v[168:171], a[20:23], v[124:127], v[168:171]
    v_mfma_f32_16x16x32_bf16 v[152:155], a[16:19], v[120:123], v[152:155]
    v_mfma_f32_16x16x32_bf16 v[164:167], a[16:19], v[124:127], v[164:167]
    s_waitcnt vmcnt(15)
    s_waitcnt lgkmcnt(4)
    v_mfma_f32_16x16x32_bf16 v[128:131], a[28:31], v[96:99], v[128:131]
    ds_read_b128 v[112:115], v1 offset:36864
    ds_read_b128 a[16:19], v95 offset:61440
    v_mfma_f32_16x16x32_bf16 v[140:143], a[28:31], v[100:103], v[140:143]
    ds_read_b128 v[116:119], v1 offset:38912
    ds_read_b128 a[20:23], v21 offset:3072
    v_mfma_f32_16x16x32_bf16 v[132:135], a[32:35], v[96:99], v[132:135]
    ds_read_b128 v[120:123], v1 offset:40960
    ds_read_b128 a[24:27], v21 offset:4096
    v_mfma_f32_16x16x32_bf16 v[144:147], a[32:35], v[100:103], v[144:147]
    ds_read_b128 v[124:127], v1 offset:43008
    v_add_f32 v200, v200, v208
    v_mfma_f32_16x16x32_bf16 v[136:139], a[36:39], v[96:99], v[136:139]
    v_add_f32 v201, v201, v209
    v_add_f32 v202, v202, v210
    v_mfma_f32_16x16x32_bf16 v[148:151], a[36:39], v[100:103], v[148:151]
    v_add_f32 v203, v203, v211
    s_waitcnt lgkmcnt(7)
    v_mfma_f32_16x16x32_bf16 v[160:163], a[36:39], v[104:107], v[160:163]
    s_add_u32 m0, s28, 117760
    s_add_u32 s26, s25, 16384
    v_mfma_f32_16x16x32_bf16 v[172:175], a[36:39], v[108:111], v[172:175]
    buffer_load_dwordx4 v1, s[8:11], s26 offen offset:0 sc1 lds
    v_mfma_f32_16x16x32_bf16 v[156:159], a[32:35], v[104:107], v[156:159]
    s_add_u32 m0, s28, 117760
    v_add_f32 v204, v204, v212
    v_mfma_f32_16x16x32_bf16 v[168:171], a[32:35], v[108:111], v[168:171]
    buffer_load_dwordx4 v1, s[8:11], s26 offen offset:1024 sc1 lds
    v_mfma_f32_16x16x32_bf16 v[152:155], a[28:31], v[104:107], v[152:155]
    v_add_f32 v205, v205, v213
    v_add_f32 v206, v206, v214
    v_mfma_f32_16x16x32_bf16 v[164:167], a[28:31], v[108:111], v[164:167]
    v_add_f32 v207, v207, v215
    s_waitcnt lgkmcnt(4)
    v_mfma_f32_16x16x32_bf16 v[128:131], a[40:43], v[112:115], v[128:131]
    ds_read_b128 v[96:99], v1 offset:44032
    ds_read_b128 a[28:31], v21 offset:11264
    v_mfma_f32_16x16x32_bf16 v[140:143], a[40:43], v[116:119], v[140:143]
    ds_read_b128 v[100:103], v1 offset:46080
    ds_read_b128 a[32:35], v21 offset:12288
    v_mfma_f32_16x16x32_bf16 v[132:135], a[44:47], v[112:115], v[132:135]
    ds_read_b128 v[104:107], v1 offset:48128
    ds_read_b128 a[36:39], v21 offset:19456
    v_mfma_f32_16x16x32_bf16 v[144:147], a[44:47], v[116:119], v[144:147]
    ds_read_b128 v[108:111], v1 offset:50176
    s_add_u32 m0, s28, 123904
    v_mfma_f32_16x16x32_bf16 v[136:139], a[48:51], v[112:115], v[136:139]
    buffer_load_dwordx4 v1, s[8:11], s26 offen offset:2048 sc1 lds
    v_mfma_f32_16x16x32_bf16 v[148:151], a[48:51], v[116:119], v[148:151]
    s_add_u32 m0, s28, 123904
    s_waitcnt lgkmcnt(7)
    v_mfma_f32_16x16x32_bf16 v[160:163], a[48:51], v[120:123], v[160:163]
    buffer_load_dwordx4 v1, s[8:11], s26 offen offset:3072 sc1 lds
    v_mfma_f32_16x16x32_bf16 v[172:175], a[48:51], v[124:127], v[172:175]
    s_add_u32 m0, s28, 134144
    s_add_u32 s26, s25, 20480
    v_mfma_f32_16x16x32_bf16 v[156:159], a[44:47], v[120:123], v[156:159]
    buffer_load_dwordx4 v1, s[8:11], s26 offen offset:0 sc1 lds
    v_mfma_f32_16x16x32_bf16 v[168:171], a[44:47], v[124:127], v[168:171]
    s_add_u32 m0, s28, 134144
    v_add_f32 v200, v200, v204
    v_mfma_f32_16x16x32_bf16 v[152:155], a[40:43], v[120:123], v[152:155]
    buffer_load_dwordx4 v1, s[8:11], s26 offen offset:1024 sc1 lds
    v_mfma_f32_16x16x32_bf16 v[164:167], a[40:43], v[124:127], v[164:167]
    v_add_f32 v201, v201, v205
    s_waitcnt lgkmcnt(4)
    v_mfma_f32_16x16x32_bf16 v[128:131], a[52:55], v[96:99], v[128:131]
    ds_read_b128 v[112:115], v1 offset:45056
    ds_read_b128 a[40:43], v21 offset:20480
    v_mfma_f32_16x16x32_bf16 v[140:143], a[52:55], v[100:103], v[140:143]
    ds_read_b128 v[116:119], v1 offset:47104
    ds_read_b128 a[44:47], v94 offset:19456
    v_mfma_f32_16x16x32_bf16 v[132:135], a[56:59], v[96:99], v[132:135]
    ds_read_b128 v[120:123], v1 offset:49152
    ds_read_b128 a[48:51], v94 offset:20480
    v_mfma_f32_16x16x32_bf16 v[144:147], a[56:59], v[100:103], v[144:147]
    ds_read_b128 v[124:127], v1 offset:51200
    v_add_f32 v202, v202, v206
    v_mfma_f32_16x16x32_bf16 v[136:139], a[60:63], v[96:99], v[136:139]
    v_add_f32 v203, v203, v207
    v_add_f32 v200, v200, v202
    v_mfma_f32_16x16x32_bf16 v[148:151], a[60:63], v[100:103], v[148:151]
    v_add_f32 v201, v201, v203
    s_waitcnt lgkmcnt(7)
    v_mfma_f32_16x16x32_bf16 v[160:163], a[60:63], v[104:107], v[160:163]
    s_add_u32 m0, s28, 140288
    v_mul_f32 v80, s64, v200
    v_mfma_f32_16x16x32_bf16 v[172:175], a[60:63], v[108:111], v[172:175]
    buffer_load_dwordx4 v1, s[8:11], s26 offen offset:2048 sc1 lds
    v_mfma_f32_16x16x32_bf16 v[156:159], a[56:59], v[104:107], v[156:159]
    s_add_u32 m0, s28, 140288
    v_mul_f32 v201, s64, v201
    v_mfma_f32_16x16x32_bf16 v[168:171], a[56:59], v[108:111], v[168:171]
    buffer_load_dwordx4 v1, s[8:11], s26 offen offset:3072 sc1 lds
    v_mfma_f32_16x16x32_bf16 v[152:155], a[52:55], v[104:107], v[152:155]
    v_fma_f32 v201, -v80, v80, v201
    v_max_f32 v201, 0, v201
    v_mfma_f32_16x16x32_bf16 v[164:167], a[52:55], v[108:111], v[164:167]
    v_add_f32 v201, s65, v201
    s_waitcnt lgkmcnt(4)
    v_mfma_f32_16x16x32_bf16 v[128:131], a[64:67], v[112:115], v[128:131]
    ds_read_b128 v[96:99], v1 offset:52224
    s_add_u32 m0, s28, 150528
    s_add_u32 s26, s25, 24576
    v_mfma_f32_16x16x32_bf16 v[140:143], a[64:67], v[116:119], v[140:143]
    ds_read_b128 v[100:103], v1 offset:54272
    v_mfma_f32_16x16x32_bf16 v[132:135], a[68:71], v[112:115], v[132:135]
    ds_read_b128 v[104:107], v1 offset:56320
    v_mfma_f32_16x16x32_bf16 v[144:147], a[68:71], v[116:119], v[144:147]
    ds_read_b128 v[108:111], v1 offset:58368
    v_mfma_f32_16x16x32_bf16 v[136:139], a[72:75], v[112:115], v[136:139]
    buffer_load_dwordx4 v1, s[8:11], s26 offen offset:0 sc1 lds
    v_mfma_f32_16x16x32_bf16 v[148:151], a[72:75], v[116:119], v[148:151]
    s_waitcnt lgkmcnt(4)
    v_mfma_f32_16x16x32_bf16 v[160:163], a[72:75], v[120:123], v[160:163]
    v_rsq_f32 v84, v201
    v_mfma_f32_16x16x32_bf16 v[172:175], a[72:75], v[124:127], v[172:175]
    v_mul_f32 v88, v201, v84
    v_mul_f32 v84, s66, v84
    v_mfma_f32_16x16x32_bf16 v[156:159], a[68:71], v[120:123], v[156:159]
    v_mov_b32 v82, v80
    v_mov_b32 v86, v84
    v_mfma_f32_16x16x32_bf16 v[168:171], a[68:71], v[124:127], v[168:171]
    s_add_u32 m0, s28, 150528
    v_mov_b32 v90, v88
    v_mfma_f32_16x16x32_bf16 v[152:155], a[64:67], v[120:123], v[152:155]
    buffer_load_dwordx4 v1, s[8:11], s26 offen offset:1024 sc1 lds
    v_mfma_f32_16x16x32_bf16 v[164:167], a[64:67], v[124:127], v[164:167]
    s_waitcnt lgkmcnt(2)
    v_mfma_f32_16x16x32_bf16 v[128:131], a[76:79], v[96:99], v[128:131]
    ds_read_b128 v[112:115], v1 offset:53248
    v_mfma_f32_16x16x32_bf16 v[140:143], a[76:79], v[100:103], v[140:143]
    ds_read_b128 v[116:119], v1 offset:55296
    v_mfma_f32_16x16x32_bf16 v[132:135], a[80:83], v[96:99], v[132:135]
    ds_read_b128 v[120:123], v1 offset:57344
    v_mfma_f32_16x16x32_bf16 v[144:147], a[80:83], v[100:103], v[144:147]
    ds_read_b128 v[124:127], v1 offset:59392
    v_mfma_f32_16x16x32_bf16 v[136:139], a[84:87], v[96:99], v[136:139]
    v_permlane32_swap_b32 v80, v82
    v_mfma_f32_16x16x32_bf16 v[148:151], a[84:87], v[100:103], v[148:151]
    s_waitcnt lgkmcnt(4)
    v_mfma_f32_16x16x32_bf16 v[160:163], a[84:87], v[104:107], v[160:163]
    v_permlane32_swap_b32 v84, v86
    v_mfma_f32_16x16x32_bf16 v[172:175], a[84:87], v[108:111], v[172:175]
    v_permlane32_swap_b32 v88, v90
    v_mfma_f32_16x16x32_bf16 v[156:159], a[80:83], v[104:107], v[156:159]
    v_mov_b32 v81, v80
    v_mov_b32 v83, v82
    v_mfma_f32_16x16x32_bf16 v[168:171], a[80:83], v[108:111], v[168:171]
    v_mov_b32 v85, v84
    v_mov_b32 v87, v86
    v_mfma_f32_16x16x32_bf16 v[152:155], a[76:79], v[104:107], v[152:155]
    v_mov_b32 v89, v88
    v_mov_b32 v91, v90
    v_mfma_f32_16x16x32_bf16 v[164:167], a[76:79], v[108:111], v[164:167]
    s_waitcnt vmcnt(19)
    s_waitcnt lgkmcnt(0)
    s_waitcnt vmcnt(10)
    s_barrier
    v_mov_b32 v199, 7
    buffer_store_dword v199, v26, s[8:11], s37 offen sc1
    v_mfma_f32_16x16x32_bf16 v[128:131], a[88:91], v[112:115], v[128:131]
    ds_read_b128 v[96:99], v1 offset:60416
    v_mfma_f32_16x16x32_bf16 v[140:143], a[88:91], v[116:119], v[140:143]
    ds_read_b128 v[100:103], v1 offset:62464
    v_mfma_f32_16x16x32_bf16 v[132:135], a[92:95], v[112:115], v[132:135]
    ds_read_b128 v[104:107], v1 offset:64512
    v_mfma_f32_16x16x32_bf16 v[144:147], a[92:95], v[116:119], v[144:147]
    ds_read_b128 v[108:111], v2 offset:1024
    v_mfma_f32_16x16x32_bf16 v[136:139], a[96:99], v[112:115], v[136:139]
    v_permlane16_swap_b32 v80, v81
    v_mfma_f32_16x16x32_bf16 v[148:151], a[96:99], v[116:119], v[148:151]
    v_mfma_f32_16x16x32_bf16 v[160:163], a[96:99], v[120:123], v[160:163]
    v_permlane16_swap_b32 v82, v83
    v_mfma_f32_16x16x32_bf16 v[172:175], a[96:99], v[124:127], v[172:175]
    v_permlane16_swap_b32 v84, v85
    v_mfma_f32_16x16x32_bf16 v[156:159], a[92:95], v[120:123], v[156:159]
    v_permlane16_swap_b32 v86, v87
    v_mfma_f32_16x16x32_bf16 v[168:171], a[92:95], v[124:127], v[168:171]
    v_permlane16_swap_b32 v88, v89
    v_mfma_f32_16x16x32_bf16 v[152:155], a[88:91], v[120:123], v[152:155]
    v_permlane16_swap_b32 v90, v91
    v_mfma_f32_16x16x32_bf16 v[164:167], a[88:91], v[124:127], v[164:167]
    s_waitcnt lgkmcnt(2)
    v_mfma_f32_16x16x32_bf16 v[128:131], a[100:103], v[96:99], v[128:131]
    ds_read_b128 v[112:115], v1 offset:61440
    v_mfma_f32_16x16x32_bf16 v[140:143], a[100:103], v[100:103], v[140:143]
    ds_read_b128 v[116:119], v1 offset:63488
    v_mfma_f32_16x16x32_bf16 v[132:135], a[104:107], v[96:99], v[132:135]
    ds_read_b128 v[120:123], v2 offset:0
    s_waitcnt vmcnt(10)
    ds_read_b128 a[56:59], v95 offset:52224
    v_mfma_f32_16x16x32_bf16 v[144:147], a[104:107], v[100:103], v[144:147]
    ds_read_b128 v[124:127], v2 offset:2048
    s_waitcnt vmcnt(9)
    ds_read_b128 a[60:63], v95 offset:53248
    v_mfma_f32_16x16x32_bf16 v[136:139], a[108:111], v[96:99], v[136:139]
    buffer_load_dwordx4 a[52:55], v1, s[8:11], s26 offen offset:2048 sc1
    v_mfma_f32_16x16x32_bf16 v[148:151], a[108:111], v[100:103], v[148:151]
    s_waitcnt vmcnt(9)
    ds_read_b128 a[64:67], v95 offset:60416
    s_waitcnt lgkmcnt(7)
    v_mfma_f32_16x16x32_bf16 v[160:163], a[108:111], v[104:107], v[160:163]
    buffer_load_dwordx4 a[68:71], v1, s[8:11], s26 offen offset:3072 sc1
    v_mfma_f32_16x16x32_bf16 v[172:175], a[108:111], v[108:111], v[172:175]
    s_waitcnt vmcnt(9)
    ds_read_b128 a[72:75], v95 offset:61440
    v_mfma_f32_16x16x32_bf16 v[156:159], a[104:107], v[104:107], v[156:159]
    v_mfma_f32_16x16x32_bf16 v[168:171], a[104:107], v[108:111], v[168:171]
    s_waitcnt vmcnt(8)
    ds_read_b128 a[76:79], v21 offset:3072
    v_mfma_f32_16x16x32_bf16 v[152:155], a[100:103], v[104:107], v[152:155]
    v_mfma_f32_16x16x32_bf16 v[164:167], a[100:103], v[108:111], v[164:167]
    s_waitcnt vmcnt(7)
    ds_read_b128 a[80:83], v21 offset:4096
    s_waitcnt lgkmcnt(8)
    v_mfma_f32_16x16x32_bf16 v[128:131], a[112:115], v[112:115], v[128:131]
    ds_read_b128 v[96:99], v2 offset:3072
    s_add_u32 s26, s25, 28672
    v_mfma_f32_16x16x32_bf16 v[140:143], a[112:115], v[116:119], v[140:143]
    ds_read_b128 v[100:103], v2 offset:5120
    v_mfma_f32_16x16x32_bf16 v[132:135], a[116:119], v[112:115], v[132:135]
    ds_read_b128 v[104:107], v2 offset:7168
    v_mfma_f32_16x16x32_bf16 v[144:147], a[116:119], v[116:119], v[144:147]
    ds_read_b128 v[108:111], v2 offset:9216
    v_mfma_f32_16x16x32_bf16 v[136:139], a[120:123], v[112:115], v[136:139]
    buffer_load_dwordx4 a[84:87], v1, s[8:11], s26 offen offset:0 sc1
    v_mfma_f32_16x16x32_bf16 v[148:151], a[120:123], v[116:119], v[148:151]
    s_waitcnt lgkmcnt(9)
    v_mfma_f32_16x16x32_bf16 v[160:163], a[120:123], v[120:123], v[160:163]
    buffer_load_dwordx4 a[88:91], v1, s[8:11], s26 offen offset:1024 sc1
    v_mfma_f32_16x16x32_bf16 v[172:175], a[120:123], v[124:127], v[172:175]
    buffer_load_dwordx4 a[92:95], v1, s[8:11], s26 offen offset:2048 sc1
    v_mfma_f32_16x16x32_bf16 v[156:159], a[116:119], v[120:123], v[156:159]
    s_waitcnt vmcnt(9)
    ds_read_b128 a[96:99], v21 offset:11264
    v_mfma_f32_16x16x32_bf16 v[168:171], a[116:119], v[124:127], v[168:171]
    v_mfma_f32_16x16x32_bf16 v[152:155], a[112:115], v[120:123], v[152:155]
    s_waitcnt vmcnt(8)
    ds_read_b128 a[100:103], v21 offset:12288
    v_mfma_f32_16x16x32_bf16 v[164:167], a[112:115], v[124:127], v[164:167]
    s_waitcnt lgkmcnt(4)
    v_mfma_f32_16x16x32_bf16 v[128:131], a[124:127], v[96:99], v[128:131]
    ds_read_b128 v[112:115], v2 offset:4096
    v_mfma_f32_16x16x32_bf16 v[140:143], a[124:127], v[100:103], v[140:143]
    ds_read_b128 v[116:119], v2 offset:6144
    v_mfma_f32_16x16x32_bf16 v[132:135], a[128:131], v[96:99], v[132:135]
    ds_read_b128 v[120:123], v2 offset:8192
    v_mfma_f32_16x16x32_bf16 v[144:147], a[128:131], v[100:103], v[144:147]
    ds_read_b128 v[124:127], v2 offset:10240
    v_mfma_f32_16x16x32_bf16 v[136:139], a[132:135], v[96:99], v[136:139]
    buffer_load_dwordx4 a[104:107], v1, s[8:11], s26 offen offset:3072 sc1
    v_mfma_f32_16x16x32_bf16 v[148:151], a[132:135], v[100:103], v[148:151]
    s_waitcnt vmcnt(8)
    ds_read_b128 a[108:111], v21 offset:19456
    s_waitcnt lgkmcnt(7)
    v_mfma_f32_16x16x32_bf16 v[160:163], a[132:135], v[104:107], v[160:163]
    s_add_u32 s26, s25, 32768
    v_mfma_f32_16x16x32_bf16 v[172:175], a[132:135], v[108:111], v[172:175]
    buffer_load_dwordx4 a[112:115], v1, s[8:11], s26 offen offset:0 sc1
    v_mfma_f32_16x16x32_bf16 v[156:159], a[128:131], v[104:107], v[156:159]
    buffer_load_dwordx4 a[116:119], v1, s[8:11], s26 offen offset:1024 sc1
    v_mfma_f32_16x16x32_bf16 v[168:171], a[128:131], v[108:111], v[168:171]
    s_add_u32 m0, s28, 115712
    v_mfma_f32_16x16x32_bf16 v[152:155], a[124:127], v[104:107], v[152:155]
    buffer_load_dwordx4 v1, s[8:11], s26 offen offset:2048 sc1 lds
    v_mfma_f32_16x16x32_bf16 v[164:167], a[124:127], v[108:111], v[164:167]
    s_waitcnt vmcnt(10)
    ds_read_b128 a[120:123], v21 offset:20480
    s_waitcnt lgkmcnt(4)
    v_mfma_f32_16x16x32_bf16 v[128:131], a[136:139], v[112:115], v[128:131]
    ds_read_b128 v[96:99], v2 offset:11264
    v_mfma_f32_16x16x32_bf16 v[140:143], a[136:139], v[116:119], v[140:143]
    ds_read_b128 v[100:103], v2 offset:13312
    v_mfma_f32_16x16x32_bf16 v[132:135], a[140:143], v[112:115], v[132:135]
    ds_read_b128 v[104:107], v2 offset:15360
    v_mfma_f32_16x16x32_bf16 v[144:147], a[140:143], v[116:119], v[144:147]
    ds_read_b128 v[108:111], v2 offset:17408
    v_mfma_f32_16x16x32_bf16 v[136:139], a[144:147], v[112:115], v[136:139]
    buffer_load_dwordx4 a[124:127], v1, s[8:11], s26 offen offset:3072 sc1
    v_mfma_f32_16x16x32_bf16 v[148:151], a[144:147], v[116:119], v[148:151]
    s_add_u32 s26, s25, 36864
    s_waitcnt lgkmcnt(6)
    v_mfma_f32_16x16x32_bf16 v[160:163], a[144:147], v[120:123], v[160:163]
    buffer_load_dwordx4 a[128:131], v1, s[8:11], s26 offen offset:0 sc1
    v_mfma_f32_16x16x32_bf16 v[172:175], a[144:147], v[124:127], v[172:175]
    s_add_u32 m0, s28, 117760
    v_mfma_f32_16x16x32_bf16 v[156:159], a[140:143], v[120:123], v[156:159]
    buffer_load_dwordx4 v1, s[8:11], s26 offen offset:1024 sc1 lds
    v_mfma_f32_16x16x32_bf16 v[168:171], a[140:143], v[124:127], v[168:171]
    v_mfma_f32_16x16x32_bf16 v[152:155], a[136:139], v[120:123], v[152:155]
    v_mfma_f32_16x16x32_bf16 v[164:167], a[136:139], v[124:127], v[164:167]
    buffer_load_dword v27, v25, s[8:11], s38 offen sc1
    s_waitcnt lgkmcnt(2)
    v_mfma_f32_16x16x32_bf16 v[128:131], a[148:151], v[96:99], v[128:131]
    ds_read_b128 v[112:115], v2 offset:12288
    v_mfma_f32_16x16x32_bf16 v[140:143], a[148:151], v[100:103], v[140:143]
    ds_read_b128 v[116:119], v2 offset:14336
    v_mfma_f32_16x16x32_bf16 v[132:135], a[152:155], v[96:99], v[132:135]
    ds_read_b128 v[120:123], v2 offset:16384
    v_mfma_f32_16x16x32_bf16 v[144:147], a[152:155], v[100:103], v[144:147]
    ds_read_b128 v[124:127], v2 offset:18432
    v_mfma_f32_16x16x32_bf16 v[136:139], a[156:159], v[96:99], v[136:139]
    v_mfma_f32_16x16x32_bf16 v[148:151], a[156:159], v[100:103], v[148:151]
    s_waitcnt lgkmcnt(4)
    v_mfma_f32_16x16x32_bf16 v[160:163], a[156:159], v[104:107], v[160:163]
    buffer_load_dwordx4 a[132:135], v1, s[8:11], s26 offen offset:2048 sc1
    v_mfma_f32_16x16x32_bf16 v[172:175], a[156:159], v[108:111], v[172:175]
    buffer_load_dwordx4 a[136:139], v1, s[8:11], s26 offen offset:3072 sc1
    v_mfma_f32_16x16x32_bf16 v[156:159], a[152:155], v[104:107], v[156:159]
    s_add_u32 m0, s28, 125952
    s_add_u32 s26, s25, 40960
    v_mfma_f32_16x16x32_bf16 v[168:171], a[152:155], v[108:111], v[168:171]
    buffer_load_dwordx4 v1, s[8:11], s26 offen offset:0 sc1 lds
    v_mfma_f32_16x16x32_bf16 v[152:155], a[148:151], v[104:107], v[152:155]
    v_mfma_f32_16x16x32_bf16 v[164:167], a[148:151], v[108:111], v[164:167]
    s_waitcnt lgkmcnt(0)
    s_barrier
    v_mfma_f32_16x16x32_bf16 v[128:131], a[160:163], v[112:115], v[128:131]
    ds_read_b128 v[96:99], v2 offset:19456
    v_mfma_f32_16x16x32_bf16 v[140:143], a[160:163], v[116:119], v[140:143]
    ds_read_b128 v[100:103], v2 offset:21504
    v_mfma_f32_16x16x32_bf16 v[132:135], a[164:167], v[112:115], v[132:135]
    ds_read_b128 v[104:107], v2 offset:23552
    v_mfma_f32_16x16x32_bf16 v[144:147], a[164:167], v[116:119], v[144:147]
    ds_read_b128 v[108:111], v2 offset:25600
    v_mfma_f32_16x16x32_bf16 v[136:139], a[168:171], v[112:115], v[136:139]
    v_mfma_f32_16x16x32_bf16 v[148:151], a[168:171], v[116:119], v[148:151]
    v_mfma_f32_16x16x32_bf16 v[160:163], a[168:171], v[120:123], v[160:163]
    buffer_load_dwordx4 a[140:143], v1, s[8:11], s26 offen offset:1024 sc1
    v_mfma_f32_16x16x32_bf16 v[172:175], a[168:171], v[124:127], v[172:175]
    v_mfma_f32_16x16x32_bf16 v[156:159], a[164:167], v[120:123], v[156:159]
    v_mfma_f32_16x16x32_bf16 v[168:171], a[164:167], v[124:127], v[168:171]
    buffer_load_dwordx4 a[144:147], v1, s[8:11], s26 offen offset:2048 sc1
    v_mfma_f32_16x16x32_bf16 v[152:155], a[160:163], v[120:123], v[152:155]
    s_add_u32 m0, s28, 123904
    v_mfma_f32_16x16x32_bf16 v[164:167], a[160:163], v[124:127], v[164:167]
    s_waitcnt lgkmcnt(2)
    v_mfma_f32_16x16x32_bf16 v[128:131], a[172:175], v[96:99], v[128:131]
    ds_read_b128 v[112:115], v2 offset:20480
    v_mfma_f32_16x16x32_bf16 v[140:143], a[172:175], v[100:103], v[140:143]
    ds_read_b128 v[116:119], v2 offset:22528
    v_mfma_f32_16x16x32_bf16 v[132:135], a[176:179], v[96:99], v[132:135]
    ds_read_b128 v[120:123], v2 offset:24576
    v_mfma_f32_16x16x32_bf16 v[144:147], a[176:179], v[100:103], v[144:147]
    ds_read_b128 v[124:127], v2 offset:26624
    v_mfma_f32_16x16x32_bf16 v[136:139], a[180:183], v[96:99], v[136:139]
    buffer_load_dwordx4 v1, s[8:11], s26 offen offset:3072 sc1 lds
    v_mfma_f32_16x16x32_bf16 v[148:151], a[180:183], v[100:103], v[148:151]
    s_add_u32 s26, s25, 45056
    s_waitcnt lgkmcnt(4)
    v_mfma_f32_16x16x32_bf16 v[160:163], a[180:183], v[104:107], v[160:163]
    buffer_load_dwordx4 a[148:151], v1, s[8:11], s26 offen offset:0 sc1
    v_mfma_f32_16x16x32_bf16 v[172:175], a[180:183], v[108:111], v[172:175]
    buffer_load_dwordx4 a[152:155], v1, s[8:11], s26 offen offset:1024 sc1
    v_mfma_f32_16x16x32_bf16 v[156:159], a[176:179], v[104:107], v[156:159]
    s_add_u32 m0, s28, 132096
    v_mfma_f32_16x16x32_bf16 v[168:171], a[176:179], v[108:111], v[168:171]
    buffer_load_dwordx4 v1, s[8:11], s26 offen offset:2048 sc1 lds
    v_mfma_f32_16x16x32_bf16 v[152:155], a[172:175], v[104:107], v[152:155]
    s_add_u32 m0, s28, 132096
    v_mfma_f32_16x16x32_bf16 v[164:167], a[172:175], v[108:111], v[164:167]
    s_waitcnt lgkmcnt(2)
    v_mfma_f32_16x16x32_bf16 v[128:131], a[184:187], v[112:115], v[128:131]
    ds_read_b128 v[96:99], v2 offset:27648
    v_mfma_f32_16x16x32_bf16 v[140:143], a[184:187], v[116:119], v[140:143]
    ds_read_b128 v[100:103], v2 offset:29696
    v_mfma_f32_16x16x32_bf16 v[132:135], a[188:191], v[112:115], v[132:135]
    ds_read_b128 v[104:107], v2 offset:31744
    v_mfma_f32_16x16x32_bf16 v[144:147], a[188:191], v[116:119], v[144:147]
    ds_read_b128 v[108:111], v2 offset:33792
    v_mfma_f32_16x16x32_bf16 v[136:139], a[192:195], v[112:115], v[136:139]
    buffer_load_dwordx4 v1, s[8:11], s26 offen offset:3072 sc1 lds
    v_mfma_f32_16x16x32_bf16 v[148:151], a[192:195], v[116:119], v[148:151]
    s_waitcnt lgkmcnt(4)
    v_mfma_f32_16x16x32_bf16 v[160:163], a[192:195], v[120:123], v[160:163]
    v_mfma_f32_16x16x32_bf16 v[172:175], a[192:195], v[124:127], v[172:175]
    v_mfma_f32_16x16x32_bf16 v[156:159], a[188:191], v[120:123], v[156:159]
    s_add_u32 s26, s25, 49152
    v_mfma_f32_16x16x32_bf16 v[168:171], a[188:191], v[124:127], v[168:171]
    buffer_load_dwordx4 a[156:159], v1, s[8:11], s26 offen offset:0 sc1
    v_mfma_f32_16x16x32_bf16 v[152:155], a[184:187], v[120:123], v[152:155]
    s_add_u32 m0, s28, 141312
    v_mfma_f32_16x16x32_bf16 v[164:167], a[184:187], v[124:127], v[164:167]
    s_waitcnt vmcnt(11)
    v_cmp_le_u32 vcc, 7, v27
    s_nop 3
    s_cmp_eq_u64 vcc, -1
    s_cbranch_scc1 L_pdone_24
    s_mov_b32 s68, 0x80000
L_poll_23:
    buffer_load_dword v27, v25, s[8:11], s38 offen sc1
    s_waitcnt vmcnt(0)
    v_cmp_le_u32 vcc, 7, v27
    s_nop 3
    s_cmp_eq_u64 vcc, -1
    s_cbranch_scc1 L_pdone_24
    s_sub_u32 s68, s68, 1
    s_cmp_lg_u32 s68, 0
    s_cbranch_scc1 L_poll_23
L_pdone_24:
    s_waitcnt lgkmcnt(2)
    v_mfma_f32_16x16x32_bf16 v[128:131], a[196:199], v[96:99], v[128:131]
    ds_read_b128 v[112:115], v2 offset:28672
    ds_read_b128 a[160:163], v95 offset:52224
    v_mfma_f32_16x16x32_bf16 v[140:143], a[196:199], v[100:103], v[140:143]
    ds_read_b128 v[116:119], v2 offset:30720
    ds_read_b128 a[164:167], v95 offset:53248
    v_mfma_f32_16x16x32_bf16 v[132:135], a[200:203], v[96:99], v[132:135]
    ds_read_b128 v[120:123], v2 offset:32768
    v_mfma_f32_16x16x32_bf16 v[144:147], a[200:203], v[100:103], v[144:147]
    ds_read_b128 v[124:127], v2 offset:34816
    v_mfma_f32_16x16x32_bf16 v[136:139], a[220:223], v[96:99], v[136:139]
    buffer_load_dwordx4 v1, s[8:11], s26 offen offset:1024 sc1 lds
    v_mfma_f32_16x16x32_bf16 v[148:151], a[220:223], v[100:103], v[148:151]
    s_add_u32 s88, s31, 14684160
    s_add_u32 s88, s88, s8
    s_addc_u32 s89, s52, 0
    s_waitcnt lgkmcnt(6)
    v_mfma_f32_16x16x32_bf16 v[160:163], a[220:223], v[104:107], v[160:163]
    global_load_dwordx4 v[216:219], v1, s[88:89] offset:-4096 sc1
    v_mfma_f32_16x16x32_bf16 v[172:175], a[220:223], v[108:111], v[172:175]
    s_add_u32 s90, s31, 14733312
    s_add_u32 s90, s90, s8
    s_addc_u32 s91, s52, 0
    v_mfma_f32_16x16x32_bf16 v[156:159], a[200:203], v[104:107], v[156:159]
    global_load_dwordx4 v[220:223], v1, s[90:91] offset:-4096 sc1
    v_mfma_f32_16x16x32_bf16 v[168:171], a[200:203], v[108:111], v[168:171]
    global_load_dwordx4 v[224:227], v1, s[88:89] offset:-3072 sc1
    v_mfma_f32_16x16x32_bf16 v[152:155], a[196:199], v[104:107], v[152:155]
    v_mfma_f32_16x16x32_bf16 v[164:167], a[196:199], v[108:111], v[164:167]
    s_waitcnt lgkmcnt(3)
    v_mfma_f32_16x16x32_bf16 v[128:131], a[240:243], v[112:115], v[128:131]
    ds_read_b128 v[96:99], v2 offset:35840
    v_mfma_f32_16x16x32_bf16 v[140:143], a[240:243], v[116:119], v[140:143]
    ds_read_b128 v[100:103], v2 offset:37888
    v_mfma_f32_16x16x32_bf16 v[132:135], a[204:207], v[112:115], v[132:135]
    ds_read_b128 v[104:107], v2 offset:39936
    v_mfma_f32_16x16x32_bf16 v[144:147], a[204:207], v[116:119], v[144:147]
    ds_read_b128 v[108:111], v2 offset:41984
    v_mfma_f32_16x16x32_bf16 v[136:139], a[224:227], v[112:115], v[136:139]
    global_load_dwordx4 v[228:231], v1, s[90:91] offset:-3072 sc1
    v_mfma_f32_16x16x32_bf16 v[148:151], a[224:227], v[116:119], v[148:151]
    s_waitcnt lgkmcnt(4)
    v_mfma_f32_16x16x32_bf16 v[160:163], a[224:227], v[120:123], v[160:163]
    s_waitcnt vmcnt(13)
    ds_read_b128 a[168:171], v95 offset:60416
    v_mfma_f32_16x16x32_bf16 v[172:175], a[224:227], v[124:127], v[172:175]
    global_load_dwordx4 v[232:235], v1, s[88:89] offset:-2048 sc1
    v_mfma_f32_16x16x32_bf16 v[156:159], a[204:207], v[120:123], v[156:159]
    global_load_dwordx4 v[236:239], v1, s[90:91] offset:-2048 sc1
    v_mfma_f32_16x16x32_bf16 v[168:171], a[204:207], v[124:127], v[168:171]
    global_load_dwordx4 v[240:243], v1, s[88:89] offset:-1024 sc1
    v_mfma_f32_16x16x32_bf16 v[152:155], a[240:243], v[120:123], v[152:155]
    v_mfma_f32_16x16x32_bf16 v[164:167], a[240:243], v[124:127], v[164:167]
    s_waitcnt lgkmcnt(3)
    v_mfma_f32_16x16x32_bf16 v[128:131], a[244:247], v[96:99], v[128:131]
    ds_read_b128 v[112:115], v2 offset:36864
    v_mfma_f32_16x16x32_bf16 v[140:143], a[244:247], v[100:103], v[140:143]
    ds_read_b128 v[116:119], v2 offset:38912
    v_mfma_f32_16x16x32_bf16 v[132:135], a[208:211], v[96:99], v[132:135]
    ds_read_b128 v[120:123], v2 offset:40960
    v_mfma_f32_16x16x32_bf16 v[144:147], a[208:211], v[100:103], v[144:147]
    ds_read_b128 v[124:127], v2 offset:43008
    v_mfma_f32_16x16x32_bf16 v[136:139], a[228:231], v[96:99], v[136:139]
    global_load_dwordx4 v[244:247], v1, s[90:91] offset:-1024 sc1
    v_mfma_f32_16x16x32_bf16 v[148:151], a[228:231], v[100:103], v[148:151]
    s_waitcnt lgkmcnt(5)
    v_mfma_f32_16x16x32_bf16 v[160:163], a[228:231], v[104:107], v[160:163]
    global_load_dwordx4 v[248:251], v1, s[88:89] offset:0 sc1
    v_mfma_f32_16x16x32_bf16 v[172:175], a[228:231], v[108:111], v[172:175]
    v_mfma_f32_16x16x32_bf16 v[156:159], a[208:211], v[104:107], v[156:159]
    v_mfma_f32_16x16x32_bf16 v[168:171], a[208:211], v[108:111], v[168:171]
    v_mfma_f32_16x16x32_bf16 v[152:155], a[244:247], v[104:107], v[152:155]
    v_mfma_f32_16x16x32_bf16 v[164:167], a[244:247], v[108:111], v[164:167]
    s_waitcnt lgkmcnt(2)
    v_mfma_f32_16x16x32_bf16 v[128:131], a[248:251], v[112:115], v[128:131]
    v_mfma_f32_16x16x32_bf16 v[140:143], a[248:251], v[116:119], v[140:143]
    s_waitcnt vmcnt(15)
    ds_read_b128 a[172:175], v95 offset:61440
    v_mfma_f32_16x16x32_bf16 v[132:135], a[212:215], v[112:115], v[132:135]
    v_mfma_f32_16x16x32_bf16 v[144:147], a[212:215], v[116:119], v[144:147]
    v_mfma_f32_16x16x32_bf16 v[136:139], a[232:235], v[112:115], v[136:139]
    v_mfma_f32_16x16x32_bf16 v[148:151], a[232:235], v[116:119], v[148:151]
    s_waitcnt lgkmcnt(1)
    v_mfma_f32_16x16x32_bf16 v[160:163], a[232:235], v[120:123], v[160:163]
    s_waitcnt vmcnt(12)
    ds_read_b128 a[176:179], v21 offset:3072
    v_mfma_f32_16x16x32_bf16 v[172:175], a[232:235], v[124:127], v[172:175]
    global_load_dwordx4 v[252:255], v1, s[90:91] offset:0 sc1
    v_mfma_f32_16x16x32_bf16 v[156:159], a[212:215], v[120:123], v[156:159]
    v_mfma_f32_16x16x32_bf16 v[168:171], a[212:215], v[124:127], v[168:171]
    v_mfma_f32_16x16x32_bf16 v[152:155], a[248:251], v[120:123], v[152:155]
    v_mfma_f32_16x16x32_bf16 v[164:167], a[248:251], v[124:127], v[164:167]
    s_add_u32 s56, s33, 14876672
    v_pk_fma_f32 v[128:129], v[80:81], v[52:53], v[128:129] op_sel:[0,0,0] op_sel_hi:[0,1,1] neg_lo:[1,0,0] neg_hi:[1,0,0]
    v_pk_fma_f32 v[130:131], v[80:81], v[54:55], v[130:131] op_sel:[0,0,0] op_sel_hi:[0,1,1] neg_lo:[1,0,0] neg_hi:[1,0,0]
    v_pk_fma_f32 v[140:141], v[80:81], v[52:53], v[140:141] op_sel:[1,0,0] op_sel_hi:[1,1,1] neg_lo:[1,0,0] neg_hi:[1,0,0]
    v_pk_fma_f32 v[142:143], v[80:81], v[54:55], v[142:143] op_sel:[1,0,0] op_sel_hi:[1,1,1] neg_lo:[1,0,0] neg_hi:[1,0,0]
    s_nop 1
    v_pk_fma_f32 v[152:153], v[82:83], v[52:53], v[152:153] op_sel:[0,0,0] op_sel_hi:[0,1,1] neg_lo:[1,0,0] neg_hi:[1,0,0]
    s_waitcnt vmcnt(12)
    ds_read_b128 a[180:183], v21 offset:4096
    v_pk_fma_f32 v[154:155], v[82:83], v[54:55], v[154:155] op_sel:[0,0,0] op_sel_hi:[0,1,1] neg_lo:[1,0,0] neg_hi:[1,0,0]
    v_pk_fma_f32 v[164:165], v[82:83], v[52:53], v[164:165] op_sel:[1,0,0] op_sel_hi:[1,1,1] neg_lo:[1,0,0] neg_hi:[1,0,0]
    v_pk_fma_f32 v[166:167], v[82:83], v[54:55], v[166:167] op_sel:[1,0,0] op_sel_hi:[1,1,1] neg_lo:[1,0,0] neg_hi:[1,0,0]
    v_pk_mul_f32 v[128:129], v[84:85], v[128:129] op_sel:[0,0] op_sel_hi:[0,1]
    v_pk_mul_f32 v[140:141], v[84:85], v[140:141] op_sel:[1,0] op_sel_hi:[1,1]
    v_pk_mul_f32 v[152:153], v[86:87], v[152:153] op_sel:[0,0] op_sel_hi:[0,1]
    v_pk_mul_f32 v[164:165], v[86:87], v[164:165] op_sel:[1,0] op_sel_hi:[1,1]
    v_exp_f32 v128, v128
    v_exp_f32 v129, v129
    v_exp_f32 v140, v140
    global_load_dwordx4 v[96:99], v1, s[88:89] offset:1024 sc1
    v_exp_f32 v141, v141
    v_exp_f32 v152, v152
    v_exp_f32 v153, v153
    v_exp_f32 v164, v164
    global_load_dwordx4 v[100:103], v1, s[90:91] offset:1024 sc1
    v_exp_f32 v165, v165
    v_pk_fma_f32 v[128:129], v[128:129], v[88:89], v[88:89] op_sel:[0,0,0] op_sel_hi:[1,0,0]
    global_load_dwordx4 v[104:107], v1, s[88:89] offset:2048 sc1
    v_pk_fma_f32 v[140:141], v[140:141], v[88:89], v[88:89] op_sel:[0,1,1] op_sel_hi:[1,1,1]
    v_pk_fma_f32 v[152:153], v[152:153], v[90:91], v[90:91] op_sel:[0,0,0] op_sel_hi:[1,0,0]
    v_pk_fma_f32 v[164:165], v[164:165], v[90:91], v[90:91] op_sel:[0,1,1] op_sel_hi:[1,1,1]
    v_rcp_f32 v128, v128
    v_rcp_f32 v129, v129
    v_rcp_f32 v140, v140
    v_rcp_f32 v141, v141
    v_rcp_f32 v152, v152
    v_rcp_f32 v153, v153
    v_rcp_f32 v164, v164
    v_rcp_f32 v165, v165
    v_pk_mul_f32 v[128:129], v[128:129], v[130:131]
    v_pk_mul_f32 v[140:141], v[140:141], v[142:143]
    v_pk_mul_f32 v[152:153], v[152:153], v[154:155]
    v_pk_mul_f32 v[164:165], v[164:165], v[166:167]
    v_cvt_pk_bf16_f32 v176, v128, v129
    v_cvt_pk_bf16_f32 v177, v140, v141
    v_cvt_pk_bf16_f32 v178, v152, v153
    v_cvt_pk_bf16_f32 v179, v164, v165
    global_load_dwordx4 v[108:111], v1, s[90:91] offset:2048 sc1
    v_permlane32_swap_b32 v176, v178
    v_permlane32_swap_b32 v177, v179
    s_nop 1
    v_permlane16_swap_b32 v176, v177
    v_permlane16_swap_b32 v178, v179
    buffer_store_dwordx4 v[176:179], v24, s[8:11], s56 offen offset:0 sc1
    v_pk_fma_f32 v[132:133], v[80:81], v[56:57], v[132:133] op_sel:[0,0,0] op_sel_hi:[0,1,1] neg_lo:[1,0,0] neg_hi:[1,0,0]
    v_pk_fma_f32 v[134:135], v[80:81], v[58:59], v[134:135] op_sel:[0,0,0] op_sel_hi:[0,1,1] neg_lo:[1,0,0] neg_hi:[1,0,0]
    v_pk_fma_f32 v[144:145], v[80:81], v[56:57], v[144:145] op_sel:[1,0,0] op_sel_hi:[1,1,1] neg_lo:[1,0,0] neg_hi:[1,0,0]
    s_waitcnt vmcnt(15)
    ds_read_b128 a[184:187], v21 offset:11264
    v_pk_fma_f32 v[146:147], v[80:81], v[58:59], v[146:147] op_sel:[1,0,0] op_sel_hi:[1,1,1] neg_lo:[1,0,0] neg_hi:[1,0,0]
    v_pk_fma_f32 v[156:157], v[82:83], v[56:57], v[156:157] op_sel:[0,0,0] op_sel_hi:[0,1,1] neg_lo:[1,0,0] neg_hi:[1,0,0]
    v_pk_fma_f32 v[158:159], v[82:83], v[58:59], v[158:159] op_sel:[0,0,0] op_sel_hi:[0,1,1] neg_lo:[1,0,0] neg_hi:[1,0,0]
    global_load_dwordx4 v[112:115], v1, s[88:89] offset:3072 sc1
    v_pk_fma_f32 v[168:169], v[82:83], v[56:57], v[168:169] op_sel:[1,0,0] op_sel_hi:[1,1,1] neg_lo:[1,0,0] neg_hi:[1,0,0]
    v_pk_fma_f32 v[170:171], v[82:83], v[58:59], v[170:171] op_sel:[1,0,0] op_sel_hi:[1,1,1] neg_lo:[1,0,0] neg_hi:[1,0,0]
    v_pk_mul_f32 v[132:133], v[84:85], v[132:133] op_sel:[0,0] op_sel_hi:[0,1]
    global_load_dwordx4 v[116:119], v1, s[90:91] offset:3072 sc1
    v_pk_mul_f32 v[144:145], v[84:85], v[144:145] op_sel:[1,0] op_sel_hi:[1,1]
    v_pk_mul_f32 v[156:157], v[86:87], v[156:157] op_sel:[0,0] op_sel_hi:[0,1]
    v_pk_mul_f32 v[168:169], v[86:87], v[168:169] op_sel:[1,0] op_sel_hi:[1,1]
    v_exp_f32 v132, v132
    v_exp_f32 v133, v133
    v_exp_f32 v144, v144
    v_exp_f32 v145, v145
    v_exp_f32 v156, v156
    v_exp_f32 v157, v157
    v_exp_f32 v168, v168
    v_exp_f32 v169, v169
    v_pk_fma_f32 v[132:133], v[132:133], v[88:89], v[88:89] op_sel:[0,0,0] op_sel_hi:[1,0,0]
    v_pk_fma_f32 v[144:145], v[144:145], v[88:89], v[88:89] op_sel:[0,1,1] op_sel_hi:[1,1,1]
    v_pk_fma_f32 v[156:157], v[156:157], v[90:91], v[90:91] op_sel:[0,0,0] op_sel_hi:[1,0,0]
    v_pk_fma_f32 v[168:169], v[168:169], v[90:91], v[90:91] op_sel:[0,1,1] op_sel_hi:[1,1,1]
    v_rcp_f32 v132, v132
    v_rcp_f32 v133, v133
    s_add_u32 s88, s31, 14692352
    s_add_u32 s88, s88, s8
    s_addc_u32 s89, s52, 0
    global_load_dwordx4 v[120:123], v1, s[88:89] offset:-4096 sc1
    v_rcp_f32 v144, v144
    v_rcp_f32 v145, v145
    s_add_u32 s90, s31, 14741504
    s_add_u32 s90, s90, s8
    s_addc_u32 s91, s52, 0
    global_load_dwordx4 v[124:127], v1, s[90:91] offset:-4096 sc1
    v_rcp_f32 v156, v156
    v_rcp_f32 v157, v157
    v_rcp_f32 v168, v168
    v_rcp_f32 v169, v169
    v_pk_mul_f32 v[132:133], v[132:133], v[134:135]
    v_pk_mul_f32 v[144:145], v[144:145], v[146:147]
    v_pk_mul_f32 v[156:157], v[156:157], v[158:159]
    v_pk_mul_f32 v[168:169], v[168:169], v[170:171]
    v_cvt_pk_bf16_f32 v180, v132, v133
    v_cvt_pk_bf16_f32 v181, v144, v145
    v_cvt_pk_bf16_f32 v182, v156, v157
    v_cvt_pk_bf16_f32 v183, v168, v169
    s_nop 0
    v_permlane32_swap_b32 v180, v182
    v_permlane32_swap_b32 v181, v183
    s_nop 1
    v_permlane16_swap_b32 v180, v181
    v_permlane16_swap_b32 v182, v183
    buffer_store_dwordx4 v[180:183], v24, s[8:11], s56 offen offset:256 sc1
    v_pk_fma_f32 v[136:137], v[80:81], v[60:61], v[136:137] op_sel:[0,0,0] op_sel_hi:[0,1,1] neg_lo:[1,0,0] neg_hi:[1,0,0]
    v_pk_fma_f32 v[138:139], v[80:81], v[62:63], v[138:139] op_sel:[0,0,0] op_sel_hi:[0,1,1] neg_lo:[1,0,0] neg_hi:[1,0,0]
    v_pk_fma_f32 v[148:149], v[80:81], v[60:61], v[148:149] op_sel:[1,0,0] op_sel_hi:[1,1,1] neg_lo:[1,0,0] neg_hi:[1,0,0]
    v_pk_fma_f32 v[150:151], v[80:81], v[62:63], v[150:151] op_sel:[1,0,0] op_sel_hi:[1,1,1] neg_lo:[1,0,0] neg_hi:[1,0,0]
    v_pk_fma_f32 v[160:161], v[82:83], v[60:61], v[160:161] op_sel:[0,0,0] op_sel_hi:[0,1,1] neg_lo:[1,0,0] neg_hi:[1,0,0]
    v_pk_fma_f32 v[162:163], v[82:83], v[62:63], v[162:163] op_sel:[0,0,0] op_sel_hi:[0,1,1] neg_lo:[1,0,0] neg_hi:[1,0,0]
    v_pk_fma_f32 v[172:173], v[82:83], v[60:61], v[172:173] op_sel:[1,0,0] op_sel_hi:[1,1,1] neg_lo:[1,0,0] neg_hi:[1,0,0]
    v_pk_fma_f32 v[174:175], v[82:83], v[62:63], v[174:175] op_sel:[1,0,0] op_sel_hi:[1,1,1] neg_lo:[1,0,0] neg_hi:[1,0,0]
    v_pk_mul_f32 v[136:137], v[84:85], v[136:137] op_sel:[0,0] op_sel_hi:[0,1]
    v_pk_mul_f32 v[148:149], v[84:85], v[148:149] op_sel:[1,0] op_sel_hi:[1,1]
    v_pk_mul_f32 v[160:161], v[86:87], v[160:161] op_sel:[0,0] op_sel_hi:[0,1]
    v_pk_mul_f32 v[172:173], v[86:87], v[172:173] op_sel:[1,0] op_sel_hi:[1,1]
    v_exp_f32 v136, v136
    v_exp_f32 v137, v137
    v_exp_f32 v148, v148
    v_exp_f32 v149, v149
    v_exp_f32 v160, v160
    v_exp_f32 v161, v161
    v_exp_f32 v172, v172
    v_exp_f32 v173, v173
    v_pk_fma_f32 v[136:137], v[136:137], v[88:89], v[88:89] op_sel:[0,0,0] op_sel_hi:[1,0,0]
    v_pk_fma_f32 v[148:149], v[148:149], v[88:89], v[88:89] op_sel:[0,1,1] op_sel_hi:[1,1,1]
    v_pk_fma_f32 v[160:161], v[160:161], v[90:91], v[90:91] op_sel:[0,0,0] op_sel_hi:[1,0,0]
    v_pk_fma_f32 v[172:173], v[172:173], v[90:91], v[90:91] op_sel:[0,1,1] op_sel_hi:[1,1,1]
    v_rcp_f32 v136, v136
    v_rcp_f32 v137, v137
    v_rcp_f32 v148, v148
    v_rcp_f32 v149, v149
    v_rcp_f32 v160, v160
    v_rcp_f32 v161, v161
    v_rcp_f32 v172, v172
    v_rcp_f32 v173, v173
    v_pk_mul_f32 v[136:137], v[136:137], v[138:139]
    v_pk_mul_f32 v[148:149], v[148:149], v[150:151]
    v_pk_mul_f32 v[160:161], v[160:161], v[162:163]
    v_pk_mul_f32 v[172:173], v[172:173], v[174:175]
    v_cvt_pk_bf16_f32 v184, v136, v137
    v_cvt_pk_bf16_f32 v185, v148, v149
    v_cvt_pk_bf16_f32 v186, v160, v161
    v_cvt_pk_bf16_f32 v187, v172, v173
    s_nop 0
    v_permlane32_swap_b32 v184, v186
    v_permlane32_swap_b32 v185, v187
    s_nop 1
    v_permlane16_swap_b32 v184, v185
    v_permlane16_swap_b32 v186, v187
    buffer_load_dwordx4 a[188:191], v1, s[8:11], s26 offen offset:2048 sc1
    buffer_store_dwordx4 v[184:187], v24, s[8:11], s56 offen offset:512 sc1
    s_waitcnt lgkmcnt(0)
    s_barrier
    s_waitcnt vmcnt(20)
    v_mfma_f32_16x16x32_bf16 v[128:131], a[252:255], v[216:219], 0
    v_mfma_f32_16x16x32_bf16 v[132:135], a[216:219], v[216:219], 0
    v_mfma_f32_16x16x32_bf16 v[136:139], a[236:239], v[216:219], 0
    global_load_dwordx4 v[168:171], v1, s[88:89] offset:-3072 sc1
    v_mfma_f32_16x16x32_bf16 v[140:143], a[0:3], v[216:219], 0
    v_mfma_f32_16x16x32_bf16 v[144:147], a[4:7], v[216:219], 0
    v_mfma_f32_16x16x32_bf16 v[148:151], a[252:255], v[220:223], 0
    v_mfma_f32_16x16x32_bf16 v[152:155], a[216:219], v[220:223], 0
    v_mfma_f32_16x16x32_bf16 v[156:159], a[236:239], v[220:223], 0
    v_mfma_f32_16x16x32_bf16 v[160:163], a[0:3], v[220:223], 0
    v_mfma_f32_16x16x32_bf16 v[164:167], a[4:7], v[220:223], 0
    s_waitcnt vmcnt(19)
    v_mfma_f32_16x16x32_bf16 v[128:131], a[8:11], v[224:227], v[128:131]
    global_load_dwordx4 v[172:175], v1, s[90:91] offset:-3072 sc1
    v_mfma_f32_16x16x32_bf16 v[132:135], a[12:15], v[224:227], v[132:135]
    v_mfma_f32_16x16x32_bf16 v[136:139], a[16:19], v[224:227], v[136:139]
    v_mfma_f32_16x16x32_bf16 v[140:143], a[20:23], v[224:227], v[140:143]
    buffer_load_dwordx4 a[192:195], v1, s[8:11], s26 offen offset:3072 sc1
    v_mfma_f32_16x16x32_bf16 v[144:147], a[24:27], v[224:227], v[144:147]
    s_add_u32 s26, s25, 53248
    v_mfma_f32_16x16x32_bf16 v[148:151], a[8:11], v[228:231], v[148:151]
    buffer_load_dwordx4 a[196:199], v1, s[8:11], s26 offen offset:0 sc1
    v_mfma_f32_16x16x32_bf16 v[152:155], a[12:15], v[228:231], v[152:155]
    v_mfma_f32_16x16x32_bf16 v[156:159], a[16:19], v[228:231], v[156:159]
    v_mfma_f32_16x16x32_bf16 v[160:163], a[20:23], v[228:231], v[160:163]
    v_mfma_f32_16x16x32_bf16 v[164:167], a[24:27], v[228:231], v[164:167]
    s_waitcnt vmcnt(20)
    v_mfma_f32_16x16x32_bf16 v[128:131], a[28:31], v[232:235], v[128:131]
    v_mfma_f32_16x16x32_bf16 v[132:135], a[32:35], v[232:235], v[132:135]
    v_mfma_f32_16x16x32_bf16 v[136:139], a[36:39], v[232:235], v[136:139]
    buffer_load_dwordx4 a[200:203], v1, s[8:11], s26 offen offset:1024 sc1
    v_mfma_f32_16x16x32_bf16 v[140:143], a[40:43], v[232:235], v[140:143]
    v_mfma_f32_16x16x32_bf16 v[144:147], a[44:47], v[232:235], v[144:147]
    buffer_load_dwordx4 a[220:223], v1, s[8:11], s26 offen offset:2048 sc1
    v_mfma_f32_16x16x32_bf16 v[148:151], a[28:31], v[236:239], v[148:151]
    v_mfma_f32_16x16x32_bf16 v[152:155], a[32:35], v[236:239], v[152:155]
    v_mfma_f32_16x16x32_bf16 v[156:159], a[36:39], v[236:239], v[156:159]
    v_mfma_f32_16x16x32_bf16 v[160:163], a[40:43], v[236:239], v[160:163]
    v_mfma_f32_16x16x32_bf16 v[164:167], a[44:47], v[236:239], v[164:167]
    s_waitcnt vmcnt(20)
    v_mfma_f32_16x16x32_bf16 v[128:131], a[48:51], v[240:243], v[128:131]
    v_mfma_f32_16x16x32_bf16 v[132:135], a[56:59], v[240:243], v[132:135]
    v_mfma_f32_16x16x32_bf16 v[136:139], a[60:63], v[240:243], v[136:139]
    v_mfma_f32_16x16x32_bf16 v[140:143], a[64:67], v[240:243], v[140:143]
    v_mfma_f32_16x16x32_bf16 v[144:147], a[72:75], v[240:243], v[144:147]
    v_mfma_f32_16x16x32_bf16 v[148:151], a[48:51], v[244:247], v[148:151]
    v_mfma_f32_16x16x32_bf16 v[152:155], a[56:59], v[244:247], v[152:155]
    global_load_dwordx4 v[216:219], v1, s[88:89] offset:-2048 sc1
    v_mfma_f32_16x16x32_bf16 v[156:159], a[60:63], v[244:247], v[156:159]
    v_mfma_f32_16x16x32_bf16 v[160:163], a[64:67], v[244:247], v[160:163]
    v_mfma_f32_16x16x32_bf16 v[164:167], a[72:75], v[244:247], v[164:167]
    s_waitcnt vmcnt(19)
    v_mfma_f32_16x16x32_bf16 v[128:131], a[76:79], v[248:251], v[128:131]
    global_load_dwordx4 v[220:223], v1, s[90:91] offset:-2048 sc1
    v_mfma_f32_16x16x32_bf16 v[132:135], a[80:83], v[248:251], v[132:135]
    v_mfma_f32_16x16x32_bf16 v[136:139], a[96:99], v[248:251], v[136:139]
    v_mfma_f32_16x16x32_bf16 v[140:143], a[100:103], v[248:251], v[140:143]
    v_mfma_f32_16x16x32_bf16 v[144:147], a[108:111], v[248:251], v[144:147]
    v_mfma_f32_16x16x32_bf16 v[148:151], a[76:79], v[252:255], v[148:151]
    v_mfma_f32_16x16x32_bf16 v[152:155], a[80:83], v[252:255], v[152:155]
    v_mfma_f32_16x16x32_bf16 v[156:159], a[96:99], v[252:255], v[156:159]
    v_mfma_f32_16x16x32_bf16 v[160:163], a[100:103], v[252:255], v[160:163]
    v_mfma_f32_16x16x32_bf16 v[164:167], a[108:111], v[252:255], v[164:167]
    s_waitcnt vmcnt(18)
    v_mfma_f32_16x16x32_bf16 v[128:131], a[120:123], v[96:99], v[128:131]
    buffer_load_dwordx4 a[240:243], v1, s[8:11], s26 offen offset:3072 sc1
    v_mfma_f32_16x16x32_bf16 v[132:135], a[52:55], v[96:99], v[132:135]
    s_add_u32 s26, s25, 57344
    v_mfma_f32_16x16x32_bf16 v[136:139], a[68:71], v[96:99], v[136:139]
    buffer_load_dwordx4 a[204:207], v1, s[8:11], s26 offen offset:0 sc1
    v_mfma_f32_16x16x32_bf16 v[140:143], a[84:87], v[96:99], v[140:143]
    buffer_load_dwordx4 a[224:227], v1, s[8:11], s26 offen offset:1024 sc1
    v_mfma_f32_16x16x32_bf16 v[144:147], a[88:91], v[96:99], v[144:147]
    v_mfma_f32_16x16x32_bf16 v[148:151], a[120:123], v[100:103], v[148:151]
    v_mfma_f32_16x16x32_bf16 v[152:155], a[52:55], v[100:103], v[152:155]
    v_mfma_f32_16x16x32_bf16 v[156:159], a[68:71], v[100:103], v[156:159]
    buffer_load_dwordx4 a[244:247], v1, s[8:11], s26 offen offset:2048 sc1
    v_mfma_f32_16x16x32_bf16 v[160:163], a[84:87], v[100:103], v[160:163]
    buffer_load_dwordx4 a[208:211], v1, s[8:11], s26 offen offset:3072 sc1
    v_mfma_f32_16x16x32_bf16 v[164:167], a[88:91], v[100:103], v[164:167]
    s_waitcnt vmcnt(21)
    v_mfma_f32_16x16x32_bf16 v[128:131], a[92:95], v[104:107], v[128:131]
    global_load_dwordx4 v[224:227], v1, s[88:89] offset:-1024 sc1
    v_mfma_f32_16x16x32_bf16 v[132:135], a[104:107], v[104:107], v[132:135]
    v_mfma_f32_16x16x32_bf16 v[136:139], a[112:115], v[104:107], v[136:139]
    global_load_dwordx4 v[228:231], v1, s[90:91] offset:-1024 sc1
    v_mfma_f32_16x16x32_bf16 v[140:143], a[116:119], v[104:107], v[140:143]
    v_mfma_f32_16x16x32_bf16 v[144:147], a[160:163], v[104:107], v[144:147]
    v_mfma_f32_16x16x32_bf16 v[148:151], a[92:95], v[108:111], v[148:151]
    v_mfma_f32_16x16x32_bf16 v[152:155], a[104:107], v[108:111], v[152:155]
    v_mfma_f32_16x16x32_bf16 v[156:159], a[112:115], v[108:111], v[156:159]
    v_mfma_f32_16x16x32_bf16 v[160:163], a[116:119], v[108:111], v[160:163]
    v_mfma_f32_16x16x32_bf16 v[164:167], a[160:163], v[108:111], v[164:167]
    s_add_u32 s26, s22, 0
    buffer_load_dwordx4 a[228:231], v1, s[8:11], s26 offen offset:0 sc1
    buffer_load_dwordx4 a[248:251], v1, s[8:11], s26 offen offset:1024 sc1
    s_waitcnt vmcnt(17)
    s_barrier
    v_mov_b32 v199, 8
    buffer_store_dword v199, v26, s[8:11], s37 offen sc1
    v_mfma_f32_16x16x32_bf16 v[128:131], a[124:127], v[112:115], v[128:131]
    v_mfma_f32_16x16x32_bf16 v[132:135], a[128:131], v[112:115], v[132:135]
    v_mfma_f32_16x16x32_bf16 v[136:139], a[164:167], v[112:115], v[136:139]
    v_mfma_f32_16x16x32_bf16 v[140:143], a[132:135], v[112:115], v[140:143]
    v_mfma_f32_16x16x32_bf16 v[144:147], a[136:139], v[112:115], v[144:147]
    v_mfma_f32_16x16x32_bf16 v[148:151], a[124:127], v[116:119], v[148:151]
    v_mfma_f32_16x16x32_bf16 v[152:155], a[128:131], v[116:119], v[152:155]
    v_mfma_f32_16x16x32_bf16 v[156:159], a[164:167], v[116:119], v[156:159]
    v_mfma_f32_16x16x32_bf16 v[160:163], a[132:135], v[116:119], v[160:163]
    v_mfma_f32_16x16x32_bf16 v[164:167], a[136:139], v[116:119], v[164:167]
    v_mfma_f32_16x16x32_bf16 v[128:131], a[168:171], v[120:123], v[128:131]
    v_mfma_f32_16x16x32_bf16 v[132:135], a[140:143], v[120:123], v[132:135]
    v_mfma_f32_16x16x32_bf16 v[136:139], a[144:147], v[120:123], v[136:139]
    v_mfma_f32_16x16x32_bf16 v[140:143], a[172:175], v[120:123], v[140:143]
    buffer_load_dwordx4 a[212:215], v1, s[8:11], s26 offen offset:2048 sc1
    v_mfma_f32_16x16x32_bf16 v[144:147], a[148:151], v[120:123], v[144:147]
    buffer_load_dwordx4 a[232:235], v1, s[8:11], s26 offen offset:3072 sc1
    v_mfma_f32_16x16x32_bf16 v[148:151], a[168:171], v[124:127], v[148:151]
    s_add_u32 m0, s28, 109568
    s_add_u32 s26, s22, 4096
    v_mfma_f32_16x16x32_bf16 v[152:155], a[140:143], v[124:127], v[152:155]
    buffer_load_dwordx4 v1, s[8:11], s26 offen offset:0 sc1 lds
    v_mfma_f32_16x16x32_bf16 v[156:159], a[144:147], v[124:127], v[156:159]
    s_add_u32 m0, s28, 109568
    v_mfma_f32_16x16x32_bf16 v[160:163], a[172:175], v[124:127], v[160:163]
    buffer_load_dwordx4 v1, s[8:11], s26 offen offset:1024 sc1 lds
    v_mfma_f32_16x16x32_bf16 v[164:167], a[148:151], v[124:127], v[164:167]
    s_waitcnt vmcnt(21)
    v_mfma_f32_16x16x32_bf16 v[128:131], a[152:155], v[168:171], v[128:131]
    s_add_u32 m0, s28, 1024
    s_waitcnt vmcnt(16)
    s_waitcnt vmcnt(15)
    v_mfma_f32_16x16x32_bf16 v[128:131], a[188:191], v[216:219], v[128:131]
    buffer_load_dwordx4 v1, s[8:11], s26 offen offset:2048 sc1 lds
    s_waitcnt vmcnt(10)
    s_add_u32 m0, s28, 1024
    s_nop 0
    buffer_load_dwordx4 v1, s[8:11], s26 offen offset:3072 sc1 lds
    s_add_u32 m0, s28, 11264
    s_add_u32 s26, s22, 8192
    buffer_load_dwordx4 v1, s[8:11], s26 offen offset:0 sc1 lds
    s_waitcnt vmcnt(11)
    v_mfma_f32_16x16x32_bf16 v[128:131], a[240:243], v[224:227], v[128:131]
    s_add_u32 m0, s28, 11264
    v_mfma_f32_16x16x32_bf16 v[148:151], a[152:155], v[172:175], v[148:151]
    buffer_load_dwordx4 v1, s[8:11], s26 offen offset:1024 sc1 lds
    v_mfma_f32_16x16x32_bf16 v[148:151], a[188:191], v[220:223], v[148:151]
    s_add_u32 m0, s28, 17408
    s_waitcnt vmcnt(11)
    v_mfma_f32_16x16x32_bf16 v[148:151], a[240:243], v[228:231], v[148:151]
    buffer_load_dwordx4 v1, s[8:11], s26 offen offset:2048 sc1 lds
    v_mfma_f32_16x16x32_bf16 v[132:135], a[176:179], v[168:171], v[132:135]
    s_add_u32 s88, s31, 14880768
    s_add_u32 s88, s88, s8
    s_addc_u32 s89, s52, 0
    v_mfma_f32_16x16x32_bf16 v[132:135], a[192:195], v[216:219], v[132:135]
    global_load_dwordx4 v[232:235], v1, s[88:89] offset:-4096 sc1
    v_mfma_f32_16x16x32_bf16 v[132:135], a[204:207], v[224:227], v[132:135]
    ds_write_b128 v17, v[128:131] offset:0
    v_mfma_f32_16x16x32_bf16 v[152:155], a[176:179], v[172:175], v[152:155]
    v_mfma_f32_16x16x32_bf16 v[152:155], a[192:195], v[220:223], v[152:155]
    v_mfma_f32_16x16x32_bf16 v[152:155], a[204:207], v[228:231], v[152:155]
    ds_write_b128 v17, v[148:151] offset:256
    v_mfma_f32_16x16x32_bf16 v[136:139], a[180:183], v[168:171], v[136:139]
    v_mfma_f32_16x16x32_bf16 v[136:139], a[196:199], v[216:219], v[136:139]
    v_mfma_f32_16x16x32_bf16 v[136:139], a[224:227], v[224:227], v[136:139]
    ds_write_b128 v17, v[132:135] offset:2304
    v_mfma_f32_16x16x32_bf16 v[156:159], a[180:183], v[172:175], v[156:159]
    v_mfma_f32_16x16x32_bf16 v[156:159], a[196:199], v[220:223], v[156:159]
    v_mfma_f32_16x16x32_bf16 v[156:159], a[224:227], v[228:231], v[156:159]
    ds_write_b128 v17, v[152:155] offset:2560
    v_mfma_f32_16x16x32_bf16 v[140:143], a[156:159], v[168:171], v[140:143]
    v_mfma_f32_16x16x32_bf16 v[140:143], a[200:203], v[216:219], v[140:143]
    v_mfma_f32_16x16x32_bf16 v[140:143], a[244:247], v[224:227], v[140:143]
    ds_write_b128 v17, v[136:139] offset:4608
    s_add_u32 s90, s31, 14929920
    s_add_u32 s90, s90, s8
    s_addc_u32 s91, s52, 0
    v_mfma_f32_16x16x32_bf16 v[160:163], a[156:159], v[172:175], v[160:163]
    global_load_dwordx4 v[236:239], v1, s[90:91] offset:-4096 sc1
    v_mfma_f32_16x16x32_bf16 v[160:163], a[200:203], v[220:223], v[160:163]
    global_load_dwordx4 v[240:243], v1, s[88:89] offset:-3072 sc1
    v_mfma_f32_16x16x32_bf16 v[160:163], a[244:247], v[228:231], v[160:163]
    ds_write_b128 v17, v[156:159] offset:4864
    v_mfma_f32_16x16x32_bf16 v[144:147], a[184:187], v[168:171], v[144:147]
    global_load_dwordx4 v[244:247], v1, s[90:91] offset:-3072 sc1
    v_mfma_f32_16x16x32_bf16 v[144:147], a[220:223], v[216:219], v[144:147]
    global_load_dwordx4 v[248:251], v1, s[88:89] offset:-2048 sc1
    v_mfma_f32_16x16x32_bf16 v[144:147], a[208:211], v[224:227], v[144:147]
    ds_write_b128 v17, v[140:143] offset:6912
    v_mfma_f32_16x16x32_bf16 v[164:167], a[184:187], v[172:175], v[164:167]
    v_mfma_f32_16x16x32_bf16 v[164:167], a[220:223], v[220:223], v[164:167]
    global_load_dwordx4 v[252:255], v1, s[90:91] offset:-2048 sc1
    v_mfma_f32_16x16x32_bf16 v[164:167], a[208:211], v[228:231], v[164:167]
    ds_write_b128 v17, v[160:163] offset:7168
    s_nop 1
    ds_write_b128 v17, v[144:147] offset:9216
    global_load_dwordx4 v[96:99], v1, s[88:89] offset:-1024 sc1
    s_nop 2
    ds_write_b128 v17, v[164:167] offset:9472
    global_load_dwordx4 v[100:103], v1, s[90:91] offset:-1024 sc1
    global_load_dwordx4 v[104:107], v1, s[88:89] offset:0 sc1
    global_load_dwordx4 v[108:111], v1, s[90:91] offset:0 sc1
    global_load_dwordx4 v[112:115], v1, s[88:89] offset:1024 sc1
    global_load_dwordx4 v[116:119], v1, s[90:91] offset:1024 sc1
    global_load_dwordx4 v[120:123], v1, s[88:89] offset:2048 sc1
    global_load_dwordx4 v[124:127], v1, s[90:91] offset:2048 sc1
    global_load_dwordx4 v[168:171], v1, s[88:89] offset:3072 sc1
    s_waitcnt lgkmcnt(0)
    s_barrier
    ds_read_b128 v[128:131], v18 offset:0
    ds_read_b128 v[132:135], v18 offset:576
    ds_read_b128 v[136:139], v18 offset:11520
    ds_read_b128 v[140:143], v18 offset:12096
    ds_read_b128 v[144:147], v18 offset:23040
    ds_read_b128 v[148:151], v18 offset:23616
    ds_read_b128 v[152:155], v18 offset:34560
    ds_read_b128 v[156:159], v18 offset:35136
    s_waitcnt lgkmcnt(4)
    v_pk_add_f32 v[128:129], v[128:129], v[136:137]
    v_pk_add_f32 v[130:131], v[130:131], v[138:139]
    v_pk_add_f32 v[132:133], v[132:133], v[140:141]
    v_pk_add_f32 v[134:135], v[134:135], v[142:143]
    ds_read_b128 v[160:163], v18 offset:9216
    ds_read_b128 v[164:167], v18 offset:9792
    ds_read_b128 v[176:179], v18 offset:20736
    ds_read_b128 v[180:183], v18 offset:21312
    v_lshlrev_b32 v136, 16, v64
    v_and_b32 v137, 0xffff0000, v64
    v_lshlrev_b32 v138, 16, v65
    v_and_b32 v139, 0xffff0000, v65
    global_load_dwordx4 v[172:175], v1, s[90:91] offset:3072 sc1
    v_lshlrev_b32 v140, 16, v66
    v_and_b32 v141, 0xffff0000, v66
    v_lshlrev_b32 v142, 16, v67
    v_and_b32 v143, 0xffff0000, v67
    s_waitcnt lgkmcnt(4)
    v_pk_add_f32 v[128:129], v[128:129], v[136:137]
    v_pk_add_f32 v[130:131], v[130:131], v[138:139]
    s_add_u32 s88, s31, 14888960
    s_add_u32 s88, s88, s8
    s_addc_u32 s89, s52, 0
    global_load_dwordx4 v[216:219], v1, s[88:89] offset:-4096 sc1
    v_pk_add_f32 v[132:133], v[132:133], v[140:141]
    s_add_u32 s90, s31, 14938112
    s_add_u32 s90, s90, s8
    s_addc_u32 s91, s52, 0
    global_load_dwordx4 v[220:223], v1, s[90:91] offset:-4096 sc1
    v_pk_add_f32 v[134:135], v[134:135], v[142:143]
    ds_read_b128 v[184:187], v18 offset:32256
    ds_read_b128 v[188:191], v18 offset:32832
    ds_read_b128 v[192:195], v18 offset:43776
    ds_read_b128 v[196:199], v18 offset:44352
    v_pk_add_f32 v[144:145], v[144:145], v[152:153]
    v_pk_add_f32 v[146:147], v[146:147], v[154:155]
    v_pk_add_f32 v[148:149], v[148:149], v[156:157]
    v_pk_add_f32 v[150:151], v[150:151], v[158:159]
    v_pk_add_f32 v[128:129], v[128:129], v[144:145]
    global_load_dwordx4 v[224:227], v1, s[88:89] offset:-3072 sc1
    v_pk_add_f32 v[130:131], v[130:131], v[146:147]
    v_pk_add_f32 v[132:133], v[132:133], v[148:149]
    v_pk_add_f32 v[134:135], v[134:135], v[150:151]
    v_cvt_pk_bf16_f32 v64, v128, v129
    v_cvt_pk_bf16_f32 v65, v130, v131
    v_cvt_pk_bf16_f32 v66, v132, v133
    v_cvt_pk_bf16_f32 v67, v134, v135
    s_add_u32 s56, s35, 32505856
    buffer_store_dwordx4 v[64:67], v8, s[8:11], s56 offen offset:0 sc1
    s_waitcnt lgkmcnt(4)
    v_pk_add_f32 v[160:161], v[160:161], v[176:177]
    v_pk_add_f32 v[162:163], v[162:163], v[178:179]
    v_pk_add_f32 v[164:165], v[164:165], v[180:181]
    v_pk_add_f32 v[166:167], v[166:167], v[182:183]
    v_lshlrev_b32 v176, 16, v68
    v_and_b32 v177, 0xffff0000, v68
    v_lshlrev_b32 v178, 16, v69
    v_and_b32 v179, 0xffff0000, v69
    v_lshlrev_b32 v180, 16, v70
    v_and_b32 v181, 0xffff0000, v70
    v_lshlrev_b32 v182, 16, v71
    v_and_b32 v183, 0xffff0000, v71
    s_waitcnt lgkmcnt(0)
    v_pk_add_f32 v[160:161], v[160:161], v[176:177]
    v_pk_add_f32 v[162:163], v[162:163], v[178:179]
    v_pk_add_f32 v[164:165], v[164:165], v[180:181]
    v_pk_add_f32 v[166:167], v[166:167], v[182:183]
    v_pk_add_f32 v[184:185], v[184:185], v[192:193]
    v_pk_add_f32 v[186:187], v[186:187], v[194:195]
    v_pk_add_f32 v[188:189], v[188:189], v[196:197]
    v_pk_add_f32 v[190:191], v[190:191], v[198:199]
    v_pk_add_f32 v[160:161], v[160:161], v[184:185]
    v_pk_add_f32 v[162:163], v[162:163], v[186:187]
    v_pk_add_f32 v[164:165], v[164:165], v[188:189]
    v_pk_add_f32 v[166:167], v[166:167], v[190:191]
    global_load_dwordx4 v[228:231], v1, s[90:91] offset:-3072 sc1
    v_cvt_pk_bf16_f32 v68, v160, v161
    v_cvt_pk_bf16_f32 v69, v162, v163
    v_cvt_pk_bf16_f32 v70, v164, v165
    v_cvt_pk_bf16_f32 v71, v166, v167
    buffer_store_dwordx4 v[68:71], v12, s[8:11], s56 offen offset:2048 sc1
    v_pk_add_f32 v[136:137], v[128:129], v[130:131]
    v_pk_mul_f32 v[140:141], v[128:129], v[128:129]
    v_pk_add_f32 v[138:139], v[160:161], v[162:163]
    v_pk_mul_f32 v[142:143], v[160:161], v[160:161]
    v_pk_fma_f32 v[140:141], v[130:131], v[130:131], v[140:141] op_sel:[0,0,0] op_sel_hi:[1,1,1]
    v_pk_fma_f32 v[142:143], v[162:163], v[162:163], v[142:143] op_sel:[0,0,0] op_sel_hi:[1,1,1]
    v_pk_add_f32 v[136:137], v[136:137], v[132:133]
    v_pk_fma_f32 v[140:141], v[132:133], v[132:133], v[140:141] op_sel:[0,0,0] op_sel_hi:[1,1,1]
    v_pk_add_f32 v[138:139], v[138:139], v[164:165]
    v_pk_fma_f32 v[142:143], v[164:165], v[164:165], v[142:143] op_sel:[0,0,0] op_sel_hi:[1,1,1]
    v_pk_add_f32 v[136:137], v[136:137], v[134:135]
    v_pk_fma_f32 v[140:141], v[134:135], v[134:135], v[140:141] op_sel:[0,0,0] op_sel_hi:[1,1,1]
    s_add_u32 m0, s28, 17408
    s_nop 0
    buffer_load_dwordx4 v1, s[8:11], s26 offen offset:3072 sc1 lds
    v_pk_add_f32 v[138:139], v[138:139], v[166:167]
    v_pk_fma_f32 v[142:143], v[166:167], v[166:167], v[142:143] op_sel:[0,0,0] op_sel_hi:[1,1,1]
    v_add_f32 v136, v136, v137
    v_add_f32 v138, v138, v139
    v_add_f32 v137, v140, v141
    v_add_f32 v139, v142, v143
    v_cndmask_b32 v138, 0, v138, s[46:47]
    v_cndmask_b32 v139, 0, v139, s[46:47]
    v_pk_add_f32 v[136:137], v[136:137], v[138:139]
    s_nop 1
    v_add_f32_dpp v136, v136, v136 row_ror:8 row_mask:0xf bank_mask:0xf
    v_add_f32_dpp v137, v137, v137 row_ror:8 row_mask:0xf bank_mask:0xf
    v_mov_b32 v138, v136
    v_mov_b32 v139, v137
    s_nop 0
    v_permlane16_swap_b32 v136, v138
    v_permlane16_swap_b32 v137, v139
    s_add_u32 m0, s28, 27648
    s_add_u32 s26, s22, 12288
    buffer_load_dwordx4 v1, s[8:11], s26 offen offset:0 sc1 lds
    v_pk_add_f32 v[136:137], v[136:137], v[138:139]
    v_mov_b32 v138, v136
    v_mov_b32 v139, v137
    s_nop 0
    v_permlane32_swap_b32 v136, v138
    v_permlane32_swap_b32 v137, v139
    v_pk_add_f32 v[136:137], v[136:137], v[138:139]
    s_add_u32 s56, s36, 35389440
    buffer_store_dwordx2 v[136:137], v20, s[8:11], s56 offen sc1
    s_waitcnt vmcnt(23)
    v_max_u32 v3, v232, v236
    v_cmp_eq_u32 vcc, -1, v3
    s_nop 3
    s_cbranch_vccnz L_fix_25
L_fixed_26:
    v_mfma_f32_16x16x32_bf16 v[128:131], a[252:255], v[232:235], 0
    v_mfma_f32_16x16x32_bf16 v[132:135], a[216:219], v[232:235], 0
    v_mfma_f32_16x16x32_bf16 v[136:139], a[236:239], v[232:235], 0
    v_mfma_f32_16x16x32_bf16 v[140:143], a[0:3], v[232:235], 0
    v_mfma_f32_16x16x32_bf16 v[144:147], a[4:7], v[232:235], 0
    s_waitcnt vmcnt(21)
    v_max_u32 v3, v240, v244
    v_cmp_eq_u32 vcc, -1, v3
    v_mfma_f32_16x16x32_bf16 v[148:151], a[252:255], v[236:239], 0
    v_mfma_f32_16x16x32_bf16 v[152:155], a[216:219], v[236:239], 0
    v_mfma_f32_16x16x32_bf16 v[156:159], a[236:239], v[236:239], 0
    v_mfma_f32_16x16x32_bf16 v[160:163], a[0:3], v[236:239], 0
    s_cbranch_vccnz L_fix_29
L_fixed_30:
    v_mfma_f32_16x16x32_bf16 v[164:167], a[4:7], v[236:239], 0
    s_add_u32 m0, s28, 27648
    v_mfma_f32_16x16x32_bf16 v[128:131], a[8:11], v[240:243], v[128:131]
    ds_read_b128 a[252:255], v95 offset:44032
    ds_read_b128 a[216:219], v95 offset:45056
    v_mfma_f32_16x16x32_bf16 v[132:135], a[12:15], v[240:243], v[132:135]
    ds_read_b128 a[236:239], v94 offset:3072
    ds_read_b128 a[0:3], v94 offset:4096
    v_mfma_f32_16x16x32_bf16 v[136:139], a[16:19], v[240:243], v[136:139]
    ds_read_b128 a[4:7], v94 offset:11264
    v_mfma_f32_16x16x32_bf16 v[140:143], a[20:23], v[240:243], v[140:143]
    buffer_load_dwordx4 v1, s[8:11], s26 offen offset:1024 sc1 lds
    v_mfma_f32_16x16x32_bf16 v[144:147], a[24:27], v[240:243], v[144:147]
    s_waitcnt vmcnt(20)
    v_max_u32 v3, v248, v252
    v_cmp_eq_u32 vcc, -1, v3
    v_mfma_f32_16x16x32_bf16 v[148:151], a[8:11], v[244:247], v[148:151]
    global_load_dwordx4 v[232:235], v1, s[88:89] offset:-2048 sc1
    v_mfma_f32_16x16x32_bf16 v[152:155], a[12:15], v[244:247], v[152:155]
    global_load_dwordx4 v[236:239], v1, s[90:91] offset:-2048 sc1
    v_mfma_f32_16x16x32_bf16 v[156:159], a[16:19], v[244:247], v[156:159]
    v_mfma_f32_16x16x32_bf16 v[160:163], a[20:23], v[244:247], v[160:163]
    s_cbranch_vccnz L_fix_33
L_fixed_34:
    v_mfma_f32_16x16x32_bf16 v[164:167], a[24:27], v[244:247], v[164:167]
    s_add_u32 m0, s28, 33792
    v_mfma_f32_16x16x32_bf16 v[128:131], a[28:31], v[248:251], v[128:131]
    ds_read_b128 a[8:11], v94 offset:12288
    ds_read_b128 a[12:15], v94 offset:19456
    v_mfma_f32_16x16x32_bf16 v[132:135], a[32:35], v[248:251], v[132:135]
    buffer_load_dwordx4 v1, s[8:11], s26 offen offset:2048 sc1 lds
    v_mfma_f32_16x16x32_bf16 v[136:139], a[36:39], v[248:251], v[136:139]
    global_load_dwordx4 v[240:243], v1, s[88:89] offset:-1024 sc1
    v_mfma_f32_16x16x32_bf16 v[140:143], a[40:43], v[248:251], v[140:143]
    global_load_dwordx4 v[244:247], v1, s[90:91] offset:-1024 sc1
    v_mfma_f32_16x16x32_bf16 v[144:147], a[44:47], v[248:251], v[144:147]
    s_waitcnt vmcnt(23)
    v_max_u32 v3, v96, v100
    v_cmp_eq_u32 vcc, -1, v3
    v_mfma_f32_16x16x32_bf16 v[148:151], a[28:31], v[252:255], v[148:151]
    v_mfma_f32_16x16x32_bf16 v[152:155], a[32:35], v[252:255], v[152:155]
    v_mfma_f32_16x16x32_bf16 v[156:159], a[36:39], v[252:255], v[156:159]
    v_mfma_f32_16x16x32_bf16 v[160:163], a[40:43], v[252:255], v[160:163]
    s_cbranch_vccnz L_fix_37
L_fixed_38:
    v_mfma_f32_16x16x32_bf16 v[164:167], a[44:47], v[252:255], v[164:167]
    v_mfma_f32_16x16x32_bf16 v[128:131], a[48:51], v[96:99], v[128:131]
    v_mfma_f32_16x16x32_bf16 v[132:135], a[56:59], v[96:99], v[132:135]
    buffer_load_dwordx4 a[16:19], v1, s[8:11], s26 offen offset:3072 sc1
    v_mfma_f32_16x16x32_bf16 v[136:139], a[60:63], v[96:99], v[136:139]
    v_mfma_f32_16x16x32_bf16 v[140:143], a[64:67], v[96:99], v[140:143]
    v_mfma_f32_16x16x32_bf16 v[144:147], a[72:75], v[96:99], v[144:147]
    s_waitcnt vmcnt(22)
    v_max_u32 v3, v104, v108
    v_cmp_eq_u32 vcc, -1, v3
    v_mfma_f32_16x16x32_bf16 v[148:151], a[48:51], v[100:103], v[148:151]
    s_add_u32 s26, s22, 16384
    v_mfma_f32_16x16x32_bf16 v[152:155], a[56:59], v[100:103], v[152:155]
    buffer_load_dwordx4 a[20:23], v1, s[8:11], s26 offen offset:0 sc1
    v_mfma_f32_16x16x32_bf16 v[156:159], a[60:63], v[100:103], v[156:159]
    v_mfma_f32_16x16x32_bf16 v[160:163], a[64:67], v[100:103], v[160:163]
    s_cbranch_vccnz L_fix_41
L_fixed_42:
    v_mfma_f32_16x16x32_bf16 v[164:167], a[72:75], v[100:103], v[164:167]
    v_mfma_f32_16x16x32_bf16 v[128:131], a[76:79], v[104:107], v[128:131]
    buffer_load_dwordx4 a[24:27], v1, s[8:11], s26 offen offset:1024 sc1
    v_mfma_f32_16x16x32_bf16 v[132:135], a[80:83], v[104:107], v[132:135]
    v_mfma_f32_16x16x32_bf16 v[136:139], a[96:99], v[104:107], v[136:139]
    v_mfma_f32_16x16x32_bf16 v[140:143], a[100:103], v[104:107], v[140:143]
    v_mfma_f32_16x16x32_bf16 v[144:147], a[108:111], v[104:107], v[144:147]
    s_waitcnt vmcnt(22)
    v_max_u32 v3, v112, v116
    v_cmp_eq_u32 vcc, -1, v3
    v_mfma_f32_16x16x32_bf16 v[148:151], a[76:79], v[108:111], v[148:151]
    v_mfma_f32_16x16x32_bf16 v[152:155], a[80:83], v[108:111], v[152:155]
    v_mfma_f32_16x16x32_bf16 v[156:159], a[96:99], v[108:111], v[156:159]
    v_mfma_f32_16x16x32_bf16 v[160:163], a[100:103], v[108:111], v[160:163]
    s_cbranch_vccnz L_fix_45
L_fixed_46:
    v_mfma_f32_16x16x32_bf16 v[164:167], a[108:111], v[108:111], v[164:167]
    v_mfma_f32_16x16x32_bf16 v[128:131], a[120:123], v[112:115], v[128:131]
    buffer_load_dwordx4 a[28:31], v1, s[8:11], s26 offen offset:2048 sc1
    v_mfma_f32_16x16x32_bf16 v[132:135], a[52:55], v[112:115], v[132:135]
    v_mfma_f32_16x16x32_bf16 v[136:139], a[68:71], v[112:115], v[136:139]
    buffer_load_dwordx4 a[32:35], v1, s[8:11], s26 offen offset:3072 sc1
    v_mfma_f32_16x16x32_bf16 v[140:143], a[84:87], v[112:115], v[140:143]
    v_mfma_f32_16x16x32_bf16 v[144:147], a[88:91], v[112:115], v[144:147]
    s_waitcnt vmcnt(22)
    v_max_u32 v3, v120, v124
    v_cmp_eq_u32 vcc, -1, v3
    v_mfma_f32_16x16x32_bf16 v[148:151], a[120:123], v[116:119], v[148:151]
    v_mfma_f32_16x16x32_bf16 v[152:155], a[52:55], v[116:119], v[152:155]
    v_mfma_f32_16x16x32_bf16 v[156:159], a[68:71], v[116:119], v[156:159]
    v_mfma_f32_16x16x32_bf16 v[160:163], a[84:87], v[116:119], v[160:163]
    s_cbranch_vccnz L_fix_49
L_fixed_50:
    v_mfma_f32_16x16x32_bf16 v[164:167], a[88:91], v[116:119], v[164:167]
    s_add_u32 s26, s22, 20480
    buffer_load_dwordx4 a[36:39], v1, s[8:11], s26 offen offset:0 sc1
    buffer_load_dwordx4 a[40:43], v1, s[8:11], s26 offen offset:1024 sc1
    buffer_load_dwordx4 a[44:47], v1, s[8:11], s26 offen offset:2048 sc1
    buffer_load_dwordx4 a[48:51], v1, s[8:11], s26 offen offset:3072 sc1
    s_add_u32 s26, s22, 24576
    buffer_load_dwordx4 a[56:59], v1, s[8:11], s26 offen offset:0 sc1
    s_waitcnt vmcnt(16)
    s_barrier
    v_mov_b32 v199, 9
    ds_read_b128 a[60:63], v94 offset:20480
    buffer_store_dword v199, v26, s[8:11], s37 offen sc1
    ds_read_b128 a[64:67], v94 offset:27648
    v_mfma_f32_16x16x32_bf16 v[128:131], a[92:95], v[120:123], v[128:131]
    buffer_load_dwordx4 a[72:75], v1, s[8:11], s26 offen offset:1024 sc1
    v_mfma_f32_16x16x32_bf16 v[132:135], a[104:107], v[120:123], v[132:135]
    v_mfma_f32_16x16x32_bf16 v[136:139], a[112:115], v[120:123], v[136:139]
    v_mfma_f32_16x16x32_bf16 v[140:143], a[116:119], v[120:123], v[140:143]
    buffer_load_dwordx4 a[76:79], v1, s[8:11], s26 offen offset:2048 sc1
    v_mfma_f32_16x16x32_bf16 v[144:147], a[160:163], v[120:123], v[144:147]
    v_max_u32 v3, v168, v172
    v_cmp_eq_u32 vcc, -1, v3
    v_mfma_f32_16x16x32_bf16 v[148:151], a[92:95], v[124:127], v[148:151]
    v_mfma_f32_16x16x32_bf16 v[152:155], a[104:107], v[124:127], v[152:155]
    v_mfma_f32_16x16x32_bf16 v[156:159], a[112:115], v[124:127], v[156:159]
    buffer_load_dwordx4 a[80:83], v1, s[8:11], s26 offen offset:3072 sc1
    v_mfma_f32_16x16x32_bf16 v[160:163], a[116:119], v[124:127], v[160:163]
    s_cbranch_vccnz L_fix_53
L_fixed_54:
    v_mfma_f32_16x16x32_bf16 v[164:167], a[160:163], v[124:127], v[164:167]
    v_mfma_f32_16x16x32_bf16 v[128:131], a[124:127], v[168:171], v[128:131]
    v_mfma_f32_16x16x32_bf16 v[132:135], a[128:131], v[168:171], v[132:135]
    v_mfma_f32_16x16x32_bf16 v[136:139], a[164:167], v[168:171], v[136:139]
    v_mfma_f32_16x16x32_bf16 v[140:143], a[132:135], v[168:171], v[140:143]
    v_mfma_f32_16x16x32_bf16 v[144:147], a[136:139], v[168:171], v[144:147]
    v_max_u32 v3, v216, v220
    v_cmp_eq_u32 vcc, -1, v3
    v_mfma_f32_16x16x32_bf16 v[148:151], a[124:127], v[172:175], v[148:151]
    s_add_u32 s26, s22, 28672
    v_mfma_f32_16x16x32_bf16 v[152:155], a[128:131], v[172:175], v[152:155]
    buffer_load_dwordx4 a[96:99], v1, s[8:11], s26 offen offset:0 sc1
    v_mfma_f32_16x16x32_bf16 v[156:159], a[164:167], v[172:175], v[156:159]
    buffer_load_dwordx4 a[100:103], v1, s[8:11], s26 offen offset:1024 sc1
    v_mfma_f32_16x16x32_bf16 v[160:163], a[132:135], v[172:175], v[160:163]
    s_cbranch_vccnz L_fix_57
L_fixed_58:
    v_mfma_f32_16x16x32_bf16 v[164:167], a[136:139], v[172:175], v[164:167]
    v_mfma_f32_16x16x32_bf16 v[128:131], a[168:171], v[216:219], v[128:131]
    v_mfma_f32_16x16x32_bf16 v[132:135], a[140:143], v[216:219], v[132:135]
    v_mfma_f32_16x16x32_bf16 v[136:139], a[144:147], v[216:219], v[136:139]
    v_mfma_f32_16x16x32_bf16 v[140:143], a[172:175], v[216:219], v[140:143]
    v_mfma_f32_16x16x32_bf16 v[144:147], a[148:151], v[216:219], v[144:147]
    s_waitcnt vmcnt(16)
    v_max3_u32 v3, v224, v228, v232
    v_max3_u32 v3, v3, v236, v240
    v_max_u32 v3, v3, v244
    v_cmp_eq_u32 vcc, -1, v3
    v_mfma_f32_16x16x32_bf16 v[148:151], a[168:171], v[220:223], v[148:151]
    ds_read_b128 a[108:111], v94 offset:28672
    ds_read_b128 a[120:123], v94 offset:35840
    v_mfma_f32_16x16x32_bf16 v[152:155], a[140:143], v[220:223], v[152:155]
    buffer_load_dwordx4 a[52:55], v1, s[8:11], s26 offen offset:2048 sc1
    v_mfma_f32_16x16x32_bf16 v[156:159], a[144:147], v[220:223], v[156:159]
    buffer_load_dwordx4 a[68:71], v1, s[8:11], s26 offen offset:3072 sc1
    v_mfma_f32_16x16x32_bf16 v[160:163], a[172:175], v[220:223], v[160:163]
    s_cbranch_vccnz L_fix_61
L_fixed_62:
    v_mfma_f32_16x16x32_bf16 v[164:167], a[148:151], v[220:223], v[164:167]
    s_add_u32 s26, s22, 32768
    s_waitcnt lgkmcnt(0)
    v_mfma_f32_16x16x32_bf16 v[128:131], a[152:155], v[224:227], v[128:131]
    buffer_load_dwordx4 a[84:87], v1, s[8:11], s26 offen offset:0 sc1
    v_mfma_f32_16x16x32_bf16 v[128:131], a[188:191], v[232:235], v[128:131]
    v_mfma_f32_16x16x32_bf16 v[128:131], a[240:243], v[240:243], v[128:131]
    v_mfma_f32_16x16x32_bf16 v[148:151], a[152:155], v[228:231], v[148:151]
    v_mfma_f32_16x16x32_bf16 v[148:151], a[188:191], v[236:239], v[148:151]
    s_add_u32 m0, s28, 44032
    s_add_u32 s49, s48, 32505856
    v_mfma_f32_16x16x32_bf16 v[148:151], a[240:243], v[244:247], v[148:151]
    buffer_load_dwordx4 v1, s[8:11], s49 offen offset:0 sc1 lds
    v_mfma_f32_16x16x32_bf16 v[132:135], a[176:179], v[224:227], v[132:135]
    v_mfma_f32_16x16x32_bf16 v[132:135], a[192:195], v[232:235], v[132:135]
    v_mfma_f32_16x16x32_bf16 v[132:135], a[204:207], v[240:243], v[132:135]
    ds_write_b128 v17, v[128:131] offset:0
    s_add_u32 m0, s28, 44032
    v_mfma_f32_16x16x32_bf16 v[152:155], a[176:179], v[228:231], v[152:155]
    buffer_load_dwordx4 v1, s[8:11], s49 offen offset:1024 sc1 lds
    v_mfma_f32_16x16x32_bf16 v[152:155], a[192:195], v[236:239], v[152:155]
    v_mfma_f32_16x16x32_bf16 v[152:155], a[204:207], v[244:247], v[152:155]
    ds_write_b128 v17, v[148:151] offset:256
    v_mfma_f32_16x16x32_bf16 v[136:139], a[180:183], v[224:227], v[136:139]
    v_mfma_f32_16x16x32_bf16 v[136:139], a[196:199], v[232:235], v[136:139]
    s_add_u32 m0, s28, 50176
    v_mfma_f32_16x16x32_bf16 v[136:139], a[224:227], v[240:243], v[136:139]
    ds_write_b128 v17, v[132:135] offset:2304
    v_mfma_f32_16x16x32_bf16 v[156:159], a[180:183], v[228:231], v[156:159]
    buffer_load_dwordx4 v1, s[8:11], s49 offen offset:2048 sc1 lds
    v_mfma_f32_16x16x32_bf16 v[156:159], a[196:199], v[236:239], v[156:159]
    v_mfma_f32_16x16x32_bf16 v[156:159], a[224:227], v[244:247], v[156:159]
    ds_write_b128 v17, v[152:155] offset:2560
    s_add_u32 m0, s28, 50176
    v_mfma_f32_16x16x32_bf16 v[140:143], a[156:159], v[224:227], v[140:143]
    buffer_load_dwordx4 v1, s[8:11], s49 offen offset:3072 sc1 lds
    v_mfma_f32_16x16x32_bf16 v[140:143], a[200:203], v[232:235], v[140:143]
    v_mfma_f32_16x16x32_bf16 v[140:143], a[244:247], v[240:243], v[140:143]
    ds_write_b128 v17, v[136:139] offset:4608
    v_mfma_f32_16x16x32_bf16 v[160:163], a[156:159], v[228:231], v[160:163]
    v_mfma_f32_16x16x32_bf16 v[160:163], a[200:203], v[236:239], v[160:163]
    s_add_u32 m0, s28, 60416
    s_add_u32 s49, s48, 32509952
    v_mfma_f32_16x16x32_bf16 v[160:163], a[244:247], v[244:247], v[160:163]
    ds_write_b128 v17, v[156:159] offset:4864
    v_mfma_f32_16x16x32_bf16 v[144:147], a[184:187], v[224:227], v[144:147]
    buffer_load_dwordx4 v1, s[8:11], s49 offen offset:0 sc1 lds
    v_mfma_f32_16x16x32_bf16 v[144:147], a[220:223], v[232:235], v[144:147]
    v_mfma_f32_16x16x32_bf16 v[144:147], a[208:211], v[240:243], v[144:147]
    ds_write_b128 v17, v[140:143] offset:6912
    s_add_u32 m0, s28, 60416
    v_mfma_f32_16x16x32_bf16 v[164:167], a[184:187], v[228:231], v[164:167]
    buffer_load_dwordx4 v1, s[8:11], s49 offen offset:1024 sc1 lds
    v_mfma_f32_16x16x32_bf16 v[164:167], a[220:223], v[236:239], v[164:167]
    v_mfma_f32_16x16x32_bf16 v[164:167], a[208:211], v[244:247], v[164:167]
    ds_write_b128 v17, v[160:163] offset:7168
    s_nop 0
    ds_write_b128 v17, v[144:147] offset:9216
    s_nop 4
    ds_write_b128 v17, v[164:167] offset:9472
    s_add_u32 m0, s28, 66560
    s_nop 0
    buffer_load_dwordx4 v1, s[8:11], s49 offen offset:2048 sc1 lds
    buffer_load_dword v27, v25, s[8:11], s38 offen sc1
    s_waitcnt lgkmcnt(0)
    s_barrier
    ds_read_b128 v[128:131], v18 offset:0
    ds_read_b128 v[132:135], v18 offset:576
    ds_read_b128 v[136:139], v18 offset:11520
    ds_read_b128 v[140:143], v18 offset:12096
    ds_read_b128 v[144:147], v18 offset:23040
    ds_read_b128 v[148:151], v18 offset:23616
    ds_read_b128 v[152:155], v18 offset:34560
    ds_read_b128 v[156:159], v18 offset:35136
    s_waitcnt lgkmcnt(4)
    v_pk_add_f32 v[128:129], v[128:129], v[136:137]
    s_add_u32 m0, s28, 66560
    s_nop 0
    buffer_load_dwordx4 v1, s[8:11], s49 offen offset:3072 sc1 lds
    v_pk_add_f32 v[130:131], v[130:131], v[138:139]
    v_pk_add_f32 v[132:133], v[132:133], v[140:141]
    v_pk_add_f32 v[134:135], v[134:135], v[142:143]
    ds_read_b128 v[160:163], v18 offset:9216
    ds_read_b128 v[164:167], v18 offset:9792
    ds_read_b128 v[176:179], v18 offset:20736
    ds_read_b128 v[180:183], v18 offset:21312
    v_lshlrev_b32 v136, 16, v72
    v_and_b32 v137, 0xffff0000, v72
    v_lshlrev_b32 v138, 16, v73
    v_and_b32 v139, 0xffff0000, v73
    v_lshlrev_b32 v140, 16, v74
    v_and_b32 v141, 0xffff0000, v74
    v_lshlrev_b32 v142, 16, v75
    v_and_b32 v143, 0xffff0000, v75
    buffer_load_dwordx4 a[88:91], v1, s[8:11], s26 offen offset:1024 sc1
    s_waitcnt lgkmcnt(4)
    v_pk_add_f32 v[128:129], v[128:129], v[136:137]
    v_pk_add_f32 v[130:131], v[130:131], v[138:139]
    v_pk_add_f32 v[132:133], v[132:133], v[140:141]
    v_pk_add_f32 v[134:135], v[134:135], v[142:143]
    ds_read_b128 v[184:187], v18 offset:32256
    ds_read_b128 v[188:191], v18 offset:32832
    ds_read_b128 v[192:195], v18 offset:43776
    ds_read_b128 v[196:199], v18 offset:44352
    v_pk_add_f32 v[144:145], v[144:145], v[152:153]
    v_pk_add_f32 v[146:147], v[146:147], v[154:155]
    v_pk_add_f32 v[148:149], v[148:149], v[156:157]
    v_pk_add_f32 v[150:151], v[150:151], v[158:159]
    v_pk_add_f32 v[128:129], v[128:129], v[144:145]
    v_pk_add_f32 v[130:131], v[130:131], v[146:147]
    v_pk_add_f32 v[132:133], v[132:133], v[148:149]
    v_pk_add_f32 v[134:135], v[134:135], v[150:151]
    buffer_load_dwordx4 a[92:95], v1, s[8:11], s26 offen offset:2048 sc1
    v_cvt_pk_bf16_f32 v72, v128, v129
    v_cvt_pk_bf16_f32 v73, v130, v131
    v_cvt_pk_bf16_f32 v74, v132, v133
    v_cvt_pk_bf16_f32 v75, v134, v135
    s_add_u32 s56, s35, 32587776
    buffer_store_dwordx4 v[72:75], v8, s[8:11], s56 offen offset:0 sc1
    s_waitcnt lgkmcnt(4)
    v_pk_add_f32 v[160:161], v[160:161], v[176:177]
    v_pk_add_f32 v[162:163], v[162:163], v[178:179]
    v_pk_add_f32 v[164:165], v[164:165], v[180:181]
    v_pk_add_f32 v[166:167], v[166:167], v[182:183]
    v_lshlrev_b32 v176, 16, v76
    v_and_b32 v177, 0xffff0000, v76
    v_lshlrev_b32 v178, 16, v77
    v_and_b32 v179, 0xffff0000, v77
    v_lshlrev_b32 v180, 16, v78
    v_and_b32 v181, 0xffff0000, v78
    v_lshlrev_b32 v182, 16, v79
    v_and_b32 v183, 0xffff0000, v79
    s_waitcnt lgkmcnt(0)
    v_pk_add_f32 v[160:161], v[160:161], v[176:177]
    v_pk_add_f32 v[162:163], v[162:163], v[178:179]
    v_pk_add_f32 v[164:165], v[164:165], v[180:181]
    v_pk_add_f32 v[166:167], v[166:167], v[182:183]
    v_pk_add_f32 v[184:185], v[184:185], v[192:193]
    v_pk_add_f32 v[186:187], v[186:187], v[194:195]
    v_pk_add_f32 v[188:189], v[188:189], v[196:197]
    v_pk_add_f32 v[190:191], v[190:191], v[198:199]
    v_pk_add_f32 v[160:161], v[160:161], v[184:185]
    v_pk_add_f32 v[162:163], v[162:163], v[186:187]
    v_pk_add_f32 v[164:165], v[164:165], v[188:189]
    v_pk_add_f32 v[166:167], v[166:167], v[190:191]
    v_cvt_pk_bf16_f32 v76, v160, v161
    v_cvt_pk_bf16_f32 v77, v162, v163
    v_cvt_pk_bf16_f32 v78, v164, v165
    v_cvt_pk_bf16_f32 v79, v166, v167
    buffer_store_dwordx4 v[76:79], v12, s[8:11], s56 offen offset:2048 sc1
    v_pk_add_f32 v[136:137], v[128:129], v[130:131]
    v_pk_mul_f32 v[140:141], v[128:129], v[128:129]
    v_pk_add_f32 v[138:139], v[160:161], v[162:163]
    v_pk_mul_f32 v[142:143], v[160:161], v[160:161]
    v_pk_fma_f32 v[140:141], v[130:131], v[130:131], v[140:141] op_sel:[0,0,0] op_sel_hi:[1,1,1]
    v_pk_fma_f32 v[142:143], v[162:163], v[162:163], v[142:143] op_sel:[0,0,0] op_sel_hi:[1,1,1]
    v_pk_add_f32 v[136:137], v[136:137], v[132:133]
    v_pk_fma_f32 v[140:141], v[132:133], v[132:133], v[140:141] op_sel:[0,0,0] op_sel_hi:[1,1,1]
    v_pk_add_f32 v[138:139], v[138:139], v[164:165]
    buffer_load_dwordx4 a[104:107], v1, s[8:11], s26 offen offset:3072 sc1
    v_pk_fma_f32 v[142:143], v[164:165], v[164:165], v[142:143] op_sel:[0,0,0] op_sel_hi:[1,1,1]
    v_pk_add_f32 v[136:137], v[136:137], v[134:135]
    v_pk_fma_f32 v[140:141], v[134:135], v[134:135], v[140:141] op_sel:[0,0,0] op_sel_hi:[1,1,1]
    v_pk_add_f32 v[138:139], v[138:139], v[166:167]
    v_pk_fma_f32 v[142:143], v[166:167], v[166:167], v[142:143] op_sel:[0,0,0] op_sel_hi:[1,1,1]
    v_add_f32 v136, v136, v137
    v_add_f32 v138, v138, v139
    v_add_f32 v137, v140, v141
    v_add_f32 v139, v142, v143
    v_cndmask_b32 v138, 0, v138, s[46:47]
    v_cndmask_b32 v139, 0, v139, s[46:47]
    v_pk_add_f32 v[136:137], v[136:137], v[138:139]
    s_nop 1
    v_add_f32_dpp v136, v136, v136 row_ror:8 row_mask:0xf bank_mask:0xf
    v_add_f32_dpp v137, v137, v137 row_ror:8 row_mask:0xf bank_mask:0xf
    v_mov_b32 v138, v136
    v_mov_b32 v139, v137
    s_nop 0
    v_permlane16_swap_b32 v136, v138
    v_permlane16_swap_b32 v137, v139
    v_pk_add_f32 v[136:137], v[136:137], v[138:139]
    v_mov_b32 v138, v136
    s_add_u32 s26, s22, 36864
    buffer_load_dwordx4 a[112:115], v1, s[8:11], s26 offen offset:0 sc1
    v_mov_b32 v139, v137
    v_permlane32_swap_b32 v136, v138
    s_nop 0
    v_permlane32_swap_b32 v137, v139
    v_pk_add_f32 v[136:137], v[136:137], v[138:139]
    s_add_u32 s56, s36, 35393536
    buffer_store_dwordx2 v[136:137], v20, s[8:11], s56 offen sc1
    s_waitcnt vmcnt(8)
    v_cmp_le_u32 vcc, 9, v27
    s_nop 3
    s_cmp_eq_u64 vcc, -1
    s_cbranch_scc1 L_pdone_66
    s_mov_b32 s68, 0x80000
L_poll_65:
    buffer_load_dword v27, v25, s[8:11], s38 offen sc1
    s_waitcnt vmcnt(0)
    v_cmp_le_u32 vcc, 9, v27
    s_nop 3
    s_cmp_eq_u64 vcc, -1
    s_cbranch_scc1 L_pdone_66
    s_sub_u32 s68, s68, 1
    s_cmp_lg_u32 s68, 0
    s_cbranch_scc1 L_poll_65
L_pdone_66:
    s_waitcnt vmcnt(7)
    ds_read_b32 v96, v94 offset:44032
    s_add_u32 m0, s28, 76800
    s_add_u32 s49, s48, 32514048
    buffer_load_dwordx4 v1, s[8:11], s49 offen offset:0 sc1 lds
    ds_read_b32 v97, v94 offset:45056
    s_add_u32 m0, s28, 76800
    s_nop 0
    buffer_load_dwordx4 v1, s[8:11], s49 offen offset:1024 sc1 lds
    ds_read_b32 v98, v94 offset:52224
    s_add_u32 m0, s28, 82944
    s_nop 0
    buffer_load_dwordx4 v1, s[8:11], s49 offen offset:2048 sc1 lds
    ds_read_b32 v99, v94 offset:53248
    s_add_u32 m0, s28, 82944
    s_nop 0
    buffer_load_dwordx4 v1, s[8:11], s49 offen offset:3072 sc1 lds
    ds_read_b32 v100, v94 offset:60416
    s_add_u32 m0, s28, 93184
    s_add_u32 s49, s48, 32518144
    buffer_load_dwordx4 v1, s[8:11], s49 offen offset:0 sc1 lds
    ds_read_b32 v101, v94 offset:61440
    ds_read_b32 v102, v95 offset:3072
    s_add_u32 m0, s28, 93184
    s_nop 0
    buffer_load_dwordx4 v1, s[8:11], s49 offen offset:1024 sc1 lds
    ds_read_b32 v103, v95 offset:4096
    s_waitcnt lgkmcnt(0)
    v_max3_u32 v3, v96, v97, v98
    v_max3_u32 v3, v3, v99, v100
    v_max3_u32 v3, v3, v101, v102
    v_max_u32 v3, v3, v103
    v_cmp_eq_u32 vcc, -1, v3
    s_nop 3
    s_cbranch_vccnz L_fix_67
L_fixed_68:
    s_barrier
    ds_read_b128 v[96:99], v1 offset:44032
    s_add_u32 s53, s36, 35389440
    buffer_load_dwordx2 v[200:201], v0, s[8:11], s53 offen offset:0 sc1
    ds_read_b128 v[100:103], v1 offset:46080
    ds_read_b128 v[104:107], v1 offset:48128
    ds_read_b128 v[108:111], v1 offset:50176
    s_waitcnt lgkmcnt(2)
    v_mfma_f32_16x16x32_bf16 v[128:131], a[228:231], v[96:99], 0
    ds_read_b128 v[112:115], v1 offset:45056
    v_mfma_f32_16x16x32_bf16 v[136:139], a[228:231], v[100:103], 0
    ds_read_b128 v[116:119], v1 offset:47104
    v_mfma_f32_16x16x32_bf16 v[132:135], a[248:251], v[96:99], 0
    ds_read_b128 v[120:123], v1 offset:49152
    v_mfma_f32_16x16x32_bf16 v[140:143], a[248:251], v[100:103], 0
    ds_read_b128 v[124:127], v1 offset:51200
    s_waitcnt lgkmcnt(4)
    v_mfma_f32_16x16x32_bf16 v[148:151], a[248:251], v[104:107], 0
    buffer_load_dwordx2 v[202:203], v0, s[8:11], s53 offen offset:512 sc1
    v_mfma_f32_16x16x32_bf16 v[156:159], a[248:251], v[108:111], 0
    buffer_load_dwordx2 v[204:205], v0, s[8:11], s53 offen offset:1024 sc1
    v_mfma_f32_16x16x32_bf16 v[144:147], a[228:231], v[104:107], 0
    v_mfma_f32_16x16x32_bf16 v[152:155], a[228:231], v[108:111], 0
    s_waitcnt lgkmcnt(2)
    v_mfma_f32_16x16x32_bf16 v[128:131], a[212:215], v[112:115], v[128:131]
    ds_read_b128 v[96:99], v1 offset:52224
    v_mfma_f32_16x16x32_bf16 v[136:139], a[212:215], v[116:119], v[136:139]
    ds_read_b128 v[100:103], v1 offset:54272
    v_mfma_f32_16x16x32_bf16 v[132:135], a[232:235], v[112:115], v[132:135]
    ds_read_b128 v[104:107], v1 offset:56320
    v_mfma_f32_16x16x32_bf16 v[140:143], a[232:235], v[116:119], v[140:143]
    ds_read_b128 v[108:111], v1 offset:58368
    s_waitcnt lgkmcnt(4)
    v_mfma_f32_16x16x32_bf16 v[148:151], a[232:235], v[120:123], v[148:151]
    buffer_load_dwordx2 v[206:207], v0, s[8:11], s53 offen offset:1536 sc1
    v_mfma_f32_16x16x32_bf16 v[156:159], a[232:235], v[124:127], v[156:159]
    buffer_load_dwordx2 v[208:209], v0, s[8:11], s53 offen offset:2048 sc1
    v_mfma_f32_16x16x32_bf16 v[144:147], a[212:215], v[120:123], v[144:147]
    v_mfma_f32_16x16x32_bf16 v[152:155], a[212:215], v[124:127], v[152:155]
    s_waitcnt lgkmcnt(2)
    v_mfma_f32_16x16x32_bf16 v[128:131], a[252:255], v[96:99], v[128:131]
    ds_read_b128 v[112:115], v1 offset:53248
    v_mfma_f32_16x16x32_bf16 v[136:139], a[252:255], v[100:103], v[136:139]
    ds_read_b128 v[116:119], v1 offset:55296
    v_mfma_f32_16x16x32_bf16 v[132:135], a[216:219], v[96:99], v[132:135]
    ds_read_b128 v[120:123], v1 offset:57344
    v_mfma_f32_16x16x32_bf16 v[140:143], a[216:219], v[100:103], v[140:143]
    ds_read_b128 v[124:127], v1 offset:59392
    s_waitcnt lgkmcnt(4)
    v_mfma_f32_16x16x32_bf16 v[148:151], a[216:219], v[104:107], v[148:151]
    v_mfma_f32_16x16x32_bf16 v[156:159], a[216:219], v[108:111], v[156:159]
    v_mfma_f32_16x16x32_bf16 v[144:147], a[252:255], v[104:107], v[144:147]
    v_mfma_f32_16x16x32_bf16 v[152:155], a[252:255], v[108:111], v[152:155]
    s_waitcnt lgkmcnt(2)
    v_mfma_f32_16x16x32_bf16 v[128:131], a[236:239], v[112:115], v[128:131]
    ds_read_b128 v[96:99], v1 offset:60416
    v_mfma_f32_16x16x32_bf16 v[136:139], a[236:239], v[116:119], v[136:139]
    ds_read_b128 v[100:103], v1 offset:62464
    v_mfma_f32_16x16x32_bf16 v[132:135], a[0:3], v[112:115], v[132:135]
    ds_read_b128 v[104:107], v1 offset:64512
    v_mfma_f32_16x16x32_bf16 v[140:143], a[0:3], v[116:119], v[140:143]
    ds_read_b128 v[108:111], v2 offset:1024
    s_waitcnt lgkmcnt(4)
    v_mfma_f32_16x16x32_bf16 v[148:151], a[0:3], v[120:123], v[148:151]
    buffer_load_dwordx2 v[210:211], v0, s[8:11], s53 offen offset:2560 sc1
    v_mfma_f32_16x16x32_bf16 v[156:159], a[0:3], v[124:127], v[156:159]
    buffer_load_dwordx2 v[212:213], v0, s[8:11], s53 offen offset:3072 sc1
    v_mfma_f32_16x16x32_bf16 v[144:147], a[236:239], v[120:123], v[144:147]
    v_mfma_f32_16x16x32_bf16 v[152:155], a[236:239], v[124:127], v[152:155]
    s_waitcnt lgkmcnt(2)
    v_mfma_f32_16x16x32_bf16 v[128:131], a[4:7], v[96:99], v[128:131]
    ds_read_b128 v[112:115], v1 offset:61440
    v_mfma_f32_16x16x32_bf16 v[136:139], a[4:7], v[100:103], v[136:139]
    ds_read_b128 v[116:119], v1 offset:63488
    v_mfma_f32_16x16x32_bf16 v[132:135], a[8:11], v[96:99], v[132:135]
    ds_read_b128 v[120:123], v2 offset:0
    v_mfma_f32_16x16x32_bf16 v[140:143], a[8:11], v[100:103], v[140:143]
    ds_read_b128 v[124:127], v2 offset:2048
    s_waitcnt lgkmcnt(4)
    v_mfma_f32_16x16x32_bf16 v[148:151], a[8:11], v[104:107], v[148:151]
    buffer_load_dwordx2 v[214:215], v0, s[8:11], s53 offen offset:3584 sc1
    v_mfma_f32_16x16x32_bf16 v[156:159], a[8:11], v[108:111], v[156:159]
    s_add_u32 m0, s28, 99328
    v_mfma_f32_16x16x32_bf16 v[144:147], a[4:7], v[104:107], v[144:147]
    buffer_load_dwordx4 v1, s[8:11], s49 offen offset:2048 sc1 lds
    v_mfma_f32_16x16x32_bf16 v[152:155], a[4:7], v[108:111], v[152:155]
    s_add_u32 m0, s28, 99328
    s_waitcnt lgkmcnt(2)
    v_mfma_f32_16x16x32_bf16 v[128:131], a[12:15], v[112:115], v[128:131]
    ds_read_b128 v[96:99], v2 offset:3072
    v_mfma_f32_16x16x32_bf16 v[136:139], a[12:15], v[116:119], v[136:139]
    ds_read_b128 v[100:103], v2 offset:5120
    v_mfma_f32_16x16x32_bf16 v[132:135], a[60:63], v[112:115], v[132:135]
    ds_read_b128 v[104:107], v2 offset:7168
    v_mfma_f32_16x16x32_bf16 v[140:143], a[60:63], v[116:119], v[140:143]
    ds_read_b128 v[108:111], v2 offset:9216
    s_waitcnt lgkmcnt(4)
    v_mfma_f32_16x16x32_bf16 v[148:151], a[60:63], v[120:123], v[148:151]
    buffer_load_dwordx4 v1, s[8:11], s49 offen offset:3072 sc1 lds
    v_mfma_f32_16x16x32_bf16 v[156:159], a[60:63], v[124:127], v[156:159]
    s_add_u32 m0, s28, 109568
    s_add_u32 s49, s48, 32522240
    v_mfma_f32_16x16x32_bf16 v[144:147], a[12:15], v[120:123], v[144:147]
    buffer_load_dwordx4 v1, s[8:11], s49 offen offset:0 sc1 lds
    v_mfma_f32_16x16x32_bf16 v[152:155], a[12:15], v[124:127], v[152:155]
    s_add_u32 m0, s28, 109568
    s_waitcnt lgkmcnt(2)
    v_mfma_f32_16x16x32_bf16 v[128:131], a[64:67], v[96:99], v[128:131]
    ds_read_b128 v[112:115], v2 offset:4096
    v_mfma_f32_16x16x32_bf16 v[136:139], a[64:67], v[100:103], v[136:139]
    ds_read_b128 v[116:119], v2 offset:6144
    v_mfma_f32_16x16x32_bf16 v[132:135], a[108:111], v[96:99], v[132:135]
    ds_read_b128 v[120:123], v2 offset:8192
    v_mfma_f32_16x16x32_bf16 v[140:143], a[108:111], v[100:103], v[140:143]
    ds_read_b128 v[124:127], v2 offset:10240
    s_waitcnt lgkmcnt(4)
    v_mfma_f32_16x16x32_bf16 v[148:151], a[108:111], v[104:107], v[148:151]
    buffer_load_dwordx4 v1, s[8:11], s49 offen offset:1024 sc1 lds
    v_mfma_f32_16x16x32_bf16 v[156:159], a[108:111], v[108:111], v[156:159]
    s_add_u32 m0, s28, 1024
    v_mfma_f32_16x16x32_bf16 v[144:147], a[64:67], v[104:107], v[144:147]
    buffer_load_dwordx4 v1, s[8:11], s49 offen offset:2048 sc1 lds
    v_mfma_f32_16x16x32_bf16 v[152:155], a[64:67], v[108:111], v[152:155]
    s_add_u32 m0, s28, 1024
    s_waitcnt vmcnt(13)
    s_waitcnt lgkmcnt(0)
    s_barrier
    v_mov_b32 v199, 10
    buffer_load_dwordx4 v1, s[8:11], s49 offen offset:3072 sc1 lds
    buffer_store_dword v199, v26, s[8:11], s37 offen sc1
    buffer_load_dwordx4 a[116:119], v1, s[8:11], s26 offen offset:1024 sc1
    v_mfma_f32_16x16x32_bf16 v[128:131], a[120:123], v[112:115], v[128:131]
    ds_read_b128 v[96:99], v2 offset:11264
    v_mfma_f32_16x16x32_bf16 v[136:139], a[120:123], v[116:119], v[136:139]
    ds_read_b128 v[100:103], v2 offset:13312
    v_mfma_f32_16x16x32_bf16 v[132:135], a[16:19], v[112:115], v[132:135]
    ds_read_b128 v[104:107], v2 offset:15360
    v_mfma_f32_16x16x32_bf16 v[140:143], a[16:19], v[116:119], v[140:143]
    ds_read_b128 v[108:111], v2 offset:17408
    v_mfma_f32_16x16x32_bf16 v[148:151], a[16:19], v[120:123], v[148:151]
    buffer_load_dwordx4 a[160:163], v1, s[8:11], s26 offen offset:2048 sc1
    v_mfma_f32_16x16x32_bf16 v[156:159], a[16:19], v[124:127], v[156:159]
    v_mfma_f32_16x16x32_bf16 v[144:147], a[120:123], v[120:123], v[144:147]
    v_mfma_f32_16x16x32_bf16 v[152:155], a[120:123], v[124:127], v[152:155]
    s_waitcnt lgkmcnt(2)
    v_mfma_f32_16x16x32_bf16 v[128:131], a[20:23], v[96:99], v[128:131]
    ds_read_b128 v[112:115], v2 offset:12288
    v_mfma_f32_16x16x32_bf16 v[136:139], a[20:23], v[100:103], v[136:139]
    ds_read_b128 v[116:119], v2 offset:14336
    v_mfma_f32_16x16x32_bf16 v[132:135], a[24:27], v[96:99], v[132:135]
    ds_read_b128 v[120:123], v2 offset:16384
    v_mfma_f32_16x16x32_bf16 v[140:143], a[24:27], v[100:103], v[140:143]
    ds_read_b128 v[124:127], v2 offset:18432
    s_waitcnt lgkmcnt(4)
    v_mfma_f32_16x16x32_bf16 v[148:151], a[24:27], v[104:107], v[148:151]
    v_mfma_f32_16x16x32_bf16 v[156:159], a[24:27], v[108:111], v[156:159]
    v_mfma_f32_16x16x32_bf16 v[144:147], a[20:23], v[104:107], v[144:147]
    v_mfma_f32_16x16x32_bf16 v[152:155], a[20:23], v[108:111], v[152:155]
    buffer_load_dwordx4 a[124:127], v1, s[8:11], s26 offen offset:3072 sc1
    s_add_u32 s26, s23, 0
    buffer_load_dwordx4 a[128:131], v1, s[8:11], s26 offen offset:0 sc1
    buffer_load_dwordx4 a[164:167], v1, s[8:11], s26 offen offset:1024 sc1
    s_waitcnt vmcnt(12)
    s_waitcnt lgkmcnt(2)
    v_mfma_f32_16x16x32_bf16 v[128:131], a[28:31], v[112:115], v[128:131]
    ds_read_b128 v[96:99], v2 offset:19456
    v_add_f32 v200, v200, v208
    v_mfma_f32_16x16x32_bf16 v[136:139], a[28:31], v[116:119], v[136:139]
    ds_read_b128 v[100:103], v2 offset:21504
    v_add_f32 v201, v201, v209
    v_mfma_f32_16x16x32_bf16 v[132:135], a[32:35], v[112:115], v[132:135]
    ds_read_b128 v[104:107], v2 offset:23552
    v_add_f32 v202, v202, v210
    v_mfma_f32_16x16x32_bf16 v[140:143], a[32:35], v[116:119], v[140:143]
    ds_read_b128 v[108:111], v2 offset:25600
    s_waitcnt lgkmcnt(4)
    v_mfma_f32_16x16x32_bf16 v[148:151], a[32:35], v[120:123], v[148:151]
    v_add_f32 v203, v203, v211
    v_add_f32 v204, v204, v212
    v_mfma_f32_16x16x32_bf16 v[156:159], a[32:35], v[124:127], v[156:159]
    v_add_f32 v205, v205, v213
    v_add_f32 v206, v206, v214
    v_mfma_f32_16x16x32_bf16 v[144:147], a[28:31], v[120:123], v[144:147]
    v_add_f32 v207, v207, v215
    v_add_f32 v200, v200, v204
    v_mfma_f32_16x16x32_bf16 v[152:155], a[28:31], v[124:127], v[152:155]
    v_add_f32 v201, v201, v205
    s_waitcnt lgkmcnt(2)
    v_mfma_f32_16x16x32_bf16 v[128:131], a[36:39], v[96:99], v[128:131]
    ds_read_b128 v[112:115], v2 offset:20480
    v_add_f32 v202, v202, v206
    v_mfma_f32_16x16x32_bf16 v[136:139], a[36:39], v[100:103], v[136:139]
    ds_read_b128 v[116:119], v2 offset:22528
    v_add_f32 v203, v203, v207
    v_mfma_f32_16x16x32_bf16 v[132:135], a[40:43], v[96:99], v[132:135]
    ds_read_b128 v[120:123], v2 offset:24576
    v_add_f32 v200, v200, v202
    v_mfma_f32_16x16x32_bf16 v[140:143], a[40:43], v[100:103], v[140:143]
    ds_read_b128 v[124:127], v2 offset:26624
    s_waitcnt lgkmcnt(4)
    v_mfma_f32_16x16x32_bf16 v[148:151], a[40:43], v[104:107], v[148:151]
    buffer_load_dwordx4 a[132:135], v1, s[8:11], s26 offen offset:2048 sc1
    v_mfma_f32_16x16x32_bf16 v[156:159], a[40:43], v[108:111], v[156:159]
    buffer_load_dwordx4 a[136:139], v1, s[8:11], s26 offen offset:3072 sc1
    v_mfma_f32_16x16x32_bf16 v[144:147], a[36:39], v[104:107], v[144:147]
    s_add_u32 s26, s23, 4096
    v_add_f32 v201, v201, v203
    v_mfma_f32_16x16x32_bf16 v[152:155], a[36:39], v[108:111], v[152:155]
    v_mul_f32 v80, s64, v200
    s_waitcnt lgkmcnt(2)
    v_mfma_f32_16x16x32_bf16 v[128:131], a[44:47], v[112:115], v[128:131]
    ds_read_b128 v[96:99], v2 offset:27648
    v_mul_f32 v201, s64, v201
    v_mfma_f32_16x16x32_bf16 v[136:139], a[44:47], v[116:119], v[136:139]
    ds_read_b128 v[100:103], v2 offset:29696
    v_fma_f32 v201, -v80, v80, v201
    v_mfma_f32_16x16x32_bf16 v[132:135], a[48:51], v[112:115], v[132:135]
    ds_read_b128 v[104:107], v2 offset:31744
    v_max_f32 v201, 0, v201
    v_mfma_f32_16x16x32_bf16 v[140:143], a[48:51], v[116:119], v[140:143]
    ds_read_b128 v[108:111], v2 offset:33792
    s_waitcnt lgkmcnt(4)
    v_mfma_f32_16x16x32_bf16 v[148:151], a[48:51], v[120:123], v[148:151]
    buffer_load_dwordx4 a[168:171], v1, s[8:11], s26 offen offset:0 sc1
    v_mfma_f32_16x16x32_bf16 v[156:159], a[48:51], v[124:127], v[156:159]
    buffer_load_dwordx4 a[140:143], v1, s[8:11], s26 offen offset:1024 sc1
    v_mfma_f32_16x16x32_bf16 v[144:147], a[44:47], v[120:123], v[144:147]
    buffer_load_dwordx4 a[144:147], v1, s[8:11], s26 offen offset:2048 sc1
    v_mfma_f32_16x16x32_bf16 v[152:155], a[44:47], v[124:127], v[152:155]
    v_add_f32 v201, s65, v201
    s_waitcnt lgkmcnt(2)
    v_mfma_f32_16x16x32_bf16 v[128:131], a[56:59], v[96:99], v[128:131]
    ds_read_b128 v[112:115], v2 offset:28672
    v_mfma_f32_16x16x32_bf16 v[136:139], a[56:59], v[100:103], v[136:139]
    ds_read_b128 v[116:119], v2 offset:30720
    v_mfma_f32_16x16x32_bf16 v[132:135], a[72:75], v[96:99], v[132:135]
    ds_read_b128 v[120:123], v2 offset:32768
    v_mfma_f32_16x16x32_bf16 v[140:143], a[72:75], v[100:103], v[140:143]
    ds_read_b128 v[124:127], v2 offset:34816
    s_waitcnt lgkmcnt(4)
    v_mfma_f32_16x16x32_bf16 v[148:151], a[72:75], v[104:107], v[148:151]
    buffer_load_dwordx4 a[172:175], v1, s[8:11], s26 offen offset:3072 sc1
    v_mfma_f32_16x16x32_bf16 v[156:159], a[72:75], v[108:111], v[156:159]
    s_add_u32 s26, s23, 8192
    v_mfma_f32_16x16x32_bf16 v[144:147], a[56:59], v[104:107], v[144:147]
    buffer_load_dwordx4 a[148:151], v1, s[8:11], s26 offen offset:0 sc1
    v_mfma_f32_16x16x32_bf16 v[152:155], a[56:59], v[108:111], v[152:155]
    s_waitcnt vmcnt(13)
    s_waitcnt lgkmcnt(0)
    s_barrier
    v_mfma_f32_16x16x32_bf16 v[128:131], a[76:79], v[112:115], v[128:131]
    ds_read_b128 v[96:99], v2 offset:35840
    v_mfma_f32_16x16x32_bf16 v[136:139], a[76:79], v[116:119], v[136:139]
    ds_read_b128 v[100:103], v2 offset:37888
    v_mfma_f32_16x16x32_bf16 v[132:135], a[80:83], v[112:115], v[132:135]
    ds_read_b128 v[104:107], v2 offset:39936
    v_mfma_f32_16x16x32_bf16 v[140:143], a[80:83], v[116:119], v[140:143]
    ds_read_b128 v[108:111], v2 offset:41984
    v_mfma_f32_16x16x32_bf16 v[148:151], a[80:83], v[120:123], v[148:151]
    buffer_load_dwordx4 a[152:155], v1, s[8:11], s26 offen offset:1024 sc1
    v_mfma_f32_16x16x32_bf16 v[156:159], a[80:83], v[124:127], v[156:159]
    buffer_load_dwordx4 a[188:191], v1, s[8:11], s26 offen offset:2048 sc1
    v_mfma_f32_16x16x32_bf16 v[144:147], a[76:79], v[120:123], v[144:147]
    buffer_load_dwordx4 a[240:243], v1, s[8:11], s26 offen offset:3072 sc1
    v_mfma_f32_16x16x32_bf16 v[152:155], a[76:79], v[124:127], v[152:155]
    s_waitcnt lgkmcnt(2)
    v_mfma_f32_16x16x32_bf16 v[128:131], a[96:99], v[96:99], v[128:131]
    ds_read_b128 v[112:115], v2 offset:36864
    v_mfma_f32_16x16x32_bf16 v[136:139], a[96:99], v[100:103], v[136:139]
    ds_read_b128 v[116:119], v2 offset:38912
    v_mfma_f32_16x16x32_bf16 v[132:135], a[100:103], v[96:99], v[132:135]
    ds_read_b128 v[120:123], v2 offset:40960
    v_mfma_f32_16x16x32_bf16 v[140:143], a[100:103], v[100:103], v[140:143]
    ds_read_b128 v[124:127], v2 offset:43008
    s_waitcnt lgkmcnt(4)
    v_mfma_f32_16x16x32_bf16 v[148:151], a[100:103], v[104:107], v[148:151]
    v_rsq_f32 v84, v201
    v_mfma_f32_16x16x32_bf16 v[156:159], a[100:103], v[108:111], v[156:159]
    v_mov_b32 v82, v80
    v_mov_b32 v86, v84
    v_mfma_f32_16x16x32_bf16 v[144:147], a[96:99], v[104:107], v[144:147]
    v_permlane32_swap_b32 v80, v82
    v_mfma_f32_16x16x32_bf16 v[152:155], a[96:99], v[108:111], v[152:155]
    buffer_load_dword v27, v25, s[8:11], s38 offen sc1
    buffer_load_dword v198, v25, s[8:11], s39 offen sc1
    s_waitcnt lgkmcnt(2)
    v_mfma_f32_16x16x32_bf16 v[128:131], a[52:55], v[112:115], v[128:131]
    ds_read_b128 v[96:99], v2 offset:44032
    v_mfma_f32_16x16x32_bf16 v[136:139], a[52:55], v[116:119], v[136:139]
    ds_read_b128 v[100:103], v2 offset:46080
    s_add_u32 s26, s23, 12288
    v_mfma_f32_16x16x32_bf16 v[132:135], a[68:71], v[112:115], v[132:135]
    ds_read_b128 v[104:107], v2 offset:48128
    v_mfma_f32_16x16x32_bf16 v[140:143], a[68:71], v[116:119], v[140:143]
    ds_read_b128 v[108:111], v2 offset:50176
    s_waitcnt lgkmcnt(4)
    v_mfma_f32_16x16x32_bf16 v[148:151], a[68:71], v[120:123], v[148:151]
    buffer_load_dwordx4 a[176:179], v1, s[8:11], s26 offen offset:0 sc1
    v_mfma_f32_16x16x32_bf16 v[156:159], a[68:71], v[124:127], v[156:159]
    buffer_load_dwordx4 a[192:195], v1, s[8:11], s26 offen offset:1024 sc1
    v_mfma_f32_16x16x32_bf16 v[144:147], a[52:55], v[120:123], v[144:147]
    v_permlane32_swap_b32 v84, v86
    v_mfma_f32_16x16x32_bf16 v[152:155], a[52:55], v[124:127], v[152:155]
    v_mov_b32 v81, v80
    s_waitcnt lgkmcnt(2)
    v_mfma_f32_16x16x32_bf16 v[128:131], a[84:87], v[96:99], v[128:131]
    ds_read_b128 v[112:115], v2 offset:45056
    v_mov_b32 v83, v82
    v_mfma_f32_16x16x32_bf16 v[136:139], a[84:87], v[100:103], v[136:139]
    ds_read_b128 v[116:119], v2 offset:47104
    v_mov_b32 v85, v84
    v_mfma_f32_16x16x32_bf16 v[132:135], a[88:91], v[96:99], v[132:135]
    ds_read_b128 v[120:123], v2 offset:49152
    v_mov_b32 v87, v86
    v_mfma_f32_16x16x32_bf16 v[140:143], a[88:91], v[100:103], v[140:143]
    ds_read_b128 v[124:127], v2 offset:51200
    s_waitcnt lgkmcnt(4)
    v_mfma_f32_16x16x32_bf16 v[148:151], a[88:91], v[104:107], v[148:151]
    buffer_load_dwordx4 a[204:207], v1, s[8:11], s26 offen offset:2048 sc1
    v_mfma_f32_16x16x32_bf16 v[156:159], a[88:91], v[108:111], v[156:159]
    buffer_load_dwordx4 a[180:183], v1, s[8:11], s26 offen offset:3072 sc1
    v_mfma_f32_16x16x32_bf16 v[144:147], a[84:87], v[104:107], v[144:147]
    s_add_u32 s26, s23, 16384
    v_mfma_f32_16x16x32_bf16 v[152:155], a[84:87], v[108:111], v[152:155]
    s_waitcnt lgkmcnt(2)
    v_mfma_f32_16x16x32_bf16 v[128:131], a[92:95], v[112:115], v[128:131]
    ds_read_b128 v[96:99], v1 offset:3072
    v_mfma_f32_16x16x32_bf16 v[136:139], a[92:95], v[116:119], v[136:139]
    ds_read_b128 v[100:103], v1 offset:5120
    v_mfma_f32_16x16x32_bf16 v[132:135], a[104:107], v[112:115], v[132:135]
    ds_read_b128 v[104:107], v1 offset:7168
    v_mfma_f32_16x16x32_bf16 v[140:143], a[104:107], v[116:119], v[140:143]
    ds_read_b128 v[108:111], v1 offset:9216
    s_waitcnt lgkmcnt(4)
    v_mfma_f32_16x16x32_bf16 v[148:151], a[104:107], v[120:123], v[148:151]
    buffer_load_dwordx4 a[196:199], v1, s[8:11], s26 offen offset:0 sc1
    v_mfma_f32_16x16x32_bf16 v[156:159], a[104:107], v[124:127], v[156:159]
    buffer_load_dwordx4 a[224:227], v1, s[8:11], s26 offen offset:1024 sc1
    v_mfma_f32_16x16x32_bf16 v[144:147], a[92:95], v[120:123], v[144:147]
    buffer_load_dwordx4 a[156:159], v1, s[8:11], s26 offen offset:2048 sc1
    v_mfma_f32_16x16x32_bf16 v[152:155], a[92:95], v[124:127], v[152:155]
    s_waitcnt vmcnt(23)
    s_waitcnt lgkmcnt(2)
    v_mfma_f32_16x16x32_bf16 v[128:131], a[112:115], v[96:99], v[128:131]
    ds_read_b128 v[112:115], v1 offset:4096
    v_mfma_f32_16x16x32_bf16 v[136:139], a[112:115], v[100:103], v[136:139]
    ds_read_b128 v[116:119], v1 offset:6144
    v_mfma_f32_16x16x32_bf16 v[132:135], a[116:119], v[96:99], v[132:135]
    ds_read_b128 v[120:123], v1 offset:8192
    v_mfma_f32_16x16x32_bf16 v[140:143], a[116:119], v[100:103], v[140:143]
    ds_read_b128 v[124:127], v1 offset:10240
    s_waitcnt lgkmcnt(4)
    v_mfma_f32_16x16x32_bf16 v[148:151], a[116:119], v[104:107], v[148:151]
    buffer_load_dwordx4 a[200:203], v1, s[8:11], s26 offen offset:3072 sc1
    v_mfma_f32_16x16x32_bf16 v[156:159], a[116:119], v[108:111], v[156:159]
    s_add_u32 s26, s23, 20480
    v_mfma_f32_16x16x32_bf16 v[144:147], a[112:115], v[104:107], v[144:147]
    buffer_load_dwordx4 a[244:247], v1, s[8:11], s26 offen offset:0 sc1
    v_mfma_f32_16x16x32_bf16 v[152:155], a[112:115], v[108:111], v[152:155]
    s_waitcnt vmcnt(23)
    s_waitcnt lgkmcnt(2)
    v_mfma_f32_16x16x32_bf16 v[128:131], a[160:163], v[112:115], v[128:131]
    buffer_load_dwordx4 a[184:187], v1, s[8:11], s26 offen offset:1024 sc1
    v_mfma_f32_16x16x32_bf16 v[136:139], a[160:163], v[116:119], v[136:139]
    v_permlane16_swap_b32 v80, v81
    v_mfma_f32_16x16x32_bf16 v[132:135], a[124:127], v[112:115], v[132:135]
    v_permlane16_swap_b32 v82, v83
    v_mfma_f32_16x16x32_bf16 v[140:143], a[124:127], v[116:119], v[140:143]
    s_waitcnt lgkmcnt(0)
    v_mfma_f32_16x16x32_bf16 v[148:151], a[124:127], v[120:123], v[148:151]
    v_permlane16_swap_b32 v84, v85
    v_mfma_f32_16x16x32_bf16 v[156:159], a[124:127], v[124:127], v[156:159]
    v_permlane16_swap_b32 v86, v87
    v_mfma_f32_16x16x32_bf16 v[144:147], a[160:163], v[120:123], v[144:147]
    v_mfma_f32_16x16x32_bf16 v[152:155], a[160:163], v[124:127], v[152:155]
    s_waitcnt vmcnt(10)
    v_cmp_le_u32 vcc, 10, v198
    s_nop 3
    s_cmp_eq_u64 vcc, -1
    s_cbranch_scc1 L_pdone_72
    s_mov_b32 s68, 0x80000
L_poll_71:
    buffer_load_dword v198, v25, s[8:11], s39 offen sc1
    s_waitcnt vmcnt(0)
    v_cmp_le_u32 vcc, 10, v198
    s_nop 3
    s_cmp_eq_u64 vcc, -1
    s_cbranch_scc1 L_pdone_72
    s_sub_u32 s68, s68, 1
    s_cmp_lg_u32 s68, 0
    s_cbranch_scc1 L_poll_71
L_pdone_72:
    s_add_u32 m0, s29, 0
    s_mov_b32 s49, 32505856
    buffer_load_dwordx4 v5, s[8:11], s49 offen offset:0 sc1 lds
    s_add_u32 m0, s29, 0
    s_nop 0
    buffer_load_dwordx4 v5, s[8:11], s49 offen offset:1024 sc1 lds
    s_add_u32 m0, s29, 0
    s_nop 0
    buffer_load_dwordx4 v5, s[8:11], s49 offen offset:2048 sc1 lds
    s_add_u32 m0, s29, 0
    s_nop 0
    buffer_load_dwordx4 v5, s[8:11], s49 offen offset:3072 sc1 lds
    s_add_u32 m0, s29, 4096
    s_mov_b32 s49, 32509952
    buffer_load_dwordx4 v5, s[8:11], s49 offen offset:0 sc1 lds
    s_mov_b32 s53, 35389440
    buffer_load_dwordx2 v[176:177], v22, s[8:11], s53 offen offset:0 sc1
    buffer_load_dwordx2 v[178:179], v22, s[8:11], s53 offen offset:512 sc1
    buffer_load_dwordx2 v[180:181], v22, s[8:11], s53 offen offset:1024 sc1
    buffer_load_dwordx2 v[182:183], v22, s[8:11], s53 offen offset:1536 sc1
    v_cmp_le_u32 vcc, 10, v27
    s_nop 3
    s_cmp_eq_u64 vcc, -1
    s_cbranch_scc1 L_pdone_74
    s_mov_b32 s68, 0x80000
L_poll_73:
    buffer_load_dword v27, v25, s[8:11], s38 offen sc1
    s_waitcnt vmcnt(0)
    v_cmp_le_u32 vcc, 10, v27
    s_nop 3
    s_cmp_eq_u64 vcc, -1
    s_cbranch_scc1 L_pdone_74
    s_sub_u32 s68, s68, 1
    s_cmp_lg_u32 s68, 0
    s_cbranch_scc1 L_poll_73
L_pdone_74:
    v_pk_fma_f32 v[128:129], v[80:81], v[44:45], v[128:129] op_sel:[0,0,0] op_sel_hi:[0,1,1] neg_lo:[1,0,0] neg_hi:[1,0,0]
    buffer_load_dwordx2 v[184:185], v22, s[8:11], s53 offen offset:2048 sc1
    v_pk_fma_f32 v[130:131], v[80:81], v[46:47], v[130:131] op_sel:[0,0,0] op_sel_hi:[0,1,1] neg_lo:[1,0,0] neg_hi:[1,0,0]
    buffer_load_dwordx2 v[186:187], v22, s[8:11], s53 offen offset:2560 sc1
    v_pk_mul_f32 v[128:129], v[84:85], v[128:129] op_sel:[0,0] op_sel_hi:[0,1]
    buffer_load_dwordx2 v[188:189], v22, s[8:11], s53 offen offset:3072 sc1
    v_pk_mul_f32 v[130:131], v[84:85], v[130:131] op_sel:[0,0] op_sel_hi:[0,1]
    v_cvt_pk_bf16_f32 v128, v128, v129
    v_cvt_pk_bf16_f32 v129, v130, v131
    ds_write_b64 v9, v[128:129] offset:2176
    v_pk_fma_f32 v[132:133], v[80:81], v[48:49], v[132:133] op_sel:[0,0,0] op_sel_hi:[0,1,1] neg_lo:[1,0,0] neg_hi:[1,0,0]
    v_pk_fma_f32 v[134:135], v[80:81], v[50:51], v[134:135] op_sel:[0,0,0] op_sel_hi:[0,1,1] neg_lo:[1,0,0] neg_hi:[1,0,0]
    v_pk_mul_f32 v[132:133], v[84:85], v[132:133] op_sel:[0,0] op_sel_hi:[0,1]
    v_pk_mul_f32 v[134:135], v[84:85], v[134:135] op_sel:[0,0] op_sel_hi:[0,1]
    v_cvt_pk_bf16_f32 v132, v132, v133
    v_cvt_pk_bf16_f32 v133, v134, v135
    ds_write_b64 v9, v[132:133] offset:2208
    v_pk_fma_f32 v[136:137], v[80:81], v[44:45], v[136:137] op_sel:[1,0,0] op_sel_hi:[1,1,1] neg_lo:[1,0,0] neg_hi:[1,0,0]
    v_pk_fma_f32 v[138:139], v[80:81], v[46:47], v[138:139] op_sel:[1,0,0] op_sel_hi:[1,1,1] neg_lo:[1,0,0] neg_hi:[1,0,0]
    buffer_load_dwordx2 v[190:191], v22, s[8:11], s53 offen offset:3584 sc1
    v_pk_mul_f32 v[136:137], v[84:85], v[136:137] op_sel:[1,0] op_sel_hi:[1,1]
    s_add_u32 m0, s28, 11264
    s_add_u32 s49, s48, 32587776
    buffer_load_dwordx4 v1, s[8:11], s49 offen offset:0 sc1 lds
    v_pk_mul_f32 v[138:139], v[84:85], v[138:139] op_sel:[1,0] op_sel_hi:[1,1]
    v_cvt_pk_bf16_f32 v136, v136, v137
    v_cvt_pk_bf16_f32 v137, v138, v139
    s_add_u32 m0, s28, 11264
    s_nop 0
    buffer_load_dwordx4 v1, s[8:11], s49 offen offset:1024 sc1 lds
    ds_write_b64 v9, v[136:137] offset:13056
    v_pk_fma_f32 v[140:141], v[80:81], v[48:49], v[140:141] op_sel:[1,0,0] op_sel_hi:[1,1,1] neg_lo:[1,0,0] neg_hi:[1,0,0]
    v_pk_fma_f32 v[142:143], v[80:81], v[50:51], v[142:143] op_sel:[1,0,0] op_sel_hi:[1,1,1] neg_lo:[1,0,0] neg_hi:[1,0,0]
    v_pk_mul_f32 v[140:141], v[84:85], v[140:141] op_sel:[1,0] op_sel_hi:[1,1]
    v_pk_mul_f32 v[142:143], v[84:85], v[142:143] op_sel:[1,0] op_sel_hi:[1,1]
    v_cvt_pk_bf16_f32 v140, v140, v141
    v_cvt_pk_bf16_f32 v141, v142, v143
    ds_write_b64 v9, v[140:141] offset:13088
    s_add_u32 m0, s28, 17408
    s_nop 0
    buffer_load_dwordx4 v1, s[8:11], s49 offen offset:2048 sc1 lds
    v_pk_fma_f32 v[144:145], v[82:83], v[44:45], v[144:145] op_sel:[0,0,0] op_sel_hi:[0,1,1] neg_lo:[1,0,0] neg_hi:[1,0,0]
    v_pk_fma_f32 v[146:147], v[82:83], v[46:47], v[146:147] op_sel:[0,0,0] op_sel_hi:[0,1,1] neg_lo:[1,0,0] neg_hi:[1,0,0]
    v_pk_mul_f32 v[144:145], v[86:87], v[144:145] op_sel:[0,0] op_sel_hi:[0,1]
    v_pk_mul_f32 v[146:147], v[86:87], v[146:147] op_sel:[0,0] op_sel_hi:[0,1]
    v_cvt_pk_bf16_f32 v144, v144, v145
    v_cvt_pk_bf16_f32 v145, v146, v147
    ds_write_b64 v9, v[144:145] offset:6528
    v_pk_fma_f32 v[148:149], v[82:83], v[48:49], v[148:149] op_sel:[0,0,0] op_sel_hi:[0,1,1] neg_lo:[1,0,0] neg_hi:[1,0,0]
    v_pk_fma_f32 v[150:151], v[82:83], v[50:51], v[150:151] op_sel:[0,0,0] op_sel_hi:[0,1,1] neg_lo:[1,0,0] neg_hi:[1,0,0]
    v_pk_mul_f32 v[148:149], v[86:87], v[148:149] op_sel:[0,0] op_sel_hi:[0,1]
    v_pk_mul_f32 v[150:151], v[86:87], v[150:151] op_sel:[0,0] op_sel_hi:[0,1]
    v_cvt_pk_bf16_f32 v148, v148, v149
    v_cvt_pk_bf16_f32 v149, v150, v151
    ds_write_b64 v9, v[148:149] offset:6560
    v_pk_fma_f32 v[152:153], v[82:83], v[44:45], v[152:153] op_sel:[1,0,0] op_sel_hi:[1,1,1] neg_lo:[1,0,0] neg_hi:[1,0,0]
    v_pk_fma_f32 v[154:155], v[82:83], v[46:47], v[154:155] op_sel:[1,0,0] op_sel_hi:[1,1,1] neg_lo:[1,0,0] neg_hi:[1,0,0]
    v_pk_mul_f32 v[152:153], v[86:87], v[152:153] op_sel:[1,0] op_sel_hi:[1,1]
    v_pk_mul_f32 v[154:155], v[86:87], v[154:155] op_sel:[1,0] op_sel_hi:[1,1]
    v_cvt_pk_bf16_f32 v152, v152, v153
    v_cvt_pk_bf16_f32 v153, v154, v155
    ds_write_b64 v9, v[152:153] offset:17408
    v_pk_fma_f32 v[156:157], v[82:83], v[48:49], v[156:157] op_sel:[1,0,0] op_sel_hi:[1,1,1] neg_lo:[1,0,0] neg_hi:[1,0,0]
    v_pk_fma_f32 v[158:159], v[82:83], v[50:51], v[158:159] op_sel:[1,0,0] op_sel_hi:[1,1,1] neg_lo:[1,0,0] neg_hi:[1,0,0]
    v_pk_mul_f32 v[156:157], v[86:87], v[156:157] op_sel:[1,0] op_sel_hi:[1,1]
    v_pk_mul_f32 v[158:159], v[86:87], v[158:159] op_sel:[1,0] op_sel_hi:[1,1]
    v_cvt_pk_bf16_f32 v156, v156, v157
    v_cvt_pk_bf16_f32 v157, v158, v159
    ds_write_b64 v9, v[156:157] offset:17440
    s_add_u32 m0, s28, 17408
    s_nop 0
    buffer_load_dwordx4 v1, s[8:11], s49 offen offset:3072 sc1 lds
    s_add_u32 m0, s28, 27648
    s_add_u32 s49, s48, 32591872
    buffer_load_dwordx4 v1, s[8:11], s49 offen offset:0 sc1 lds
    s_add_u32 m0, s28, 27648
    s_nop 0
    buffer_load_dwordx4 v1, s[8:11], s49 offen offset:1024 sc1 lds
    s_waitcnt vmcnt(14)
    s_waitcnt lgkmcnt(0)
    s_barrier
    v_add_u32 v198, 117760, v1
    s_add_u32 m0, s28, 33792
    s_nop 0
    buffer_load_dwordx4 v1, s[8:11], s49 offen offset:2048 sc1 lds
    ds_read_b128 v[96:99], v198 offset:0
    s_add_u32 m0, s28, 33792
    s_nop 0
    buffer_load_dwordx4 v1, s[8:11], s49 offen offset:3072 sc1 lds
    ds_read_b128 v[100:103], v198 offset:1024
    s_add_u32 s53, s36, 35393536
    buffer_load_dwordx2 v[200:201], v0, s[8:11], s53 offen offset:0 sc1
    ds_read_b128 v[104:107], v198 offset:2048
    buffer_load_dwordx2 v[202:203], v0, s[8:11], s53 offen offset:512 sc1
    ds_read_b128 v[108:111], v198 offset:3072
    ds_read_b128 v[112:115], v198 offset:4096
    ds_read_b128 v[116:119], v198 offset:5120
    s_waitcnt lgkmcnt(5)
    v_mfma_f32_16x16x32_bf16 v[160:163], a[228:231], v[96:99], 0
    v_mfma_f32_16x16x32_bf16 v[164:167], a[248:251], v[96:99], 0
    ds_read_b128 v[120:123], v198 offset:6144
    s_waitcnt lgkmcnt(5)
    v_mfma_f32_16x16x32_bf16 v[160:163], a[212:215], v[100:103], v[160:163]
    buffer_load_dwordx2 v[204:205], v0, s[8:11], s53 offen offset:1024 sc1
    v_mfma_f32_16x16x32_bf16 v[164:167], a[232:235], v[100:103], v[164:167]
    ds_read_b128 v[124:127], v198 offset:7168
    s_waitcnt lgkmcnt(5)
    v_mfma_f32_16x16x32_bf16 v[160:163], a[252:255], v[104:107], v[160:163]
    v_mfma_f32_16x16x32_bf16 v[164:167], a[216:219], v[104:107], v[164:167]
    ds_read_b128 v[96:99], v198 offset:8192
    s_waitcnt lgkmcnt(5)
    v_mfma_f32_16x16x32_bf16 v[160:163], a[236:239], v[108:111], v[160:163]
    buffer_load_dwordx2 v[206:207], v0, s[8:11], s53 offen offset:1536 sc1
    v_mfma_f32_16x16x32_bf16 v[164:167], a[0:3], v[108:111], v[164:167]
    ds_read_b128 v[100:103], v198 offset:9216
    s_waitcnt lgkmcnt(5)
    v_mfma_f32_16x16x32_bf16 v[160:163], a[4:7], v[112:115], v[160:163]
    buffer_load_dwordx2 v[208:209], v0, s[8:11], s53 offen offset:2048 sc1
    v_mfma_f32_16x16x32_bf16 v[164:167], a[8:11], v[112:115], v[164:167]
    ds_read_b128 v[104:107], v198 offset:10240
    s_waitcnt lgkmcnt(5)
    v_mfma_f32_16x16x32_bf16 v[160:163], a[12:15], v[116:119], v[160:163]
    buffer_load_dwordx2 v[210:211], v0, s[8:11], s53 offen offset:2560 sc1
    v_mfma_f32_16x16x32_bf16 v[164:167], a[60:63], v[116:119], v[164:167]
    ds_read_b128 v[108:111], v198 offset:11264
    s_waitcnt lgkmcnt(5)
    v_mfma_f32_16x16x32_bf16 v[160:163], a[64:67], v[120:123], v[160:163]
    buffer_load_dwordx2 v[212:213], v0, s[8:11], s53 offen offset:3072 sc1
    v_mfma_f32_16x16x32_bf16 v[164:167], a[108:111], v[120:123], v[164:167]
    ds_read_b128 v[112:115], v198 offset:12288
    s_waitcnt lgkmcnt(5)
    v_mfma_f32_16x16x32_bf16 v[160:163], a[120:123], v[124:127], v[160:163]
    buffer_load_dwordx2 v[214:215], v0, s[8:11], s53 offen offset:3584 sc1
    v_mfma_f32_16x16x32_bf16 v[164:167], a[16:19], v[124:127], v[164:167]
    ds_read_b128 v[116:119], v198 offset:13312
    s_waitcnt lgkmcnt(5)
    v_mfma_f32_16x16x32_bf16 v[160:163], a[20:23], v[96:99], v[160:163]
    s_add_u32 m0, s28, 44032
    s_add_u32 s49, s48, 32595968
    v_mfma_f32_16x16x32_bf16 v[164:167], a[24:27], v[96:99], v[164:167]
    ds_read_b128 v[120:123], v198 offset:14336
    s_waitcnt lgkmcnt(5)
    v_mfma_f32_16x16x32_bf16 v[160:163], a[28:31], v[100:103], v[160:163]
    buffer_load_dwordx4 v1, s[8:11], s49 offen offset:0 sc1 lds
    v_mfma_f32_16x16x32_bf16 v[164:167], a[32:35], v[100:103], v[164:167]
    ds_read_b128 v[124:127], v198 offset:15360
    s_waitcnt lgkmcnt(5)
    v_mfma_f32_16x16x32_bf16 v[160:163], a[36:39], v[104:107], v[160:163]
    s_add_u32 m0, s28, 44032
    v_mfma_f32_16x16x32_bf16 v[164:167], a[40:43], v[104:107], v[164:167]
    ds_read_b128 v[96:99], v198 offset:16384
    s_waitcnt lgkmcnt(5)
    v_mfma_f32_16x16x32_bf16 v[160:163], a[44:47], v[108:111], v[160:163]
    buffer_load_dwordx4 v1, s[8:11], s49 offen offset:1024 sc1 lds
    v_mfma_f32_16x16x32_bf16 v[164:167], a[48:51], v[108:111], v[164:167]
    ds_read_b128 v[100:103], v198 offset:17408
    s_waitcnt lgkmcnt(5)
    v_mfma_f32_16x16x32_bf16 v[160:163], a[56:59], v[112:115], v[160:163]
    s_add_u32 m0, s28, 50176
    v_mfma_f32_16x16x32_bf16 v[164:167], a[72:75], v[112:115], v[164:167]
    ds_read_b128 v[104:107], v198 offset:18432
    s_waitcnt lgkmcnt(5)
    v_mfma_f32_16x16x32_bf16 v[160:163], a[76:79], v[116:119], v[160:163]
    buffer_load_dwordx4 v1, s[8:11], s49 offen offset:2048 sc1 lds
    v_mfma_f32_16x16x32_bf16 v[164:167], a[80:83], v[116:119], v[164:167]
    ds_read_b128 v[108:111], v198 offset:19456
    s_waitcnt lgkmcnt(5)
    v_mfma_f32_16x16x32_bf16 v[160:163], a[96:99], v[120:123], v[160:163]
    v_mfma_f32_16x16x32_bf16 v[164:167], a[100:103], v[120:123], v[164:167]
    s_waitcnt lgkmcnt(4)
    v_mfma_f32_16x16x32_bf16 v[160:163], a[52:55], v[124:127], v[160:163]
    v_mfma_f32_16x16x32_bf16 v[164:167], a[68:71], v[124:127], v[164:167]
    s_waitcnt lgkmcnt(3)
    v_mfma_f32_16x16x32_bf16 v[160:163], a[84:87], v[96:99], v[160:163]
    v_mfma_f32_16x16x32_bf16 v[164:167], a[88:91], v[96:99], v[164:167]
    s_waitcnt lgkmcnt(2)
    v_mfma_f32_16x16x32_bf16 v[160:163], a[92:95], v[100:103], v[160:163]
    v_mfma_f32_16x16x32_bf16 v[164:167], a[104:107], v[100:103], v[164:167]
    s_waitcnt lgkmcnt(1)
    v_mfma_f32_16x16x32_bf16 v[160:163], a[112:115], v[104:107], v[160:163]
    v_mfma_f32_16x16x32_bf16 v[164:167], a[116:119], v[104:107], v[164:167]
    s_waitcnt lgkmcnt(0)
    v_mfma_f32_16x16x32_bf16 v[160:163], a[160:163], v[108:111], v[160:163]
    v_mfma_f32_16x16x32_bf16 v[164:167], a[124:127], v[108:111], v[164:167]
    s_waitcnt vmcnt(19)
    v_pk_add_f32 v[176:177], v[176:177], v[184:185]
    s_add_u32 m0, s28, 50176
    s_nop 0
    buffer_load_dwordx4 v1, s[8:11], s49 offen offset:3072 sc1 lds
    v_pk_add_f32 v[178:179], v[178:179], v[186:187]
    v_pk_add_f32 v[180:181], v[180:181], v[188:189]
    v_pk_add_f32 v[182:183], v[182:183], v[190:191]
    v_pk_add_f32 v[176:177], v[176:177], v[180:181]
    v_pk_add_f32 v[178:179], v[178:179], v[182:183]
    v_pk_add_f32 v[176:177], v[176:177], v[178:179]
    v_mul_f32 v92, s64, v176
    v_mul_f32 v177, s64, v177
    v_fma_f32 v177, -v92, v92, v177
    v_max_f32 v177, 0, v177
    s_add_u32 m0, s28, 60416
    s_add_u32 s49, s48, 32600064
    buffer_load_dwordx4 v1, s[8:11], s49 offen offset:0 sc1 lds
    v_add_f32 v177, s65, v177
    s_add_u32 m0, s28, 60416
    s_nop 0
    buffer_load_dwordx4 v1, s[8:11], s49 offen offset:1024 sc1 lds
    v_rsq_f32 v93, v177
    s_add_u32 m0, s28, 66560
    s_nop 0
    buffer_load_dwordx4 v1, s[8:11], s49 offen offset:2048 sc1 lds
    v_pk_fma_f32 v[160:161], v[92:93], v[44:45], v[160:161] op_sel:[0,0,0] op_sel_hi:[0,1,1] neg_lo:[1,0,0] neg_hi:[1,0,0]
    v_pk_fma_f32 v[162:163], v[92:93], v[46:47], v[162:163] op_sel:[0,0,0] op_sel_hi:[0,1,1] neg_lo:[1,0,0] neg_hi:[1,0,0]
    v_pk_mul_f32 v[160:161], v[92:93], v[160:161] op_sel:[1,0] op_sel_hi:[1,1]
    v_pk_mul_f32 v[162:163], v[92:93], v[162:163] op_sel:[1,0] op_sel_hi:[1,1]
    v_cvt_pk_bf16_f32 v160, v160, v161
    v_cvt_pk_bf16_f32 v161, v162, v163
    ds_write_b64 v10, v[160:161] offset:0
    v_pk_fma_f32 v[164:165], v[92:93], v[48:49], v[164:165] op_sel:[0,0,0] op_sel_hi:[0,1,1] neg_lo:[1,0,0] neg_hi:[1,0,0]
    v_pk_fma_f32 v[166:167], v[92:93], v[50:51], v[166:167] op_sel:[0,0,0] op_sel_hi:[0,1,1] neg_lo:[1,0,0] neg_hi:[1,0,0]
    v_pk_mul_f32 v[164:165], v[92:93], v[164:165] op_sel:[1,0] op_sel_hi:[1,1]
    v_pk_mul_f32 v[166:167], v[92:93], v[166:167] op_sel:[1,0] op_sel_hi:[1,1]
    v_cvt_pk_bf16_f32 v164, v164, v165
    v_cvt_pk_bf16_f32 v165, v166, v167
    s_add_u32 m0, s28, 66560
    s_nop 0
    buffer_load_dwordx4 v1, s[8:11], s49 offen offset:3072 sc1 lds
    ds_write_b64 v10, v[164:165] offset:32
    s_waitcnt vmcnt(16)
    s_waitcnt lgkmcnt(0)
    s_barrier
    ds_read_b128 v[128:131], v11 offset:2176
    ds_read_b128 v[132:135], v11 offset:80
    ds_read_b128 v[136:139], v11 offset:2256
    ds_read_b128 v[140:143], v11 offset:2208
    ds_read_b128 v[144:147], v11 offset:112
    ds_read_b128 v[148:151], v11 offset:2288
    s_waitcnt lgkmcnt(5)
    v_cndmask_b32 v128, 0, v128, s[40:41]
    v_cndmask_b32 v129, 0, v129, s[40:41]
    v_cndmask_b32 v130, 0, v130, s[42:43]
    v_cndmask_b32 v131, 0, v131, s[42:43]
    s_waitcnt lgkmcnt(3)
    s_nop 0
    v_mfma_f32_16x16x32_bf16 v[96:99], v[132:135], v[128:131], v[40:43]
    v_mfma_f32_16x16x32_bf16 v[100:103], v[136:139], v[128:131], v[36:39]
    s_add_u32 m0, s28, 76800
    s_add_u32 s49, s48, 32604160
    buffer_load_dwordx4 v1, s[8:11], s49 offen offset:0 sc1 lds
    s_waitcnt lgkmcnt(2)
    v_cndmask_b32 v140, 0, v140, s[44:45]
    v_cndmask_b32 v141, 0, v141, s[44:45]
    v_cndmask_b32 v142, 0, v142, s[40:41]
    v_cndmask_b32 v143, 0, v143, s[40:41]
    s_waitcnt lgkmcnt(0)
    s_nop 0
    v_mfma_f32_16x16x32_bf16 v[104:107], v[144:147], v[140:143], v[40:43]
    v_mfma_f32_16x16x32_bf16 v[108:111], v[148:151], v[140:143], v[36:39]
    s_add_u32 m0, s28, 76800
    s_nop 0
    buffer_load_dwordx4 v1, s[8:11], s49 offen offset:1024 sc1 lds
    ds_read_b64_tr_b16 v[152:153], v14 offset:160
    ds_read_b64_tr_b16 v[154:155], v14 offset:2336
    ds_read_b64_tr_b16 v[156:157], v14 offset:192
    ds_read_b64_tr_b16 v[158:159], v14 offset:2368
    v_max3_f32 v120, v96, v97, v98
    v_max3_f32 v121, v100, v101, v102
    v_max3_f32 v120, v120, v99, v103
    v_max_f32 v120, v120, v121
    v_mov_b32 v121, v120
    v_max3_f32 v122, v104, v105, v106
    v_max3_f32 v123, v108, v109, v110
    v_max3_f32 v122, v122, v107, v111
    v_max_f32 v122, v122, v123
    v_mov_b32 v123, v122
    v_permlane32_swap_b32 v120, v121
    s_nop 0
    v_permlane32_swap_b32 v122, v123
    v_max_f32 v120, v120, v121
    v_mov_b32 v121, v120
    s_add_u32 m0, s28, 82944
    s_nop 0
    buffer_load_dwordx4 v1, s[8:11], s49 offen offset:2048 sc1 lds
    v_max_f32 v122, v122, v123
    v_mov_b32 v123, v122
    v_permlane16_swap_b32 v120, v121
    s_nop 0
    v_permlane16_swap_b32 v122, v123
    v_max_f32 v120, v120, v121
    v_max_f32 v122, v122, v123
    ds_read_b64_tr_b16 v[160:161], v14 offset:200
    ds_read_b64_tr_b16 v[162:163], v14 offset:2376
    ds_read_b64_tr_b16 v[164:165], v14 offset:232
    ds_read_b64_tr_b16 v[166:167], v14 offset:2408
    v_mov_b32 v124, s67
    v_mul_f32 v120, v124, v120
    s_add_u32 m0, s28, 82944
    s_nop 0
    buffer_load_dwordx4 v1, s[8:11], s49 offen offset:3072 sc1 lds
    v_mul_f32 v122, v124, v122
    v_pk_fma_f32 v[96:97], v[96:97], v[124:125], v[120:121] op_sel:[0,0,0] op_sel_hi:[1,0,0] neg_lo:[0,0,1] neg_hi:[0,0,1]
    v_pk_fma_f32 v[98:99], v[98:99], v[124:125], v[120:121] op_sel:[0,0,0] op_sel_hi:[1,0,0] neg_lo:[0,0,1] neg_hi:[0,0,1]
    v_pk_fma_f32 v[100:101], v[100:101], v[124:125], v[120:121] op_sel:[0,0,0] op_sel_hi:[1,0,0] neg_lo:[0,0,1] neg_hi:[0,0,1]
    v_pk_fma_f32 v[102:103], v[102:103], v[124:125], v[120:121] op_sel:[0,0,0] op_sel_hi:[1,0,0] neg_lo:[0,0,1] neg_hi:[0,0,1]
    v_pk_fma_f32 v[104:105], v[104:105], v[124:125], v[122:123] op_sel:[0,0,0] op_sel_hi:[1,0,0] neg_lo:[0,0,1] neg_hi:[0,0,1]
    v_pk_fma_f32 v[106:107], v[106:107], v[124:125], v[122:123] op_sel:[0,0,0] op_sel_hi:[1,0,0] neg_lo:[0,0,1] neg_hi:[0,0,1]
    v_pk_fma_f32 v[108:109], v[108:109], v[124:125], v[122:123] op_sel:[0,0,0] op_sel_hi:[1,0,0] neg_lo:[0,0,1] neg_hi:[0,0,1]
    v_pk_fma_f32 v[110:111], v[110:111], v[124:125], v[122:123] op_sel:[0,0,0] op_sel_hi:[1,0,0] neg_lo:[0,0,1] neg_hi:[0,0,1]
    v_exp_f32 v96, v96
    v_exp_f32 v97, v97
    buffer_load_dwordx4 a[220:223], v1, s[8:11], s26 offen offset:2048 sc1
    v_exp_f32 v98, v98
    v_exp_f32 v99, v99
    v_exp_f32 v100, v100
    v_exp_f32 v101, v101
    v_exp_f32 v102, v102
    v_exp_f32 v103, v103
    v_cvt_pk_bf16_f32 v112, v96, v97
    v_cvt_pk_bf16_f32 v113, v98, v99
    v_cvt_pk_bf16_f32 v114, v100, v101
    v_cvt_pk_bf16_f32 v115, v102, v103
    s_waitcnt lgkmcnt(4)
    v_exp_f32 v104, v104
    v_exp_f32 v105, v105
    v_mfma_f32_16x16x32_bf16 v[184:187], v[28:31], v[112:115], 0
    v_exp_f32 v106, v106
    v_exp_f32 v107, v107
    v_mfma_f32_16x16x32_bf16 v[176:179], v[152:155], v[112:115], 0
    v_exp_f32 v108, v108
    v_exp_f32 v109, v109
    v_mfma_f32_16x16x32_bf16 v[180:183], v[156:159], v[112:115], 0
    v_exp_f32 v110, v110
    v_exp_f32 v111, v111
    v_cvt_pk_bf16_f32 v116, v104, v105
    v_cvt_pk_bf16_f32 v117, v106, v107
    v_cvt_pk_bf16_f32 v118, v108, v109
    v_cvt_pk_bf16_f32 v119, v110, v111
    v_rcp_f32 v184, v184
    s_waitcnt lgkmcnt(0)
    v_mfma_f32_16x16x32_bf16 v[196:199], v[28:31], v[116:119], 0
    v_mul_f32 v176, v184, v176
    v_mul_f32 v177, v184, v177
    v_mul_f32 v178, v184, v178
    v_mfma_f32_16x16x32_bf16 v[188:191], v[160:163], v[116:119], 0
    v_mul_f32 v179, v184, v179
    buffer_load_dwordx4 a[208:211], v1, s[8:11], s26 offen offset:3072 sc1
    v_mul_f32 v180, v184, v180
    v_mul_f32 v181, v184, v181
    v_mfma_f32_16x16x32_bf16 v[192:195], v[164:167], v[116:119], 0
    v_mul_f32 v182, v184, v182
    v_mul_f32 v183, v184, v183
    ds_read_b128 v[96:99], v1 offset:11264
    ds_read_b128 v[100:103], v1 offset:13312
    ds_read_b128 v[104:107], v1 offset:15360
    ds_read_b128 v[108:111], v1 offset:17408
    v_cvt_pk_bf16_f32 v168, v176, v177
    v_cvt_pk_bf16_f32 v172, v180, v181
    v_cvt_pk_bf16_f32 v169, v178, v179
    v_cvt_pk_bf16_f32 v173, v182, v183
    v_rcp_f32 v196, v196
    s_nop 0
    v_pk_mul_f32 v[188:189], v[196:197], v[188:189] op_sel:[0,0] op_sel_hi:[0,1]
    v_pk_mul_f32 v[192:193], v[196:197], v[192:193] op_sel:[0,0] op_sel_hi:[0,1]
    v_pk_mul_f32 v[190:191], v[196:197], v[190:191] op_sel:[0,0] op_sel_hi:[0,1]
    v_pk_mul_f32 v[194:195], v[196:197], v[194:195] op_sel:[0,0] op_sel_hi:[0,1]
    v_cvt_pk_bf16_f32 v170, v188, v189
    v_cvt_pk_bf16_f32 v174, v192, v193
    v_cvt_pk_bf16_f32 v171, v190, v191
    v_cvt_pk_bf16_f32 v175, v194, v195
    s_add_u32 s56, s32, 12058624
    buffer_store_dwordx4 v[168:171], v1, s[8:11], s56 offen sc1
    buffer_store_dwordx4 v[172:175], v23, s[8:11], s56 offen offset:1024 sc1
    s_waitcnt lgkmcnt(2)
    v_mfma_f32_16x16x32_bf16 v[128:131], a[228:231], v[96:99], 0
    ds_read_b128 v[112:115], v1 offset:12288
    v_mfma_f32_16x16x32_bf16 v[136:139], a[228:231], v[100:103], 0
    ds_read_b128 v[116:119], v1 offset:14336
    v_mfma_f32_16x16x32_bf16 v[132:135], a[248:251], v[96:99], 0
    ds_read_b128 v[120:123], v1 offset:16384
    v_mfma_f32_16x16x32_bf16 v[140:143], a[248:251], v[100:103], 0
    ds_read_b128 v[124:127], v1 offset:18432
    s_waitcnt lgkmcnt(4)
    v_mfma_f32_16x16x32_bf16 v[148:151], a[248:251], v[104:107], 0
    v_mfma_f32_16x16x32_bf16 v[156:159], a[248:251], v[108:111], 0
    v_mfma_f32_16x16x32_bf16 v[144:147], a[228:231], v[104:107], 0
    v_mfma_f32_16x16x32_bf16 v[152:155], a[228:231], v[108:111], 0
    s_waitcnt lgkmcnt(2)
    v_mfma_f32_16x16x32_bf16 v[128:131], a[212:215], v[112:115], v[128:131]
    ds_read_b128 v[96:99], v1 offset:19456
    s_add_u32 s26, s23, 24576
    v_mfma_f32_16x16x32_bf16 v[136:139], a[212:215], v[116:119], v[136:139]
    ds_read_b128 v[100:103], v1 offset:21504
    v_mfma_f32_16x16x32_bf16 v[132:135], a[232:235], v[112:115], v[132:135]
    ds_read_b128 v[104:107], v1 offset:23552
    v_mfma_f32_16x16x32_bf16 v[140:143], a[232:235], v[116:119], v[140:143]
    ds_read_b128 v[108:111], v1 offset:25600
    s_waitcnt lgkmcnt(4)
    v_mfma_f32_16x16x32_bf16 v[148:151], a[232:235], v[120:123], v[148:151]
    buffer_load_dwordx4 a[228:231], v1, s[8:11], s26 offen offset:0 sc1
    v_mfma_f32_16x16x32_bf16 v[156:159], a[232:235], v[124:127], v[156:159]
    s_add_u32 s26, s24, 0
    v_mfma_f32_16x16x32_bf16 v[144:147], a[212:215], v[120:123], v[144:147]
    buffer_load_dwordx4 a[248:251], v1, s[8:11], s26 offen offset:0 sc1
    v_mfma_f32_16x16x32_bf16 v[152:155], a[212:215], v[124:127], v[152:155]
    s_waitcnt vmcnt(18)
    s_waitcnt lgkmcnt(2)
    v_mfma_f32_16x16x32_bf16 v[128:131], a[252:255], v[96:99], v[128:131]
    ds_read_b128 v[112:115], v1 offset:20480
    v_add_f32 v200, v200, v208
    v_mfma_f32_16x16x32_bf16 v[136:139], a[252:255], v[100:103], v[136:139]
    ds_read_b128 v[116:119], v1 offset:22528
    v_add_f32 v201, v201, v209
    v_mfma_f32_16x16x32_bf16 v[132:135], a[216:219], v[96:99], v[132:135]
    ds_read_b128 v[120:123], v1 offset:24576
    v_add_f32 v202, v202, v210
    v_mfma_f32_16x16x32_bf16 v[140:143], a[216:219], v[100:103], v[140:143]
    ds_read_b128 v[124:127], v1 offset:26624
    s_waitcnt lgkmcnt(4)
    v_mfma_f32_16x16x32_bf16 v[148:151], a[216:219], v[104:107], v[148:151]
    buffer_load_dwordx4 a[212:215], v1, s[8:11], s26 offen offset:1024 sc1
    v_mfma_f32_16x16x32_bf16 v[156:159], a[216:219], v[108:111], v[156:159]
    buffer_load_dwordx4 a[232:235], v1, s[8:11], s26 offen offset:2048 sc1
    v_mfma_f32_16x16x32_bf16 v[144:147], a[252:255], v[104:107], v[144:147]
    v_add_f32 v203, v203, v211
    v_add_f32 v204, v204, v212
    v_mfma_f32_16x16x32_bf16 v[152:155], a[252:255], v[108:111], v[152:155]
    v_add_f32 v205, v205, v213
    s_waitcnt lgkmcnt(2)
    v_mfma_f32_16x16x32_bf16 v[128:131], a[236:239], v[112:115], v[128:131]
    ds_read_b128 v[96:99], v1 offset:27648
    v_add_f32 v206, v206, v214
    v_mfma_f32_16x16x32_bf16 v[136:139], a[236:239], v[116:119], v[136:139]
    ds_read_b128 v[100:103], v1 offset:29696
    v_add_f32 v207, v207, v215
    v_mfma_f32_16x16x32_bf16 v[132:135], a[0:3], v[112:115], v[132:135]
    ds_read_b128 v[104:107], v1 offset:31744
    v_add_f32 v200, v200, v204
    v_mfma_f32_16x16x32_bf16 v[140:143], a[0:3], v[116:119], v[140:143]
    ds_read_b128 v[108:111], v1 offset:33792
    s_waitcnt lgkmcnt(4)
    v_mfma_f32_16x16x32_bf16 v[148:151], a[0:3], v[120:123], v[148:151]
    buffer_load_dwordx4 a[252:255], v1, s[8:11], s26 offen offset:3072 sc1
    v_mfma_f32_16x16x32_bf16 v[156:159], a[0:3], v[124:127], v[156:159]
    s_add_u32 s26, s24, 4096
    v_add_f32 v201, v201, v205
    v_mfma_f32_16x16x32_bf16 v[144:147], a[236:239], v[120:123], v[144:147]
    buffer_load_dwordx4 a[216:219], v1, s[8:11], s26 offen offset:0 sc1
    v_mfma_f32_16x16x32_bf16 v[152:155], a[236:239], v[124:127], v[152:155]
    v_add_f32 v202, v202, v206
    s_waitcnt lgkmcnt(2)
    v_mfma_f32_16x16x32_bf16 v[128:131], a[4:7], v[96:99], v[128:131]
    ds_read_b128 v[112:115], v1 offset:28672
    v_add_f32 v203, v203, v207
    v_mfma_f32_16x16x32_bf16 v[136:139], a[4:7], v[100:103], v[136:139]
    ds_read_b128 v[116:119], v1 offset:30720
    v_add_f32 v200, v200, v202
    v_mfma_f32_16x16x32_bf16 v[132:135], a[8:11], v[96:99], v[132:135]
    ds_read_b128 v[120:123], v1 offset:32768
    v_add_f32 v201, v201, v203
    v_mfma_f32_16x16x32_bf16 v[140:143], a[8:11], v[100:103], v[140:143]
    ds_read_b128 v[124:127], v1 offset:34816
    s_waitcnt lgkmcnt(4)
    v_mfma_f32_16x16x32_bf16 v[148:151], a[8:11], v[104:107], v[148:151]
    buffer_load_dwordx4 a[236:239], v1, s[8:11], s26 offen offset:1024 sc1
    v_mfma_f32_16x16x32_bf16 v[156:159], a[8:11], v[108:111], v[156:159]
    buffer_load_dwordx4 a[0:3], v1, s[8:11], s26 offen offset:2048 sc1
    v_mfma_f32_16x16x32_bf16 v[144:147], a[4:7], v[104:107], v[144:147]
    v_mul_f32 v80, s64, v200
    v_mul_f32 v201, s64, v201
    v_mfma_f32_16x16x32_bf16 v[152:155], a[4:7], v[108:111], v[152:155]
    v_fma_f32 v201, -v80, v80, v201
    s_waitcnt lgkmcnt(2)
    v_mfma_f32_16x16x32_bf16 v[128:131], a[12:15], v[112:115], v[128:131]
    ds_read_b128 v[96:99], v1 offset:35840
    v_max_f32 v201, 0, v201
    v_mfma_f32_16x16x32_bf16 v[136:139], a[12:15], v[116:119], v[136:139]
    ds_read_b128 v[100:103], v1 offset:37888
    v_add_f32 v201, s65, v201
    v_mfma_f32_16x16x32_bf16 v[132:135], a[60:63], v[112:115], v[132:135]
    ds_read_b128 v[104:107], v1 offset:39936
    v_mfma_f32_16x16x32_bf16 v[140:143], a[60:63], v[116:119], v[140:143]
    ds_read_b128 v[108:111], v1 offset:41984
    s_waitcnt lgkmcnt(4)
    v_mfma_f32_16x16x32_bf16 v[148:151], a[60:63], v[120:123], v[148:151]
    buffer_load_dwordx4 a[4:7], v1, s[8:11], s26 offen offset:3072 sc1
    v_mfma_f32_16x16x32_bf16 v[156:159], a[60:63], v[124:127], v[156:159]
    v_rsq_f32 v84, v201
    v_mfma_f32_16x16x32_bf16 v[144:147], a[12:15], v[120:123], v[144:147]
    v_mov_b32 v82, v80
    v_mov_b32 v86, v84
    v_mfma_f32_16x16x32_bf16 v[152:155], a[12:15], v[124:127], v[152:155]
    s_waitcnt lgkmcnt(2)
    v_mfma_f32_16x16x32_bf16 v[128:131], a[64:67], v[96:99], v[128:131]
    ds_read_b128 v[112:115], v1 offset:36864
    v_mfma_f32_16x16x32_bf16 v[136:139], a[64:67], v[100:103], v[136:139]
    ds_read_b128 v[116:119], v1 offset:38912
    v_mfma_f32_16x16x32_bf16 v[132:135], a[108:111], v[96:99], v[132:135]
    ds_read_b128 v[120:123], v1 offset:40960
    s_add_u32 s26, s24, 8192
    v_mfma_f32_16x16x32_bf16 v[140:143], a[108:111], v[100:103], v[140:143]
    ds_read_b128 v[124:127], v1 offset:43008
    s_waitcnt lgkmcnt(4)
    v_mfma_f32_16x16x32_bf16 v[148:151], a[108:111], v[104:107], v[148:151]
    buffer_load_dwordx4 a[8:11], v1, s[8:11], s26 offen offset:0 sc1
    v_mfma_f32_16x16x32_bf16 v[156:159], a[108:111], v[108:111], v[156:159]
    buffer_load_dwordx4 a[12:15], v1, s[8:11], s26 offen offset:1024 sc1
    v_mfma_f32_16x16x32_bf16 v[144:147], a[64:67], v[104:107], v[144:147]
    v_permlane32_swap_b32 v80, v82
    v_mfma_f32_16x16x32_bf16 v[152:155], a[64:67], v[108:111], v[152:155]
    s_waitcnt vmcnt(21)
    s_waitcnt lgkmcnt(0)
    buffer_load_dwordx4 a[60:63], v1, s[8:11], s26 offen offset:2048 sc1
    buffer_load_dwordx4 a[64:67], v1, s[8:11], s26 offen offset:3072 sc1
    s_add_u32 s26, s24, 12288
    buffer_load_dwordx4 a[108:111], v1, s[8:11], s26 offen offset:0 sc1
    s_waitcnt vmcnt(14)
    s_barrier
    v_mov_b32 v199, 11
    buffer_store_dword v199, v26, s[8:11], s37 offen sc1
    v_mfma_f32_16x16x32_bf16 v[128:131], a[120:123], v[112:115], v[128:131]
    ds_read_b128 v[96:99], v1 offset:44032
    v_mfma_f32_16x16x32_bf16 v[136:139], a[120:123], v[116:119], v[136:139]
    ds_read_b128 v[100:103], v1 offset:46080
    v_mfma_f32_16x16x32_bf16 v[132:135], a[16:19], v[112:115], v[132:135]
    ds_read_b128 v[104:107], v1 offset:48128
    v_mfma_f32_16x16x32_bf16 v[140:143], a[16:19], v[116:119], v[140:143]
    ds_read_b128 v[108:111], v1 offset:50176
    v_mfma_f32_16x16x32_bf16 v[148:151], a[16:19], v[120:123], v[148:151]
    v_permlane32_swap_b32 v84, v86
    v_mfma_f32_16x16x32_bf16 v[156:159], a[16:19], v[124:127], v[156:159]
    v_mov_b32 v81, v80
    v_mov_b32 v83, v82
    v_mfma_f32_16x16x32_bf16 v[144:147], a[120:123], v[120:123], v[144:147]
    v_mov_b32 v85, v84
    v_mov_b32 v87, v86
    v_mfma_f32_16x16x32_bf16 v[152:155], a[120:123], v[124:127], v[152:155]
    s_waitcnt lgkmcnt(2)
    v_mfma_f32_16x16x32_bf16 v[128:131], a[20:23], v[96:99], v[128:131]
    ds_read_b128 v[112:115], v1 offset:45056
    v_mfma_f32_16x16x32_bf16 v[136:139], a[20:23], v[100:103], v[136:139]
    ds_read_b128 v[116:119], v1 offset:47104
    v_mfma_f32_16x16x32_bf16 v[132:135], a[24:27], v[96:99], v[132:135]
    ds_read_b128 v[120:123], v1 offset:49152
    v_mfma_f32_16x16x32_bf16 v[140:143], a[24:27], v[100:103], v[140:143]
    ds_read_b128 v[124:127], v1 offset:51200
    s_waitcnt lgkmcnt(4)
    v_mfma_f32_16x16x32_bf16 v[148:151], a[24:27], v[104:107], v[148:151]
    buffer_load_dwordx4 a[120:123], v1, s[8:11], s26 offen offset:1024 sc1
    v_mfma_f32_16x16x32_bf16 v[156:159], a[24:27], v[108:111], v[156:159]
    buffer_load_dwordx4 a[16:19], v1, s[8:11], s26 offen offset:2048 sc1
    v_mfma_f32_16x16x32_bf16 v[144:147], a[20:23], v[104:107], v[144:147]
    v_permlane16_swap_b32 v80, v81
    v_mfma_f32_16x16x32_bf16 v[152:155], a[20:23], v[108:111], v[152:155]
    s_waitcnt lgkmcnt(2)
    v_mfma_f32_16x16x32_bf16 v[128:131], a[28:31], v[112:115], v[128:131]
    ds_read_b128 v[96:99], v1 offset:52224
    v_mfma_f32_16x16x32_bf16 v[136:139], a[28:31], v[116:119], v[136:139]
    ds_read_b128 v[100:103], v1 offset:54272
    v_mfma_f32_16x16x32_bf16 v[132:135], a[32:35], v[112:115], v[132:135]
    ds_read_b128 v[104:107], v1 offset:56320
    v_mfma_f32_16x16x32_bf16 v[140:143], a[32:35], v[116:119], v[140:143]
    ds_read_b128 v[108:111], v1 offset:58368
    s_waitcnt lgkmcnt(4)
    v_mfma_f32_16x16x32_bf16 v[148:151], a[32:35], v[120:123], v[148:151]
    buffer_load_dwordx4 a[20:23], v1, s[8:11], s26 offen offset:3072 sc1
    v_mfma_f32_16x16x32_bf16 v[156:159], a[32:35], v[124:127], v[156:159]
    s_add_u32 s26, s24, 16384
    v_mfma_f32_16x16x32_bf16 v[144:147], a[28:31], v[120:123], v[144:147]
    buffer_load_dwordx4 a[24:27], v1, s[8:11], s26 offen offset:0 sc1
    v_mfma_f32_16x16x32_bf16 v[152:155], a[28:31], v[124:127], v[152:155]
    s_waitcnt lgkmcnt(2)
    v_mfma_f32_16x16x32_bf16 v[128:131], a[36:39], v[96:99], v[128:131]
    ds_read_b128 v[112:115], v1 offset:53248
    v_mfma_f32_16x16x32_bf16 v[136:139], a[36:39], v[100:103], v[136:139]
    ds_read_b128 v[116:119], v1 offset:55296
    v_mfma_f32_16x16x32_bf16 v[132:135], a[40:43], v[96:99], v[132:135]
    ds_read_b128 v[120:123], v1 offset:57344
    v_mfma_f32_16x16x32_bf16 v[140:143], a[40:43], v[100:103], v[140:143]
    ds_read_b128 v[124:127], v1 offset:59392
    s_waitcnt lgkmcnt(4)
    v_mfma_f32_16x16x32_bf16 v[148:151], a[40:43], v[104:107], v[148:151]
    buffer_load_dwordx4 a[28:31], v1, s[8:11], s26 offen offset:1024 sc1
    v_mfma_f32_16x16x32_bf16 v[156:159], a[40:43], v[108:111], v[156:159]
    buffer_load_dwordx4 a[32:35], v1, s[8:11], s26 offen offset:2048 sc1
    v_mfma_f32_16x16x32_bf16 v[144:147], a[36:39], v[104:107], v[144:147]
    v_permlane16_swap_b32 v82, v83
    v_mfma_f32_16x16x32_bf16 v[152:155], a[36:39], v[108:111], v[152:155]
    s_waitcnt lgkmcnt(2)
    v_mfma_f32_16x16x32_bf16 v[128:131], a[44:47], v[112:115], v[128:131]
    ds_read_b128 v[96:99], v1 offset:60416
    v_mfma_f32_16x16x32_bf16 v[136:139], a[44:47], v[116:119], v[136:139]
    ds_read_b128 v[100:103], v1 offset:62464
    v_mfma_f32_16x16x32_bf16 v[132:135], a[48:51], v[112:115], v[132:135]
    ds_read_b128 v[104:107], v1 offset:64512
    v_mfma_f32_16x16x32_bf16 v[140:143], a[48:51], v[116:119], v[140:143]
    ds_read_b128 v[108:111], v2 offset:1024
    s_waitcnt lgkmcnt(4)
    v_mfma_f32_16x16x32_bf16 v[148:151], a[48:51], v[120:123], v[148:151]
    buffer_load_dwordx4 a[36:39], v1, s[8:11], s26 offen offset:3072 sc1
    v_mfma_f32_16x16x32_bf16 v[156:159], a[48:51], v[124:127], v[156:159]
    s_add_u32 s26, s24, 20480
    v_mfma_f32_16x16x32_bf16 v[144:147], a[44:47], v[120:123], v[144:147]
    buffer_load_dwordx4 a[40:43], v1, s[8:11], s26 offen offset:0 sc1
    v_mfma_f32_16x16x32_bf16 v[152:155], a[44:47], v[124:127], v[152:155]
    s_waitcnt lgkmcnt(2)
    v_mfma_f32_16x16x32_bf16 v[128:131], a[56:59], v[96:99], v[128:131]
    ds_read_b128 v[112:115], v1 offset:61440
    v_mfma_f32_16x16x32_bf16 v[136:139], a[56:59], v[100:103], v[136:139]
    ds_read_b128 v[116:119], v1 offset:63488
    v_mfma_f32_16x16x32_bf16 v[132:135], a[72:75], v[96:99], v[132:135]
    ds_read_b128 v[120:123], v2 offset:0
    v_mfma_f32_16x16x32_bf16 v[140:143], a[72:75], v[100:103], v[140:143]
    ds_read_b128 v[124:127], v2 offset:2048
    s_waitcnt lgkmcnt(4)
    v_mfma_f32_16x16x32_bf16 v[148:151], a[72:75], v[104:107], v[148:151]
    buffer_load_dwordx4 a[44:47], v1, s[8:11], s26 offen offset:1024 sc1
    v_mfma_f32_16x16x32_bf16 v[156:159], a[72:75], v[108:111], v[156:159]
    buffer_load_dwordx4 a[48:51], v1, s[8:11], s26 offen offset:2048 sc1
    v_mfma_f32_16x16x32_bf16 v[144:147], a[56:59], v[104:107], v[144:147]
    v_permlane16_swap_b32 v84, v85
    v_mfma_f32_16x16x32_bf16 v[152:155], a[56:59], v[108:111], v[152:155]
    s_waitcnt lgkmcnt(0)
    s_barrier
    v_mfma_f32_16x16x32_bf16 v[128:131], a[76:79], v[112:115], v[128:131]
    ds_read_b128 v[96:99], v2 offset:3072
    v_mfma_f32_16x16x32_bf16 v[136:139], a[76:79], v[116:119], v[136:139]
    ds_read_b128 v[100:103], v2 offset:5120
    v_mfma_f32_16x16x32_bf16 v[132:135], a[80:83], v[112:115], v[132:135]
    ds_read_b128 v[104:107], v2 offset:7168
    v_mfma_f32_16x16x32_bf16 v[140:143], a[80:83], v[116:119], v[140:143]
    ds_read_b128 v[108:111], v2 offset:9216
    v_mfma_f32_16x16x32_bf16 v[148:151], a[80:83], v[120:123], v[148:151]
    buffer_load_dwordx4 a[56:59], v1, s[8:11], s26 offen offset:3072 sc1
    v_mfma_f32_16x16x32_bf16 v[156:159], a[80:83], v[124:127], v[156:159]
    s_add_u32 s26, s24, 24576
    v_mfma_f32_16x16x32_bf16 v[144:147], a[76:79], v[120:123], v[144:147]
    buffer_load_dwordx4 a[72:75], v1, s[8:11], s26 offen offset:0 sc1
    v_mfma_f32_16x16x32_bf16 v[152:155], a[76:79], v[124:127], v[152:155]
    s_waitcnt lgkmcnt(2)
    v_mfma_f32_16x16x32_bf16 v[128:131], a[96:99], v[96:99], v[128:131]
    ds_read_b128 v[112:115], v2 offset:4096
    v_mfma_f32_16x16x32_bf16 v[136:139], a[96:99], v[100:103], v[136:139]
    ds_read_b128 v[116:119], v2 offset:6144
    v_mfma_f32_16x16x32_bf16 v[132:135], a[100:103], v[96:99], v[132:135]
    ds_read_b128 v[120:123], v2 offset:8192
    v_mfma_f32_16x16x32_bf16 v[140:143], a[100:103], v[100:103], v[140:143]
    ds_read_b128 v[124:127], v2 offset:10240
    s_waitcnt lgkmcnt(4)
    v_mfma_f32_16x16x32_bf16 v[148:151], a[100:103], v[104:107], v[148:151]
    buffer_load_dwordx4 a[76:79], v1, s[8:11], s26 offen offset:1024 sc1
    v_mfma_f32_16x16x32_bf16 v[156:159], a[100:103], v[108:111], v[156:159]
    buffer_load_dwordx4 a[80:83], v1, s[8:11], s26 offen offset:2048 sc1
    v_mfma_f32_16x16x32_bf16 v[144:147], a[96:99], v[104:107], v[144:147]
    v_permlane16_swap_b32 v86, v87
    v_mfma_f32_16x16x32_bf16 v[152:155], a[96:99], v[108:111], v[152:155]
    buffer_load_dword v27, v25, s[8:11], s38 offen sc1
    s_waitcnt lgkmcnt(2)
    v_mfma_f32_16x16x32_bf16 v[128:131], a[52:55], v[112:115], v[128:131]
    ds_read_b128 v[96:99], v2 offset:11264
    v_mfma_f32_16x16x32_bf16 v[136:139], a[52:55], v[116:119], v[136:139]
    ds_read_b128 v[100:103], v2 offset:13312
    v_mfma_f32_16x16x32_bf16 v[132:135], a[68:71], v[112:115], v[132:135]
    ds_read_b128 v[104:107], v2 offset:15360
    v_mfma_f32_16x16x32_bf16 v[140:143], a[68:71], v[116:119], v[140:143]
    ds_read_b128 v[108:111], v2 offset:17408
    s_waitcnt lgkmcnt(4)
    v_mfma_f32_16x16x32_bf16 v[148:151], a[68:71], v[120:123], v[148:151]
    buffer_load_dwordx4 a[96:99], v1, s[8:11], s26 offen offset:3072 sc1
    v_mfma_f32_16x16x32_bf16 v[156:159], a[68:71], v[124:127], v[156:159]
    s_add_u32 s26, s24, 28672
    v_mfma_f32_16x16x32_bf16 v[144:147], a[52:55], v[120:123], v[144:147]
    buffer_load_dwordx4 a[100:103], v1, s[8:11], s26 offen offset:0 sc1
    v_mfma_f32_16x16x32_bf16 v[152:155], a[52:55], v[124:127], v[152:155]
    s_waitcnt lgkmcnt(2)
    v_mfma_f32_16x16x32_bf16 v[128:131], a[84:87], v[96:99], v[128:131]
    ds_read_b128 v[112:115], v2 offset:12288
    v_mfma_f32_16x16x32_bf16 v[136:139], a[84:87], v[100:103], v[136:139]
    ds_read_b128 v[116:119], v2 offset:14336
    v_mfma_f32_16x16x32_bf16 v[132:135], a[88:91], v[96:99], v[132:135]
    ds_read_b128 v[120:123], v2 offset:16384
    v_mfma_f32_16x16x32_bf16 v[140:143], a[88:91], v[100:103], v[140:143]
    ds_read_b128 v[124:127], v2 offset:18432
    s_waitcnt lgkmcnt(4)
    v_mfma_f32_16x16x32_bf16 v[148:151], a[88:91], v[104:107], v[148:151]
    buffer_load_dwordx4 a[52:55], v1, s[8:11], s26 offen offset:1024 sc1
    v_mfma_f32_16x16x32_bf16 v[156:159], a[88:91], v[108:111], v[156:159]
    buffer_load_dwordx4 a[68:71], v1, s[8:11], s26 offen offset:2048 sc1
    v_mfma_f32_16x16x32_bf16 v[144:147], a[84:87], v[104:107], v[144:147]
    v_mfma_f32_16x16x32_bf16 v[152:155], a[84:87], v[108:111], v[152:155]
    s_waitcnt lgkmcnt(2)
    v_mfma_f32_16x16x32_bf16 v[128:131], a[92:95], v[112:115], v[128:131]
    ds_read_b128 v[96:99], v2 offset:19456
    v_mfma_f32_16x16x32_bf16 v[136:139], a[92:95], v[116:119], v[136:139]
    ds_read_b128 v[100:103], v2 offset:21504
    v_mfma_f32_16x16x32_bf16 v[132:135], a[104:107], v[112:115], v[132:135]
    ds_read_b128 v[104:107], v2 offset:23552
    v_mfma_f32_16x16x32_bf16 v[140:143], a[104:107], v[116:119], v[140:143]
    ds_read_b128 v[108:111], v2 offset:25600
    s_waitcnt lgkmcnt(4)
    v_mfma_f32_16x16x32_bf16 v[148:151], a[104:107], v[120:123], v[148:151]
    buffer_load_dwordx4 a[84:87], v1, s[8:11], s26 offen offset:3072 sc1
    v_mfma_f32_16x16x32_bf16 v[156:159], a[104:107], v[124:127], v[156:159]
    s_add_u32 s26, s24, 32768
    v_mfma_f32_16x16x32_bf16 v[144:147], a[92:95], v[120:123], v[144:147]
    buffer_load_dwordx4 a[88:91], v1, s[8:11], s26 offen offset:0 sc1
    v_mfma_f32_16x16x32_bf16 v[152:155], a[92:95], v[124:127], v[152:155]
    s_waitcnt lgkmcnt(2)
    v_mfma_f32_16x16x32_bf16 v[128:131], a[112:115], v[96:99], v[128:131]
    ds_read_b128 v[112:115], v2 offset:20480
    v_mfma_f32_16x16x32_bf16 v[136:139], a[112:115], v[100:103], v[136:139]
    ds_read_b128 v[116:119], v2 offset:22528
    v_mfma_f32_16x16x32_bf16 v[132:135], a[116:119], v[96:99], v[132:135]
    ds_read_b128 v[120:123], v2 offset:24576
    v_mfma_f32_16x16x32_bf16 v[140:143], a[116:119], v[100:103], v[140:143]
    ds_read_b128 v[124:127], v2 offset:26624
    s_waitcnt lgkmcnt(4)
    v_mfma_f32_16x16x32_bf16 v[148:151], a[116:119], v[104:107], v[148:151]
    buffer_load_dwordx4 a[92:95], v1, s[8:11], s26 offen offset:1024 sc1
    v_mfma_f32_16x16x32_bf16 v[156:159], a[116:119], v[108:111], v[156:159]
    buffer_load_dwordx4 a[104:107], v1, s[8:11], s26 offen offset:2048 sc1
    v_mfma_f32_16x16x32_bf16 v[144:147], a[112:115], v[104:107], v[144:147]
    v_mfma_f32_16x16x32_bf16 v[152:155], a[112:115], v[108:111], v[152:155]
    s_waitcnt lgkmcnt(2)
    v_mfma_f32_16x16x32_bf16 v[128:131], a[160:163], v[112:115], v[128:131]
    v_mfma_f32_16x16x32_bf16 v[136:139], a[160:163], v[116:119], v[136:139]
    v_mfma_f32_16x16x32_bf16 v[132:135], a[124:127], v[112:115], v[132:135]
    buffer_load_dwordx4 a[112:115], v1, s[8:11], s26 offen offset:3072 sc1
    v_mfma_f32_16x16x32_bf16 v[140:143], a[124:127], v[116:119], v[140:143]
    s_add_u32 s26, s24, 36864
    s_waitcnt lgkmcnt(0)
    v_mfma_f32_16x16x32_bf16 v[148:151], a[124:127], v[120:123], v[148:151]
    buffer_load_dwordx4 a[116:119], v1, s[8:11], s26 offen offset:0 sc1
    v_mfma_f32_16x16x32_bf16 v[156:159], a[124:127], v[124:127], v[156:159]
    v_mfma_f32_16x16x32_bf16 v[144:147], a[160:163], v[120:123], v[144:147]
    v_mfma_f32_16x16x32_bf16 v[152:155], a[160:163], v[124:127], v[152:155]
    s_waitcnt vmcnt(10)
    v_cmp_le_u32 vcc, 11, v27
    s_nop 3
    s_cmp_eq_u64 vcc, -1
    s_cbranch_scc1 L_pdone_76
    s_mov_b32 s68, 0x80000
L_poll_75:
    buffer_load_dword v27, v25, s[8:11], s38 offen sc1
    s_waitcnt vmcnt(0)
    v_cmp_le_u32 vcc, 11, v27
    s_nop 3
    s_cmp_eq_u64 vcc, -1
    s_cbranch_scc1 L_pdone_76
    s_sub_u32 s68, s68, 1
    s_cmp_lg_u32 s68, 0
    s_cbranch_scc1 L_poll_75
L_pdone_76:
    v_pk_fma_f32 v[128:129], v[80:81], v[44:45], v[128:129] op_sel:[0,0,0] op_sel_hi:[0,1,1] neg_lo:[1,0,0] neg_hi:[1,0,0]
    s_add_u32 s88, s30, 12062720
    s_add_u32 s88, s88, s8
    s_addc_u32 s89, s52, 0
    global_load_dwordx4 v[216:219], v1, s[88:89] offset:-4096 sc1
    v_pk_fma_f32 v[130:131], v[80:81], v[46:47], v[130:131] op_sel:[0,0,0] op_sel_hi:[0,1,1] neg_lo:[1,0,0] neg_hi:[1,0,0]
    s_add_u32 s90, s30, 12083200
    s_add_u32 s90, s90, s8
    s_addc_u32 s91, s52, 0
    global_load_dwordx4 v[220:223], v1, s[90:91] offset:-4096 sc1
    v_pk_mul_f32 v[128:129], v[84:85], v[128:129] op_sel:[0,0] op_sel_hi:[0,1]
    global_load_dwordx4 v[224:227], v1, s[88:89] offset:-3072 sc1
    v_pk_mul_f32 v[130:131], v[84:85], v[130:131] op_sel:[0,0] op_sel_hi:[0,1]
    global_load_dwordx4 v[228:231], v1, s[90:91] offset:-3072 sc1
    v_cvt_pk_bf16_f32 v128, v128, v129
    v_cvt_pk_bf16_f32 v129, v130, v131
    ds_write_b64 v9, v[128:129] offset:0
    v_pk_fma_f32 v[132:133], v[80:81], v[48:49], v[132:133] op_sel:[0,0,0] op_sel_hi:[0,1,1] neg_lo:[1,0,0] neg_hi:[1,0,0]
    v_pk_fma_f32 v[134:135], v[80:81], v[50:51], v[134:135] op_sel:[0,0,0] op_sel_hi:[0,1,1] neg_lo:[1,0,0] neg_hi:[1,0,0]
    v_pk_mul_f32 v[132:133], v[84:85], v[132:133] op_sel:[0,0] op_sel_hi:[0,1]
    v_pk_mul_f32 v[134:135], v[84:85], v[134:135] op_sel:[0,0] op_sel_hi:[0,1]
    v_cvt_pk_bf16_f32 v132, v132, v133
    v_cvt_pk_bf16_f32 v133, v134, v135
    ds_write_b64 v9, v[132:133] offset:32
    v_pk_fma_f32 v[136:137], v[80:81], v[44:45], v[136:137] op_sel:[1,0,0] op_sel_hi:[1,1,1] neg_lo:[1,0,0] neg_hi:[1,0,0]
    v_pk_fma_f32 v[138:139], v[80:81], v[46:47], v[138:139] op_sel:[1,0,0] op_sel_hi:[1,1,1] neg_lo:[1,0,0] neg_hi:[1,0,0]
    v_pk_mul_f32 v[136:137], v[84:85], v[136:137] op_sel:[1,0] op_sel_hi:[1,1]
    global_load_dwordx4 v[232:235], v1, s[88:89] offset:-2048 sc1
    v_pk_mul_f32 v[138:139], v[84:85], v[138:139] op_sel:[1,0] op_sel_hi:[1,1]
    v_cvt_pk_bf16_f32 v136, v136, v137
    v_cvt_pk_bf16_f32 v137, v138, v139
    ds_write_b64 v9, v[136:137] offset:10880
    v_pk_fma_f32 v[140:141], v[80:81], v[48:49], v[140:141] op_sel:[1,0,0] op_sel_hi:[1,1,1] neg_lo:[1,0,0] neg_hi:[1,0,0]
    v_pk_fma_f32 v[142:143], v[80:81], v[50:51], v[142:143] op_sel:[1,0,0] op_sel_hi:[1,1,1] neg_lo:[1,0,0] neg_hi:[1,0,0]
    v_pk_mul_f32 v[140:141], v[84:85], v[140:141] op_sel:[1,0] op_sel_hi:[1,1]
    global_load_dwordx4 v[236:239], v1, s[90:91] offset:-2048 sc1
    v_pk_mul_f32 v[142:143], v[84:85], v[142:143] op_sel:[1,0] op_sel_hi:[1,1]
    v_cvt_pk_bf16_f32 v140, v140, v141
    v_cvt_pk_bf16_f32 v141, v142, v143
    ds_write_b64 v9, v[140:141] offset:10912
    v_pk_fma_f32 v[144:145], v[82:83], v[44:45], v[144:145] op_sel:[0,0,0] op_sel_hi:[0,1,1] neg_lo:[1,0,0] neg_hi:[1,0,0]
    v_pk_fma_f32 v[146:147], v[82:83], v[46:47], v[146:147] op_sel:[0,0,0] op_sel_hi:[0,1,1] neg_lo:[1,0,0] neg_hi:[1,0,0]
    v_pk_mul_f32 v[144:145], v[86:87], v[144:145] op_sel:[0,0] op_sel_hi:[0,1]
    v_pk_mul_f32 v[146:147], v[86:87], v[146:147] op_sel:[0,0] op_sel_hi:[0,1]
    v_cvt_pk_bf16_f32 v144, v144, v145
    v_cvt_pk_bf16_f32 v145, v146, v147
    ds_write_b64 v9, v[144:145] offset:4352
    v_pk_fma_f32 v[148:149], v[82:83], v[48:49], v[148:149] op_sel:[0,0,0] op_sel_hi:[0,1,1] neg_lo:[1,0,0] neg_hi:[1,0,0]
    v_pk_fma_f32 v[150:151], v[82:83], v[50:51], v[150:151] op_sel:[0,0,0] op_sel_hi:[0,1,1] neg_lo:[1,0,0] neg_hi:[1,0,0]
    v_pk_mul_f32 v[148:149], v[86:87], v[148:149] op_sel:[0,0] op_sel_hi:[0,1]
    v_pk_mul_f32 v[150:151], v[86:87], v[150:151] op_sel:[0,0] op_sel_hi:[0,1]
    v_cvt_pk_bf16_f32 v148, v148, v149
    v_cvt_pk_bf16_f32 v149, v150, v151
    ds_write_b64 v9, v[148:149] offset:4384
    v_pk_fma_f32 v[152:153], v[82:83], v[44:45], v[152:153] op_sel:[1,0,0] op_sel_hi:[1,1,1] neg_lo:[1,0,0] neg_hi:[1,0,0]
    v_pk_fma_f32 v[154:155], v[82:83], v[46:47], v[154:155] op_sel:[1,0,0] op_sel_hi:[1,1,1] neg_lo:[1,0,0] neg_hi:[1,0,0]
    v_pk_mul_f32 v[152:153], v[86:87], v[152:153] op_sel:[1,0] op_sel_hi:[1,1]
    v_pk_mul_f32 v[154:155], v[86:87], v[154:155] op_sel:[1,0] op_sel_hi:[1,1]
    v_cvt_pk_bf16_f32 v152, v152, v153
    global_load_dwordx4 v[240:243], v1, s[88:89] offset:-1024 sc1
    v_cvt_pk_bf16_f32 v153, v154, v155
    ds_write_b64 v9, v[152:153] offset:15232
    v_pk_fma_f32 v[156:157], v[82:83], v[48:49], v[156:157] op_sel:[1,0,0] op_sel_hi:[1,1,1] neg_lo:[1,0,0] neg_hi:[1,0,0]
    global_load_dwordx4 v[244:247], v1, s[90:91] offset:-1024 sc1
    v_pk_fma_f32 v[158:159], v[82:83], v[50:51], v[158:159] op_sel:[1,0,0] op_sel_hi:[1,1,1] neg_lo:[1,0,0] neg_hi:[1,0,0]
    v_pk_mul_f32 v[156:157], v[86:87], v[156:157] op_sel:[1,0] op_sel_hi:[1,1]
    v_pk_mul_f32 v[158:159], v[86:87], v[158:159] op_sel:[1,0] op_sel_hi:[1,1]
    v_cvt_pk_bf16_f32 v156, v156, v157
    v_cvt_pk_bf16_f32 v157, v158, v159
    ds_write_b64 v9, v[156:157] offset:15264
    s_waitcnt lgkmcnt(0)
    s_barrier
    ds_read_b128 v[128:131], v11 offset:0
    ds_read_b128 v[132:135], v13 offset:80
    ds_read_b128 v[136:139], v11 offset:80
    ds_read_b128 v[140:143], v11 offset:32
    ds_read_b128 v[144:147], v13 offset:112
    ds_read_b128 v[148:151], v11 offset:112
    s_waitcnt lgkmcnt(5)
    v_cndmask_b32 v128, 0, v128, s[40:41]
    v_cndmask_b32 v129, 0, v129, s[40:41]
    v_cndmask_b32 v130, 0, v130, s[42:43]
    v_cndmask_b32 v131, 0, v131, s[42:43]
    global_load_dwordx4 v[248:251], v1, s[88:89] offset:0 sc1
    s_waitcnt lgkmcnt(3)
    v_mfma_f32_16x16x32_bf16 v[96:99], v[132:135], v[128:131], v[32:35]
    v_mfma_f32_16x16x32_bf16 v[100:103], v[136:139], v[128:131], v[36:39]
    global_load_dwordx4 v[252:255], v1, s[90:91] offset:0 sc1
    s_waitcnt lgkmcnt(2)
    v_cndmask_b32 v140, 0, v140, s[44:45]
    v_cndmask_b32 v141, 0, v141, s[44:45]
    v_cndmask_b32 v142, 0, v142, s[40:41]
    v_cndmask_b32 v143, 0, v143, s[40:41]
    s_waitcnt lgkmcnt(0)
    s_nop 0
    v_mfma_f32_16x16x32_bf16 v[104:107], v[144:147], v[140:143], v[32:35]
    v_mfma_f32_16x16x32_bf16 v[108:111], v[148:151], v[140:143], v[36:39]
    ds_read_b64_tr_b16 v[152:153], v16 offset:160
    ds_read_b64_tr_b16 v[154:155], v14 offset:160
    ds_read_b64_tr_b16 v[156:157], v16 offset:192
    ds_read_b64_tr_b16 v[158:159], v14 offset:192
    v_max3_f32 v120, v96, v97, v98
    v_max3_f32 v121, v100, v101, v102
    v_max3_f32 v120, v120, v99, v103
    v_max_f32 v120, v120, v121
    v_mov_b32 v121, v120
    v_max3_f32 v122, v104, v105, v106
    v_max3_f32 v123, v108, v109, v110
    v_max3_f32 v122, v122, v107, v111
    v_max_f32 v122, v122, v123
    v_mov_b32 v123, v122
    v_permlane32_swap_b32 v120, v121
    s_nop 0
    v_permlane32_swap_b32 v122, v123
    v_max_f32 v120, v120, v121
    v_mov_b32 v121, v120
    v_max_f32 v122, v122, v123
    v_mov_b32 v123, v122
    v_permlane16_swap_b32 v120, v121
    s_nop 0
    v_permlane16_swap_b32 v122, v123
    v_max_f32 v120, v120, v121
    v_max_f32 v122, v122, v123
    ds_read_b64_tr_b16 v[160:161], v16 offset:200
    ds_read_b64_tr_b16 v[162:163], v14 offset:200
    ds_read_b64_tr_b16 v[164:165], v16 offset:232
    ds_read_b64_tr_b16 v[166:167], v14 offset:232
    v_mov_b32 v124, s67
    v_mul_f32 v120, v124, v120
    v_mul_f32 v122, v124, v122
    v_pk_fma_f32 v[96:97], v[96:97], v[124:125], v[120:121] op_sel:[0,0,0] op_sel_hi:[1,0,0] neg_lo:[0,0,1] neg_hi:[0,0,1]
    v_pk_fma_f32 v[98:99], v[98:99], v[124:125], v[120:121] op_sel:[0,0,0] op_sel_hi:[1,0,0] neg_lo:[0,0,1] neg_hi:[0,0,1]
    v_pk_fma_f32 v[100:101], v[100:101], v[124:125], v[120:121] op_sel:[0,0,0] op_sel_hi:[1,0,0] neg_lo:[0,0,1] neg_hi:[0,0,1]
    v_pk_fma_f32 v[102:103], v[102:103], v[124:125], v[120:121] op_sel:[0,0,0] op_sel_hi:[1,0,0] neg_lo:[0,0,1] neg_hi:[0,0,1]
    v_pk_fma_f32 v[104:105], v[104:105], v[124:125], v[122:123] op_sel:[0,0,0] op_sel_hi:[1,0,0] neg_lo:[0,0,1] neg_hi:[0,0,1]
    v_pk_fma_f32 v[106:107], v[106:107], v[124:125], v[122:123] op_sel:[0,0,0] op_sel_hi:[1,0,0] neg_lo:[0,0,1] neg_hi:[0,0,1]
    v_pk_fma_f32 v[108:109], v[108:109], v[124:125], v[122:123] op_sel:[0,0,0] op_sel_hi:[1,0,0] neg_lo:[0,0,1] neg_hi:[0,0,1]
    v_pk_fma_f32 v[110:111], v[110:111], v[124:125], v[122:123] op_sel:[0,0,0] op_sel_hi:[1,0,0] neg_lo:[0,0,1] neg_hi:[0,0,1]
    v_exp_f32 v96, v96
    v_exp_f32 v97, v97
    v_exp_f32 v98, v98
    v_exp_f32 v99, v99
    v_exp_f32 v100, v100
    v_exp_f32 v101, v101
    v_exp_f32 v102, v102
    v_exp_f32 v103, v103
    v_cvt_pk_bf16_f32 v112, v96, v97
    v_cvt_pk_bf16_f32 v113, v98, v99
    v_cvt_pk_bf16_f32 v114, v100, v101
    v_cvt_pk_bf16_f32 v115, v102, v103
    s_waitcnt lgkmcnt(4)
    v_exp_f32 v104, v104
    v_exp_f32 v105, v105
    v_mfma_f32_16x16x32_bf16 v[184:187], v[28:31], v[112:115], 0
    v_exp_f32 v106, v106
    v_exp_f32 v107, v107
    v_mfma_f32_16x16x32_bf16 v[176:179], v[152:155], v[112:115], 0
    v_exp_f32 v108, v108
    v_exp_f32 v109, v109
    v_mfma_f32_16x16x32_bf16 v[180:183], v[156:159], v[112:115], 0
    v_exp_f32 v110, v110
    v_exp_f32 v111, v111
    v_cvt_pk_bf16_f32 v116, v104, v105
    v_cvt_pk_bf16_f32 v117, v106, v107
    v_cvt_pk_bf16_f32 v118, v108, v109
    buffer_load_dwordx4 a[160:163], v1, s[8:11], s26 offen offset:1024 sc1
    v_cvt_pk_bf16_f32 v119, v110, v111
    v_rcp_f32 v184, v184
    s_waitcnt lgkmcnt(0)
    v_mfma_f32_16x16x32_bf16 v[196:199], v[28:31], v[116:119], 0
    buffer_load_dwordx4 a[124:127], v1, s[8:11], s26 offen offset:2048 sc1
    v_mul_f32 v176, v184, v176
    v_mul_f32 v177, v184, v177
    v_mul_f32 v178, v184, v178
    v_mfma_f32_16x16x32_bf16 v[188:191], v[160:163], v[116:119], 0
    v_mul_f32 v179, v184, v179
    v_mul_f32 v180, v184, v180
    v_mul_f32 v181, v184, v181
    v_mfma_f32_16x16x32_bf16 v[192:195], v[164:167], v[116:119], 0
    v_mul_f32 v182, v184, v182
    v_mul_f32 v183, v184, v183
    v_cvt_pk_bf16_f32 v96, v176, v177
    v_cvt_pk_bf16_f32 v100, v180, v181
    v_cvt_pk_bf16_f32 v97, v178, v179
    v_cvt_pk_bf16_f32 v101, v182, v183
    v_rcp_f32 v196, v196
    s_nop 0
    v_pk_mul_f32 v[188:189], v[196:197], v[188:189] op_sel:[0,0] op_sel_hi:[0,1]
    v_pk_mul_f32 v[192:193], v[196:197], v[192:193] op_sel:[0,0] op_sel_hi:[0,1]
    v_pk_mul_f32 v[190:191], v[196:197], v[190:191] op_sel:[0,0] op_sel_hi:[0,1]
    v_pk_mul_f32 v[194:195], v[196:197], v[194:195] op_sel:[0,0] op_sel_hi:[0,1]
    v_cvt_pk_bf16_f32 v98, v188, v189
    v_cvt_pk_bf16_f32 v102, v192, v193
    v_cvt_pk_bf16_f32 v99, v190, v191
    v_cvt_pk_bf16_f32 v103, v194, v195
    s_add_u32 s56, s32, 12140544
    buffer_store_dwordx4 v[96:99], v1, s[8:11], s56 offen sc1
    buffer_store_dwordx4 v[100:103], v23, s[8:11], s56 offen offset:1024 sc1
    s_barrier
    s_waitcnt vmcnt(12)
    v_mfma_f32_16x16x32_bf16 v[128:131], a[128:131], v[216:219], 0
    v_mfma_f32_16x16x32_bf16 v[132:135], a[164:167], v[216:219], 0
    v_mfma_f32_16x16x32_bf16 v[136:139], a[132:135], v[216:219], 0
    v_mfma_f32_16x16x32_bf16 v[140:143], a[136:139], v[216:219], 0
    v_mfma_f32_16x16x32_bf16 v[144:147], a[168:171], v[216:219], 0
    v_mfma_f32_16x16x32_bf16 v[148:151], a[128:131], v[220:223], 0
    v_mfma_f32_16x16x32_bf16 v[152:155], a[164:167], v[220:223], 0
    v_mfma_f32_16x16x32_bf16 v[156:159], a[132:135], v[220:223], 0
    v_mfma_f32_16x16x32_bf16 v[160:163], a[136:139], v[220:223], 0
    v_mfma_f32_16x16x32_bf16 v[164:167], a[168:171], v[220:223], 0
    s_waitcnt vmcnt(10)
    v_mfma_f32_16x16x32_bf16 v[128:131], a[140:143], v[224:227], v[128:131]
    v_mfma_f32_16x16x32_bf16 v[132:135], a[144:147], v[224:227], v[132:135]
    v_mfma_f32_16x16x32_bf16 v[136:139], a[172:175], v[224:227], v[136:139]
    v_mfma_f32_16x16x32_bf16 v[140:143], a[148:151], v[224:227], v[140:143]
    v_mfma_f32_16x16x32_bf16 v[144:147], a[152:155], v[224:227], v[144:147]
    v_mfma_f32_16x16x32_bf16 v[148:151], a[140:143], v[228:231], v[148:151]
    v_mfma_f32_16x16x32_bf16 v[152:155], a[144:147], v[228:231], v[152:155]
    v_mfma_f32_16x16x32_bf16 v[156:159], a[172:175], v[228:231], v[156:159]
    v_mfma_f32_16x16x32_bf16 v[160:163], a[148:151], v[228:231], v[160:163]
    v_mfma_f32_16x16x32_bf16 v[164:167], a[152:155], v[228:231], v[164:167]
    s_waitcnt vmcnt(9)
    v_mfma_f32_16x16x32_bf16 v[128:131], a[188:191], v[232:235], v[128:131]
    s_waitcnt vmcnt(7)
    v_mfma_f32_16x16x32_bf16 v[128:131], a[180:183], v[240:243], v[128:131]
    s_waitcnt vmcnt(5)
    v_mfma_f32_16x16x32_bf16 v[128:131], a[244:247], v[248:251], v[128:131]
    v_mfma_f32_16x16x32_bf16 v[148:151], a[188:191], v[236:239], v[148:151]
    v_mfma_f32_16x16x32_bf16 v[148:151], a[180:183], v[244:247], v[148:151]
    s_waitcnt vmcnt(4)
    v_mfma_f32_16x16x32_bf16 v[148:151], a[244:247], v[252:255], v[148:151]
    v_mfma_f32_16x16x32_bf16 v[132:135], a[240:243], v[232:235], v[132:135]
    v_mfma_f32_16x16x32_bf16 v[132:135], a[196:199], v[240:243], v[132:135]
    v_mfma_f32_16x16x32_bf16 v[132:135], a[184:187], v[248:251], v[132:135]
    s_nop 0
    ds_write_b128 v17, v[128:131] offset:0
    v_mfma_f32_16x16x32_bf16 v[152:155], a[240:243], v[236:239], v[152:155]
    v_mfma_f32_16x16x32_bf16 v[152:155], a[196:199], v[244:247], v[152:155]
    v_mfma_f32_16x16x32_bf16 v[152:155], a[184:187], v[252:255], v[152:155]
    ds_write_b128 v17, v[148:151] offset:256
    v_mfma_f32_16x16x32_bf16 v[136:139], a[176:179], v[232:235], v[136:139]
    v_mfma_f32_16x16x32_bf16 v[136:139], a[224:227], v[240:243], v[136:139]
    v_mfma_f32_16x16x32_bf16 v[136:139], a[220:223], v[248:251], v[136:139]
    ds_write_b128 v17, v[132:135] offset:2304
    v_mfma_f32_16x16x32_bf16 v[156:159], a[176:179], v[236:239], v[156:159]
    v_mfma_f32_16x16x32_bf16 v[156:159], a[224:227], v[244:247], v[156:159]
    v_mfma_f32_16x16x32_bf16 v[156:159], a[220:223], v[252:255], v[156:159]
    ds_write_b128 v17, v[152:155] offset:2560
    v_mfma_f32_16x16x32_bf16 v[140:143], a[192:195], v[232:235], v[140:143]
    v_mfma_f32_16x16x32_bf16 v[140:143], a[156:159], v[240:243], v[140:143]
    v_mfma_f32_16x16x32_bf16 v[140:143], a[208:211], v[248:251], v[140:143]
    ds_write_b128 v17, v[136:139] offset:4608
    v_mfma_f32_16x16x32_bf16 v[160:163], a[192:195], v[236:239], v[160:163]
    v_mfma_f32_16x16x32_bf16 v[160:163], a[156:159], v[244:247], v[160:163]
    v_mfma_f32_16x16x32_bf16 v[160:163], a[208:211], v[252:255], v[160:163]
    ds_write_b128 v17, v[156:159] offset:4864
    v_mfma_f32_16x16x32_bf16 v[144:147], a[204:207], v[232:235], v[144:147]
    v_mfma_f32_16x16x32_bf16 v[144:147], a[200:203], v[240:243], v[144:147]
    v_mfma_f32_16x16x32_bf16 v[144:147], a[228:231], v[248:251], v[144:147]
    ds_write_b128 v17, v[140:143] offset:6912
    v_mfma_f32_16x16x32_bf16 v[164:167], a[204:207], v[236:239], v[164:167]
    v_mfma_f32_16x16x32_bf16 v[164:167], a[200:203], v[244:247], v[164:167]
    v_mfma_f32_16x16x32_bf16 v[164:167], a[228:231], v[252:255], v[164:167]
    ds_write_b128 v17, v[160:163] offset:7168
    s_nop 2
    ds_write_b128 v17, v[144:147] offset:9216
    s_nop 2
    ds_write_b128 v17, v[164:167] offset:9472
    s_waitcnt lgkmcnt(0)
    s_waitcnt vmcnt(0)
    s_barrier
    v_mov_b32 v199, 12
    buffer_store_dword v199, v26, s[8:11], s37 offen sc1
    ds_read_b128 v[128:131], v18 offset:0
    ds_read_b128 v[132:135], v18 offset:576
    ds_read_b128 v[136:139], v18 offset:11520
    ds_read_b128 v[140:143], v18 offset:12096
    ds_read_b128 v[144:147], v18 offset:23040
    ds_read_b128 v[148:151], v18 offset:23616
    ds_read_b128 v[152:155], v18 offset:34560
    ds_read_b128 v[156:159], v18 offset:35136
    s_waitcnt lgkmcnt(4)
    v_pk_add_f32 v[128:129], v[128:129], v[136:137]
    v_pk_add_f32 v[130:131], v[130:131], v[138:139]
    v_pk_add_f32 v[132:133], v[132:133], v[140:141]
    v_pk_add_f32 v[134:135], v[134:135], v[142:143]
    ds_read_b128 v[160:163], v18 offset:9216
    ds_read_b128 v[164:167], v18 offset:9792
    ds_read_b128 v[176:179], v18 offset:20736
    ds_read_b128 v[180:183], v18 offset:21312
    v_lshlrev_b32 v136, 16, v64
    v_and_b32 v137, 0xffff0000, v64
    v_lshlrev_b32 v138, 16, v65
    v_and_b32 v139, 0xffff0000, v65
    v_lshlrev_b32 v140, 16, v66
    v_and_b32 v141, 0xffff0000, v66
    v_lshlrev_b32 v142, 16, v67
    v_and_b32 v143, 0xffff0000, v67
    s_waitcnt lgkmcnt(4)
    v_pk_add_f32 v[128:129], v[128:129], v[136:137]
    v_pk_add_f32 v[130:131], v[130:131], v[138:139]
    v_pk_add_f32 v[132:133], v[132:133], v[140:141]
    v_pk_add_f32 v[134:135], v[134:135], v[142:143]
    ds_read_b128 v[184:187], v18 offset:32256
    ds_read_b128 v[188:191], v18 offset:32832
    ds_read_b128 v[192:195], v18 offset:43776
    ds_read_b128 v[196:199], v18 offset:44352
    v_pk_add_f32 v[144:145], v[144:145], v[152:153]
    v_pk_add_f32 v[146:147], v[146:147], v[154:155]
    v_pk_add_f32 v[148:149], v[148:149], v[156:157]
    v_pk_add_f32 v[150:151], v[150:151], v[158:159]
    v_pk_add_f32 v[128:129], v[128:129], v[144:145]
    v_pk_add_f32 v[130:131], v[130:131], v[146:147]
    v_pk_add_f32 v[132:133], v[132:133], v[148:149]
    v_pk_add_f32 v[134:135], v[134:135], v[150:151]
    v_cvt_pk_bf16_f32 v64, v128, v129
    v_cvt_pk_bf16_f32 v65, v130, v131
    v_cvt_pk_bf16_f32 v66, v132, v133
    v_cvt_pk_bf16_f32 v67, v134, v135
    s_add_u32 s56, s35, 29884416
    buffer_store_dwordx4 v[64:67], v8, s[8:11], s56 offen offset:0 sc1
    s_waitcnt lgkmcnt(4)
    v_pk_add_f32 v[160:161], v[160:161], v[176:177]
    v_pk_add_f32 v[162:163], v[162:163], v[178:179]
    v_pk_add_f32 v[164:165], v[164:165], v[180:181]
    v_pk_add_f32 v[166:167], v[166:167], v[182:183]
    v_lshlrev_b32 v176, 16, v68
    v_and_b32 v177, 0xffff0000, v68
    v_lshlrev_b32 v178, 16, v69
    v_and_b32 v179, 0xffff0000, v69
    v_lshlrev_b32 v180, 16, v70
    v_and_b32 v181, 0xffff0000, v70
    v_lshlrev_b32 v182, 16, v71
    v_and_b32 v183, 0xffff0000, v71
    s_waitcnt lgkmcnt(0)
    v_pk_add_f32 v[160:161], v[160:161], v[176:177]
    v_pk_add_f32 v[162:163], v[162:163], v[178:179]
    v_pk_add_f32 v[164:165], v[164:165], v[180:181]
    v_pk_add_f32 v[166:167], v[166:167], v[182:183]
    v_pk_add_f32 v[184:185], v[184:185], v[192:193]
    v_pk_add_f32 v[186:187], v[186:187], v[194:195]
    v_pk_add_f32 v[188:189], v[188:189], v[196:197]
    v_pk_add_f32 v[190:191], v[190:191], v[198:199]
    v_pk_add_f32 v[160:161], v[160:161], v[184:185]
    v_pk_add_f32 v[162:163], v[162:163], v[186:187]
    v_pk_add_f32 v[164:165], v[164:165], v[188:189]
    v_pk_add_f32 v[166:167], v[166:167], v[190:191]
    v_cvt_pk_bf16_f32 v68, v160, v161
    v_cvt_pk_bf16_f32 v69, v162, v163
    v_cvt_pk_bf16_f32 v70, v164, v165
    v_cvt_pk_bf16_f32 v71, v166, v167
    buffer_store_dwordx4 v[68:71], v12, s[8:11], s56 offen offset:2048 sc1
    v_pk_add_f32 v[136:137], v[128:129], v[130:131]
    v_pk_mul_f32 v[140:141], v[128:129], v[128:129]
    v_pk_add_f32 v[138:139], v[160:161], v[162:163]
    v_pk_mul_f32 v[142:143], v[160:161], v[160:161]
    v_pk_fma_f32 v[140:141], v[130:131], v[130:131], v[140:141] op_sel:[0,0,0] op_sel_hi:[1,1,1]
    v_pk_fma_f32 v[142:143], v[162:163], v[162:163], v[142:143] op_sel:[0,0,0] op_sel_hi:[1,1,1]
    v_pk_add_f32 v[136:137], v[136:137], v[132:133]
    v_pk_fma_f32 v[140:141], v[132:133], v[132:133], v[140:141] op_sel:[0,0,0] op_sel_hi:[1,1,1]
    v_pk_add_f32 v[138:139], v[138:139], v[164:165]
    v_pk_fma_f32 v[142:143], v[164:165], v[164:165], v[142:143] op_sel:[0,0,0] op_sel_hi:[1,1,1]
    v_pk_add_f32 v[136:137], v[136:137], v[134:135]
    v_pk_fma_f32 v[140:141], v[134:135], v[134:135], v[140:141] op_sel:[0,0,0] op_sel_hi:[1,1,1]
    v_pk_add_f32 v[138:139], v[138:139], v[166:167]
    v_pk_fma_f32 v[142:143], v[166:167], v[166:167], v[142:143] op_sel:[0,0,0] op_sel_hi:[1,1,1]
    v_add_f32 v136, v136, v137
    v_add_f32 v138, v138, v139
    v_add_f32 v137, v140, v141
    v_add_f32 v139, v142, v143
    v_cndmask_b32 v138, 0, v138, s[46:47]
    v_cndmask_b32 v139, 0, v139, s[46:47]
    v_pk_add_f32 v[136:137], v[136:137], v[138:139]
    s_nop 1
    v_add_f32_dpp v136, v136, v136 row_ror:8 row_mask:0xf bank_mask:0xf
    v_add_f32_dpp v137, v137, v137 row_ror:8 row_mask:0xf bank_mask:0xf
    v_mov_b32 v138, v136
    v_mov_b32 v139, v137
    s_nop 0
    v_permlane16_swap_b32 v136, v138
    v_permlane16_swap_b32 v137, v139
    v_pk_add_f32 v[136:137], v[136:137], v[138:139]
    v_mov_b32 v138, v136
    v_mov_b32 v139, v137
    s_nop 0
    v_permlane32_swap_b32 v136, v138
    v_permlane32_swap_b32 v137, v139
    v_pk_add_f32 v[136:137], v[136:137], v[138:139]
    s_add_u32 s56, s36, 35520512
    buffer_store_dwordx2 v[136:137], v20, s[8:11], s56 offen sc1
    s_add_u32 s88, s30, 12144640
    s_add_u32 s88, s88, s8
    s_addc_u32 s89, s52, 0
    global_load_dwordx4 v[96:99], v1, s[88:89] offset:-4096 sc1
    s_add_u32 s90, s30, 12165120
    s_add_u32 s90, s90, s8
    s_addc_u32 s91, s52, 0
    global_load_dwordx4 v[100:103], v1, s[90:91] offset:-4096 sc1
    global_load_dwordx4 v[104:107], v1, s[88:89] offset:-3072 sc1
    global_load_dwordx4 v[108:111], v1, s[90:91] offset:-3072 sc1
    global_load_dwordx4 v[112:115], v1, s[88:89] offset:-2048 sc1
    global_load_dwordx4 v[116:119], v1, s[90:91] offset:-2048 sc1
    global_load_dwordx4 v[120:123], v1, s[88:89] offset:-1024 sc1
    global_load_dwordx4 v[124:127], v1, s[90:91] offset:-1024 sc1
    global_load_dwordx4 v[168:171], v1, s[88:89] offset:0 sc1
    global_load_dwordx4 v[172:175], v1, s[90:91] offset:0 sc1
    s_waitcnt vmcnt(10)
    s_barrier
    v_mov_b32 v199, 13
    buffer_store_dword v199, v26, s[8:11], s37 offen sc1
    s_waitcnt vmcnt(9)
    v_max_u32 v3, v96, v100
    v_cmp_eq_u32 vcc, -1, v3
    s_nop 3
    s_cbranch_vccnz L_fix_77
L_fixed_78:
    v_mfma_f32_16x16x32_bf16 v[128:131], a[128:131], v[96:99], 0
    v_mfma_f32_16x16x32_bf16 v[132:135], a[164:167], v[96:99], 0
    v_mfma_f32_16x16x32_bf16 v[136:139], a[132:135], v[96:99], 0
    v_mfma_f32_16x16x32_bf16 v[140:143], a[136:139], v[96:99], 0
    v_mfma_f32_16x16x32_bf16 v[144:147], a[168:171], v[96:99], 0
    s_waitcnt vmcnt(7)
    v_max_u32 v3, v104, v108
    v_cmp_eq_u32 vcc, -1, v3
    v_mfma_f32_16x16x32_bf16 v[148:151], a[128:131], v[100:103], 0
    v_mfma_f32_16x16x32_bf16 v[152:155], a[164:167], v[100:103], 0
    v_mfma_f32_16x16x32_bf16 v[156:159], a[132:135], v[100:103], 0
    v_mfma_f32_16x16x32_bf16 v[160:163], a[136:139], v[100:103], 0
    s_cbranch_vccnz L_fix_81
L_fixed_82:
    v_mfma_f32_16x16x32_bf16 v[164:167], a[168:171], v[100:103], 0
    v_mfma_f32_16x16x32_bf16 v[128:131], a[140:143], v[104:107], v[128:131]
    buffer_load_dwordx4 a[128:131], v1, s[8:11], s26 offen offset:3072 sc1
    v_mfma_f32_16x16x32_bf16 v[132:135], a[144:147], v[104:107], v[132:135]
    s_add_u32 s26, s24, 40960
    v_mfma_f32_16x16x32_bf16 v[136:139], a[172:175], v[104:107], v[136:139]
    buffer_load_dwordx4 a[164:167], v1, s[8:11], s26 offen offset:0 sc1
    v_mfma_f32_16x16x32_bf16 v[140:143], a[148:151], v[104:107], v[140:143]
    buffer_load_dwordx4 a[132:135], v1, s[8:11], s26 offen offset:1024 sc1
    v_mfma_f32_16x16x32_bf16 v[144:147], a[152:155], v[104:107], v[144:147]
    s_waitcnt vmcnt(4)
    v_max3_u32 v3, v112, v116, v120
    v_max3_u32 v3, v3, v124, v168
    v_max_u32 v3, v3, v172
    v_cmp_eq_u32 vcc, -1, v3
    v_mfma_f32_16x16x32_bf16 v[148:151], a[140:143], v[108:111], v[148:151]
    buffer_load_dwordx4 a[136:139], v1, s[8:11], s26 offen offset:2048 sc1
    v_mfma_f32_16x16x32_bf16 v[152:155], a[144:147], v[108:111], v[152:155]
    buffer_load_dwordx4 a[168:171], v1, s[8:11], s26 offen offset:3072 sc1
    v_mfma_f32_16x16x32_bf16 v[156:159], a[172:175], v[108:111], v[156:159]
    v_mfma_f32_16x16x32_bf16 v[160:163], a[148:151], v[108:111], v[160:163]
    s_cbranch_vccnz L_fix_85
L_fixed_86:
    v_mfma_f32_16x16x32_bf16 v[164:167], a[152:155], v[108:111], v[164:167]
    v_mfma_f32_16x16x32_bf16 v[128:131], a[188:191], v[112:115], v[128:131]
    s_add_u32 m0, s28, 93184
    s_add_u32 s49, s48, 29884416
    v_mfma_f32_16x16x32_bf16 v[128:131], a[180:183], v[120:123], v[128:131]
    buffer_load_dwordx4 v1, s[8:11], s49 offen offset:0 sc1 lds
    v_mfma_f32_16x16x32_bf16 v[128:131], a[244:247], v[168:171], v[128:131]
    s_add_u32 m0, s28, 93184
    v_mfma_f32_16x16x32_bf16 v[148:151], a[188:191], v[116:119], v[148:151]
    buffer_load_dwordx4 v1, s[8:11], s49 offen offset:1024 sc1 lds
    v_mfma_f32_16x16x32_bf16 v[148:151], a[180:183], v[124:127], v[148:151]
    s_add_u32 m0, s28, 99328
    v_mfma_f32_16x16x32_bf16 v[148:151], a[244:247], v[172:175], v[148:151]
    buffer_load_dwordx4 v1, s[8:11], s49 offen offset:2048 sc1 lds
    v_mfma_f32_16x16x32_bf16 v[132:135], a[240:243], v[112:115], v[132:135]
    s_add_u32 m0, s28, 99328
    v_mfma_f32_16x16x32_bf16 v[132:135], a[196:199], v[120:123], v[132:135]
    buffer_load_dwordx4 v1, s[8:11], s49 offen offset:3072 sc1 lds
    v_mfma_f32_16x16x32_bf16 v[132:135], a[184:187], v[168:171], v[132:135]
    ds_write_b128 v17, v[128:131] offset:0
    s_add_u32 m0, s28, 109568
    s_add_u32 s49, s48, 29888512
    v_mfma_f32_16x16x32_bf16 v[152:155], a[240:243], v[116:119], v[152:155]
    buffer_load_dwordx4 v1, s[8:11], s49 offen offset:0 sc1 lds
    v_mfma_f32_16x16x32_bf16 v[152:155], a[196:199], v[124:127], v[152:155]
    v_mfma_f32_16x16x32_bf16 v[152:155], a[184:187], v[172:175], v[152:155]
    ds_write_b128 v17, v[148:151] offset:256
    v_mfma_f32_16x16x32_bf16 v[136:139], a[176:179], v[112:115], v[136:139]
    v_mfma_f32_16x16x32_bf16 v[136:139], a[224:227], v[120:123], v[136:139]
    v_mfma_f32_16x16x32_bf16 v[136:139], a[220:223], v[168:171], v[136:139]
    ds_write_b128 v17, v[132:135] offset:2304
    v_mfma_f32_16x16x32_bf16 v[156:159], a[176:179], v[116:119], v[156:159]
    v_mfma_f32_16x16x32_bf16 v[156:159], a[224:227], v[124:127], v[156:159]
    v_mfma_f32_16x16x32_bf16 v[156:159], a[220:223], v[172:175], v[156:159]
    ds_write_b128 v17, v[152:155] offset:2560
    v_mfma_f32_16x16x32_bf16 v[140:143], a[192:195], v[112:115], v[140:143]
    v_mfma_f32_16x16x32_bf16 v[140:143], a[156:159], v[120:123], v[140:143]
    v_mfma_f32_16x16x32_bf16 v[140:143], a[208:211], v[168:171], v[140:143]
    ds_write_b128 v17, v[136:139] offset:4608
    v_mfma_f32_16x16x32_bf16 v[160:163], a[192:195], v[116:119], v[160:163]
    v_mfma_f32_16x16x32_bf16 v[160:163], a[156:159], v[124:127], v[160:163]
    v_mfma_f32_16x16x32_bf16 v[160:163], a[208:211], v[172:175], v[160:163]
    ds_write_b128 v17, v[156:159] offset:4864
    v_mfma_f32_16x16x32_bf16 v[144:147], a[204:207], v[112:115], v[144:147]
    v_mfma_f32_16x16x32_bf16 v[144:147], a[200:203], v[120:123], v[144:147]
    v_mfma_f32_16x16x32_bf16 v[144:147], a[228:231], v[168:171], v[144:147]
    ds_write_b128 v17, v[140:143] offset:6912
    v_mfma_f32_16x16x32_bf16 v[164:167], a[204:207], v[116:119], v[164:167]
    s_add_u32 m0, s28, 109568
    v_mfma_f32_16x16x32_bf16 v[164:167], a[200:203], v[124:127], v[164:167]
    buffer_load_dwordx4 v1, s[8:11], s49 offen offset:1024 sc1 lds
    v_mfma_f32_16x16x32_bf16 v[164:167], a[228:231], v[172:175], v[164:167]
    ds_write_b128 v17, v[160:163] offset:7168
    s_add_u32 m0, s28, 1024
    ds_write_b128 v17, v[144:147] offset:9216
    buffer_load_dwordx4 v1, s[8:11], s49 offen offset:2048 sc1 lds
    s_nop 3
    ds_write_b128 v17, v[164:167] offset:9472
    s_add_u32 m0, s28, 1024
    s_nop 0
    buffer_load_dwordx4 v1, s[8:11], s49 offen offset:3072 sc1 lds
    buffer_load_dword v27, v25, s[8:11], s38 offen sc1
    s_add_u32 s26, s24, 45056
    buffer_load_dwordx4 a[140:143], v1, s[8:11], s26 offen offset:0 sc1
    s_waitcnt lgkmcnt(0)
    s_barrier
    ds_read_b128 v[128:131], v18 offset:0
    buffer_load_dwordx4 a[144:147], v1, s[8:11], s26 offen offset:1024 sc1
    ds_read_b128 v[132:135], v18 offset:576
    ds_read_b128 v[136:139], v18 offset:11520
    ds_read_b128 v[140:143], v18 offset:12096
    ds_read_b128 v[144:147], v18 offset:23040
    ds_read_b128 v[148:151], v18 offset:23616
    ds_read_b128 v[152:155], v18 offset:34560
    ds_read_b128 v[156:159], v18 offset:35136
    s_waitcnt lgkmcnt(4)
    v_pk_add_f32 v[128:129], v[128:129], v[136:137]
    v_pk_add_f32 v[130:131], v[130:131], v[138:139]
    v_pk_add_f32 v[132:133], v[132:133], v[140:141]
    v_pk_add_f32 v[134:135], v[134:135], v[142:143]
    ds_read_b128 v[160:163], v18 offset:9216
    ds_read_b128 v[164:167], v18 offset:9792
    ds_read_b128 v[176:179], v18 offset:20736
    ds_read_b128 v[180:183], v18 offset:21312
    v_lshlrev_b32 v136, 16, v72
    v_and_b32 v137, 0xffff0000, v72
    v_lshlrev_b32 v138, 16, v73
    v_and_b32 v139, 0xffff0000, v73
    v_lshlrev_b32 v140, 16, v74
    v_and_b32 v141, 0xffff0000, v74
    v_lshlrev_b32 v142, 16, v75
    v_and_b32 v143, 0xffff0000, v75
    s_waitcnt lgkmcnt(4)
    v_pk_add_f32 v[128:129], v[128:129], v[136:137]
    v_pk_add_f32 v[130:131], v[130:131], v[138:139]
    v_pk_add_f32 v[132:133], v[132:133], v[140:141]
    v_pk_add_f32 v[134:135], v[134:135], v[142:143]
    ds_read_b128 v[184:187], v18 offset:32256
    ds_read_b128 v[188:191], v18 offset:32832
    ds_read_b128 v[192:195], v18 offset:43776
    ds_read_b128 v[196:199], v18 offset:44352
    v_pk_add_f32 v[144:145], v[144:145], v[152:153]
    v_pk_add_f32 v[146:147], v[146:147], v[154:155]
    v_pk_add_f32 v[148:149], v[148:149], v[156:157]
    v_pk_add_f32 v[150:151], v[150:151], v[158:159]
    v_pk_add_f32 v[128:129], v[128:129], v[144:145]
    v_pk_add_f32 v[130:131], v[130:131], v[146:147]
    v_pk_add_f32 v[132:133], v[132:133], v[148:149]
    v_pk_add_f32 v[134:135], v[134:135], v[150:151]
    v_cvt_pk_bf16_f32 v72, v128, v129
    v_cvt_pk_bf16_f32 v73, v130, v131
    v_cvt_pk_bf16_f32 v74, v132, v133
    v_cvt_pk_bf16_f32 v75, v134, v135
    s_add_u32 s56, s35, 29966336
    buffer_store_dwordx4 v[72:75], v8, s[8:11], s56 offen offset:0 sc1
    s_waitcnt lgkmcnt(4)
    v_pk_add_f32 v[160:161], v[160:161], v[176:177]
    v_pk_add_f32 v[162:163], v[162:163], v[178:179]
    v_pk_add_f32 v[164:165], v[164:165], v[180:181]
    v_pk_add_f32 v[166:167], v[166:167], v[182:183]
    v_lshlrev_b32 v176, 16, v76
    v_and_b32 v177, 0xffff0000, v76
    v_lshlrev_b32 v178, 16, v77
    v_and_b32 v179, 0xffff0000, v77
    v_lshlrev_b32 v180, 16, v78
    v_and_b32 v181, 0xffff0000, v78
    v_lshlrev_b32 v182, 16, v79
    v_and_b32 v183, 0xffff0000, v79
    s_waitcnt lgkmcnt(0)
    v_pk_add_f32 v[160:161], v[160:161], v[176:177]
    v_pk_add_f32 v[162:163], v[162:163], v[178:179]
    v_pk_add_f32 v[164:165], v[164:165], v[180:181]
    buffer_load_dwordx4 a[172:175], v1, s[8:11], s26 offen offset:2048 sc1
    v_pk_add_f32 v[166:167], v[166:167], v[182:183]
    v_pk_add_f32 v[184:185], v[184:185], v[192:193]
    v_pk_add_f32 v[186:187], v[186:187], v[194:195]
    v_pk_add_f32 v[188:189], v[188:189], v[196:197]
    v_pk_add_f32 v[190:191], v[190:191], v[198:199]
    v_pk_add_f32 v[160:161], v[160:161], v[184:185]
    v_pk_add_f32 v[162:163], v[162:163], v[186:187]
    buffer_load_dwordx4 a[148:151], v1, s[8:11], s26 offen offset:3072 sc1
    v_pk_add_f32 v[164:165], v[164:165], v[188:189]
    v_pk_add_f32 v[166:167], v[166:167], v[190:191]
    v_cvt_pk_bf16_f32 v76, v160, v161
    v_cvt_pk_bf16_f32 v77, v162, v163
    v_cvt_pk_bf16_f32 v78, v164, v165
    v_cvt_pk_bf16_f32 v79, v166, v167
    buffer_store_dwordx4 v[76:79], v12, s[8:11], s56 offen offset:2048 sc1
    s_add_u32 s26, s24, 49152
    buffer_load_dwordx4 a[152:155], v1, s[8:11], s26 offen offset:0 sc1
    v_pk_add_f32 v[136:137], v[128:129], v[130:131]
    v_pk_mul_f32 v[140:141], v[128:129], v[128:129]
    v_pk_add_f32 v[138:139], v[160:161], v[162:163]
    v_pk_mul_f32 v[142:143], v[160:161], v[160:161]
    v_pk_fma_f32 v[140:141], v[130:131], v[130:131], v[140:141] op_sel:[0,0,0] op_sel_hi:[1,1,1]
    v_pk_fma_f32 v[142:143], v[162:163], v[162:163], v[142:143] op_sel:[0,0,0] op_sel_hi:[1,1,1]
    v_pk_add_f32 v[136:137], v[136:137], v[132:133]
    buffer_load_dwordx4 a[188:191], v1, s[8:11], s26 offen offset:1024 sc1
    v_pk_fma_f32 v[140:141], v[132:133], v[132:133], v[140:141] op_sel:[0,0,0] op_sel_hi:[1,1,1]
    v_pk_add_f32 v[138:139], v[138:139], v[164:165]
    v_pk_fma_f32 v[142:143], v[164:165], v[164:165], v[142:143] op_sel:[0,0,0] op_sel_hi:[1,1,1]
    v_pk_add_f32 v[136:137], v[136:137], v[134:135]
    v_pk_fma_f32 v[140:141], v[134:135], v[134:135], v[140:141] op_sel:[0,0,0] op_sel_hi:[1,1,1]
    v_pk_add_f32 v[138:139], v[138:139], v[166:167]
    v_pk_fma_f32 v[142:143], v[166:167], v[166:167], v[142:143] op_sel:[0,0,0] op_sel_hi:[1,1,1]
    v_add_f32 v136, v136, v137
    v_add_f32 v138, v138, v139
    v_add_f32 v137, v140, v141
    v_add_f32 v139, v142, v143
    v_cndmask_b32 v138, 0, v138, s[46:47]
    v_cndmask_b32 v139, 0, v139, s[46:47]
    v_pk_add_f32 v[136:137], v[136:137], v[138:139]
    s_nop 1
    v_add_f32_dpp v136, v136, v136 row_ror:8 row_mask:0xf bank_mask:0xf
    v_add_f32_dpp v137, v137, v137 row_ror:8 row_mask:0xf bank_mask:0xf
    v_mov_b32 v138, v136
    v_mov_b32 v139, v137
    s_nop 0
    v_permlane16_swap_b32 v136, v138
    v_permlane16_swap_b32 v137, v139
    v_pk_add_f32 v[136:137], v[136:137], v[138:139]
    v_mov_b32 v138, v136
    v_mov_b32 v139, v137
    s_nop 0
    v_permlane32_swap_b32 v136, v138
    v_permlane32_swap_b32 v137, v139
    v_pk_add_f32 v[136:137], v[136:137], v[138:139]
    s_add_u32 s56, s36, 35524608
    buffer_store_dwordx2 v[136:137], v20, s[8:11], s56 offen sc1
    s_waitcnt vmcnt(9)
    v_cmp_le_u32 vcc, 13, v27
    s_nop 3
    s_cmp_eq_u64 vcc, -1
    s_cbranch_scc1 L_pdone_90
    s_mov_b32 s68, 0x80000
L_poll_89:
    buffer_load_dword v27, v25, s[8:11], s38 offen sc1
    s_waitcnt vmcnt(0)
    v_cmp_le_u32 vcc, 13, v27
    s_nop 3
    s_cmp_eq_u64 vcc, -1
    s_cbranch_scc1 L_pdone_90
    s_sub_u32 s68, s68, 1
    s_cmp_lg_u32 s68, 0
    s_cbranch_scc1 L_poll_89
L_pdone_90:
    ds_read_b32 v96, v95 offset:27648
    s_add_u32 m0, s28, 11264
    s_add_u32 s49, s48, 29892608
    buffer_load_dwordx4 v1, s[8:11], s49 offen offset:0 sc1 lds
    ds_read_b32 v97, v95 offset:28672
    s_add_u32 m0, s28, 11264
    s_nop 0
    buffer_load_dwordx4 v1, s[8:11], s49 offen offset:1024 sc1 lds
    ds_read_b32 v98, v95 offset:35840
    s_add_u32 m0, s28, 17408
    s_nop 0
    buffer_load_dwordx4 v1, s[8:11], s49 offen offset:2048 sc1 lds
    ds_read_b32 v99, v95 offset:36864
    s_add_u32 m0, s28, 17408
    s_nop 0
    buffer_load_dwordx4 v1, s[8:11], s49 offen offset:3072 sc1 lds
    ds_read_b32 v100, v95 offset:44032
    s_add_u32 m0, s28, 27648
    s_add_u32 s49, s48, 29896704
    buffer_load_dwordx4 v1, s[8:11], s49 offen offset:0 sc1 lds
    ds_read_b32 v101, v95 offset:45056
    ds_read_b32 v102, v94 offset:3072
    s_add_u32 m0, s28, 27648
    s_nop 0
    buffer_load_dwordx4 v1, s[8:11], s49 offen offset:1024 sc1 lds
    ds_read_b32 v103, v94 offset:4096
    s_waitcnt lgkmcnt(0)
    v_max3_u32 v3, v96, v97, v98
    v_max3_u32 v3, v3, v99, v100
    v_max3_u32 v3, v3, v101, v102
    v_max_u32 v3, v3, v103
    v_cmp_eq_u32 vcc, -1, v3
    s_nop 3
    s_cbranch_vccnz L_fix_91
L_fixed_92:
    s_barrier
    ds_read_b128 v[96:99], v2 offset:27648
    s_add_u32 s53, s36, 35520512
    buffer_load_dwordx2 v[200:201], v0, s[8:11], s53 offen offset:0 sc1
    ds_read_b128 v[100:103], v2 offset:29696
    buffer_load_dwordx2 v[202:203], v0, s[8:11], s53 offen offset:512 sc1
    ds_read_b128 v[104:107], v2 offset:31744
    ds_read_b128 v[108:111], v2 offset:33792
    s_waitcnt lgkmcnt(2)
    v_mfma_f32_16x16x32_bf16 v[128:131], a[248:251], v[96:99], 0
    ds_read_b128 v[112:115], v2 offset:28672
    v_mfma_f32_16x16x32_bf16 v[140:143], a[248:251], v[100:103], 0
    ds_read_b128 v[116:119], v2 offset:30720
    v_mfma_f32_16x16x32_bf16 v[132:135], a[212:215], v[96:99], 0
    ds_read_b128 v[120:123], v2 offset:32768
    v_mfma_f32_16x16x32_bf16 v[144:147], a[212:215], v[100:103], 0
    ds_read_b128 v[124:127], v2 offset:34816
    v_mfma_f32_16x16x32_bf16 v[136:139], a[232:235], v[96:99], 0
    buffer_load_dwordx2 v[204:205], v0, s[8:11], s53 offen offset:1024 sc1
    v_mfma_f32_16x16x32_bf16 v[148:151], a[232:235], v[100:103], 0
    s_waitcnt lgkmcnt(4)
    v_mfma_f32_16x16x32_bf16 v[160:163], a[232:235], v[104:107], 0
    buffer_load_dwordx2 v[206:207], v0, s[8:11], s53 offen offset:1536 sc1
    v_mfma_f32_16x16x32_bf16 v[172:175], a[232:235], v[108:111], 0
    buffer_load_dwordx2 v[208:209], v0, s[8:11], s53 offen offset:2048 sc1
    v_mfma_f32_16x16x32_bf16 v[156:159], a[212:215], v[104:107], 0
    v_mfma_f32_16x16x32_bf16 v[168:171], a[212:215], v[108:111], 0
    v_mfma_f32_16x16x32_bf16 v[152:155], a[248:251], v[104:107], 0
    v_mfma_f32_16x16x32_bf16 v[164:167], a[248:251], v[108:111], 0
    s_waitcnt lgkmcnt(2)
    v_mfma_f32_16x16x32_bf16 v[128:131], a[252:255], v[112:115], v[128:131]
    ds_read_b128 v[96:99], v2 offset:35840
    v_mfma_f32_16x16x32_bf16 v[140:143], a[252:255], v[116:119], v[140:143]
    ds_read_b128 v[100:103], v2 offset:37888
    v_mfma_f32_16x16x32_bf16 v[132:135], a[216:219], v[112:115], v[132:135]
    ds_read_b128 v[104:107], v2 offset:39936
    v_mfma_f32_16x16x32_bf16 v[144:147], a[216:219], v[116:119], v[144:147]
    ds_read_b128 v[108:111], v2 offset:41984
    v_mfma_f32_16x16x32_bf16 v[136:139], a[236:239], v[112:115], v[136:139]
    v_mfma_f32_16x16x32_bf16 v[148:151], a[236:239], v[116:119], v[148:151]
    s_waitcnt lgkmcnt(4)
    v_mfma_f32_16x16x32_bf16 v[160:163], a[236:239], v[120:123], v[160:163]
    v_mfma_f32_16x16x32_bf16 v[172:175], a[236:239], v[124:127], v[172:175]
    v_mfma_f32_16x16x32_bf16 v[156:159], a[216:219], v[120:123], v[156:159]
    v_mfma_f32_16x16x32_bf16 v[168:171], a[216:219], v[124:127], v[168:171]
    v_mfma_f32_16x16x32_bf16 v[152:155], a[252:255], v[120:123], v[152:155]
    v_mfma_f32_16x16x32_bf16 v[164:167], a[252:255], v[124:127], v[164:167]
    s_waitcnt lgkmcnt(2)
    v_mfma_f32_16x16x32_bf16 v[128:131], a[0:3], v[96:99], v[128:131]
    ds_read_b128 v[112:115], v2 offset:36864
    v_mfma_f32_16x16x32_bf16 v[140:143], a[0:3], v[100:103], v[140:143]
    ds_read_b128 v[116:119], v2 offset:38912
    v_mfma_f32_16x16x32_bf16 v[132:135], a[4:7], v[96:99], v[132:135]
    ds_read_b128 v[120:123], v2 offset:40960
    v_mfma_f32_16x16x32_bf16 v[144:147], a[4:7], v[100:103], v[144:147]
    ds_read_b128 v[124:127], v2 offset:43008
    v_mfma_f32_16x16x32_bf16 v[136:139], a[8:11], v[96:99], v[136:139]
    buffer_load_dwordx2 v[210:211], v0, s[8:11], s53 offen offset:2560 sc1
    v_mfma_f32_16x16x32_bf16 v[148:151], a[8:11], v[100:103], v[148:151]
    s_waitcnt lgkmcnt(4)
    v_mfma_f32_16x16x32_bf16 v[160:163], a[8:11], v[104:107], v[160:163]
    buffer_load_dwordx2 v[212:213], v0, s[8:11], s53 offen offset:3072 sc1
    v_mfma_f32_16x16x32_bf16 v[172:175], a[8:11], v[108:111], v[172:175]
    v_mfma_f32_16x16x32_bf16 v[156:159], a[4:7], v[104:107], v[156:159]
    v_mfma_f32_16x16x32_bf16 v[168:171], a[4:7], v[108:111], v[168:171]
    v_mfma_f32_16x16x32_bf16 v[152:155], a[0:3], v[104:107], v[152:155]
    v_mfma_f32_16x16x32_bf16 v[164:167], a[0:3], v[108:111], v[164:167]
    s_waitcnt lgkmcnt(2)
    v_mfma_f32_16x16x32_bf16 v[128:131], a[12:15], v[112:115], v[128:131]
    ds_read_b128 v[96:99], v2 offset:44032
    v_mfma_f32_16x16x32_bf16 v[140:143], a[12:15], v[116:119], v[140:143]
    ds_read_b128 v[100:103], v2 offset:46080
    v_mfma_f32_16x16x32_bf16 v[132:135], a[60:63], v[112:115], v[132:135]
    ds_read_b128 v[104:107], v2 offset:48128
    v_mfma_f32_16x16x32_bf16 v[144:147], a[60:63], v[116:119], v[144:147]
    ds_read_b128 v[108:111], v2 offset:50176
    v_mfma_f32_16x16x32_bf16 v[136:139], a[64:67], v[112:115], v[136:139]
    buffer_load_dwordx2 v[214:215], v0, s[8:11], s53 offen offset:3584 sc1
    v_mfma_f32_16x16x32_bf16 v[148:151], a[64:67], v[116:119], v[148:151]
    s_add_u32 m0, s28, 33792
    s_waitcnt lgkmcnt(4)
    v_mfma_f32_16x16x32_bf16 v[160:163], a[64:67], v[120:123], v[160:163]
    buffer_load_dwordx4 v1, s[8:11], s49 offen offset:2048 sc1 lds
    v_mfma_f32_16x16x32_bf16 v[172:175], a[64:67], v[124:127], v[172:175]
    s_add_u32 m0, s28, 33792
    v_mfma_f32_16x16x32_bf16 v[156:159], a[60:63], v[120:123], v[156:159]
    buffer_load_dwordx4 v1, s[8:11], s49 offen offset:3072 sc1 lds
    v_mfma_f32_16x16x32_bf16 v[168:171], a[60:63], v[124:127], v[168:171]
    s_add_u32 m0, s28, 44032
    s_add_u32 s49, s48, 29900800
    v_mfma_f32_16x16x32_bf16 v[152:155], a[12:15], v[120:123], v[152:155]
    buffer_load_dwordx4 v1, s[8:11], s49 offen offset:0 sc1 lds
    v_mfma_f32_16x16x32_bf16 v[164:167], a[12:15], v[124:127], v[164:167]
    s_add_u32 m0, s28, 44032
    s_waitcnt lgkmcnt(2)
    v_mfma_f32_16x16x32_bf16 v[128:131], a[108:111], v[96:99], v[128:131]
    ds_read_b128 v[112:115], v2 offset:45056
    v_mfma_f32_16x16x32_bf16 v[140:143], a[108:111], v[100:103], v[140:143]
    ds_read_b128 v[116:119], v2 offset:47104
    v_mfma_f32_16x16x32_bf16 v[132:135], a[120:123], v[96:99], v[132:135]
    ds_read_b128 v[120:123], v2 offset:49152
    v_mfma_f32_16x16x32_bf16 v[144:147], a[120:123], v[100:103], v[144:147]
    ds_read_b128 v[124:127], v2 offset:51200
    v_mfma_f32_16x16x32_bf16 v[136:139], a[16:19], v[96:99], v[136:139]
    buffer_load_dwordx4 v1, s[8:11], s49 offen offset:1024 sc1 lds
    v_mfma_f32_16x16x32_bf16 v[148:151], a[16:19], v[100:103], v[148:151]
    s_add_u32 m0, s28, 50176
    s_waitcnt lgkmcnt(4)
    v_mfma_f32_16x16x32_bf16 v[160:163], a[16:19], v[104:107], v[160:163]
    buffer_load_dwordx4 v1, s[8:11], s49 offen offset:2048 sc1 lds
    v_mfma_f32_16x16x32_bf16 v[172:175], a[16:19], v[108:111], v[172:175]
    s_add_u32 m0, s28, 50176
    v_mfma_f32_16x16x32_bf16 v[156:159], a[120:123], v[104:107], v[156:159]
    buffer_load_dwordx4 v1, s[8:11], s49 offen offset:3072 sc1 lds
    v_mfma_f32_16x16x32_bf16 v[168:171], a[120:123], v[108:111], v[168:171]
    buffer_load_dwordx4 a[180:183], v1, s[8:11], s26 offen offset:2048 sc1
    v_mfma_f32_16x16x32_bf16 v[152:155], a[108:111], v[104:107], v[152:155]
    buffer_load_dwordx4 a[244:247], v1, s[8:11], s26 offen offset:3072 sc1
    v_mfma_f32_16x16x32_bf16 v[164:167], a[108:111], v[108:111], v[164:167]
    s_add_u32 s26, s24, 53248
    s_waitcnt lgkmcnt(2)
    v_mfma_f32_16x16x32_bf16 v[128:131], a[20:23], v[112:115], v[128:131]
    ds_read_b128 v[96:99], v1 offset:3072
    v_mfma_f32_16x16x32_bf16 v[140:143], a[20:23], v[116:119], v[140:143]
    ds_read_b128 v[100:103], v1 offset:5120
    v_mfma_f32_16x16x32_bf16 v[132:135], a[24:27], v[112:115], v[132:135]
    ds_read_b128 v[104:107], v1 offset:7168
    v_mfma_f32_16x16x32_bf16 v[144:147], a[24:27], v[116:119], v[144:147]
    ds_read_b128 v[108:111], v1 offset:9216
    v_mfma_f32_16x16x32_bf16 v[136:139], a[28:31], v[112:115], v[136:139]
    buffer_load_dwordx4 a[240:243], v1, s[8:11], s26 offen offset:0 sc1
    v_mfma_f32_16x16x32_bf16 v[148:151], a[28:31], v[116:119], v[148:151]
    s_waitcnt lgkmcnt(4)
    v_mfma_f32_16x16x32_bf16 v[160:163], a[28:31], v[120:123], v[160:163]
    v_mfma_f32_16x16x32_bf16 v[172:175], a[28:31], v[124:127], v[172:175]
    v_mfma_f32_16x16x32_bf16 v[156:159], a[24:27], v[120:123], v[156:159]
    v_mfma_f32_16x16x32_bf16 v[168:171], a[24:27], v[124:127], v[168:171]
    v_mfma_f32_16x16x32_bf16 v[152:155], a[20:23], v[120:123], v[152:155]
    v_mfma_f32_16x16x32_bf16 v[164:167], a[20:23], v[124:127], v[164:167]
    s_waitcnt lgkmcnt(2)
    v_mfma_f32_16x16x32_bf16 v[128:131], a[32:35], v[96:99], v[128:131]
    ds_read_b128 v[112:115], v1 offset:4096
    v_mfma_f32_16x16x32_bf16 v[140:143], a[32:35], v[100:103], v[140:143]
    ds_read_b128 v[116:119], v1 offset:6144
    v_mfma_f32_16x16x32_bf16 v[132:135], a[36:39], v[96:99], v[132:135]
    ds_read_b128 v[120:123], v1 offset:8192
    v_mfma_f32_16x16x32_bf16 v[144:147], a[36:39], v[100:103], v[144:147]
    ds_read_b128 v[124:127], v1 offset:10240
    v_mfma_f32_16x16x32_bf16 v[136:139], a[40:43], v[96:99], v[136:139]
    v_mfma_f32_16x16x32_bf16 v[148:151], a[40:43], v[100:103], v[148:151]
    s_waitcnt lgkmcnt(4)
    v_mfma_f32_16x16x32_bf16 v[160:163], a[40:43], v[104:107], v[160:163]
    buffer_load_dwordx4 a[196:199], v1, s[8:11], s26 offen offset:1024 sc1
    v_mfma_f32_16x16x32_bf16 v[172:175], a[40:43], v[108:111], v[172:175]
    v_mfma_f32_16x16x32_bf16 v[156:159], a[36:39], v[104:107], v[156:159]
    v_mfma_f32_16x16x32_bf16 v[168:171], a[36:39], v[108:111], v[168:171]
    v_mfma_f32_16x16x32_bf16 v[152:155], a[32:35], v[104:107], v[152:155]
    v_mfma_f32_16x16x32_bf16 v[164:167], a[32:35], v[108:111], v[164:167]
    s_waitcnt vmcnt(18)
    s_waitcnt lgkmcnt(0)
    s_barrier
    v_mov_b32 v199, 14
    buffer_store_dword v199, v26, s[8:11], s37 offen sc1
    v_mfma_f32_16x16x32_bf16 v[128:131], a[44:47], v[112:115], v[128:131]
    ds_read_b128 v[96:99], v1 offset:11264
    v_mfma_f32_16x16x32_bf16 v[140:143], a[44:47], v[116:119], v[140:143]
    ds_read_b128 v[100:103], v1 offset:13312
    v_mfma_f32_16x16x32_bf16 v[132:135], a[48:51], v[112:115], v[132:135]
    ds_read_b128 v[104:107], v1 offset:15360
    v_mfma_f32_16x16x32_bf16 v[144:147], a[48:51], v[116:119], v[144:147]
    ds_read_b128 v[108:111], v1 offset:17408
    v_mfma_f32_16x16x32_bf16 v[136:139], a[56:59], v[112:115], v[136:139]
    v_mfma_f32_16x16x32_bf16 v[148:151], a[56:59], v[116:119], v[148:151]
    v_mfma_f32_16x16x32_bf16 v[160:163], a[56:59], v[120:123], v[160:163]
    buffer_load_dwordx4 a[184:187], v1, s[8:11], s26 offen offset:2048 sc1
    v_mfma_f32_16x16x32_bf16 v[172:175], a[56:59], v[124:127], v[172:175]
    buffer_load_dwordx4 a[176:179], v1, s[8:11], s26 offen offset:3072 sc1
    v_mfma_f32_16x16x32_bf16 v[156:159], a[48:51], v[120:123], v[156:159]
    v_mfma_f32_16x16x32_bf16 v[168:171], a[48:51], v[124:127], v[168:171]
    s_add_u32 s26, s24, 57344
    v_mfma_f32_16x16x32_bf16 v[152:155], a[44:47], v[120:123], v[152:155]
    buffer_load_dwordx4 a[224:227], v1, s[8:11], s26 offen offset:0 sc1
    v_mfma_f32_16x16x32_bf16 v[164:167], a[44:47], v[124:127], v[164:167]
    s_waitcnt vmcnt(14)
    s_waitcnt lgkmcnt(2)
    v_mfma_f32_16x16x32_bf16 v[128:131], a[72:75], v[96:99], v[128:131]
    ds_read_b128 v[112:115], v1 offset:12288
    v_add_f32 v200, v200, v208
    v_mfma_f32_16x16x32_bf16 v[140:143], a[72:75], v[100:103], v[140:143]
    ds_read_b128 v[116:119], v1 offset:14336
    v_add_f32 v201, v201, v209
    v_mfma_f32_16x16x32_bf16 v[132:135], a[76:79], v[96:99], v[132:135]
    ds_read_b128 v[120:123], v1 offset:16384
    v_add_f32 v202, v202, v210
    v_mfma_f32_16x16x32_bf16 v[144:147], a[76:79], v[100:103], v[144:147]
    ds_read_b128 v[124:127], v1 offset:18432
    v_add_f32 v203, v203, v211
    v_mfma_f32_16x16x32_bf16 v[136:139], a[80:83], v[96:99], v[136:139]
    buffer_load_dwordx4 a[220:223], v1, s[8:11], s26 offen offset:1024 sc1
    v_mfma_f32_16x16x32_bf16 v[148:151], a[80:83], v[100:103], v[148:151]
    v_add_f32 v204, v204, v212
    s_waitcnt lgkmcnt(4)
    v_mfma_f32_16x16x32_bf16 v[160:163], a[80:83], v[104:107], v[160:163]
    buffer_load_dwordx4 a[192:195], v1, s[8:11], s26 offen offset:2048 sc1
    v_mfma_f32_16x16x32_bf16 v[172:175], a[80:83], v[108:111], v[172:175]
    buffer_load_dwordx4 a[156:159], v1, s[8:11], s26 offen offset:3072 sc1
    v_mfma_f32_16x16x32_bf16 v[156:159], a[76:79], v[104:107], v[156:159]
    s_add_u32 s26, s25, 0
    v_add_f32 v205, v205, v213
    v_mfma_f32_16x16x32_bf16 v[168:171], a[76:79], v[108:111], v[168:171]
    buffer_load_dwordx4 a[208:211], v1, s[8:11], s26 offen offset:0 sc1
    v_mfma_f32_16x16x32_bf16 v[152:155], a[72:75], v[104:107], v[152:155]
    buffer_load_dwordx4 a[204:207], v1, s[8:11], s26 offen offset:1024 sc1
    v_mfma_f32_16x16x32_bf16 v[164:167], a[72:75], v[108:111], v[164:167]
    v_add_f32 v206, v206, v214
    s_waitcnt lgkmcnt(2)
    v_mfma_f32_16x16x32_bf16 v[128:131], a[96:99], v[112:115], v[128:131]
    ds_read_b128 v[96:99], v1 offset:19456
    v_add_f32 v207, v207, v215
    v_mfma_f32_16x16x32_bf16 v[140:143], a[96:99], v[116:119], v[140:143]
    ds_read_b128 v[100:103], v1 offset:21504
    v_add_f32 v200, v200, v204
    v_mfma_f32_16x16x32_bf16 v[132:135], a[100:103], v[112:115], v[132:135]
    ds_read_b128 v[104:107], v1 offset:23552
    v_add_f32 v201, v201, v205
    v_mfma_f32_16x16x32_bf16 v[144:147], a[100:103], v[116:119], v[144:147]
    ds_read_b128 v[108:111], v1 offset:25600
    v_add_f32 v202, v202, v206
    v_mfma_f32_16x16x32_bf16 v[136:139], a[52:55], v[112:115], v[136:139]
    buffer_load_dwordx4 a[200:203], v1, s[8:11], s26 offen offset:2048 sc1
    v_mfma_f32_16x16x32_bf16 v[148:151], a[52:55], v[116:119], v[148:151]
    v_add_f32 v203, v203, v207
    s_waitcnt lgkmcnt(4)
    v_mfma_f32_16x16x32_bf16 v[160:163], a[52:55], v[120:123], v[160:163]
    v_add_f32 v200, v200, v202
    v_add_f32 v201, v201, v203
    v_mfma_f32_16x16x32_bf16 v[172:175], a[52:55], v[124:127], v[172:175]
    buffer_load_dwordx4 a[228:231], v1, s[8:11], s26 offen offset:3072 sc1
    v_mfma_f32_16x16x32_bf16 v[156:159], a[100:103], v[120:123], v[156:159]
    v_mul_f32 v80, s64, v200
    v_mul_f32 v201, s64, v201
    v_mfma_f32_16x16x32_bf16 v[168:171], a[100:103], v[124:127], v[168:171]
    v_fma_f32 v201, -v80, v80, v201
    v_max_f32 v201, 0, v201
    v_mfma_f32_16x16x32_bf16 v[152:155], a[96:99], v[120:123], v[152:155]
    v_add_f32 v201, s65, v201
    v_mfma_f32_16x16x32_bf16 v[164:167], a[96:99], v[124:127], v[164:167]
    s_waitcnt lgkmcnt(2)
    v_mfma_f32_16x16x32_bf16 v[128:131], a[68:71], v[96:99], v[128:131]
    ds_read_b128 v[112:115], v1 offset:20480
    v_mfma_f32_16x16x32_bf16 v[140:143], a[68:71], v[100:103], v[140:143]
    ds_read_b128 v[116:119], v1 offset:22528
    v_mfma_f32_16x16x32_bf16 v[132:135], a[84:87], v[96:99], v[132:135]
    ds_read_b128 v[120:123], v1 offset:24576
    v_mfma_f32_16x16x32_bf16 v[144:147], a[84:87], v[100:103], v[144:147]
    ds_read_b128 v[124:127], v1 offset:26624
    v_mfma_f32_16x16x32_bf16 v[136:139], a[88:91], v[96:99], v[136:139]
    v_rsq_f32 v84, v201
    v_mfma_f32_16x16x32_bf16 v[148:151], a[88:91], v[100:103], v[148:151]
    v_mul_f32 v88, v201, v84
    s_waitcnt lgkmcnt(4)
    v_mfma_f32_16x16x32_bf16 v[160:163], a[88:91], v[104:107], v[160:163]
    v_mul_f32 v84, s66, v84
    v_mov_b32 v82, v80
    v_mfma_f32_16x16x32_bf16 v[172:175], a[88:91], v[108:111], v[172:175]
    v_mov_b32 v86, v84
    v_mov_b32 v90, v88
    v_mfma_f32_16x16x32_bf16 v[156:159], a[84:87], v[104:107], v[156:159]
    s_add_u32 m0, s28, 117760
    s_add_u32 s26, s25, 4096
    v_mfma_f32_16x16x32_bf16 v[168:171], a[84:87], v[108:111], v[168:171]
    buffer_load_dwordx4 v1, s[8:11], s26 offen offset:0 sc1 lds
    v_mfma_f32_16x16x32_bf16 v[152:155], a[68:71], v[104:107], v[152:155]
    s_add_u32 m0, s28, 117760
    v_mfma_f32_16x16x32_bf16 v[164:167], a[68:71], v[108:111], v[164:167]
    s_waitcnt lgkmcnt(2)
    v_mfma_f32_16x16x32_bf16 v[128:131], a[92:95], v[112:115], v[128:131]
    ds_read_b128 v[96:99], v1 offset:27648
    v_mfma_f32_16x16x32_bf16 v[140:143], a[92:95], v[116:119], v[140:143]
    ds_read_b128 v[100:103], v1 offset:29696
    v_mfma_f32_16x16x32_bf16 v[132:135], a[104:107], v[112:115], v[132:135]
    ds_read_b128 v[104:107], v1 offset:31744
    v_mfma_f32_16x16x32_bf16 v[144:147], a[104:107], v[116:119], v[144:147]
    ds_read_b128 v[108:111], v1 offset:33792
    v_mfma_f32_16x16x32_bf16 v[136:139], a[112:115], v[112:115], v[136:139]
    buffer_load_dwordx4 v1, s[8:11], s26 offen offset:1024 sc1 lds
    v_mfma_f32_16x16x32_bf16 v[148:151], a[112:115], v[116:119], v[148:151]
    s_add_u32 m0, s28, 123904
    s_waitcnt lgkmcnt(4)
    v_mfma_f32_16x16x32_bf16 v[160:163], a[112:115], v[120:123], v[160:163]
    buffer_load_dwordx4 v1, s[8:11], s26 offen offset:2048 sc1 lds
    v_mfma_f32_16x16x32_bf16 v[172:175], a[112:115], v[124:127], v[172:175]
    s_add_u32 m0, s28, 123904
    v_mfma_f32_16x16x32_bf16 v[156:159], a[104:107], v[120:123], v[156:159]
    buffer_load_dwordx4 v1, s[8:11], s26 offen offset:3072 sc1 lds
    v_mfma_f32_16x16x32_bf16 v[168:171], a[104:107], v[124:127], v[168:171]
    s_add_u32 m0, s28, 134144
    s_add_u32 s26, s25, 8192
    v_mfma_f32_16x16x32_bf16 v[152:155], a[92:95], v[120:123], v[152:155]
    buffer_load_dwordx4 v1, s[8:11], s26 offen offset:0 sc1 lds
    v_mfma_f32_16x16x32_bf16 v[164:167], a[92:95], v[124:127], v[164:167]
    s_add_u32 m0, s28, 134144
    buffer_load_dword v27, v25, s[8:11], s38 offen sc1
    buffer_load_dwordx4 v1, s[8:11], s26 offen offset:1024 sc1 lds
    s_waitcnt lgkmcnt(2)
    v_mfma_f32_16x16x32_bf16 v[128:131], a[116:119], v[96:99], v[128:131]
    ds_read_b128 v[112:115], v1 offset:28672
    s_add_u32 m0, s28, 140288
    v_mfma_f32_16x16x32_bf16 v[140:143], a[116:119], v[100:103], v[140:143]
    ds_read_b128 v[116:119], v1 offset:30720
    v_mfma_f32_16x16x32_bf16 v[132:135], a[160:163], v[96:99], v[132:135]
    ds_read_b128 v[120:123], v1 offset:32768
    v_mfma_f32_16x16x32_bf16 v[144:147], a[160:163], v[100:103], v[144:147]
    ds_read_b128 v[124:127], v1 offset:34816
    v_mfma_f32_16x16x32_bf16 v[136:139], a[124:127], v[96:99], v[136:139]
    buffer_load_dwordx4 v1, s[8:11], s26 offen offset:2048 sc1 lds
    v_mfma_f32_16x16x32_bf16 v[148:151], a[124:127], v[100:103], v[148:151]
    s_add_u32 m0, s28, 140288
    s_waitcnt lgkmcnt(4)
    v_mfma_f32_16x16x32_bf16 v[160:163], a[124:127], v[104:107], v[160:163]
    buffer_load_dwordx4 v1, s[8:11], s26 offen offset:3072 sc1 lds
    v_mfma_f32_16x16x32_bf16 v[172:175], a[124:127], v[108:111], v[172:175]
    s_add_u32 m0, s28, 150528
    s_add_u32 s26, s25, 12288
    v_mfma_f32_16x16x32_bf16 v[156:159], a[160:163], v[104:107], v[156:159]
    buffer_load_dwordx4 v1, s[8:11], s26 offen offset:0 sc1 lds
    v_mfma_f32_16x16x32_bf16 v[168:171], a[160:163], v[108:111], v[168:171]
    s_add_u32 m0, s28, 150528
    v_mfma_f32_16x16x32_bf16 v[152:155], a[116:119], v[104:107], v[152:155]
    buffer_load_dwordx4 v1, s[8:11], s26 offen offset:1024 sc1 lds
    v_mfma_f32_16x16x32_bf16 v[164:167], a[116:119], v[108:111], v[164:167]
    s_waitcnt vmcnt(26)
    s_waitcnt lgkmcnt(0)
    s_barrier
    v_mfma_f32_16x16x32_bf16 v[128:131], a[128:131], v[112:115], v[128:131]
    ds_read_b128 v[96:99], v1 offset:35840
    v_mfma_f32_16x16x32_bf16 v[140:143], a[128:131], v[116:119], v[140:143]
    ds_read_b128 v[100:103], v1 offset:37888
    v_mfma_f32_16x16x32_bf16 v[132:135], a[164:167], v[112:115], v[132:135]
    ds_read_b128 v[104:107], v1 offset:39936
    v_mfma_f32_16x16x32_bf16 v[144:147], a[164:167], v[116:119], v[144:147]
    ds_read_b128 v[108:111], v1 offset:41984
    v_mfma_f32_16x16x32_bf16 v[136:139], a[132:135], v[112:115], v[136:139]
    v_permlane32_swap_b32 v80, v82
    v_mfma_f32_16x16x32_bf16 v[148:151], a[132:135], v[116:119], v[148:151]
    v_mfma_f32_16x16x32_bf16 v[160:163], a[132:135], v[120:123], v[160:163]
    v_permlane32_swap_b32 v84, v86
    v_mfma_f32_16x16x32_bf16 v[172:175], a[132:135], v[124:127], v[172:175]
    v_permlane32_swap_b32 v88, v90
    v_mfma_f32_16x16x32_bf16 v[156:159], a[164:167], v[120:123], v[156:159]
    v_mov_b32 v81, v80
    v_mov_b32 v83, v82
    v_mfma_f32_16x16x32_bf16 v[168:171], a[164:167], v[124:127], v[168:171]
    v_mov_b32 v85, v84
    v_mov_b32 v87, v86
    v_mfma_f32_16x16x32_bf16 v[152:155], a[128:131], v[120:123], v[152:155]
    s_add_u32 m0, s28, 58368
    v_mov_b32 v89, v88
    v_mfma_f32_16x16x32_bf16 v[164:167], a[128:131], v[124:127], v[164:167]
    v_mov_b32 v91, v90
    s_waitcnt lgkmcnt(2)
    v_mfma_f32_16x16x32_bf16 v[128:131], a[136:139], v[96:99], v[128:131]
    ds_read_b128 v[112:115], v1 offset:36864
    v_mfma_f32_16x16x32_bf16 v[140:143], a[136:139], v[100:103], v[140:143]
    ds_read_b128 v[116:119], v1 offset:38912
    v_mfma_f32_16x16x32_bf16 v[132:135], a[168:171], v[96:99], v[132:135]
    ds_read_b128 v[120:123], v1 offset:40960
    v_mfma_f32_16x16x32_bf16 v[144:147], a[168:171], v[100:103], v[144:147]
    ds_read_b128 v[124:127], v1 offset:43008
    v_mfma_f32_16x16x32_bf16 v[136:139], a[140:143], v[96:99], v[136:139]
    buffer_load_dwordx4 v1, s[8:11], s26 offen offset:2048 sc1 lds
    v_mfma_f32_16x16x32_bf16 v[148:151], a[140:143], v[100:103], v[148:151]
    s_add_u32 m0, s28, 58368
    s_waitcnt lgkmcnt(4)
    v_mfma_f32_16x16x32_bf16 v[160:163], a[140:143], v[104:107], v[160:163]
    buffer_load_dwordx4 v1, s[8:11], s26 offen offset:3072 sc1 lds
    v_mfma_f32_16x16x32_bf16 v[172:175], a[140:143], v[108:111], v[172:175]
    s_add_u32 m0, s28, 68608
    s_add_u32 s26, s25, 16384
    v_mfma_f32_16x16x32_bf16 v[156:159], a[168:171], v[104:107], v[156:159]
    buffer_load_dwordx4 v1, s[8:11], s26 offen offset:0 sc1 lds
    v_mfma_f32_16x16x32_bf16 v[168:171], a[168:171], v[108:111], v[168:171]
    s_add_u32 m0, s28, 68608
    v_mfma_f32_16x16x32_bf16 v[152:155], a[136:139], v[104:107], v[152:155]
    buffer_load_dwordx4 v1, s[8:11], s26 offen offset:1024 sc1 lds
    v_mfma_f32_16x16x32_bf16 v[164:167], a[136:139], v[108:111], v[164:167]
    s_waitcnt lgkmcnt(2)
    v_mfma_f32_16x16x32_bf16 v[128:131], a[144:147], v[112:115], v[128:131]
    ds_read_b128 v[96:99], v1 offset:44032
    v_mfma_f32_16x16x32_bf16 v[140:143], a[144:147], v[116:119], v[140:143]
    ds_read_b128 v[100:103], v1 offset:46080
    v_mfma_f32_16x16x32_bf16 v[132:135], a[172:175], v[112:115], v[132:135]
    ds_read_b128 v[104:107], v1 offset:48128
    v_mfma_f32_16x16x32_bf16 v[144:147], a[172:175], v[116:119], v[144:147]
    ds_read_b128 v[108:111], v1 offset:50176
    v_mfma_f32_16x16x32_bf16 v[136:139], a[148:151], v[112:115], v[136:139]
    v_permlane16_swap_b32 v80, v81
    v_mfma_f32_16x16x32_bf16 v[148:151], a[148:151], v[116:119], v[148:151]
    s_waitcnt lgkmcnt(4)
    v_mfma_f32_16x16x32_bf16 v[160:163], a[148:151], v[120:123], v[160:163]
    v_permlane16_swap_b32 v82, v83
    v_mfma_f32_16x16x32_bf16 v[172:175], a[148:151], v[124:127], v[172:175]
    v_permlane16_swap_b32 v84, v85
    v_mfma_f32_16x16x32_bf16 v[156:159], a[172:175], v[120:123], v[156:159]
    v_permlane16_swap_b32 v86, v87
    v_mfma_f32_16x16x32_bf16 v[168:171], a[172:175], v[124:127], v[168:171]
    v_permlane16_swap_b32 v88, v89
    v_mfma_f32_16x16x32_bf16 v[152:155], a[144:147], v[120:123], v[152:155]
    v_permlane16_swap_b32 v90, v91
    v_mfma_f32_16x16x32_bf16 v[164:167], a[144:147], v[124:127], v[164:167]
    s_waitcnt vmcnt(9)
    v_cmp_le_u32 vcc, 14, v27
    s_nop 3
    s_cmp_eq_u64 vcc, -1
    s_cbranch_scc1 L_pdone_96
    s_mov_b32 s68, 0x80000
L_poll_95:
    buffer_load_dword v27, v25, s[8:11], s38 offen sc1
    s_waitcnt vmcnt(0)
    v_cmp_le_u32 vcc, 14, v27
    s_nop 3
    s_cmp_eq_u64 vcc, -1
    s_cbranch_scc1 L_pdone_96
    s_sub_u32 s68, s68, 1
    s_cmp_lg_u32 s68, 0
    s_cbranch_scc1 L_poll_95
L_pdone_96:
    s_waitcnt lgkmcnt(2)
    v_mfma_f32_16x16x32_bf16 v[128:131], a[152:155], v[96:99], v[128:131]
    ds_read_b128 v[112:115], v1 offset:45056
    s_add_u32 m0, s28, 76800
    s_add_u32 s49, s48, 29966336
    v_mfma_f32_16x16x32_bf16 v[140:143], a[152:155], v[100:103], v[140:143]
    ds_read_b128 v[116:119], v1 offset:47104
    v_mfma_f32_16x16x32_bf16 v[132:135], a[188:191], v[96:99], v[132:135]
    ds_read_b128 v[120:123], v1 offset:49152
    v_mfma_f32_16x16x32_bf16 v[144:147], a[188:191], v[100:103], v[144:147]
    ds_read_b128 v[124:127], v1 offset:51200
    v_mfma_f32_16x16x32_bf16 v[136:139], a[180:183], v[96:99], v[136:139]
    buffer_load_dwordx4 v1, s[8:11], s49 offen offset:0 sc1 lds
    v_mfma_f32_16x16x32_bf16 v[148:151], a[180:183], v[100:103], v[148:151]
    s_add_u32 m0, s28, 76800
    s_waitcnt lgkmcnt(4)
    v_mfma_f32_16x16x32_bf16 v[160:163], a[180:183], v[104:107], v[160:163]
    buffer_load_dwordx4 v1, s[8:11], s49 offen offset:1024 sc1 lds
    v_mfma_f32_16x16x32_bf16 v[172:175], a[180:183], v[108:111], v[172:175]
    s_add_u32 m0, s28, 82944
    v_mfma_f32_16x16x32_bf16 v[156:159], a[188:191], v[104:107], v[156:159]
    buffer_load_dwordx4 v1, s[8:11], s49 offen offset:2048 sc1 lds
    v_mfma_f32_16x16x32_bf16 v[168:171], a[188:191], v[108:111], v[168:171]
    s_add_u32 m0, s28, 82944
    v_mfma_f32_16x16x32_bf16 v[152:155], a[152:155], v[104:107], v[152:155]
    buffer_load_dwordx4 v1, s[8:11], s49 offen offset:3072 sc1 lds
    v_mfma_f32_16x16x32_bf16 v[164:167], a[152:155], v[108:111], v[164:167]
    s_add_u32 m0, s28, 93184
    s_add_u32 s49, s48, 29970432
    s_waitcnt lgkmcnt(2)
    v_mfma_f32_16x16x32_bf16 v[128:131], a[244:247], v[112:115], v[128:131]
    ds_read_b128 v[96:99], v1 offset:52224
    v_mfma_f32_16x16x32_bf16 v[140:143], a[244:247], v[116:119], v[140:143]
    ds_read_b128 v[100:103], v1 offset:54272
    v_mfma_f32_16x16x32_bf16 v[132:135], a[240:243], v[112:115], v[132:135]
    ds_read_b128 v[104:107], v1 offset:56320
    v_mfma_f32_16x16x32_bf16 v[144:147], a[240:243], v[116:119], v[144:147]
    ds_read_b128 v[108:111], v1 offset:58368
    v_mfma_f32_16x16x32_bf16 v[136:139], a[196:199], v[112:115], v[136:139]
    buffer_load_dwordx4 v1, s[8:11], s49 offen offset:0 sc1 lds
    v_mfma_f32_16x16x32_bf16 v[148:151], a[196:199], v[116:119], v[148:151]
    s_add_u32 m0, s28, 93184
    s_waitcnt lgkmcnt(4)
    v_mfma_f32_16x16x32_bf16 v[160:163], a[196:199], v[120:123], v[160:163]
    buffer_load_dwordx4 v1, s[8:11], s49 offen offset:1024 sc1 lds
    v_mfma_f32_16x16x32_bf16 v[172:175], a[196:199], v[124:127], v[172:175]
    s_add_u32 m0, s28, 99328
    v_mfma_f32_16x16x32_bf16 v[156:159], a[240:243], v[120:123], v[156:159]
    buffer_load_dwordx4 v1, s[8:11], s49 offen offset:2048 sc1 lds
    v_mfma_f32_16x16x32_bf16 v[168:171], a[240:243], v[124:127], v[168:171]
    s_add_u32 m0, s28, 99328
    v_mfma_f32_16x16x32_bf16 v[152:155], a[244:247], v[120:123], v[152:155]
    buffer_load_dwordx4 v1, s[8:11], s49 offen offset:3072 sc1 lds
    v_mfma_f32_16x16x32_bf16 v[164:167], a[244:247], v[124:127], v[164:167]
    s_add_u32 s53, s36, 35524608
    s_waitcnt lgkmcnt(2)
    v_mfma_f32_16x16x32_bf16 v[128:131], a[184:187], v[96:99], v[128:131]
    ds_read_b128 v[112:115], v1 offset:53248
    v_mfma_f32_16x16x32_bf16 v[140:143], a[184:187], v[100:103], v[140:143]
    ds_read_b128 v[116:119], v1 offset:55296
    v_mfma_f32_16x16x32_bf16 v[132:135], a[176:179], v[96:99], v[132:135]
    ds_read_b128 v[120:123], v1 offset:57344
    v_mfma_f32_16x16x32_bf16 v[144:147], a[176:179], v[100:103], v[144:147]
    ds_read_b128 v[124:127], v1 offset:59392
    v_mfma_f32_16x16x32_bf16 v[136:139], a[224:227], v[96:99], v[136:139]
    buffer_load_dwordx2 v[200:201], v0, s[8:11], s53 offen offset:0 sc1
    v_mfma_f32_16x16x32_bf16 v[148:151], a[224:227], v[100:103], v[148:151]
    s_waitcnt lgkmcnt(4)
    v_mfma_f32_16x16x32_bf16 v[160:163], a[224:227], v[104:107], v[160:163]
    buffer_load_dwordx2 v[202:203], v0, s[8:11], s53 offen offset:512 sc1
    v_mfma_f32_16x16x32_bf16 v[172:175], a[224:227], v[108:111], v[172:175]
    buffer_load_dwordx2 v[204:205], v0, s[8:11], s53 offen offset:1024 sc1
    v_mfma_f32_16x16x32_bf16 v[156:159], a[176:179], v[104:107], v[156:159]
    buffer_load_dwordx2 v[206:207], v0, s[8:11], s53 offen offset:1536 sc1
    v_mfma_f32_16x16x32_bf16 v[168:171], a[176:179], v[108:111], v[168:171]
    v_mfma_f32_16x16x32_bf16 v[152:155], a[184:187], v[104:107], v[152:155]
    v_mfma_f32_16x16x32_bf16 v[164:167], a[184:187], v[108:111], v[164:167]
    s_waitcnt lgkmcnt(2)
    v_mfma_f32_16x16x32_bf16 v[128:131], a[220:223], v[112:115], v[128:131]
    v_mfma_f32_16x16x32_bf16 v[140:143], a[220:223], v[116:119], v[140:143]
    v_mfma_f32_16x16x32_bf16 v[132:135], a[192:195], v[112:115], v[132:135]
    v_mfma_f32_16x16x32_bf16 v[144:147], a[192:195], v[116:119], v[144:147]
    v_mfma_f32_16x16x32_bf16 v[136:139], a[156:159], v[112:115], v[136:139]
    v_mfma_f32_16x16x32_bf16 v[148:151], a[156:159], v[116:119], v[148:151]
    s_waitcnt lgkmcnt(0)
    v_mfma_f32_16x16x32_bf16 v[160:163], a[156:159], v[120:123], v[160:163]
    v_mfma_f32_16x16x32_bf16 v[172:175], a[156:159], v[124:127], v[172:175]
    v_mfma_f32_16x16x32_bf16 v[156:159], a[192:195], v[120:123], v[156:159]
    v_mfma_f32_16x16x32_bf16 v[168:171], a[192:195], v[124:127], v[168:171]
    v_mfma_f32_16x16x32_bf16 v[152:155], a[220:223], v[120:123], v[152:155]
    v_mfma_f32_16x16x32_bf16 v[164:167], a[220:223], v[124:127], v[164:167]
    s_add_u32 s56, s33, 20971520
    v_pk_fma_f32 v[128:129], v[80:81], v[52:53], v[128:129] op_sel:[0,0,0] op_sel_hi:[0,1,1] neg_lo:[1,0,0] neg_hi:[1,0,0]
    v_pk_fma_f32 v[130:131], v[80:81], v[54:55], v[130:131] op_sel:[0,0,0] op_sel_hi:[0,1,1] neg_lo:[1,0,0] neg_hi:[1,0,0]
    v_pk_fma_f32 v[140:141], v[80:81], v[52:53], v[140:141] op_sel:[1,0,0] op_sel_hi:[1,1,1] neg_lo:[1,0,0] neg_hi:[1,0,0]
    v_pk_fma_f32 v[142:143], v[80:81], v[54:55], v[142:143] op_sel:[1,0,0] op_sel_hi:[1,1,1] neg_lo:[1,0,0] neg_hi:[1,0,0]
    s_nop 1
    v_pk_fma_f32 v[152:153], v[82:83], v[52:53], v[152:153] op_sel:[0,0,0] op_sel_hi:[0,1,1] neg_lo:[1,0,0] neg_hi:[1,0,0]
    v_pk_fma_f32 v[154:155], v[82:83], v[54:55], v[154:155] op_sel:[0,0,0] op_sel_hi:[0,1,1] neg_lo:[1,0,0] neg_hi:[1,0,0]
    v_pk_fma_f32 v[164:165], v[82:83], v[52:53], v[164:165] op_sel:[1,0,0] op_sel_hi:[1,1,1] neg_lo:[1,0,0] neg_hi:[1,0,0]
    v_pk_fma_f32 v[166:167], v[82:83], v[54:55], v[166:167] op_sel:[1,0,0] op_sel_hi:[1,1,1] neg_lo:[1,0,0] neg_hi:[1,0,0]
    v_pk_mul_f32 v[128:129], v[84:85], v[128:129] op_sel:[0,0] op_sel_hi:[0,1]
    v_pk_mul_f32 v[140:141], v[84:85], v[140:141] op_sel:[1,0] op_sel_hi:[1,1]
    v_pk_mul_f32 v[152:153], v[86:87], v[152:153] op_sel:[0,0] op_sel_hi:[0,1]
    v_pk_mul_f32 v[164:165], v[86:87], v[164:165] op_sel:[1,0] op_sel_hi:[1,1]
    buffer_load_dwordx2 v[208:209], v0, s[8:11], s53 offen offset:2048 sc1
    v_exp_f32 v128, v128
    buffer_load_dwordx2 v[210:211], v0, s[8:11], s53 offen offset:2560 sc1
    v_exp_f32 v129, v129
    v_exp_f32 v140, v140
    buffer_load_dwordx2 v[212:213], v0, s[8:11], s53 offen offset:3072 sc1
    v_exp_f32 v141, v141
    buffer_load_dwordx2 v[214:215], v0, s[8:11], s53 offen offset:3584 sc1
    v_exp_f32 v152, v152
    v_exp_f32 v153, v153
    s_add_u32 m0, s28, 109568
    s_add_u32 s49, s48, 29974528
    buffer_load_dwordx4 v1, s[8:11], s49 offen offset:0 sc1 lds
    v_exp_f32 v164, v164
    v_exp_f32 v165, v165
    v_pk_fma_f32 v[128:129], v[128:129], v[88:89], v[88:89] op_sel:[0,0,0] op_sel_hi:[1,0,0]
    s_add_u32 m0, s28, 109568
    s_nop 0
    buffer_load_dwordx4 v1, s[8:11], s49 offen offset:1024 sc1 lds
    v_pk_fma_f32 v[140:141], v[140:141], v[88:89], v[88:89] op_sel:[0,1,1] op_sel_hi:[1,1,1]
    v_pk_fma_f32 v[152:153], v[152:153], v[90:91], v[90:91] op_sel:[0,0,0] op_sel_hi:[1,0,0]
    v_pk_fma_f32 v[164:165], v[164:165], v[90:91], v[90:91] op_sel:[0,1,1] op_sel_hi:[1,1,1]
    v_rcp_f32 v128, v128
    v_rcp_f32 v129, v129
    v_rcp_f32 v140, v140
    v_rcp_f32 v141, v141
    v_rcp_f32 v152, v152
    v_rcp_f32 v153, v153
    v_rcp_f32 v164, v164
    v_rcp_f32 v165, v165
    v_pk_mul_f32 v[128:129], v[128:129], v[130:131]
    v_pk_mul_f32 v[140:141], v[140:141], v[142:143]
    v_pk_mul_f32 v[152:153], v[152:153], v[154:155]
    s_add_u32 m0, s28, 1024
    s_nop 0
    buffer_load_dwordx4 v1, s[8:11], s49 offen offset:2048 sc1 lds
    v_pk_mul_f32 v[164:165], v[164:165], v[166:167]
    v_cvt_pk_bf16_f32 v176, v128, v129
    v_cvt_pk_bf16_f32 v177, v140, v141
    v_cvt_pk_bf16_f32 v178, v152, v153
    v_cvt_pk_bf16_f32 v179, v164, v165
    s_add_u32 m0, s28, 1024
    s_nop 0
    buffer_load_dwordx4 v1, s[8:11], s49 offen offset:3072 sc1 lds
    v_permlane32_swap_b32 v176, v178
    v_permlane32_swap_b32 v177, v179
    s_nop 1
    v_permlane16_swap_b32 v176, v177
    s_add_u32 m0, s28, 11264
    s_add_u32 s49, s48, 29978624
    buffer_load_dwordx4 v1, s[8:11], s49 offen offset:0 sc1 lds
    v_permlane16_swap_b32 v178, v179
    buffer_store_dwordx4 v[176:179], v24, s[8:11], s56 offen offset:0 sc1
    v_pk_fma_f32 v[132:133], v[80:81], v[56:57], v[132:133] op_sel:[0,0,0] op_sel_hi:[0,1,1] neg_lo:[1,0,0] neg_hi:[1,0,0]
    v_pk_fma_f32 v[134:135], v[80:81], v[58:59], v[134:135] op_sel:[0,0,0] op_sel_hi:[0,1,1] neg_lo:[1,0,0] neg_hi:[1,0,0]
    v_pk_fma_f32 v[144:145], v[80:81], v[56:57], v[144:145] op_sel:[1,0,0] op_sel_hi:[1,1,1] neg_lo:[1,0,0] neg_hi:[1,0,0]
    v_pk_fma_f32 v[146:147], v[80:81], v[58:59], v[146:147] op_sel:[1,0,0] op_sel_hi:[1,1,1] neg_lo:[1,0,0] neg_hi:[1,0,0]
    v_pk_fma_f32 v[156:157], v[82:83], v[56:57], v[156:157] op_sel:[0,0,0] op_sel_hi:[0,1,1] neg_lo:[1,0,0] neg_hi:[1,0,0]
    v_pk_fma_f32 v[158:159], v[82:83], v[58:59], v[158:159] op_sel:[0,0,0] op_sel_hi:[0,1,1] neg_lo:[1,0,0] neg_hi:[1,0,0]
    v_pk_fma_f32 v[168:169], v[82:83], v[56:57], v[168:169] op_sel:[1,0,0] op_sel_hi:[1,1,1] neg_lo:[1,0,0] neg_hi:[1,0,0]
    v_pk_fma_f32 v[170:171], v[82:83], v[58:59], v[170:171] op_sel:[1,0,0] op_sel_hi:[1,1,1] neg_lo:[1,0,0] neg_hi:[1,0,0]
    v_pk_mul_f32 v[132:133], v[84:85], v[132:133] op_sel:[0,0] op_sel_hi:[0,1]
    v_pk_mul_f32 v[144:145], v[84:85], v[144:145] op_sel:[1,0] op_sel_hi:[1,1]
    v_pk_mul_f32 v[156:157], v[86:87], v[156:157] op_sel:[0,0] op_sel_hi:[0,1]
    v_pk_mul_f32 v[168:169], v[86:87], v[168:169] op_sel:[1,0] op_sel_hi:[1,1]
    v_exp_f32 v132, v132
    v_exp_f32 v133, v133
    v_exp_f32 v144, v144
    v_exp_f32 v145, v145
    v_exp_f32 v156, v156
    v_exp_f32 v157, v157
    v_exp_f32 v168, v168
    v_exp_f32 v169, v169
    s_add_u32 m0, s28, 11264
    s_nop 0
    buffer_load_dwordx4 v1, s[8:11], s49 offen offset:1024 sc1 lds
    v_pk_fma_f32 v[132:133], v[132:133], v[88:89], v[88:89] op_sel:[0,0,0] op_sel_hi:[1,0,0]
    v_pk_fma_f32 v[144:145], v[144:145], v[88:89], v[88:89] op_sel:[0,1,1] op_sel_hi:[1,1,1]
    v_pk_fma_f32 v[156:157], v[156:157], v[90:91], v[90:91] op_sel:[0,0,0] op_sel_hi:[1,0,0]
    v_pk_fma_f32 v[168:169], v[168:169], v[90:91], v[90:91] op_sel:[0,1,1] op_sel_hi:[1,1,1]
    v_rcp_f32 v132, v132
    v_rcp_f32 v133, v133
    s_add_u32 m0, s28, 17408
    s_nop 0
    buffer_load_dwordx4 v1, s[8:11], s49 offen offset:2048 sc1 lds
    v_rcp_f32 v144, v144
    v_rcp_f32 v145, v145
    v_rcp_f32 v156, v156
    v_rcp_f32 v157, v157
    v_rcp_f32 v168, v168
    v_rcp_f32 v169, v169
    v_pk_mul_f32 v[132:133], v[132:133], v[134:135]
    v_pk_mul_f32 v[144:145], v[144:145], v[146:147]
    v_pk_mul_f32 v[156:157], v[156:157], v[158:159]
    v_pk_mul_f32 v[168:169], v[168:169], v[170:171]
    v_cvt_pk_bf16_f32 v180, v132, v133
    v_cvt_pk_bf16_f32 v181, v144, v145
    v_cvt_pk_bf16_f32 v182, v156, v157
    v_cvt_pk_bf16_f32 v183, v168, v169
    s_nop 0
    v_permlane32_swap_b32 v180, v182
    v_permlane32_swap_b32 v181, v183
    s_nop 1
    v_permlane16_swap_b32 v180, v181
    v_permlane16_swap_b32 v182, v183
    buffer_store_dwordx4 v[180:183], v24, s[8:11], s56 offen offset:256 sc1
    v_pk_fma_f32 v[136:137], v[80:81], v[60:61], v[136:137] op_sel:[0,0,0] op_sel_hi:[0,1,1] neg_lo:[1,0,0] neg_hi:[1,0,0]
    v_pk_fma_f32 v[138:139], v[80:81], v[62:63], v[138:139] op_sel:[0,0,0] op_sel_hi:[0,1,1] neg_lo:[1,0,0] neg_hi:[1,0,0]
    v_pk_fma_f32 v[148:149], v[80:81], v[60:61], v[148:149] op_sel:[1,0,0] op_sel_hi:[1,1,1] neg_lo:[1,0,0] neg_hi:[1,0,0]
    v_pk_fma_f32 v[150:151], v[80:81], v[62:63], v[150:151] op_sel:[1,0,0] op_sel_hi:[1,1,1] neg_lo:[1,0,0] neg_hi:[1,0,0]
    v_pk_fma_f32 v[160:161], v[82:83], v[60:61], v[160:161] op_sel:[0,0,0] op_sel_hi:[0,1,1] neg_lo:[1,0,0] neg_hi:[1,0,0]
    v_pk_fma_f32 v[162:163], v[82:83], v[62:63], v[162:163] op_sel:[0,0,0] op_sel_hi:[0,1,1] neg_lo:[1,0,0] neg_hi:[1,0,0]
    v_pk_fma_f32 v[172:173], v[82:83], v[60:61], v[172:173] op_sel:[1,0,0] op_sel_hi:[1,1,1] neg_lo:[1,0,0] neg_hi:[1,0,0]
    v_pk_fma_f32 v[174:175], v[82:83], v[62:63], v[174:175] op_sel:[1,0,0] op_sel_hi:[1,1,1] neg_lo:[1,0,0] neg_hi:[1,0,0]
    v_pk_mul_f32 v[136:137], v[84:85], v[136:137] op_sel:[0,0] op_sel_hi:[0,1]
    v_pk_mul_f32 v[148:149], v[84:85], v[148:149] op_sel:[1,0] op_sel_hi:[1,1]
    v_pk_mul_f32 v[160:161], v[86:87], v[160:161] op_sel:[0,0] op_sel_hi:[0,1]
    v_pk_mul_f32 v[172:173], v[86:87], v[172:173] op_sel:[1,0] op_sel_hi:[1,1]
    v_exp_f32 v136, v136
    v_exp_f32 v137, v137
    v_exp_f32 v148, v148
    v_exp_f32 v149, v149
    v_exp_f32 v160, v160
    v_exp_f32 v161, v161
    v_exp_f32 v172, v172
    v_exp_f32 v173, v173
    v_pk_fma_f32 v[136:137], v[136:137], v[88:89], v[88:89] op_sel:[0,0,0] op_sel_hi:[1,0,0]
    v_pk_fma_f32 v[148:149], v[148:149], v[88:89], v[88:89] op_sel:[0,1,1] op_sel_hi:[1,1,1]
    v_pk_fma_f32 v[160:161], v[160:161], v[90:91], v[90:91] op_sel:[0,0,0] op_sel_hi:[1,0,0]
    v_pk_fma_f32 v[172:173], v[172:173], v[90:91], v[90:91] op_sel:[0,1,1] op_sel_hi:[1,1,1]
    v_rcp_f32 v136, v136
    v_rcp_f32 v137, v137
    v_rcp_f32 v148, v148
    v_rcp_f32 v149, v149
    v_rcp_f32 v160, v160
    v_rcp_f32 v161, v161
    v_rcp_f32 v172, v172
    v_rcp_f32 v173, v173
    v_pk_mul_f32 v[136:137], v[136:137], v[138:139]
    v_pk_mul_f32 v[148:149], v[148:149], v[150:151]
    v_pk_mul_f32 v[160:161], v[160:161], v[162:163]
    v_pk_mul_f32 v[172:173], v[172:173], v[174:175]
    s_waitcnt vmcnt(17)
    s_barrier
    ds_read_b128 v[96:99], v2 offset:11264
    ds_read_b128 v[100:103], v2 offset:13312
    s_add_u32 m0, s28, 17408
    s_nop 0
    buffer_load_dwordx4 v1, s[8:11], s49 offen offset:3072 sc1 lds
    ds_read_b128 v[104:107], v2 offset:15360
    ds_read_b128 v[108:111], v2 offset:17408
    v_cvt_pk_bf16_f32 v184, v136, v137
    v_cvt_pk_bf16_f32 v185, v148, v149
    v_cvt_pk_bf16_f32 v186, v160, v161
    v_cvt_pk_bf16_f32 v187, v172, v173
    s_nop 0
    v_permlane32_swap_b32 v184, v186
    s_add_u32 m0, s28, 27648
    s_add_u32 s49, s48, 29982720
    buffer_load_dwordx4 v1, s[8:11], s49 offen offset:0 sc1 lds
    v_permlane32_swap_b32 v185, v187
    s_nop 1
    v_permlane16_swap_b32 v184, v185
    s_add_u32 m0, s28, 27648
    s_nop 0
    buffer_load_dwordx4 v1, s[8:11], s49 offen offset:1024 sc1 lds
    v_permlane16_swap_b32 v186, v187
    buffer_store_dwordx4 v[184:187], v24, s[8:11], s56 offen offset:512 sc1
    s_waitcnt lgkmcnt(2)
    v_mfma_f32_16x16x32_bf16 v[128:131], a[248:251], v[96:99], 0
    ds_read_b128 v[112:115], v2 offset:12288
    v_mfma_f32_16x16x32_bf16 v[140:143], a[248:251], v[100:103], 0
    ds_read_b128 v[116:119], v2 offset:14336
    v_mfma_f32_16x16x32_bf16 v[132:135], a[212:215], v[96:99], 0
    ds_read_b128 v[120:123], v2 offset:16384
    v_mfma_f32_16x16x32_bf16 v[144:147], a[212:215], v[100:103], 0
    ds_read_b128 v[124:127], v2 offset:18432
    v_mfma_f32_16x16x32_bf16 v[136:139], a[232:235], v[96:99], 0
    v_mfma_f32_16x16x32_bf16 v[148:151], a[232:235], v[100:103], 0
    s_waitcnt lgkmcnt(4)
    v_mfma_f32_16x16x32_bf16 v[160:163], a[232:235], v[104:107], 0
    s_add_u32 m0, s28, 33792
    v_mfma_f32_16x16x32_bf16 v[172:175], a[232:235], v[108:111], 0
    buffer_load_dwordx4 v1, s[8:11], s49 offen offset:2048 sc1 lds
    v_mfma_f32_16x16x32_bf16 v[156:159], a[212:215], v[104:107], 0
    v_mfma_f32_16x16x32_bf16 v[168:171], a[212:215], v[108:111], 0
    s_add_u32 m0, s28, 33792
    v_mfma_f32_16x16x32_bf16 v[152:155], a[248:251], v[104:107], 0
    buffer_load_dwordx4 v1, s[8:11], s49 offen offset:3072 sc1 lds
    v_mfma_f32_16x16x32_bf16 v[164:167], a[248:251], v[108:111], 0
    s_waitcnt lgkmcnt(2)
    v_mfma_f32_16x16x32_bf16 v[128:131], a[252:255], v[112:115], v[128:131]
    ds_read_b128 v[96:99], v2 offset:19456
    ds_read_b128 a[248:251], v95 offset:52224
    v_mfma_f32_16x16x32_bf16 v[140:143], a[252:255], v[116:119], v[140:143]
    ds_read_b128 v[100:103], v2 offset:21504
    ds_read_b128 a[212:215], v95 offset:53248
    v_mfma_f32_16x16x32_bf16 v[132:135], a[216:219], v[112:115], v[132:135]
    ds_read_b128 v[104:107], v2 offset:23552
    ds_read_b128 a[232:235], v95 offset:60416
    v_mfma_f32_16x16x32_bf16 v[144:147], a[216:219], v[116:119], v[144:147]
    ds_read_b128 v[108:111], v2 offset:25600
    v_mfma_f32_16x16x32_bf16 v[136:139], a[236:239], v[112:115], v[136:139]
    v_mfma_f32_16x16x32_bf16 v[148:151], a[236:239], v[116:119], v[148:151]
    s_waitcnt lgkmcnt(7)
    v_mfma_f32_16x16x32_bf16 v[160:163], a[236:239], v[120:123], v[160:163]
    v_mfma_f32_16x16x32_bf16 v[172:175], a[236:239], v[124:127], v[172:175]
    v_mfma_f32_16x16x32_bf16 v[156:159], a[216:219], v[120:123], v[156:159]
    v_mfma_f32_16x16x32_bf16 v[168:171], a[216:219], v[124:127], v[168:171]
    v_mfma_f32_16x16x32_bf16 v[152:155], a[252:255], v[120:123], v[152:155]
    v_mfma_f32_16x16x32_bf16 v[164:167], a[252:255], v[124:127], v[164:167]
    s_waitcnt vmcnt(15)
    s_waitcnt lgkmcnt(4)
    v_mfma_f32_16x16x32_bf16 v[128:131], a[0:3], v[96:99], v[128:131]
    ds_read_b128 v[112:115], v2 offset:20480
    ds_read_b128 a[252:255], v95 offset:61440
    v_mfma_f32_16x16x32_bf16 v[140:143], a[0:3], v[100:103], v[140:143]
    ds_read_b128 v[116:119], v2 offset:22528
    ds_read_b128 a[216:219], v21 offset:3072
    v_mfma_f32_16x16x32_bf16 v[132:135], a[4:7], v[96:99], v[132:135]
    ds_read_b128 v[120:123], v2 offset:24576
    ds_read_b128 a[236:239], v21 offset:4096
    v_mfma_f32_16x16x32_bf16 v[144:147], a[4:7], v[100:103], v[144:147]
    ds_read_b128 v[124:127], v2 offset:26624
    v_add_f32 v200, v200, v208
    v_mfma_f32_16x16x32_bf16 v[136:139], a[8:11], v[96:99], v[136:139]
    v_add_f32 v201, v201, v209
    v_add_f32 v202, v202, v210
    v_mfma_f32_16x16x32_bf16 v[148:151], a[8:11], v[100:103], v[148:151]
    v_add_f32 v203, v203, v211
    s_waitcnt lgkmcnt(7)
    v_mfma_f32_16x16x32_bf16 v[160:163], a[8:11], v[104:107], v[160:163]
    s_add_u32 m0, s28, 115712
    v_add_f32 v204, v204, v212
    v_mfma_f32_16x16x32_bf16 v[172:175], a[8:11], v[108:111], v[172:175]
    buffer_load_dwordx4 v1, s[8:11], s26 offen offset:2048 sc1 lds
    v_mfma_f32_16x16x32_bf16 v[156:159], a[4:7], v[104:107], v[156:159]
    s_add_u32 m0, s28, 115712
    v_add_f32 v205, v205, v213
    v_mfma_f32_16x16x32_bf16 v[168:171], a[4:7], v[108:111], v[168:171]
    buffer_load_dwordx4 v1, s[8:11], s26 offen offset:3072 sc1 lds
    v_mfma_f32_16x16x32_bf16 v[152:155], a[0:3], v[104:107], v[152:155]
    v_add_f32 v206, v206, v214
    v_add_f32 v207, v207, v215
    v_mfma_f32_16x16x32_bf16 v[164:167], a[0:3], v[108:111], v[164:167]
    v_add_f32 v200, v200, v204
    s_waitcnt lgkmcnt(4)
    v_mfma_f32_16x16x32_bf16 v[128:131], a[12:15], v[112:115], v[128:131]
    ds_read_b128 v[96:99], v2 offset:27648
    ds_read_b128 a[0:3], v21 offset:11264
    v_mfma_f32_16x16x32_bf16 v[140:143], a[12:15], v[116:119], v[140:143]
    ds_read_b128 v[100:103], v2 offset:29696
    ds_read_b128 a[4:7], v21 offset:12288
    v_mfma_f32_16x16x32_bf16 v[132:135], a[60:63], v[112:115], v[132:135]
    ds_read_b128 v[104:107], v2 offset:31744
    ds_read_b128 a[8:11], v21 offset:19456
    v_mfma_f32_16x16x32_bf16 v[144:147], a[60:63], v[116:119], v[144:147]
    ds_read_b128 v[108:111], v2 offset:33792
    s_add_u32 m0, s28, 125952
    s_add_u32 s26, s25, 20480
    v_mfma_f32_16x16x32_bf16 v[136:139], a[64:67], v[112:115], v[136:139]
    buffer_load_dwordx4 v1, s[8:11], s26 offen offset:0 sc1 lds
    v_mfma_f32_16x16x32_bf16 v[148:151], a[64:67], v[116:119], v[148:151]
    s_add_u32 m0, s28, 125952
    s_waitcnt lgkmcnt(7)
    v_mfma_f32_16x16x32_bf16 v[160:163], a[64:67], v[120:123], v[160:163]
    buffer_load_dwordx4 v1, s[8:11], s26 offen offset:1024 sc1 lds
    v_mfma_f32_16x16x32_bf16 v[172:175], a[64:67], v[124:127], v[172:175]
    v_add_f32 v201, v201, v205
    v_add_f32 v202, v202, v206
    v_mfma_f32_16x16x32_bf16 v[156:159], a[60:63], v[120:123], v[156:159]
    s_add_u32 m0, s28, 132096
    v_add_f32 v203, v203, v207
    v_mfma_f32_16x16x32_bf16 v[168:171], a[60:63], v[124:127], v[168:171]
    buffer_load_dwordx4 v1, s[8:11], s26 offen offset:2048 sc1 lds
    v_mfma_f32_16x16x32_bf16 v[152:155], a[12:15], v[120:123], v[152:155]
    s_add_u32 m0, s28, 132096
    v_add_f32 v200, v200, v202
    v_mfma_f32_16x16x32_bf16 v[164:167], a[12:15], v[124:127], v[164:167]
    v_add_f32 v201, v201, v203
    s_waitcnt lgkmcnt(4)
    v_mfma_f32_16x16x32_bf16 v[128:131], a[108:111], v[96:99], v[128:131]
    ds_read_b128 v[112:115], v2 offset:28672
    ds_read_b128 a[12:15], v21 offset:20480
    v_mfma_f32_16x16x32_bf16 v[140:143], a[108:111], v[100:103], v[140:143]
    ds_read_b128 v[116:119], v2 offset:30720
    ds_read_b128 a[60:63], v94 offset:60416
    v_mfma_f32_16x16x32_bf16 v[132:135], a[120:123], v[96:99], v[132:135]
    ds_read_b128 v[120:123], v2 offset:32768
    ds_read_b128 a[64:67], v94 offset:61440
    v_mfma_f32_16x16x32_bf16 v[144:147], a[120:123], v[100:103], v[144:147]
    ds_read_b128 v[124:127], v2 offset:34816
    v_mul_f32 v80, s64, v200
    v_mfma_f32_16x16x32_bf16 v[136:139], a[16:19], v[96:99], v[136:139]
    buffer_load_dwordx4 v1, s[8:11], s26 offen offset:3072 sc1 lds
    v_mfma_f32_16x16x32_bf16 v[148:151], a[16:19], v[100:103], v[148:151]
    v_mul_f32 v201, s64, v201
    s_waitcnt lgkmcnt(7)
    v_mfma_f32_16x16x32_bf16 v[160:163], a[16:19], v[104:107], v[160:163]
    s_add_u32 m0, s28, 142336
    s_add_u32 s26, s25, 24576
    v_mfma_f32_16x16x32_bf16 v[172:175], a[16:19], v[108:111], v[172:175]
    buffer_load_dwordx4 v1, s[8:11], s26 offen offset:0 sc1 lds
    v_mfma_f32_16x16x32_bf16 v[156:159], a[120:123], v[104:107], v[156:159]
    s_add_u32 m0, s28, 142336
    v_fma_f32 v201, -v80, v80, v201
    v_mfma_f32_16x16x32_bf16 v[168:171], a[120:123], v[108:111], v[168:171]
    buffer_load_dwordx4 v1, s[8:11], s26 offen offset:1024 sc1 lds
    v_mfma_f32_16x16x32_bf16 v[152:155], a[108:111], v[104:107], v[152:155]
    v_max_f32 v201, 0, v201
    v_add_f32 v201, s65, v201
    v_mfma_f32_16x16x32_bf16 v[164:167], a[108:111], v[108:111], v[164:167]
    s_waitcnt lgkmcnt(4)
    v_mfma_f32_16x16x32_bf16 v[128:131], a[20:23], v[112:115], v[128:131]
    ds_read_b128 v[96:99], v2 offset:35840
    ds_read_b128 a[108:111], v95 offset:3072
    v_mfma_f32_16x16x32_bf16 v[140:143], a[20:23], v[116:119], v[140:143]
    ds_read_b128 v[100:103], v2 offset:37888
    ds_read_b128 a[120:123], v95 offset:4096
    v_mfma_f32_16x16x32_bf16 v[132:135], a[24:27], v[112:115], v[132:135]
    ds_read_b128 v[104:107], v2 offset:39936
    s_add_u32 m0, s28, 148480
    v_mfma_f32_16x16x32_bf16 v[144:147], a[24:27], v[116:119], v[144:147]
    ds_read_b128 v[108:111], v2 offset:41984
    v_mfma_f32_16x16x32_bf16 v[136:139], a[28:31], v[112:115], v[136:139]
    buffer_load_dwordx4 v1, s[8:11], s26 offen offset:2048 sc1 lds
    v_mfma_f32_16x16x32_bf16 v[148:151], a[28:31], v[116:119], v[148:151]
    s_waitcnt lgkmcnt(6)
    v_mfma_f32_16x16x32_bf16 v[160:163], a[28:31], v[120:123], v[160:163]
    v_rsq_f32 v84, v201
    v_mfma_f32_16x16x32_bf16 v[172:175], a[28:31], v[124:127], v[172:175]
    v_mul_f32 v88, v201, v84
    v_mul_f32 v84, s66, v84
    v_mfma_f32_16x16x32_bf16 v[156:159], a[24:27], v[120:123], v[156:159]
    v_mov_b32 v82, v80
    v_mov_b32 v86, v84
    v_mfma_f32_16x16x32_bf16 v[168:171], a[24:27], v[124:127], v[168:171]
    s_add_u32 m0, s28, 148480
    v_mov_b32 v90, v88
    v_mfma_f32_16x16x32_bf16 v[152:155], a[20:23], v[120:123], v[152:155]
    buffer_load_dwordx4 v1, s[8:11], s26 offen offset:3072 sc1 lds
    v_mfma_f32_16x16x32_bf16 v[164:167], a[20:23], v[124:127], v[164:167]
    s_waitcnt lgkmcnt(3)
    v_mfma_f32_16x16x32_bf16 v[128:131], a[32:35], v[96:99], v[128:131]
    ds_read_b128 v[112:115], v2 offset:36864
    v_mfma_f32_16x16x32_bf16 v[140:143], a[32:35], v[100:103], v[140:143]
    ds_read_b128 v[116:119], v2 offset:38912
    v_mfma_f32_16x16x32_bf16 v[132:135], a[36:39], v[96:99], v[132:135]
    ds_read_b128 v[120:123], v2 offset:40960
    v_mfma_f32_16x16x32_bf16 v[144:147], a[36:39], v[100:103], v[144:147]
    ds_read_b128 v[124:127], v2 offset:43008
    v_mfma_f32_16x16x32_bf16 v[136:139], a[40:43], v[96:99], v[136:139]
    v_permlane32_swap_b32 v80, v82
    v_mfma_f32_16x16x32_bf16 v[148:151], a[40:43], v[100:103], v[148:151]
    s_waitcnt lgkmcnt(4)
    v_mfma_f32_16x16x32_bf16 v[160:163], a[40:43], v[104:107], v[160:163]
    v_permlane32_swap_b32 v84, v86
    v_mfma_f32_16x16x32_bf16 v[172:175], a[40:43], v[108:111], v[172:175]
    v_permlane32_swap_b32 v88, v90
    v_mfma_f32_16x16x32_bf16 v[156:159], a[36:39], v[104:107], v[156:159]
    v_mov_b32 v81, v80
    v_mov_b32 v83, v82
    v_mfma_f32_16x16x32_bf16 v[168:171], a[36:39], v[108:111], v[168:171]
    v_mov_b32 v85, v84
    v_mov_b32 v87, v86
    v_mfma_f32_16x16x32_bf16 v[152:155], a[32:35], v[104:107], v[152:155]
    v_mov_b32 v89, v88
    v_mov_b32 v91, v90
    v_mfma_f32_16x16x32_bf16 v[164:167], a[32:35], v[108:111], v[164:167]
    s_waitcnt vmcnt(18)
    s_waitcnt lgkmcnt(0)
    s_waitcnt vmcnt(12)
    s_barrier
    v_mov_b32 v199, 15
    buffer_store_dword v199, v26, s[8:11], s37 offen sc1
    v_mfma_f32_16x16x32_bf16 v[128:131], a[44:47], v[112:115], v[128:131]
    ds_read_b128 v[96:99], v2 offset:44032
    v_mfma_f32_16x16x32_bf16 v[140:143], a[44:47], v[116:119], v[140:143]
    ds_read_b128 v[100:103], v2 offset:46080
    v_mfma_f32_16x16x32_bf16 v[132:135], a[48:51], v[112:115], v[132:135]
    ds_read_b128 v[104:107], v2 offset:48128
    v_mfma_f32_16x16x32_bf16 v[144:147], a[48:51], v[116:119], v[144:147]
    ds_read_b128 v[108:111], v2 offset:50176
    v_mfma_f32_16x16x32_bf16 v[136:139], a[56:59], v[112:115], v[136:139]
    v_permlane16_swap_b32 v80, v81
    v_mfma_f32_16x16x32_bf16 v[148:151], a[56:59], v[116:119], v[148:151]
    v_mfma_f32_16x16x32_bf16 v[160:163], a[56:59], v[120:123], v[160:163]
    v_permlane16_swap_b32 v82, v83
    v_mfma_f32_16x16x32_bf16 v[172:175], a[56:59], v[124:127], v[172:175]
    v_permlane16_swap_b32 v84, v85
    v_mfma_f32_16x16x32_bf16 v[156:159], a[48:51], v[120:123], v[156:159]
    v_permlane16_swap_b32 v86, v87
    v_mfma_f32_16x16x32_bf16 v[168:171], a[48:51], v[124:127], v[168:171]
    v_permlane16_swap_b32 v88, v89
    v_mfma_f32_16x16x32_bf16 v[152:155], a[44:47], v[120:123], v[152:155]
    v_permlane16_swap_b32 v90, v91
    v_mfma_f32_16x16x32_bf16 v[164:167], a[44:47], v[124:127], v[164:167]
    s_waitcnt lgkmcnt(2)
    v_mfma_f32_16x16x32_bf16 v[128:131], a[72:75], v[96:99], v[128:131]
    ds_read_b128 v[112:115], v2 offset:45056
    v_mfma_f32_16x16x32_bf16 v[140:143], a[72:75], v[100:103], v[140:143]
    ds_read_b128 v[116:119], v2 offset:47104
    v_mfma_f32_16x16x32_bf16 v[132:135], a[76:79], v[96:99], v[132:135]
    ds_read_b128 v[120:123], v2 offset:49152
    s_waitcnt vmcnt(10)
    ds_read_b128 a[16:19], v95 offset:52224
    v_mfma_f32_16x16x32_bf16 v[144:147], a[76:79], v[100:103], v[144:147]
    ds_read_b128 v[124:127], v2 offset:51200
    s_waitcnt vmcnt(9)
    ds_read_b128 a[20:23], v95 offset:53248
    v_mfma_f32_16x16x32_bf16 v[136:139], a[80:83], v[96:99], v[136:139]
    v_mfma_f32_16x16x32_bf16 v[148:151], a[80:83], v[100:103], v[148:151]
    s_waitcnt vmcnt(8)
    ds_read_b128 a[24:27], v95 offset:60416
    s_waitcnt lgkmcnt(7)
    v_mfma_f32_16x16x32_bf16 v[160:163], a[80:83], v[104:107], v[160:163]
    v_mfma_f32_16x16x32_bf16 v[172:175], a[80:83], v[108:111], v[172:175]
    s_waitcnt vmcnt(7)
    ds_read_b128 a[28:31], v95 offset:61440
    v_mfma_f32_16x16x32_bf16 v[156:159], a[76:79], v[104:107], v[156:159]
    v_mfma_f32_16x16x32_bf16 v[168:171], a[76:79], v[108:111], v[168:171]
    v_mfma_f32_16x16x32_bf16 v[152:155], a[72:75], v[104:107], v[152:155]
    s_waitcnt vmcnt(6)
    ds_read_b128 a[32:35], v21 offset:3072
    v_mfma_f32_16x16x32_bf16 v[164:167], a[72:75], v[108:111], v[164:167]
    s_waitcnt lgkmcnt(7)
    v_mfma_f32_16x16x32_bf16 v[128:131], a[96:99], v[112:115], v[128:131]
    ds_read_b128 v[96:99], v1 offset:3072
    s_add_u32 s26, s25, 28672
    v_mfma_f32_16x16x32_bf16 v[140:143], a[96:99], v[116:119], v[140:143]
    ds_read_b128 v[100:103], v1 offset:5120
    v_mfma_f32_16x16x32_bf16 v[132:135], a[100:103], v[112:115], v[132:135]
    ds_read_b128 v[104:107], v1 offset:7168
    v_mfma_f32_16x16x32_bf16 v[144:147], a[100:103], v[116:119], v[144:147]
    ds_read_b128 v[108:111], v1 offset:9216
    v_mfma_f32_16x16x32_bf16 v[136:139], a[52:55], v[112:115], v[136:139]
    buffer_load_dwordx4 a[36:39], v1, s[8:11], s26 offen offset:0 sc1
    v_mfma_f32_16x16x32_bf16 v[148:151], a[52:55], v[116:119], v[148:151]
    s_waitcnt vmcnt(6)
    ds_read_b128 a[40:43], v21 offset:4096
    s_waitcnt lgkmcnt(9)
    v_mfma_f32_16x16x32_bf16 v[160:163], a[52:55], v[120:123], v[160:163]
    buffer_load_dwordx4 a[44:47], v1, s[8:11], s26 offen offset:1024 sc1
    v_mfma_f32_16x16x32_bf16 v[172:175], a[52:55], v[124:127], v[172:175]
    buffer_load_dwordx4 a[48:51], v1, s[8:11], s26 offen offset:2048 sc1
    v_mfma_f32_16x16x32_bf16 v[156:159], a[100:103], v[120:123], v[156:159]
    s_waitcnt vmcnt(7)
    ds_read_b128 a[56:59], v21 offset:11264
    v_mfma_f32_16x16x32_bf16 v[168:171], a[100:103], v[124:127], v[168:171]
    v_mfma_f32_16x16x32_bf16 v[152:155], a[96:99], v[120:123], v[152:155]
    s_waitcnt vmcnt(6)
    ds_read_b128 a[72:75], v21 offset:12288
    v_mfma_f32_16x16x32_bf16 v[164:167], a[96:99], v[124:127], v[164:167]
    s_waitcnt lgkmcnt(5)
    v_mfma_f32_16x16x32_bf16 v[128:131], a[68:71], v[96:99], v[128:131]
    ds_read_b128 v[112:115], v1 offset:4096
    v_mfma_f32_16x16x32_bf16 v[140:143], a[68:71], v[100:103], v[140:143]
    ds_read_b128 v[116:119], v1 offset:6144
    v_mfma_f32_16x16x32_bf16 v[132:135], a[84:87], v[96:99], v[132:135]
    ds_read_b128 v[120:123], v1 offset:8192
    v_mfma_f32_16x16x32_bf16 v[144:147], a[84:87], v[100:103], v[144:147]
    ds_read_b128 v[124:127], v1 offset:10240
    v_mfma_f32_16x16x32_bf16 v[136:139], a[88:91], v[96:99], v[136:139]
    buffer_load_dwordx4 a[76:79], v1, s[8:11], s26 offen offset:3072 sc1
    v_mfma_f32_16x16x32_bf16 v[148:151], a[88:91], v[100:103], v[148:151]
    s_waitcnt vmcnt(6)
    ds_read_b128 a[80:83], v21 offset:19456
    s_waitcnt lgkmcnt(8)
    v_mfma_f32_16x16x32_bf16 v[160:163], a[88:91], v[104:107], v[160:163]
    s_add_u32 s26, s25, 32768
    v_mfma_f32_16x16x32_bf16 v[172:175], a[88:91], v[108:111], v[172:175]
    buffer_load_dwordx4 a[96:99], v1, s[8:11], s26 offen offset:0 sc1
    v_mfma_f32_16x16x32_bf16 v[156:159], a[84:87], v[104:107], v[156:159]
    buffer_load_dwordx4 a[100:103], v1, s[8:11], s26 offen offset:1024 sc1
    v_mfma_f32_16x16x32_bf16 v[168:171], a[84:87], v[108:111], v[168:171]
    s_add_u32 m0, s28, 115712
    v_mfma_f32_16x16x32_bf16 v[152:155], a[68:71], v[104:107], v[152:155]
    buffer_load_dwordx4 v1, s[8:11], s26 offen offset:2048 sc1 lds
    v_mfma_f32_16x16x32_bf16 v[164:167], a[68:71], v[108:111], v[164:167]
    s_waitcnt vmcnt(8)
    ds_read_b128 a[52:55], v21 offset:20480
    s_waitcnt lgkmcnt(4)
    v_mfma_f32_16x16x32_bf16 v[128:131], a[92:95], v[112:115], v[128:131]
    ds_read_b128 v[96:99], v1 offset:11264
    v_mfma_f32_16x16x32_bf16 v[140:143], a[92:95], v[116:119], v[140:143]
    ds_read_b128 v[100:103], v1 offset:13312
    v_mfma_f32_16x16x32_bf16 v[132:135], a[104:107], v[112:115], v[132:135]
    ds_read_b128 v[104:107], v1 offset:15360
    v_mfma_f32_16x16x32_bf16 v[144:147], a[104:107], v[116:119], v[144:147]
    ds_read_b128 v[108:111], v1 offset:17408
    v_mfma_f32_16x16x32_bf16 v[136:139], a[112:115], v[112:115], v[136:139]
    buffer_load_dwordx4 a[68:71], v1, s[8:11], s26 offen offset:3072 sc1
    v_mfma_f32_16x16x32_bf16 v[148:151], a[112:115], v[116:119], v[148:151]
    s_add_u32 s26, s25, 36864
    s_waitcnt lgkmcnt(6)
    v_mfma_f32_16x16x32_bf16 v[160:163], a[112:115], v[120:123], v[160:163]
    buffer_load_dwordx4 a[84:87], v1, s[8:11], s26 offen offset:0 sc1
    v_mfma_f32_16x16x32_bf16 v[172:175], a[112:115], v[124:127], v[172:175]
    s_add_u32 m0, s28, 117760
    v_mfma_f32_16x16x32_bf16 v[156:159], a[104:107], v[120:123], v[156:159]
    buffer_load_dwordx4 v1, s[8:11], s26 offen offset:1024 sc1 lds
    v_mfma_f32_16x16x32_bf16 v[168:171], a[104:107], v[124:127], v[168:171]
    v_mfma_f32_16x16x32_bf16 v[152:155], a[92:95], v[120:123], v[152:155]
    v_mfma_f32_16x16x32_bf16 v[164:167], a[92:95], v[124:127], v[164:167]
    buffer_load_dword v27, v25, s[8:11], s38 offen sc1
    s_waitcnt lgkmcnt(2)
    v_mfma_f32_16x16x32_bf16 v[128:131], a[116:119], v[96:99], v[128:131]
    ds_read_b128 v[112:115], v1 offset:12288
    v_mfma_f32_16x16x32_bf16 v[140:143], a[116:119], v[100:103], v[140:143]
    ds_read_b128 v[116:119], v1 offset:14336
    v_mfma_f32_16x16x32_bf16 v[132:135], a[160:163], v[96:99], v[132:135]
    ds_read_b128 v[120:123], v1 offset:16384
    v_mfma_f32_16x16x32_bf16 v[144:147], a[160:163], v[100:103], v[144:147]
    ds_read_b128 v[124:127], v1 offset:18432
    v_mfma_f32_16x16x32_bf16 v[136:139], a[124:127], v[96:99], v[136:139]
    v_mfma_f32_16x16x32_bf16 v[148:151], a[124:127], v[100:103], v[148:151]
    s_waitcnt lgkmcnt(4)
    v_mfma_f32_16x16x32_bf16 v[160:163], a[124:127], v[104:107], v[160:163]
    buffer_load_dwordx4 a[88:91], v1, s[8:11], s26 offen offset:2048 sc1
    v_mfma_f32_16x16x32_bf16 v[172:175], a[124:127], v[108:111], v[172:175]
    buffer_load_dwordx4 a[92:95], v1, s[8:11], s26 offen offset:3072 sc1
    v_mfma_f32_16x16x32_bf16 v[156:159], a[160:163], v[104:107], v[156:159]
    s_add_u32 m0, s28, 125952
    s_add_u32 s26, s25, 40960
    v_mfma_f32_16x16x32_bf16 v[168:171], a[160:163], v[108:111], v[168:171]
    buffer_load_dwordx4 v1, s[8:11], s26 offen offset:0 sc1 lds
    v_mfma_f32_16x16x32_bf16 v[152:155], a[116:119], v[104:107], v[152:155]
    v_mfma_f32_16x16x32_bf16 v[164:167], a[116:119], v[108:111], v[164:167]
    s_waitcnt lgkmcnt(0)
    s_barrier
    v_mfma_f32_16x16x32_bf16 v[128:131], a[128:131], v[112:115], v[128:131]
    ds_read_b128 v[96:99], v1 offset:19456
    v_mfma_f32_16x16x32_bf16 v[140:143], a[128:131], v[116:119], v[140:143]
    ds_read_b128 v[100:103], v1 offset:21504
    v_mfma_f32_16x16x32_bf16 v[132:135], a[164:167], v[112:115], v[132:135]
    ds_read_b128 v[104:107], v1 offset:23552
    v_mfma_f32_16x16x32_bf16 v[144:147], a[164:167], v[116:119], v[144:147]
    ds_read_b128 v[108:111], v1 offset:25600
    v_mfma_f32_16x16x32_bf16 v[136:139], a[132:135], v[112:115], v[136:139]
    v_mfma_f32_16x16x32_bf16 v[148:151], a[132:135], v[116:119], v[148:151]
    v_mfma_f32_16x16x32_bf16 v[160:163], a[132:135], v[120:123], v[160:163]
    buffer_load_dwordx4 a[104:107], v1, s[8:11], s26 offen offset:1024 sc1
    v_mfma_f32_16x16x32_bf16 v[172:175], a[132:135], v[124:127], v[172:175]
    v_mfma_f32_16x16x32_bf16 v[156:159], a[164:167], v[120:123], v[156:159]
    v_mfma_f32_16x16x32_bf16 v[168:171], a[164:167], v[124:127], v[168:171]
    buffer_load_dwordx4 a[112:115], v1, s[8:11], s26 offen offset:2048 sc1
    v_mfma_f32_16x16x32_bf16 v[152:155], a[128:131], v[120:123], v[152:155]
    s_add_u32 m0, s28, 123904
    v_mfma_f32_16x16x32_bf16 v[164:167], a[128:131], v[124:127], v[164:167]
    s_waitcnt lgkmcnt(2)
    v_mfma_f32_16x16x32_bf16 v[128:131], a[136:139], v[96:99], v[128:131]
    ds_read_b128 v[112:115], v1 offset:20480
    v_mfma_f32_16x16x32_bf16 v[140:143], a[136:139], v[100:103], v[140:143]
    ds_read_b128 v[116:119], v1 offset:22528
    v_mfma_f32_16x16x32_bf16 v[132:135], a[168:171], v[96:99], v[132:135]
    ds_read_b128 v[120:123], v1 offset:24576
    v_mfma_f32_16x16x32_bf16 v[144:147], a[168:171], v[100:103], v[144:147]
    ds_read_b128 v[124:127], v1 offset:26624
    v_mfma_f32_16x16x32_bf16 v[136:139], a[140:143], v[96:99], v[136:139]
    buffer_load_dwordx4 v1, s[8:11], s26 offen offset:3072 sc1 lds
    v_mfma_f32_16x16x32_bf16 v[148:151], a[140:143], v[100:103], v[148:151]
    s_add_u32 s26, s25, 45056
    s_waitcnt lgkmcnt(4)
    v_mfma_f32_16x16x32_bf16 v[160:163], a[140:143], v[104:107], v[160:163]
    buffer_load_dwordx4 a[116:119], v1, s[8:11], s26 offen offset:0 sc1
    v_mfma_f32_16x16x32_bf16 v[172:175], a[140:143], v[108:111], v[172:175]
    buffer_load_dwordx4 a[160:163], v1, s[8:11], s26 offen offset:1024 sc1
    v_mfma_f32_16x16x32_bf16 v[156:159], a[168:171], v[104:107], v[156:159]
    s_add_u32 m0, s28, 132096
    v_mfma_f32_16x16x32_bf16 v[168:171], a[168:171], v[108:111], v[168:171]
    buffer_load_dwordx4 v1, s[8:11], s26 offen offset:2048 sc1 lds
    v_mfma_f32_16x16x32_bf16 v[152:155], a[136:139], v[104:107], v[152:155]
    s_add_u32 m0, s28, 132096
    v_mfma_f32_16x16x32_bf16 v[164:167], a[136:139], v[108:111], v[164:167]
    s_waitcnt lgkmcnt(2)
    v_mfma_f32_16x16x32_bf16 v[128:131], a[144:147], v[112:115], v[128:131]
    ds_read_b128 v[96:99], v1 offset:27648
    v_mfma_f32_16x16x32_bf16 v[140:143], a[144:147], v[116:119], v[140:143]
    ds_read_b128 v[100:103], v1 offset:29696
    v_mfma_f32_16x16x32_bf16 v[132:135], a[172:175], v[112:115], v[132:135]
    ds_read_b128 v[104:107], v1 offset:31744
    v_mfma_f32_16x16x32_bf16 v[144:147], a[172:175], v[116:119], v[144:147]
    ds_read_b128 v[108:111], v1 offset:33792
    v_mfma_f32_16x16x32_bf16 v[136:139], a[148:151], v[112:115], v[136:139]
    buffer_load_dwordx4 v1, s[8:11], s26 offen offset:3072 sc1 lds
    v_mfma_f32_16x16x32_bf16 v[148:151], a[148:151], v[116:119], v[148:151]
    s_waitcnt lgkmcnt(4)
    v_mfma_f32_16x16x32_bf16 v[160:163], a[148:151], v[120:123], v[160:163]
    v_mfma_f32_16x16x32_bf16 v[172:175], a[148:151], v[124:127], v[172:175]
    v_mfma_f32_16x16x32_bf16 v[156:159], a[172:175], v[120:123], v[156:159]
    s_add_u32 s26, s25, 49152
    v_mfma_f32_16x16x32_bf16 v[168:171], a[172:175], v[124:127], v[168:171]
    buffer_load_dwordx4 a[124:127], v1, s[8:11], s26 offen offset:0 sc1
    v_mfma_f32_16x16x32_bf16 v[152:155], a[144:147], v[120:123], v[152:155]
    s_add_u32 m0, s28, 141312
    v_mfma_f32_16x16x32_bf16 v[164:167], a[144:147], v[124:127], v[164:167]
    s_waitcnt vmcnt(11)
    v_cmp_le_u32 vcc, 15, v27
    s_nop 3
    s_cmp_eq_u64 vcc, -1
    s_cbranch_scc1 L_pdone_98
    s_mov_b32 s68, 0x80000
L_poll_97:
    buffer_load_dword v27, v25, s[8:11], s38 offen sc1
    s_waitcnt vmcnt(0)
    v_cmp_le_u32 vcc, 15, v27
    s_nop 3
    s_cmp_eq_u64 vcc, -1
    s_cbranch_scc1 L_pdone_98
    s_sub_u32 s68, s68, 1
    s_cmp_lg_u32 s68, 0
    s_cbranch_scc1 L_poll_97
L_pdone_98:
    s_waitcnt lgkmcnt(2)
    v_mfma_f32_16x16x32_bf16 v[128:131], a[152:155], v[96:99], v[128:131]
    ds_read_b128 v[112:115], v1 offset:28672
    ds_read_b128 a[128:131], v95 offset:52224
    v_mfma_f32_16x16x32_bf16 v[140:143], a[152:155], v[100:103], v[140:143]
    ds_read_b128 v[116:119], v1 offset:30720
    ds_read_b128 a[164:167], v95 offset:53248
    v_mfma_f32_16x16x32_bf16 v[132:135], a[188:191], v[96:99], v[132:135]
    ds_read_b128 v[120:123], v1 offset:32768
    v_mfma_f32_16x16x32_bf16 v[144:147], a[188:191], v[100:103], v[144:147]
    ds_read_b128 v[124:127], v1 offset:34816
    v_mfma_f32_16x16x32_bf16 v[136:139], a[180:183], v[96:99], v[136:139]
    buffer_load_dwordx4 v1, s[8:11], s26 offen offset:1024 sc1 lds
    v_mfma_f32_16x16x32_bf16 v[148:151], a[180:183], v[100:103], v[148:151]
    s_add_u32 s88, s31, 20975616
    s_add_u32 s88, s88, s8
    s_addc_u32 s89, s52, 0
    s_waitcnt lgkmcnt(6)
    v_mfma_f32_16x16x32_bf16 v[160:163], a[180:183], v[104:107], v[160:163]
    global_load_dwordx4 v[216:219], v1, s[88:89] offset:-4096 sc1
    v_mfma_f32_16x16x32_bf16 v[172:175], a[180:183], v[108:111], v[172:175]
    s_add_u32 s90, s31, 21024768
    s_add_u32 s90, s90, s8
    s_addc_u32 s91, s52, 0
    v_mfma_f32_16x16x32_bf16 v[156:159], a[188:191], v[104:107], v[156:159]
    global_load_dwordx4 v[220:223], v1, s[90:91] offset:-4096 sc1
    v_mfma_f32_16x16x32_bf16 v[168:171], a[188:191], v[108:111], v[168:171]
    global_load_dwordx4 v[224:227], v1, s[88:89] offset:-3072 sc1
    v_mfma_f32_16x16x32_bf16 v[152:155], a[152:155], v[104:107], v[152:155]
    v_mfma_f32_16x16x32_bf16 v[164:167], a[152:155], v[108:111], v[164:167]
    s_waitcnt lgkmcnt(3)
    v_mfma_f32_16x16x32_bf16 v[128:131], a[244:247], v[112:115], v[128:131]
    ds_read_b128 v[96:99], v1 offset:35840
    v_mfma_f32_16x16x32_bf16 v[140:143], a[244:247], v[116:119], v[140:143]
    ds_read_b128 v[100:103], v1 offset:37888
    v_mfma_f32_16x16x32_bf16 v[132:135], a[240:243], v[112:115], v[132:135]
    ds_read_b128 v[104:107], v1 offset:39936
    v_mfma_f32_16x16x32_bf16 v[144:147], a[240:243], v[116:119], v[144:147]
    ds_read_b128 v[108:111], v1 offset:41984
    v_mfma_f32_16x16x32_bf16 v[136:139], a[196:199], v[112:115], v[136:139]
    global_load_dwordx4 v[228:231], v1, s[90:91] offset:-3072 sc1
    v_mfma_f32_16x16x32_bf16 v[148:151], a[196:199], v[116:119], v[148:151]
    s_waitcnt lgkmcnt(4)
    v_mfma_f32_16x16x32_bf16 v[160:163], a[196:199], v[120:123], v[160:163]
    s_waitcnt vmcnt(13)
    ds_read_b128 a[132:135], v95 offset:60416
    v_mfma_f32_16x16x32_bf16 v[172:175], a[196:199], v[124:127], v[172:175]
    global_load_dwordx4 v[232:235], v1, s[88:89] offset:-2048 sc1
    v_mfma_f32_16x16x32_bf16 v[156:159], a[240:243], v[120:123], v[156:159]
    global_load_dwordx4 v[236:239], v1, s[90:91] offset:-2048 sc1
    v_mfma_f32_16x16x32_bf16 v[168:171], a[240:243], v[124:127], v[168:171]
    global_load_dwordx4 v[240:243], v1, s[88:89] offset:-1024 sc1
    v_mfma_f32_16x16x32_bf16 v[152:155], a[244:247], v[120:123], v[152:155]
    v_mfma_f32_16x16x32_bf16 v[164:167], a[244:247], v[124:127], v[164:167]
    s_waitcnt lgkmcnt(3)
    v_mfma_f32_16x16x32_bf16 v[128:131], a[184:187], v[96:99], v[128:131]
    ds_read_b128 v[112:115], v1 offset:36864
    v_mfma_f32_16x16x32_bf16 v[140:143], a[184:187], v[100:103], v[140:143]
    ds_read_b128 v[116:119], v1 offset:38912
    v_mfma_f32_16x16x32_bf16 v[132:135], a[176:179], v[96:99], v[132:135]
    ds_read_b128 v[120:123], v1 offset:40960
    v_mfma_f32_16x16x32_bf16 v[144:147], a[176:179], v[100:103], v[144:147]
    ds_read_b128 v[124:127], v1 offset:43008
    v_mfma_f32_16x16x32_bf16 v[136:139], a[224:227], v[96:99], v[136:139]
    global_load_dwordx4 v[244:247], v1, s[90:91] offset:-1024 sc1
    v_mfma_f32_16x16x32_bf16 v[148:151], a[224:227], v[100:103], v[148:151]
    s_waitcnt lgkmcnt(5)
    v_mfma_f32_16x16x32_bf16 v[160:163], a[224:227], v[104:107], v[160:163]
    global_load_dwordx4 v[248:251], v1, s[88:89] offset:0 sc1
    v_mfma_f32_16x16x32_bf16 v[172:175], a[224:227], v[108:111], v[172:175]
    v_mfma_f32_16x16x32_bf16 v[156:159], a[176:179], v[104:107], v[156:159]
    v_mfma_f32_16x16x32_bf16 v[168:171], a[176:179], v[108:111], v[168:171]
    v_mfma_f32_16x16x32_bf16 v[152:155], a[184:187], v[104:107], v[152:155]
    v_mfma_f32_16x16x32_bf16 v[164:167], a[184:187], v[108:111], v[164:167]
    s_waitcnt lgkmcnt(2)
    v_mfma_f32_16x16x32_bf16 v[128:131], a[220:223], v[112:115], v[128:131]
    v_mfma_f32_16x16x32_bf16 v[140:143], a[220:223], v[116:119], v[140:143]
    s_waitcnt vmcnt(15)
    ds_read_b128 a[136:139], v95 offset:61440
    v_mfma_f32_16x16x32_bf16 v[132:135], a[192:195], v[112:115], v[132:135]
    v_mfma_f32_16x16x32_bf16 v[144:147], a[192:195], v[116:119], v[144:147]
    v_mfma_f32_16x16x32_bf16 v[136:139], a[156:159], v[112:115], v[136:139]
    v_mfma_f32_16x16x32_bf16 v[148:151], a[156:159], v[116:119], v[148:151]
    s_waitcnt lgkmcnt(1)
    v_mfma_f32_16x16x32_bf16 v[160:163], a[156:159], v[120:123], v[160:163]
    s_waitcnt vmcnt(12)
    ds_read_b128 a[168:171], v21 offset:3072
    v_mfma_f32_16x16x32_bf16 v[172:175], a[156:159], v[124:127], v[172:175]
    global_load_dwordx4 v[252:255], v1, s[90:91] offset:0 sc1
    v_mfma_f32_16x16x32_bf16 v[156:159], a[192:195], v[120:123], v[156:159]
    v_mfma_f32_16x16x32_bf16 v[168:171], a[192:195], v[124:127], v[168:171]
    v_mfma_f32_16x16x32_bf16 v[152:155], a[220:223], v[120:123], v[152:155]
    v_mfma_f32_16x16x32_bf16 v[164:167], a[220:223], v[124:127], v[164:167]
    s_add_u32 s56, s33, 21168128
    v_pk_fma_f32 v[128:129], v[80:81], v[52:53], v[128:129] op_sel:[0,0,0] op_sel_hi:[0,1,1] neg_lo:[1,0,0] neg_hi:[1,0,0]
    v_pk_fma_f32 v[130:131], v[80:81], v[54:55], v[130:131] op_sel:[0,0,0] op_sel_hi:[0,1,1] neg_lo:[1,0,0] neg_hi:[1,0,0]
    v_pk_fma_f32 v[140:141], v[80:81], v[52:53], v[140:141] op_sel:[1,0,0] op_sel_hi:[1,1,1] neg_lo:[1,0,0] neg_hi:[1,0,0]
    v_pk_fma_f32 v[142:143], v[80:81], v[54:55], v[142:143] op_sel:[1,0,0] op_sel_hi:[1,1,1] neg_lo:[1,0,0] neg_hi:[1,0,0]
    s_nop 1
    v_pk_fma_f32 v[152:153], v[82:83], v[52:53], v[152:153] op_sel:[0,0,0] op_sel_hi:[0,1,1] neg_lo:[1,0,0] neg_hi:[1,0,0]
    s_waitcnt vmcnt(12)
    ds_read_b128 a[140:143], v21 offset:4096
    v_pk_fma_f32 v[154:155], v[82:83], v[54:55], v[154:155] op_sel:[0,0,0] op_sel_hi:[0,1,1] neg_lo:[1,0,0] neg_hi:[1,0,0]
    v_pk_fma_f32 v[164:165], v[82:83], v[52:53], v[164:165] op_sel:[1,0,0] op_sel_hi:[1,1,1] neg_lo:[1,0,0] neg_hi:[1,0,0]
    v_pk_fma_f32 v[166:167], v[82:83], v[54:55], v[166:167] op_sel:[1,0,0] op_sel_hi:[1,1,1] neg_lo:[1,0,0] neg_hi:[1,0,0]
    v_pk_mul_f32 v[128:129], v[84:85], v[128:129] op_sel:[0,0] op_sel_hi:[0,1]
    v_pk_mul_f32 v[140:141], v[84:85], v[140:141] op_sel:[1,0] op_sel_hi:[1,1]
    v_pk_mul_f32 v[152:153], v[86:87], v[152:153] op_sel:[0,0] op_sel_hi:[0,1]
    v_pk_mul_f32 v[164:165], v[86:87], v[164:165] op_sel:[1,0] op_sel_hi:[1,1]
    v_exp_f32 v128, v128
    v_exp_f32 v129, v129
    v_exp_f32 v140, v140
    global_load_dwordx4 v[96:99], v1, s[88:89] offset:1024 sc1
    v_exp_f32 v141, v141
    v_exp_f32 v152, v152
    v_exp_f32 v153, v153
    v_exp_f32 v164, v164
    global_load_dwordx4 v[100:103], v1, s[90:91] offset:1024 sc1
    v_exp_f32 v165, v165
    v_pk_fma_f32 v[128:129], v[128:129], v[88:89], v[88:89] op_sel:[0,0,0] op_sel_hi:[1,0,0]
    global_load_dwordx4 v[104:107], v1, s[88:89] offset:2048 sc1
    v_pk_fma_f32 v[140:141], v[140:141], v[88:89], v[88:89] op_sel:[0,1,1] op_sel_hi:[1,1,1]
    v_pk_fma_f32 v[152:153], v[152:153], v[90:91], v[90:91] op_sel:[0,0,0] op_sel_hi:[1,0,0]
    v_pk_fma_f32 v[164:165], v[164:165], v[90:91], v[90:91] op_sel:[0,1,1] op_sel_hi:[1,1,1]
    v_rcp_f32 v128, v128
    v_rcp_f32 v129, v129
    v_rcp_f32 v140, v140
    v_rcp_f32 v141, v141
    v_rcp_f32 v152, v152
    v_rcp_f32 v153, v153
    v_rcp_f32 v164, v164
    v_rcp_f32 v165, v165
    v_pk_mul_f32 v[128:129], v[128:129], v[130:131]
    v_pk_mul_f32 v[140:141], v[140:141], v[142:143]
    v_pk_mul_f32 v[152:153], v[152:153], v[154:155]
    v_pk_mul_f32 v[164:165], v[164:165], v[166:167]
    v_cvt_pk_bf16_f32 v176, v128, v129
    v_cvt_pk_bf16_f32 v177, v140, v141
    v_cvt_pk_bf16_f32 v178, v152, v153
    v_cvt_pk_bf16_f32 v179, v164, v165
    global_load_dwordx4 v[108:111], v1, s[90:91] offset:2048 sc1
    v_permlane32_swap_b32 v176, v178
    v_permlane32_swap_b32 v177, v179
    s_nop 1
    v_permlane16_swap_b32 v176, v177
    v_permlane16_swap_b32 v178, v179
    buffer_store_dwordx4 v[176:179], v24, s[8:11], s56 offen offset:0 sc1
    v_pk_fma_f32 v[132:133], v[80:81], v[56:57], v[132:133] op_sel:[0,0,0] op_sel_hi:[0,1,1] neg_lo:[1,0,0] neg_hi:[1,0,0]
    v_pk_fma_f32 v[134:135], v[80:81], v[58:59], v[134:135] op_sel:[0,0,0] op_sel_hi:[0,1,1] neg_lo:[1,0,0] neg_hi:[1,0,0]
    v_pk_fma_f32 v[144:145], v[80:81], v[56:57], v[144:145] op_sel:[1,0,0] op_sel_hi:[1,1,1] neg_lo:[1,0,0] neg_hi:[1,0,0]
    s_waitcnt vmcnt(15)
    ds_read_b128 a[144:147], v21 offset:11264
    v_pk_fma_f32 v[146:147], v[80:81], v[58:59], v[146:147] op_sel:[1,0,0] op_sel_hi:[1,1,1] neg_lo:[1,0,0] neg_hi:[1,0,0]
    v_pk_fma_f32 v[156:157], v[82:83], v[56:57], v[156:157] op_sel:[0,0,0] op_sel_hi:[0,1,1] neg_lo:[1,0,0] neg_hi:[1,0,0]
    v_pk_fma_f32 v[158:159], v[82:83], v[58:59], v[158:159] op_sel:[0,0,0] op_sel_hi:[0,1,1] neg_lo:[1,0,0] neg_hi:[1,0,0]
    global_load_dwordx4 v[112:115], v1, s[88:89] offset:3072 sc1
    v_pk_fma_f32 v[168:169], v[82:83], v[56:57], v[168:169] op_sel:[1,0,0] op_sel_hi:[1,1,1] neg_lo:[1,0,0] neg_hi:[1,0,0]
    v_pk_fma_f32 v[170:171], v[82:83], v[58:59], v[170:171] op_sel:[1,0,0] op_sel_hi:[1,1,1] neg_lo:[1,0,0] neg_hi:[1,0,0]
    v_pk_mul_f32 v[132:133], v[84:85], v[132:133] op_sel:[0,0] op_sel_hi:[0,1]
    global_load_dwordx4 v[116:119], v1, s[90:91] offset:3072 sc1
    v_pk_mul_f32 v[144:145], v[84:85], v[144:145] op_sel:[1,0] op_sel_hi:[1,1]
    v_pk_mul_f32 v[156:157], v[86:87], v[156:157] op_sel:[0,0] op_sel_hi:[0,1]
    v_pk_mul_f32 v[168:169], v[86:87], v[168:169] op_sel:[1,0] op_sel_hi:[1,1]
    v_exp_f32 v132, v132
    v_exp_f32 v133, v133
    v_exp_f32 v144, v144
    v_exp_f32 v145, v145
    v_exp_f32 v156, v156
    v_exp_f32 v157, v157
    v_exp_f32 v168, v168
    v_exp_f32 v169, v169
    v_pk_fma_f32 v[132:133], v[132:133], v[88:89], v[88:89] op_sel:[0,0,0] op_sel_hi:[1,0,0]
    v_pk_fma_f32 v[144:145], v[144:145], v[88:89], v[88:89] op_sel:[0,1,1] op_sel_hi:[1,1,1]
    v_pk_fma_f32 v[156:157], v[156:157], v[90:91], v[90:91] op_sel:[0,0,0] op_sel_hi:[1,0,0]
    v_pk_fma_f32 v[168:169], v[168:169], v[90:91], v[90:91] op_sel:[0,1,1] op_sel_hi:[1,1,1]
    v_rcp_f32 v132, v132
    v_rcp_f32 v133, v133
    s_add_u32 s88, s31, 20983808
    s_add_u32 s88, s88, s8
    s_addc_u32 s89, s52, 0
    global_load_dwordx4 v[120:123], v1, s[88:89] offset:-4096 sc1
    v_rcp_f32 v144, v144
    v_rcp_f32 v145, v145
    s_add_u32 s90, s31, 21032960
    s_add_u32 s90, s90, s8
    s_addc_u32 s91, s52, 0
    global_load_dwordx4 v[124:127], v1, s[90:91] offset:-4096 sc1
    v_rcp_f32 v156, v156
    v_rcp_f32 v157, v157
    v_rcp_f32 v168, v168
    v_rcp_f32 v169, v169
    v_pk_mul_f32 v[132:133], v[132:133], v[134:135]
    v_pk_mul_f32 v[144:145], v[144:145], v[146:147]
    v_pk_mul_f32 v[156:157], v[156:157], v[158:159]
    v_pk_mul_f32 v[168:169], v[168:169], v[170:171]
    v_cvt_pk_bf16_f32 v180, v132, v133
    v_cvt_pk_bf16_f32 v181, v144, v145
    v_cvt_pk_bf16_f32 v182, v156, v157
    v_cvt_pk_bf16_f32 v183, v168, v169
    s_nop 0
    v_permlane32_swap_b32 v180, v182
    v_permlane32_swap_b32 v181, v183
    s_nop 1
    v_permlane16_swap_b32 v180, v181
    v_permlane16_swap_b32 v182, v183
    buffer_store_dwordx4 v[180:183], v24, s[8:11], s56 offen offset:256 sc1
    v_pk_fma_f32 v[136:137], v[80:81], v[60:61], v[136:137] op_sel:[0,0,0] op_sel_hi:[0,1,1] neg_lo:[1,0,0] neg_hi:[1,0,0]
    v_pk_fma_f32 v[138:139], v[80:81], v[62:63], v[138:139] op_sel:[0,0,0] op_sel_hi:[0,1,1] neg_lo:[1,0,0] neg_hi:[1,0,0]
    v_pk_fma_f32 v[148:149], v[80:81], v[60:61], v[148:149] op_sel:[1,0,0] op_sel_hi:[1,1,1] neg_lo:[1,0,0] neg_hi:[1,0,0]
    v_pk_fma_f32 v[150:151], v[80:81], v[62:63], v[150:151] op_sel:[1,0,0] op_sel_hi:[1,1,1] neg_lo:[1,0,0] neg_hi:[1,0,0]
    v_pk_fma_f32 v[160:161], v[82:83], v[60:61], v[160:161] op_sel:[0,0,0] op_sel_hi:[0,1,1] neg_lo:[1,0,0] neg_hi:[1,0,0]
    v_pk_fma_f32 v[162:163], v[82:83], v[62:63], v[162:163] op_sel:[0,0,0] op_sel_hi:[0,1,1] neg_lo:[1,0,0] neg_hi:[1,0,0]
    v_pk_fma_f32 v[172:173], v[82:83], v[60:61], v[172:173] op_sel:[1,0,0] op_sel_hi:[1,1,1] neg_lo:[1,0,0] neg_hi:[1,0,0]
    v_pk_fma_f32 v[174:175], v[82:83], v[62:63], v[174:175] op_sel:[1,0,0] op_sel_hi:[1,1,1] neg_lo:[1,0,0] neg_hi:[1,0,0]
    v_pk_mul_f32 v[136:137], v[84:85], v[136:137] op_sel:[0,0] op_sel_hi:[0,1]
    v_pk_mul_f32 v[148:149], v[84:85], v[148:149] op_sel:[1,0] op_sel_hi:[1,1]
    v_pk_mul_f32 v[160:161], v[86:87], v[160:161] op_sel:[0,0] op_sel_hi:[0,1]
    v_pk_mul_f32 v[172:173], v[86:87], v[172:173] op_sel:[1,0] op_sel_hi:[1,1]
    v_exp_f32 v136, v136
    v_exp_f32 v137, v137
    v_exp_f32 v148, v148
    v_exp_f32 v149, v149
    v_exp_f32 v160, v160
    v_exp_f32 v161, v161
    v_exp_f32 v172, v172
    v_exp_f32 v173, v173
    v_pk_fma_f32 v[136:137], v[136:137], v[88:89], v[88:89] op_sel:[0,0,0] op_sel_hi:[1,0,0]
    v_pk_fma_f32 v[148:149], v[148:149], v[88:89], v[88:89] op_sel:[0,1,1] op_sel_hi:[1,1,1]
    v_pk_fma_f32 v[160:161], v[160:161], v[90:91], v[90:91] op_sel:[0,0,0] op_sel_hi:[1,0,0]
    v_pk_fma_f32 v[172:173], v[172:173], v[90:91], v[90:91] op_sel:[0,1,1] op_sel_hi:[1,1,1]
    v_rcp_f32 v136, v136
    v_rcp_f32 v137, v137
    v_rcp_f32 v148, v148
    v_rcp_f32 v149, v149
    v_rcp_f32 v160, v160
    v_rcp_f32 v161, v161
    v_rcp_f32 v172, v172
    v_rcp_f32 v173, v173
    v_pk_mul_f32 v[136:137], v[136:137], v[138:139]
    v_pk_mul_f32 v[148:149], v[148:149], v[150:151]
    v_pk_mul_f32 v[160:161], v[160:161], v[162:163]
    v_pk_mul_f32 v[172:173], v[172:173], v[174:175]
    v_cvt_pk_bf16_f32 v184, v136, v137
    v_cvt_pk_bf16_f32 v185, v148, v149
    v_cvt_pk_bf16_f32 v186, v160, v161
    v_cvt_pk_bf16_f32 v187, v172, v173
    s_nop 0
    v_permlane32_swap_b32 v184, v186
    v_permlane32_swap_b32 v185, v187
    s_nop 1
    v_permlane16_swap_b32 v184, v185
    v_permlane16_swap_b32 v186, v187
    buffer_load_dwordx4 a[172:175], v1, s[8:11], s26 offen offset:2048 sc1
    buffer_store_dwordx4 v[184:187], v24, s[8:11], s56 offen offset:512 sc1
    s_waitcnt lgkmcnt(0)
    s_waitcnt vmcnt(20)
    v_mfma_f32_16x16x32_bf16 v[128:131], a[208:211], v[216:219], 0
    v_mfma_f32_16x16x32_bf16 v[132:135], a[204:207], v[216:219], 0
    v_mfma_f32_16x16x32_bf16 v[136:139], a[200:203], v[216:219], 0
    global_load_dwordx4 v[168:171], v1, s[88:89] offset:-3072 sc1
    v_mfma_f32_16x16x32_bf16 v[140:143], a[228:231], v[216:219], 0
    v_mfma_f32_16x16x32_bf16 v[144:147], a[248:251], v[216:219], 0
    v_mfma_f32_16x16x32_bf16 v[148:151], a[208:211], v[220:223], 0
    v_mfma_f32_16x16x32_bf16 v[152:155], a[204:207], v[220:223], 0
    v_mfma_f32_16x16x32_bf16 v[156:159], a[200:203], v[220:223], 0
    v_mfma_f32_16x16x32_bf16 v[160:163], a[228:231], v[220:223], 0
    v_mfma_f32_16x16x32_bf16 v[164:167], a[248:251], v[220:223], 0
    s_waitcnt vmcnt(19)
    v_mfma_f32_16x16x32_bf16 v[128:131], a[212:215], v[224:227], v[128:131]
    global_load_dwordx4 v[172:175], v1, s[90:91] offset:-3072 sc1
    v_mfma_f32_16x16x32_bf16 v[132:135], a[232:235], v[224:227], v[132:135]
    v_mfma_f32_16x16x32_bf16 v[136:139], a[252:255], v[224:227], v[136:139]
    v_mfma_f32_16x16x32_bf16 v[140:143], a[216:219], v[224:227], v[140:143]
    buffer_load_dwordx4 a[148:151], v1, s[8:11], s26 offen offset:3072 sc1
    v_mfma_f32_16x16x32_bf16 v[144:147], a[236:239], v[224:227], v[144:147]
    s_add_u32 s26, s25, 53248
    v_mfma_f32_16x16x32_bf16 v[148:151], a[212:215], v[228:231], v[148:151]
    buffer_load_dwordx4 a[152:155], v1, s[8:11], s26 offen offset:0 sc1
    v_mfma_f32_16x16x32_bf16 v[152:155], a[232:235], v[228:231], v[152:155]
    v_mfma_f32_16x16x32_bf16 v[156:159], a[252:255], v[228:231], v[156:159]
    v_mfma_f32_16x16x32_bf16 v[160:163], a[216:219], v[228:231], v[160:163]
    v_mfma_f32_16x16x32_bf16 v[164:167], a[236:239], v[228:231], v[164:167]
    s_waitcnt vmcnt(20)
    v_mfma_f32_16x16x32_bf16 v[128:131], a[0:3], v[232:235], v[128:131]
    v_mfma_f32_16x16x32_bf16 v[132:135], a[4:7], v[232:235], v[132:135]
    v_mfma_f32_16x16x32_bf16 v[136:139], a[8:11], v[232:235], v[136:139]
    buffer_load_dwordx4 a[188:191], v1, s[8:11], s26 offen offset:1024 sc1
    v_mfma_f32_16x16x32_bf16 v[140:143], a[12:15], v[232:235], v[140:143]
    v_mfma_f32_16x16x32_bf16 v[144:147], a[60:63], v[232:235], v[144:147]
    buffer_load_dwordx4 a[180:183], v1, s[8:11], s26 offen offset:2048 sc1
    v_mfma_f32_16x16x32_bf16 v[148:151], a[0:3], v[236:239], v[148:151]
    v_mfma_f32_16x16x32_bf16 v[152:155], a[4:7], v[236:239], v[152:155]
    v_mfma_f32_16x16x32_bf16 v[156:159], a[8:11], v[236:239], v[156:159]
    v_mfma_f32_16x16x32_bf16 v[160:163], a[12:15], v[236:239], v[160:163]
    v_mfma_f32_16x16x32_bf16 v[164:167], a[60:63], v[236:239], v[164:167]
    s_waitcnt vmcnt(20)
    v_mfma_f32_16x16x32_bf16 v[128:131], a[64:67], v[240:243], v[128:131]
    v_mfma_f32_16x16x32_bf16 v[132:135], a[108:111], v[240:243], v[132:135]
    v_mfma_f32_16x16x32_bf16 v[136:139], a[120:123], v[240:243], v[136:139]
    v_mfma_f32_16x16x32_bf16 v[140:143], a[16:19], v[240:243], v[140:143]
    v_mfma_f32_16x16x32_bf16 v[144:147], a[20:23], v[240:243], v[144:147]
    v_mfma_f32_16x16x32_bf16 v[148:151], a[64:67], v[244:247], v[148:151]
    v_mfma_f32_16x16x32_bf16 v[152:155], a[108:111], v[244:247], v[152:155]
    global_load_dwordx4 v[216:219], v1, s[88:89] offset:-2048 sc1
    v_mfma_f32_16x16x32_bf16 v[156:159], a[120:123], v[244:247], v[156:159]
    v_mfma_f32_16x16x32_bf16 v[160:163], a[16:19], v[244:247], v[160:163]
    v_mfma_f32_16x16x32_bf16 v[164:167], a[20:23], v[244:247], v[164:167]
    s_waitcnt vmcnt(19)
    v_mfma_f32_16x16x32_bf16 v[128:131], a[24:27], v[248:251], v[128:131]
    global_load_dwordx4 v[220:223], v1, s[90:91] offset:-2048 sc1
    v_mfma_f32_16x16x32_bf16 v[132:135], a[28:31], v[248:251], v[132:135]
    v_mfma_f32_16x16x32_bf16 v[136:139], a[32:35], v[248:251], v[136:139]
    v_mfma_f32_16x16x32_bf16 v[140:143], a[40:43], v[248:251], v[140:143]
    v_mfma_f32_16x16x32_bf16 v[144:147], a[56:59], v[248:251], v[144:147]
    v_mfma_f32_16x16x32_bf16 v[148:151], a[24:27], v[252:255], v[148:151]
    v_mfma_f32_16x16x32_bf16 v[152:155], a[28:31], v[252:255], v[152:155]
    v_mfma_f32_16x16x32_bf16 v[156:159], a[32:35], v[252:255], v[156:159]
    v_mfma_f32_16x16x32_bf16 v[160:163], a[40:43], v[252:255], v[160:163]
    v_mfma_f32_16x16x32_bf16 v[164:167], a[56:59], v[252:255], v[164:167]
    s_waitcnt vmcnt(18)
    v_mfma_f32_16x16x32_bf16 v[128:131], a[72:75], v[96:99], v[128:131]
    buffer_load_dwordx4 a[244:247], v1, s[8:11], s26 offen offset:3072 sc1
    v_mfma_f32_16x16x32_bf16 v[132:135], a[80:83], v[96:99], v[132:135]
    s_add_u32 s26, s25, 57344
    v_mfma_f32_16x16x32_bf16 v[136:139], a[52:55], v[96:99], v[136:139]
    buffer_load_dwordx4 a[240:243], v1, s[8:11], s26 offen offset:0 sc1
    v_mfma_f32_16x16x32_bf16 v[140:143], a[36:39], v[96:99], v[140:143]
    buffer_load_dwordx4 a[196:199], v1, s[8:11], s26 offen offset:1024 sc1
    v_mfma_f32_16x16x32_bf16 v[144:147], a[44:47], v[96:99], v[144:147]
    v_mfma_f32_16x16x32_bf16 v[148:151], a[72:75], v[100:103], v[148:151]
    v_mfma_f32_16x16x32_bf16 v[152:155], a[80:83], v[100:103], v[152:155]
    v_mfma_f32_16x16x32_bf16 v[156:159], a[52:55], v[100:103], v[156:159]
    buffer_load_dwordx4 a[184:187], v1, s[8:11], s26 offen offset:2048 sc1
    v_mfma_f32_16x16x32_bf16 v[160:163], a[36:39], v[100:103], v[160:163]
    buffer_load_dwordx4 a[176:179], v1, s[8:11], s26 offen offset:3072 sc1
    v_mfma_f32_16x16x32_bf16 v[164:167], a[44:47], v[100:103], v[164:167]
    s_waitcnt vmcnt(21)
    v_mfma_f32_16x16x32_bf16 v[128:131], a[48:51], v[104:107], v[128:131]
    global_load_dwordx4 v[224:227], v1, s[88:89] offset:-1024 sc1
    v_mfma_f32_16x16x32_bf16 v[132:135], a[76:79], v[104:107], v[132:135]
    v_mfma_f32_16x16x32_bf16 v[136:139], a[96:99], v[104:107], v[136:139]
    global_load_dwordx4 v[228:231], v1, s[90:91] offset:-1024 sc1
    v_mfma_f32_16x16x32_bf16 v[140:143], a[100:103], v[104:107], v[140:143]
    v_mfma_f32_16x16x32_bf16 v[144:147], a[128:131], v[104:107], v[144:147]
    v_mfma_f32_16x16x32_bf16 v[148:151], a[48:51], v[108:111], v[148:151]
    v_mfma_f32_16x16x32_bf16 v[152:155], a[76:79], v[108:111], v[152:155]
    v_mfma_f32_16x16x32_bf16 v[156:159], a[96:99], v[108:111], v[156:159]
    v_mfma_f32_16x16x32_bf16 v[160:163], a[100:103], v[108:111], v[160:163]
    v_mfma_f32_16x16x32_bf16 v[164:167], a[128:131], v[108:111], v[164:167]
    s_waitcnt vmcnt(15)
    s_barrier
    v_mov_b32 v199, 16
    buffer_store_dword v199, v26, s[8:11], s37 offen sc1
    v_mfma_f32_16x16x32_bf16 v[128:131], a[68:71], v[112:115], v[128:131]
    v_mfma_f32_16x16x32_bf16 v[132:135], a[84:87], v[112:115], v[132:135]
    v_mfma_f32_16x16x32_bf16 v[136:139], a[164:167], v[112:115], v[136:139]
    v_mfma_f32_16x16x32_bf16 v[140:143], a[88:91], v[112:115], v[140:143]
    v_mfma_f32_16x16x32_bf16 v[144:147], a[92:95], v[112:115], v[144:147]
    v_mfma_f32_16x16x32_bf16 v[148:151], a[68:71], v[116:119], v[148:151]
    v_mfma_f32_16x16x32_bf16 v[152:155], a[84:87], v[116:119], v[152:155]
    v_mfma_f32_16x16x32_bf16 v[156:159], a[164:167], v[116:119], v[156:159]
    v_mfma_f32_16x16x32_bf16 v[160:163], a[88:91], v[116:119], v[160:163]
    v_mfma_f32_16x16x32_bf16 v[164:167], a[92:95], v[116:119], v[164:167]
    v_mfma_f32_16x16x32_bf16 v[128:131], a[132:135], v[120:123], v[128:131]
    v_mfma_f32_16x16x32_bf16 v[132:135], a[104:107], v[120:123], v[132:135]
    v_mfma_f32_16x16x32_bf16 v[136:139], a[112:115], v[120:123], v[136:139]
    v_mfma_f32_16x16x32_bf16 v[140:143], a[136:139], v[120:123], v[140:143]
    v_mfma_f32_16x16x32_bf16 v[144:147], a[116:119], v[120:123], v[144:147]
    v_mfma_f32_16x16x32_bf16 v[148:151], a[132:135], v[124:127], v[148:151]
    v_mfma_f32_16x16x32_bf16 v[152:155], a[104:107], v[124:127], v[152:155]
    v_mfma_f32_16x16x32_bf16 v[156:159], a[112:115], v[124:127], v[156:159]
    v_mfma_f32_16x16x32_bf16 v[160:163], a[136:139], v[124:127], v[160:163]
    v_mfma_f32_16x16x32_bf16 v[164:167], a[116:119], v[124:127], v[164:167]
    s_waitcnt vmcnt(15)
    v_mfma_f32_16x16x32_bf16 v[128:131], a[160:163], v[168:171], v[128:131]
    s_waitcnt vmcnt(10)
    s_waitcnt vmcnt(9)
    v_mfma_f32_16x16x32_bf16 v[128:131], a[172:175], v[216:219], v[128:131]
    s_waitcnt vmcnt(3)
    s_waitcnt vmcnt(2)
    v_mfma_f32_16x16x32_bf16 v[128:131], a[244:247], v[224:227], v[128:131]
    v_mfma_f32_16x16x32_bf16 v[148:151], a[160:163], v[172:175], v[148:151]
    v_mfma_f32_16x16x32_bf16 v[148:151], a[172:175], v[220:223], v[148:151]
    s_waitcnt vmcnt(1)
    v_mfma_f32_16x16x32_bf16 v[148:151], a[244:247], v[228:231], v[148:151]
    v_mfma_f32_16x16x32_bf16 v[132:135], a[168:171], v[168:171], v[132:135]
    s_add_u32 s88, s31, 21172224
    s_add_u32 s88, s88, s8
    s_addc_u32 s89, s52, 0
    v_mfma_f32_16x16x32_bf16 v[132:135], a[148:151], v[216:219], v[132:135]
    global_load_dwordx4 v[232:235], v1, s[88:89] offset:-4096 sc1
    v_mfma_f32_16x16x32_bf16 v[132:135], a[240:243], v[224:227], v[132:135]
    ds_write_b128 v17, v[128:131] offset:0
    s_add_u32 s90, s31, 21221376
    s_add_u32 s90, s90, s8
    s_addc_u32 s91, s52, 0
    v_mfma_f32_16x16x32_bf16 v[152:155], a[168:171], v[172:175], v[152:155]
    global_load_dwordx4 v[236:239], v1, s[90:91] offset:-4096 sc1
    v_mfma_f32_16x16x32_bf16 v[152:155], a[148:151], v[220:223], v[152:155]
    global_load_dwordx4 v[240:243], v1, s[88:89] offset:-3072 sc1
    v_mfma_f32_16x16x32_bf16 v[152:155], a[240:243], v[228:231], v[152:155]
    ds_write_b128 v17, v[148:151] offset:256
    v_mfma_f32_16x16x32_bf16 v[136:139], a[140:143], v[168:171], v[136:139]
    global_load_dwordx4 v[244:247], v1, s[90:91] offset:-3072 sc1
    v_mfma_f32_16x16x32_bf16 v[136:139], a[152:155], v[216:219], v[136:139]
    global_load_dwordx4 v[248:251], v1, s[88:89] offset:-2048 sc1
    v_mfma_f32_16x16x32_bf16 v[136:139], a[196:199], v[224:227], v[136:139]
    ds_write_b128 v17, v[132:135] offset:2304
    v_mfma_f32_16x16x32_bf16 v[156:159], a[140:143], v[172:175], v[156:159]
    global_load_dwordx4 v[252:255], v1, s[90:91] offset:-2048 sc1
    v_mfma_f32_16x16x32_bf16 v[156:159], a[152:155], v[220:223], v[156:159]
    global_load_dwordx4 v[96:99], v1, s[88:89] offset:-1024 sc1
    v_mfma_f32_16x16x32_bf16 v[156:159], a[196:199], v[228:231], v[156:159]
    ds_write_b128 v17, v[152:155] offset:2560
    v_mfma_f32_16x16x32_bf16 v[140:143], a[124:127], v[168:171], v[140:143]
    global_load_dwordx4 v[100:103], v1, s[90:91] offset:-1024 sc1
    v_mfma_f32_16x16x32_bf16 v[140:143], a[188:191], v[216:219], v[140:143]
    global_load_dwordx4 v[104:107], v1, s[88:89] offset:0 sc1
    v_mfma_f32_16x16x32_bf16 v[140:143], a[184:187], v[224:227], v[140:143]
    ds_write_b128 v17, v[136:139] offset:4608
    v_mfma_f32_16x16x32_bf16 v[160:163], a[124:127], v[172:175], v[160:163]
    global_load_dwordx4 v[108:111], v1, s[90:91] offset:0 sc1
    v_mfma_f32_16x16x32_bf16 v[160:163], a[188:191], v[220:223], v[160:163]
    v_mfma_f32_16x16x32_bf16 v[160:163], a[184:187], v[228:231], v[160:163]
    ds_write_b128 v17, v[156:159] offset:4864
    v_mfma_f32_16x16x32_bf16 v[144:147], a[144:147], v[168:171], v[144:147]
    v_mfma_f32_16x16x32_bf16 v[144:147], a[180:183], v[216:219], v[144:147]
    v_mfma_f32_16x16x32_bf16 v[144:147], a[176:179], v[224:227], v[144:147]
    ds_write_b128 v17, v[140:143] offset:6912
    v_mfma_f32_16x16x32_bf16 v[164:167], a[144:147], v[172:175], v[164:167]
    v_mfma_f32_16x16x32_bf16 v[164:167], a[180:183], v[220:223], v[164:167]
    v_mfma_f32_16x16x32_bf16 v[164:167], a[176:179], v[228:231], v[164:167]
    ds_write_b128 v17, v[160:163] offset:7168
    s_nop 2
    ds_write_b128 v17, v[144:147] offset:9216
    s_nop 2
    ds_write_b128 v17, v[164:167] offset:9472
    global_load_dwordx4 v[112:115], v1, s[88:89] offset:1024 sc1
    global_load_dwordx4 v[116:119], v1, s[90:91] offset:1024 sc1
    global_load_dwordx4 v[120:123], v1, s[88:89] offset:2048 sc1
    global_load_dwordx4 v[124:127], v1, s[90:91] offset:2048 sc1
    global_load_dwordx4 v[168:171], v1, s[88:89] offset:3072 sc1
    global_load_dwordx4 v[172:175], v1, s[90:91] offset:3072 sc1
    s_add_u32 s88, s31, 21180416
    s_add_u32 s88, s88, s8
    s_addc_u32 s89, s52, 0
    global_load_dwordx4 v[216:219], v1, s[88:89] offset:-4096 sc1
    s_add_u32 s90, s31, 21229568
    s_add_u32 s90, s90, s8
    s_addc_u32 s91, s52, 0
    global_load_dwordx4 v[220:223], v1, s[90:91] offset:-4096 sc1
    s_waitcnt lgkmcnt(0)
    s_barrier
    ds_read_b128 v[128:131], v18 offset:0
    ds_read_b128 v[132:135], v18 offset:576
    ds_read_b128 v[136:139], v18 offset:11520
    ds_read_b128 v[140:143], v18 offset:12096
    ds_read_b128 v[144:147], v18 offset:23040
    ds_read_b128 v[148:151], v18 offset:23616
    ds_read_b128 v[152:155], v18 offset:34560
    ds_read_b128 v[156:159], v18 offset:35136
    s_waitcnt lgkmcnt(4)
    v_pk_add_f32 v[128:129], v[128:129], v[136:137]
    v_pk_add_f32 v[130:131], v[130:131], v[138:139]
    v_pk_add_f32 v[132:133], v[132:133], v[140:141]
    v_pk_add_f32 v[134:135], v[134:135], v[142:143]
    global_load_dwordx4 v[224:227], v1, s[88:89] offset:-3072 sc1
    ds_read_b128 v[160:163], v18 offset:9216
    ds_read_b128 v[164:167], v18 offset:9792
    ds_read_b128 v[176:179], v18 offset:20736
    ds_read_b128 v[180:183], v18 offset:21312
    v_lshlrev_b32 v136, 16, v64
    v_and_b32 v137, 0xffff0000, v64
    v_lshlrev_b32 v138, 16, v65
    global_load_dwordx4 v[228:231], v1, s[90:91] offset:-3072 sc1
    v_and_b32 v139, 0xffff0000, v65
    v_lshlrev_b32 v140, 16, v66
    v_and_b32 v141, 0xffff0000, v66
    v_lshlrev_b32 v142, 16, v67
    v_and_b32 v143, 0xffff0000, v67
    s_waitcnt lgkmcnt(4)
    v_pk_add_f32 v[128:129], v[128:129], v[136:137]
    v_pk_add_f32 v[130:131], v[130:131], v[138:139]
    v_pk_add_f32 v[132:133], v[132:133], v[140:141]
    v_pk_add_f32 v[134:135], v[134:135], v[142:143]
    ds_read_b128 v[184:187], v18 offset:32256
    ds_read_b128 v[188:191], v18 offset:32832
    ds_read_b128 v[192:195], v18 offset:43776
    ds_read_b128 v[196:199], v18 offset:44352
    v_pk_add_f32 v[144:145], v[144:145], v[152:153]
    v_pk_add_f32 v[146:147], v[146:147], v[154:155]
    v_pk_add_f32 v[148:149], v[148:149], v[156:157]
    v_pk_add_f32 v[150:151], v[150:151], v[158:159]
    v_pk_add_f32 v[128:129], v[128:129], v[144:145]
    v_pk_add_f32 v[130:131], v[130:131], v[146:147]
    v_pk_add_f32 v[132:133], v[132:133], v[148:149]
    v_pk_add_f32 v[134:135], v[134:135], v[150:151]
    v_cvt_pk_bf16_f32 v64, v128, v129
    v_cvt_pk_bf16_f32 v65, v130, v131
    v_cvt_pk_bf16_f32 v66, v132, v133
    v_cvt_pk_bf16_f32 v67, v134, v135
    s_add_u32 s56, s34, 0
    buffer_store_dwordx4 v[64:67], v15, s[12:15], s56 offen offset:0
    s_waitcnt lgkmcnt(4)
    v_pk_add_f32 v[160:161], v[160:161], v[176:177]
    v_pk_add_f32 v[162:163], v[162:163], v[178:179]
    v_pk_add_f32 v[164:165], v[164:165], v[180:181]
    v_pk_add_f32 v[166:167], v[166:167], v[182:183]
    v_lshlrev_b32 v176, 16, v68
    v_and_b32 v177, 0xffff0000, v68
    v_lshlrev_b32 v178, 16, v69
    v_and_b32 v179, 0xffff0000, v69
    v_lshlrev_b32 v180, 16, v70
    v_and_b32 v181, 0xffff0000, v70
    v_lshlrev_b32 v182, 16, v71
    v_and_b32 v183, 0xffff0000, v71
    s_waitcnt lgkmcnt(0)
    v_pk_add_f32 v[160:161], v[160:161], v[176:177]
    v_pk_add_f32 v[162:163], v[162:163], v[178:179]
    v_pk_add_f32 v[164:165], v[164:165], v[180:181]
    v_pk_add_f32 v[166:167], v[166:167], v[182:183]
    v_pk_add_f32 v[184:185], v[184:185], v[192:193]
    v_pk_add_f32 v[186:187], v[186:187], v[194:195]
    v_pk_add_f32 v[188:189], v[188:189], v[196:197]
    v_pk_add_f32 v[190:191], v[190:191], v[198:199]
    v_pk_add_f32 v[160:161], v[160:161], v[184:185]
    v_pk_add_f32 v[162:163], v[162:163], v[186:187]
    v_pk_add_f32 v[164:165], v[164:165], v[188:189]
    v_pk_add_f32 v[166:167], v[166:167], v[190:191]
    v_cvt_pk_bf16_f32 v68, v160, v161
    v_cvt_pk_bf16_f32 v69, v162, v163
    v_cvt_pk_bf16_f32 v70, v164, v165
    v_cvt_pk_bf16_f32 v71, v166, v167
    buffer_store_dwordx4 v[68:71], v19, s[12:15], s56 offen offset:128
    s_waitcnt vmcnt(20)
    v_max_u32 v3, v232, v236
    v_cmp_eq_u32 vcc, -1, v3
    s_nop 3
    s_cbranch_vccnz L_fix_99
L_fixed_100:
    v_mfma_f32_16x16x32_bf16 v[128:131], a[208:211], v[232:235], 0
    v_mfma_f32_16x16x32_bf16 v[132:135], a[204:207], v[232:235], 0
    v_mfma_f32_16x16x32_bf16 v[136:139], a[200:203], v[232:235], 0
    v_mfma_f32_16x16x32_bf16 v[140:143], a[228:231], v[232:235], 0
    v_mfma_f32_16x16x32_bf16 v[144:147], a[248:251], v[232:235], 0
    s_waitcnt vmcnt(18)
    v_max_u32 v3, v240, v244
    v_cmp_eq_u32 vcc, -1, v3
    v_mfma_f32_16x16x32_bf16 v[148:151], a[208:211], v[236:239], 0
    v_mfma_f32_16x16x32_bf16 v[152:155], a[204:207], v[236:239], 0
    v_mfma_f32_16x16x32_bf16 v[156:159], a[200:203], v[236:239], 0
    v_mfma_f32_16x16x32_bf16 v[160:163], a[228:231], v[236:239], 0
    s_cbranch_vccnz L_fix_103
L_fixed_104:
    v_mfma_f32_16x16x32_bf16 v[164:167], a[248:251], v[236:239], 0
    v_mfma_f32_16x16x32_bf16 v[128:131], a[212:215], v[240:243], v[128:131]
    v_mfma_f32_16x16x32_bf16 v[132:135], a[232:235], v[240:243], v[132:135]
    v_mfma_f32_16x16x32_bf16 v[136:139], a[252:255], v[240:243], v[136:139]
    v_mfma_f32_16x16x32_bf16 v[140:143], a[216:219], v[240:243], v[140:143]
    v_mfma_f32_16x16x32_bf16 v[144:147], a[236:239], v[240:243], v[144:147]
    s_waitcnt vmcnt(16)
    v_max_u32 v3, v248, v252
    v_cmp_eq_u32 vcc, -1, v3
    v_mfma_f32_16x16x32_bf16 v[148:151], a[212:215], v[244:247], v[148:151]
    global_load_dwordx4 v[232:235], v1, s[88:89] offset:-2048 sc1
    v_mfma_f32_16x16x32_bf16 v[152:155], a[232:235], v[244:247], v[152:155]
    v_mfma_f32_16x16x32_bf16 v[156:159], a[252:255], v[244:247], v[156:159]
    global_load_dwordx4 v[236:239], v1, s[90:91] offset:-2048 sc1
    v_mfma_f32_16x16x32_bf16 v[160:163], a[216:219], v[244:247], v[160:163]
    s_cbranch_vccnz L_fix_107
L_fixed_108:
    v_mfma_f32_16x16x32_bf16 v[164:167], a[236:239], v[244:247], v[164:167]
    v_mfma_f32_16x16x32_bf16 v[128:131], a[0:3], v[248:251], v[128:131]
    global_load_dwordx4 v[240:243], v1, s[88:89] offset:-1024 sc1
    v_mfma_f32_16x16x32_bf16 v[132:135], a[4:7], v[248:251], v[132:135]
    global_load_dwordx4 v[244:247], v1, s[90:91] offset:-1024 sc1
    v_mfma_f32_16x16x32_bf16 v[136:139], a[8:11], v[248:251], v[136:139]
    v_mfma_f32_16x16x32_bf16 v[140:143], a[12:15], v[248:251], v[140:143]
    v_mfma_f32_16x16x32_bf16 v[144:147], a[60:63], v[248:251], v[144:147]
    s_waitcnt vmcnt(18)
    v_max_u32 v3, v96, v100
    v_cmp_eq_u32 vcc, -1, v3
    v_mfma_f32_16x16x32_bf16 v[148:151], a[0:3], v[252:255], v[148:151]
    v_mfma_f32_16x16x32_bf16 v[152:155], a[4:7], v[252:255], v[152:155]
    v_mfma_f32_16x16x32_bf16 v[156:159], a[8:11], v[252:255], v[156:159]
    v_mfma_f32_16x16x32_bf16 v[160:163], a[12:15], v[252:255], v[160:163]
    s_cbranch_vccnz L_fix_111
L_fixed_112:
    v_mfma_f32_16x16x32_bf16 v[164:167], a[60:63], v[252:255], v[164:167]
    v_mfma_f32_16x16x32_bf16 v[128:131], a[64:67], v[96:99], v[128:131]
    v_mfma_f32_16x16x32_bf16 v[132:135], a[108:111], v[96:99], v[132:135]
    v_mfma_f32_16x16x32_bf16 v[136:139], a[120:123], v[96:99], v[136:139]
    v_mfma_f32_16x16x32_bf16 v[140:143], a[16:19], v[96:99], v[140:143]
    v_mfma_f32_16x16x32_bf16 v[144:147], a[20:23], v[96:99], v[144:147]
    s_waitcnt vmcnt(16)
    v_max_u32 v3, v104, v108
    v_cmp_eq_u32 vcc, -1, v3
    v_mfma_f32_16x16x32_bf16 v[148:151], a[64:67], v[100:103], v[148:151]
    v_mfma_f32_16x16x32_bf16 v[152:155], a[108:111], v[100:103], v[152:155]
    v_mfma_f32_16x16x32_bf16 v[156:159], a[120:123], v[100:103], v[156:159]
    v_mfma_f32_16x16x32_bf16 v[160:163], a[16:19], v[100:103], v[160:163]
    s_cbranch_vccnz L_fix_115
L_fixed_116:
    v_mfma_f32_16x16x32_bf16 v[164:167], a[20:23], v[100:103], v[164:167]
    v_mfma_f32_16x16x32_bf16 v[128:131], a[24:27], v[104:107], v[128:131]
    v_mfma_f32_16x16x32_bf16 v[132:135], a[28:31], v[104:107], v[132:135]
    v_mfma_f32_16x16x32_bf16 v[136:139], a[32:35], v[104:107], v[136:139]
    v_mfma_f32_16x16x32_bf16 v[140:143], a[40:43], v[104:107], v[140:143]
    v_mfma_f32_16x16x32_bf16 v[144:147], a[56:59], v[104:107], v[144:147]
    s_waitcnt vmcnt(14)
    v_max_u32 v3, v112, v116
    v_cmp_eq_u32 vcc, -1, v3
    v_mfma_f32_16x16x32_bf16 v[148:151], a[24:27], v[108:111], v[148:151]
    v_mfma_f32_16x16x32_bf16 v[152:155], a[28:31], v[108:111], v[152:155]
    v_mfma_f32_16x16x32_bf16 v[156:159], a[32:35], v[108:111], v[156:159]
    v_mfma_f32_16x16x32_bf16 v[160:163], a[40:43], v[108:111], v[160:163]
    s_cbranch_vccnz L_fix_119
L_fixed_120:
    v_mfma_f32_16x16x32_bf16 v[164:167], a[56:59], v[108:111], v[164:167]
    v_mfma_f32_16x16x32_bf16 v[128:131], a[72:75], v[112:115], v[128:131]
    v_mfma_f32_16x16x32_bf16 v[132:135], a[80:83], v[112:115], v[132:135]
    v_mfma_f32_16x16x32_bf16 v[136:139], a[52:55], v[112:115], v[136:139]
    v_mfma_f32_16x16x32_bf16 v[140:143], a[36:39], v[112:115], v[140:143]
    v_mfma_f32_16x16x32_bf16 v[144:147], a[44:47], v[112:115], v[144:147]
    s_waitcnt vmcnt(12)
    v_max_u32 v3, v120, v124
    v_cmp_eq_u32 vcc, -1, v3
    v_mfma_f32_16x16x32_bf16 v[148:151], a[72:75], v[116:119], v[148:151]
    v_mfma_f32_16x16x32_bf16 v[152:155], a[80:83], v[116:119], v[152:155]
    v_mfma_f32_16x16x32_bf16 v[156:159], a[52:55], v[116:119], v[156:159]
    v_mfma_f32_16x16x32_bf16 v[160:163], a[36:39], v[116:119], v[160:163]
    s_cbranch_vccnz L_fix_123
L_fixed_124:
    v_mfma_f32_16x16x32_bf16 v[164:167], a[44:47], v[116:119], v[164:167]
    s_barrier
    v_mfma_f32_16x16x32_bf16 v[128:131], a[48:51], v[120:123], v[128:131]
    v_mfma_f32_16x16x32_bf16 v[132:135], a[76:79], v[120:123], v[132:135]
    v_mfma_f32_16x16x32_bf16 v[136:139], a[96:99], v[120:123], v[136:139]
    v_mfma_f32_16x16x32_bf16 v[140:143], a[100:103], v[120:123], v[140:143]
    v_mfma_f32_16x16x32_bf16 v[144:147], a[128:131], v[120:123], v[144:147]
    s_waitcnt vmcnt(10)
    v_max_u32 v3, v168, v172
    v_cmp_eq_u32 vcc, -1, v3
    v_mfma_f32_16x16x32_bf16 v[148:151], a[48:51], v[124:127], v[148:151]
    v_mfma_f32_16x16x32_bf16 v[152:155], a[76:79], v[124:127], v[152:155]
    v_mfma_f32_16x16x32_bf16 v[156:159], a[96:99], v[124:127], v[156:159]
    v_mfma_f32_16x16x32_bf16 v[160:163], a[100:103], v[124:127], v[160:163]
    s_cbranch_vccnz L_fix_127
L_fixed_128:
    v_mfma_f32_16x16x32_bf16 v[164:167], a[128:131], v[124:127], v[164:167]
    v_mfma_f32_16x16x32_bf16 v[128:131], a[68:71], v[168:171], v[128:131]
    v_mfma_f32_16x16x32_bf16 v[132:135], a[84:87], v[168:171], v[132:135]
    v_mfma_f32_16x16x32_bf16 v[136:139], a[164:167], v[168:171], v[136:139]
    v_mfma_f32_16x16x32_bf16 v[140:143], a[88:91], v[168:171], v[140:143]
    v_mfma_f32_16x16x32_bf16 v[144:147], a[92:95], v[168:171], v[144:147]
    s_waitcnt vmcnt(8)
    v_max_u32 v3, v216, v220
    v_cmp_eq_u32 vcc, -1, v3
    v_mfma_f32_16x16x32_bf16 v[148:151], a[68:71], v[172:175], v[148:151]
    v_mfma_f32_16x16x32_bf16 v[152:155], a[84:87], v[172:175], v[152:155]
    v_mfma_f32_16x16x32_bf16 v[156:159], a[164:167], v[172:175], v[156:159]
    v_mfma_f32_16x16x32_bf16 v[160:163], a[88:91], v[172:175], v[160:163]
    s_cbranch_vccnz L_fix_131
L_fixed_132:
    v_mfma_f32_16x16x32_bf16 v[164:167], a[92:95], v[172:175], v[164:167]
    v_mfma_f32_16x16x32_bf16 v[128:131], a[132:135], v[216:219], v[128:131]
    v_mfma_f32_16x16x32_bf16 v[132:135], a[104:107], v[216:219], v[132:135]
    v_mfma_f32_16x16x32_bf16 v[136:139], a[112:115], v[216:219], v[136:139]
    v_mfma_f32_16x16x32_bf16 v[140:143], a[136:139], v[216:219], v[140:143]
    v_mfma_f32_16x16x32_bf16 v[144:147], a[116:119], v[216:219], v[144:147]
    s_waitcnt vmcnt(0)
    v_max3_u32 v3, v224, v228, v232
    v_max3_u32 v3, v3, v236, v240
    v_max_u32 v3, v3, v244
    v_cmp_eq_u32 vcc, -1, v3
    v_mfma_f32_16x16x32_bf16 v[148:151], a[132:135], v[220:223], v[148:151]
    v_mfma_f32_16x16x32_bf16 v[152:155], a[104:107], v[220:223], v[152:155]
    v_mfma_f32_16x16x32_bf16 v[156:159], a[112:115], v[220:223], v[156:159]
    v_mfma_f32_16x16x32_bf16 v[160:163], a[136:139], v[220:223], v[160:163]
    s_cbranch_vccnz L_fix_135
L_fixed_136:
    v_mfma_f32_16x16x32_bf16 v[164:167], a[116:119], v[220:223], v[164:167]
    v_mfma_f32_16x16x32_bf16 v[128:131], a[160:163], v[224:227], v[128:131]
    v_mfma_f32_16x16x32_bf16 v[128:131], a[172:175], v[232:235], v[128:131]
    v_mfma_f32_16x16x32_bf16 v[128:131], a[244:247], v[240:243], v[128:131]
    v_mfma_f32_16x16x32_bf16 v[148:151], a[160:163], v[228:231], v[148:151]
    v_mfma_f32_16x16x32_bf16 v[148:151], a[172:175], v[236:239], v[148:151]
    v_mfma_f32_16x16x32_bf16 v[148:151], a[244:247], v[244:247], v[148:151]
    v_mfma_f32_16x16x32_bf16 v[132:135], a[168:171], v[224:227], v[132:135]
    v_mfma_f32_16x16x32_bf16 v[132:135], a[148:151], v[232:235], v[132:135]
    v_mfma_f32_16x16x32_bf16 v[132:135], a[240:243], v[240:243], v[132:135]
    s_nop 1
    ds_write_b128 v17, v[128:131] offset:0
    v_mfma_f32_16x16x32_bf16 v[152:155], a[168:171], v[228:231], v[152:155]
    v_mfma_f32_16x16x32_bf16 v[152:155], a[148:151], v[236:239], v[152:155]
    v_mfma_f32_16x16x32_bf16 v[152:155], a[240:243], v[244:247], v[152:155]
    ds_write_b128 v17, v[148:151] offset:256
    v_mfma_f32_16x16x32_bf16 v[136:139], a[140:143], v[224:227], v[136:139]
    v_mfma_f32_16x16x32_bf16 v[136:139], a[152:155], v[232:235], v[136:139]
    v_mfma_f32_16x16x32_bf16 v[136:139], a[196:199], v[240:243], v[136:139]
    ds_write_b128 v17, v[132:135] offset:2304
    v_mfma_f32_16x16x32_bf16 v[156:159], a[140:143], v[228:231], v[156:159]
    v_mfma_f32_16x16x32_bf16 v[156:159], a[152:155], v[236:239], v[156:159]
    v_mfma_f32_16x16x32_bf16 v[156:159], a[196:199], v[244:247], v[156:159]
    ds_write_b128 v17, v[152:155] offset:2560
    v_mfma_f32_16x16x32_bf16 v[140:143], a[124:127], v[224:227], v[140:143]
    v_mfma_f32_16x16x32_bf16 v[140:143], a[188:191], v[232:235], v[140:143]
    v_mfma_f32_16x16x32_bf16 v[140:143], a[184:187], v[240:243], v[140:143]
    ds_write_b128 v17, v[136:139] offset:4608
    v_mfma_f32_16x16x32_bf16 v[160:163], a[124:127], v[228:231], v[160:163]
    v_mfma_f32_16x16x32_bf16 v[160:163], a[188:191], v[236:239], v[160:163]
    v_mfma_f32_16x16x32_bf16 v[160:163], a[184:187], v[244:247], v[160:163]
    ds_write_b128 v17, v[156:159] offset:4864
    v_mfma_f32_16x16x32_bf16 v[144:147], a[144:147], v[224:227], v[144:147]
    v_mfma_f32_16x16x32_bf16 v[144:147], a[180:183], v[232:235], v[144:147]
    v_mfma_f32_16x16x32_bf16 v[144:147], a[176:179], v[240:243], v[144:147]
    ds_write_b128 v17, v[140:143] offset:6912
    v_mfma_f32_16x16x32_bf16 v[164:167], a[144:147], v[228:231], v[164:167]
    v_mfma_f32_16x16x32_bf16 v[164:167], a[180:183], v[236:239], v[164:167]
    v_mfma_f32_16x16x32_bf16 v[164:167], a[176:179], v[244:247], v[164:167]
    ds_write_b128 v17, v[160:163] offset:7168
    s_nop 2
    ds_write_b128 v17, v[144:147] offset:9216
    s_nop 2
    ds_write_b128 v17, v[164:167] offset:9472
    s_waitcnt lgkmcnt(0)
    s_barrier
    ds_read_b128 v[128:131], v18 offset:0
    ds_read_b128 v[132:135], v18 offset:576
    ds_read_b128 v[136:139], v18 offset:11520
    ds_read_b128 v[140:143], v18 offset:12096
    ds_read_b128 v[144:147], v18 offset:23040
    ds_read_b128 v[148:151], v18 offset:23616
    ds_read_b128 v[152:155], v18 offset:34560
    ds_read_b128 v[156:159], v18 offset:35136
    s_waitcnt lgkmcnt(4)
    v_pk_add_f32 v[128:129], v[128:129], v[136:137]
    v_pk_add_f32 v[130:131], v[130:131], v[138:139]
    v_pk_add_f32 v[132:133], v[132:133], v[140:141]
    v_pk_add_f32 v[134:135], v[134:135], v[142:143]
    ds_read_b128 v[160:163], v18 offset:9216
    ds_read_b128 v[164:167], v18 offset:9792
    ds_read_b128 v[176:179], v18 offset:20736
    ds_read_b128 v[180:183], v18 offset:21312
    v_lshlrev_b32 v136, 16, v72
    v_and_b32 v137, 0xffff0000, v72
    v_lshlrev_b32 v138, 16, v73
    v_and_b32 v139, 0xffff0000, v73
    v_lshlrev_b32 v140, 16, v74
    v_and_b32 v141, 0xffff0000, v74
    v_lshlrev_b32 v142, 16, v75
    v_and_b32 v143, 0xffff0000, v75
    s_waitcnt lgkmcnt(4)
    v_pk_add_f32 v[128:129], v[128:129], v[136:137]
    v_pk_add_f32 v[130:131], v[130:131], v[138:139]
    v_pk_add_f32 v[132:133], v[132:133], v[140:141]
    v_pk_add_f32 v[134:135], v[134:135], v[142:143]
    ds_read_b128 v[184:187], v18 offset:32256
    ds_read_b128 v[188:191], v18 offset:32832
    ds_read_b128 v[192:195], v18 offset:43776
    ds_read_b128 v[196:199], v18 offset:44352
    v_pk_add_f32 v[144:145], v[144:145], v[152:153]
    v_pk_add_f32 v[146:147], v[146:147], v[154:155]
    v_pk_add_f32 v[148:149], v[148:149], v[156:157]
    v_pk_add_f32 v[150:151], v[150:151], v[158:159]
    v_pk_add_f32 v[128:129], v[128:129], v[144:145]
    v_pk_add_f32 v[130:131], v[130:131], v[146:147]
    v_pk_add_f32 v[132:133], v[132:133], v[148:149]
    v_pk_add_f32 v[134:135], v[134:135], v[150:151]
    v_cvt_pk_bf16_f32 v72, v128, v129
    v_cvt_pk_bf16_f32 v73, v130, v131
    v_cvt_pk_bf16_f32 v74, v132, v133
    v_cvt_pk_bf16_f32 v75, v134, v135
    s_add_u32 s56, s34, 81920
    buffer_store_dwordx4 v[72:75], v15, s[12:15], s56 offen offset:0
    s_waitcnt lgkmcnt(4)
    v_pk_add_f32 v[160:161], v[160:161], v[176:177]
    v_pk_add_f32 v[162:163], v[162:163], v[178:179]
    v_pk_add_f32 v[164:165], v[164:165], v[180:181]
    v_pk_add_f32 v[166:167], v[166:167], v[182:183]
    v_lshlrev_b32 v176, 16, v76
    v_and_b32 v177, 0xffff0000, v76
    v_lshlrev_b32 v178, 16, v77
    v_and_b32 v179, 0xffff0000, v77
    v_lshlrev_b32 v180, 16, v78
    v_and_b32 v181, 0xffff0000, v78
    v_lshlrev_b32 v182, 16, v79
    v_and_b32 v183, 0xffff0000, v79
    s_waitcnt lgkmcnt(0)
    v_pk_add_f32 v[160:161], v[160:161], v[176:177]
    v_pk_add_f32 v[162:163], v[162:163], v[178:179]
    v_pk_add_f32 v[164:165], v[164:165], v[180:181]
    v_pk_add_f32 v[166:167], v[166:167], v[182:183]
    v_pk_add_f32 v[184:185], v[184:185], v[192:193]
    v_pk_add_f32 v[186:187], v[186:187], v[194:195]
    v_pk_add_f32 v[188:189], v[188:189], v[196:197]
    v_pk_add_f32 v[190:191], v[190:191], v[198:199]
    v_pk_add_f32 v[160:161], v[160:161], v[184:185]
    v_pk_add_f32 v[162:163], v[162:163], v[186:187]
    v_pk_add_f32 v[164:165], v[164:165], v[188:189]
    v_pk_add_f32 v[166:167], v[166:167], v[190:191]
    v_cvt_pk_bf16_f32 v76, v160, v161
    v_cvt_pk_bf16_f32 v77, v162, v163
    v_cvt_pk_bf16_f32 v78, v164, v165
    v_cvt_pk_bf16_f32 v79, v166, v167
    buffer_store_dwordx4 v[76:79], v19, s[12:15], s56 offen offset:128
    s_waitcnt vmcnt(0)
L_main_end:
    s_endpgm
L_fix_3:
    s_mov_b32 s68, 0x80000
L_fixp_5:
    buffer_load_dword v3, v25, s[8:11], s38 offen sc1
    s_waitcnt vmcnt(0)
    v_cmp_le_u32 vcc, 4, v3
    s_nop 3
    s_cmp_eq_u64 vcc, -1
    s_cbranch_scc1 L_fixd_6
    s_sub_u32 s68, s68, 1
    s_cmp_lg_u32 s68, 0
    s_cbranch_scc1 L_fixp_5
L_fixd_6:
    s_add_u32 s57, s30, 9519104
    buffer_load_dwordx4 v[96:99], v1, s[8:11], s57 offen offset:0 sc1
    s_add_u32 s57, s30, 9539584
    buffer_load_dwordx4 v[100:103], v1, s[8:11], s57 offen offset:0 sc1
    s_add_u32 s57, s30, 9519104
    buffer_load_dwordx4 v[104:107], v1, s[8:11], s57 offen offset:1024 sc1
    s_add_u32 s57, s30, 9539584
    buffer_load_dwordx4 v[108:111], v1, s[8:11], s57 offen offset:1024 sc1
    s_add_u32 s57, s30, 9519104
    buffer_load_dwordx4 v[112:115], v1, s[8:11], s57 offen offset:2048 sc1
    s_add_u32 s57, s30, 9539584
    buffer_load_dwordx4 v[116:119], v1, s[8:11], s57 offen offset:2048 sc1
    s_add_u32 s57, s30, 9519104
    buffer_load_dwordx4 v[120:123], v1, s[8:11], s57 offen offset:3072 sc1
    s_add_u32 s57, s30, 9539584
    buffer_load_dwordx4 v[124:127], v1, s[8:11], s57 offen offset:3072 sc1
    s_add_u32 s57, s30, 9523200
    buffer_load_dwordx4 v[168:171], v1, s[8:11], s57 offen offset:0 sc1
    s_add_u32 s57, s30, 9543680
    buffer_load_dwordx4 v[172:175], v1, s[8:11], s57 offen offset:0 sc1
    s_waitcnt vmcnt(0)
    s_branch L_fixed_4
L_fix_7:
    s_mov_b32 s68, 0x80000
L_fixp_9:
    buffer_load_dword v3, v25, s[8:11], s38 offen sc1
    s_waitcnt vmcnt(0)
    v_cmp_le_u32 vcc, 4, v3
    s_nop 3
    s_cmp_eq_u64 vcc, -1
    s_cbranch_scc1 L_fixd_10
    s_sub_u32 s68, s68, 1
    s_cmp_lg_u32 s68, 0
    s_cbranch_scc1 L_fixp_9
L_fixd_10:
    s_add_u32 s57, s30, 9519104
    buffer_load_dwordx4 v[104:107], v1, s[8:11], s57 offen offset:1024 sc1
    s_add_u32 s57, s30, 9539584
    buffer_load_dwordx4 v[108:111], v1, s[8:11], s57 offen offset:1024 sc1
    s_add_u32 s57, s30, 9519104
    buffer_load_dwordx4 v[112:115], v1, s[8:11], s57 offen offset:2048 sc1
    s_add_u32 s57, s30, 9539584
    buffer_load_dwordx4 v[116:119], v1, s[8:11], s57 offen offset:2048 sc1
    s_add_u32 s57, s30, 9519104
    buffer_load_dwordx4 v[120:123], v1, s[8:11], s57 offen offset:3072 sc1
    s_add_u32 s57, s30, 9539584
    buffer_load_dwordx4 v[124:127], v1, s[8:11], s57 offen offset:3072 sc1
    s_add_u32 s57, s30, 9523200
    buffer_load_dwordx4 v[168:171], v1, s[8:11], s57 offen offset:0 sc1
    s_add_u32 s57, s30, 9543680
    buffer_load_dwordx4 v[172:175], v1, s[8:11], s57 offen offset:0 sc1
    s_waitcnt vmcnt(0)
    s_branch L_fixed_8
L_fix_11:
    s_mov_b32 s68, 0x80000
L_fixp_13:
    buffer_load_dword v3, v25, s[8:11], s38 offen sc1
    s_waitcnt vmcnt(0)
    v_cmp_le_u32 vcc, 4, v3
    s_nop 3
    s_cmp_eq_u64 vcc, -1
    s_cbranch_scc1 L_fixd_14
    s_sub_u32 s68, s68, 1
    s_cmp_lg_u32 s68, 0
    s_cbranch_scc1 L_fixp_13
L_fixd_14:
    s_add_u32 s57, s30, 9519104
    buffer_load_dwordx4 v[112:115], v1, s[8:11], s57 offen offset:2048 sc1
    s_add_u32 s57, s30, 9539584
    buffer_load_dwordx4 v[116:119], v1, s[8:11], s57 offen offset:2048 sc1
    s_add_u32 s57, s30, 9519104
    buffer_load_dwordx4 v[120:123], v1, s[8:11], s57 offen offset:3072 sc1
    s_add_u32 s57, s30, 9539584
    buffer_load_dwordx4 v[124:127], v1, s[8:11], s57 offen offset:3072 sc1
    s_add_u32 s57, s30, 9523200
    buffer_load_dwordx4 v[168:171], v1, s[8:11], s57 offen offset:0 sc1
    s_add_u32 s57, s30, 9543680
    buffer_load_dwordx4 v[172:175], v1, s[8:11], s57 offen offset:0 sc1
    s_waitcnt vmcnt(0)
    s_branch L_fixed_12
L_fix_17:
    s_mov_b32 s68, 0x80000
L_fixp_19:
    buffer_load_dword v3, v25, s[8:11], s38 offen sc1
    s_waitcnt vmcnt(0)
    v_cmp_le_u32 vcc, 5, v3
    s_nop 3
    s_cmp_eq_u64 vcc, -1
    s_cbranch_scc1 L_fixd_20
    s_sub_u32 s68, s68, 1
    s_cmp_lg_u32 s68, 0
    s_cbranch_scc1 L_fixp_19
L_fixd_20:
    s_add_u32 m0, s28, 52224
    s_add_u32 s57, s48, 27262976
    buffer_load_dwordx4 v1, s[8:11], s57 offen offset:0 sc1 lds
    s_add_u32 m0, s28, 52224
    s_add_u32 s57, s48, 27262976
    buffer_load_dwordx4 v1, s[8:11], s57 offen offset:1024 sc1 lds
    s_add_u32 m0, s28, 58368
    s_add_u32 s57, s48, 27262976
    buffer_load_dwordx4 v1, s[8:11], s57 offen offset:2048 sc1 lds
    s_add_u32 m0, s28, 58368
    s_add_u32 s57, s48, 27262976
    buffer_load_dwordx4 v1, s[8:11], s57 offen offset:3072 sc1 lds
    s_add_u32 m0, s28, 68608
    s_add_u32 s57, s48, 27267072
    buffer_load_dwordx4 v1, s[8:11], s57 offen offset:0 sc1 lds
    s_add_u32 m0, s28, 68608
    s_add_u32 s57, s48, 27267072
    buffer_load_dwordx4 v1, s[8:11], s57 offen offset:1024 sc1 lds
    s_add_u32 m0, s28, 74752
    s_add_u32 s57, s48, 27267072
    buffer_load_dwordx4 v1, s[8:11], s57 offen offset:2048 sc1 lds
    s_add_u32 m0, s28, 74752
    s_add_u32 s57, s48, 27267072
    buffer_load_dwordx4 v1, s[8:11], s57 offen offset:3072 sc1 lds
    s_waitcnt vmcnt(0)
    s_branch L_fixed_18
L_fix_25:
    s_mov_b32 s68, 0x80000
L_fixp_27:
    buffer_load_dword v3, v25, s[8:11], s38 offen sc1
    s_waitcnt vmcnt(0)
    v_cmp_le_u32 vcc, 8, v3
    s_nop 3
    s_cmp_eq_u64 vcc, -1
    s_cbranch_scc1 L_fixd_28
    s_sub_u32 s68, s68, 1
    s_cmp_lg_u32 s68, 0
    s_cbranch_scc1 L_fixp_27
L_fixd_28:
    s_add_u32 s57, s31, 14876672
    buffer_load_dwordx4 v[232:235], v1, s[8:11], s57 offen offset:0 sc1
    s_add_u32 s57, s31, 14925824
    buffer_load_dwordx4 v[236:239], v1, s[8:11], s57 offen offset:0 sc1
    s_add_u32 s57, s31, 14876672
    buffer_load_dwordx4 v[240:243], v1, s[8:11], s57 offen offset:1024 sc1
    s_add_u32 s57, s31, 14925824
    buffer_load_dwordx4 v[244:247], v1, s[8:11], s57 offen offset:1024 sc1
    s_add_u32 s57, s31, 14876672
    buffer_load_dwordx4 v[248:251], v1, s[8:11], s57 offen offset:2048 sc1
    s_add_u32 s57, s31, 14925824
    buffer_load_dwordx4 v[252:255], v1, s[8:11], s57 offen offset:2048 sc1
    s_add_u32 s57, s31, 14876672
    buffer_load_dwordx4 v[96:99], v1, s[8:11], s57 offen offset:3072 sc1
    s_add_u32 s57, s31, 14925824
    buffer_load_dwordx4 v[100:103], v1, s[8:11], s57 offen offset:3072 sc1
    s_add_u32 s57, s31, 14880768
    buffer_load_dwordx4 v[104:107], v1, s[8:11], s57 offen offset:0 sc1
    s_add_u32 s57, s31, 14929920
    buffer_load_dwordx4 v[108:111], v1, s[8:11], s57 offen offset:0 sc1
    s_add_u32 s57, s31, 14880768
    buffer_load_dwordx4 v[112:115], v1, s[8:11], s57 offen offset:1024 sc1
    s_add_u32 s57, s31, 14929920
    buffer_load_dwordx4 v[116:119], v1, s[8:11], s57 offen offset:1024 sc1
    s_add_u32 s57, s31, 14880768
    buffer_load_dwordx4 v[120:123], v1, s[8:11], s57 offen offset:2048 sc1
    s_add_u32 s57, s31, 14929920
    buffer_load_dwordx4 v[124:127], v1, s[8:11], s57 offen offset:2048 sc1
    s_add_u32 s57, s31, 14880768
    buffer_load_dwordx4 v[168:171], v1, s[8:11], s57 offen offset:3072 sc1
    s_add_u32 s57, s31, 14929920
    buffer_load_dwordx4 v[172:175], v1, s[8:11], s57 offen offset:3072 sc1
    s_add_u32 s57, s31, 14884864
    buffer_load_dwordx4 v[216:219], v1, s[8:11], s57 offen offset:0 sc1
    s_add_u32 s57, s31, 14934016
    buffer_load_dwordx4 v[220:223], v1, s[8:11], s57 offen offset:0 sc1
    s_add_u32 s57, s31, 14884864
    buffer_load_dwordx4 v[224:227], v1, s[8:11], s57 offen offset:1024 sc1
    s_add_u32 s57, s31, 14934016
    buffer_load_dwordx4 v[228:231], v1, s[8:11], s57 offen offset:1024 sc1
    s_waitcnt vmcnt(0)
    s_branch L_fixed_26
L_fix_29:
    s_mov_b32 s68, 0x80000
L_fixp_31:
    buffer_load_dword v3, v25, s[8:11], s38 offen sc1
    s_waitcnt vmcnt(0)
    v_cmp_le_u32 vcc, 8, v3
    s_nop 3
    s_cmp_eq_u64 vcc, -1
    s_cbranch_scc1 L_fixd_32
    s_sub_u32 s68, s68, 1
    s_cmp_lg_u32 s68, 0
    s_cbranch_scc1 L_fixp_31
L_fixd_32:
    s_add_u32 s57, s31, 14876672
    buffer_load_dwordx4 v[240:243], v1, s[8:11], s57 offen offset:1024 sc1
    s_add_u32 s57, s31, 14925824
    buffer_load_dwordx4 v[244:247], v1, s[8:11], s57 offen offset:1024 sc1
    s_add_u32 s57, s31, 14876672
    buffer_load_dwordx4 v[248:251], v1, s[8:11], s57 offen offset:2048 sc1
    s_add_u32 s57, s31, 14925824
    buffer_load_dwordx4 v[252:255], v1, s[8:11], s57 offen offset:2048 sc1
    s_add_u32 s57, s31, 14876672
    buffer_load_dwordx4 v[96:99], v1, s[8:11], s57 offen offset:3072 sc1
    s_add_u32 s57, s31, 14925824
    buffer_load_dwordx4 v[100:103], v1, s[8:11], s57 offen offset:3072 sc1
    s_add_u32 s57, s31, 14880768
    buffer_load_dwordx4 v[104:107], v1, s[8:11], s57 offen offset:0 sc1
    s_add_u32 s57, s31, 14929920
    buffer_load_dwordx4 v[108:111], v1, s[8:11], s57 offen offset:0 sc1
    s_add_u32 s57, s31, 14880768
    buffer_load_dwordx4 v[112:115], v1, s[8:11], s57 offen offset:1024 sc1
    s_add_u32 s57, s31, 14929920
    buffer_load_dwordx4 v[116:119], v1, s[8:11], s57 offen offset:1024 sc1
    s_add_u32 s57, s31, 14880768
    buffer_load_dwordx4 v[120:123], v1, s[8:11], s57 offen offset:2048 sc1
    s_add_u32 s57, s31, 14929920
    buffer_load_dwordx4 v[124:127], v1, s[8:11], s57 offen offset:2048 sc1
    s_add_u32 s57, s31, 14880768
    buffer_load_dwordx4 v[168:171], v1, s[8:11], s57 offen offset:3072 sc1
    s_add_u32 s57, s31, 14929920
    buffer_load_dwordx4 v[172:175], v1, s[8:11], s57 offen offset:3072 sc1
    s_add_u32 s57, s31, 14884864
    buffer_load_dwordx4 v[216:219], v1, s[8:11], s57 offen offset:0 sc1
    s_add_u32 s57, s31, 14934016
    buffer_load_dwordx4 v[220:223], v1, s[8:11], s57 offen offset:0 sc1
    s_add_u32 s57, s31, 14884864
    buffer_load_dwordx4 v[224:227], v1, s[8:11], s57 offen offset:1024 sc1
    s_add_u32 s57, s31, 14934016
    buffer_load_dwordx4 v[228:231], v1, s[8:11], s57 offen offset:1024 sc1
    s_waitcnt vmcnt(0)
    s_branch L_fixed_30
L_fix_33:
    s_mov_b32 s68, 0x80000
L_fixp_35:
    buffer_load_dword v3, v25, s[8:11], s38 offen sc1
    s_waitcnt vmcnt(0)
    v_cmp_le_u32 vcc, 8, v3
    s_nop 3
    s_cmp_eq_u64 vcc, -1
    s_cbranch_scc1 L_fixd_36
    s_sub_u32 s68, s68, 1
    s_cmp_lg_u32 s68, 0
    s_cbranch_scc1 L_fixp_35
L_fixd_36:
    s_add_u32 s57, s31, 14876672
    buffer_load_dwordx4 v[248:251], v1, s[8:11], s57 offen offset:2048 sc1
    s_add_u32 s57, s31, 14925824
    buffer_load_dwordx4 v[252:255], v1, s[8:11], s57 offen offset:2048 sc1
    s_add_u32 s57, s31, 14876672
    buffer_load_dwordx4 v[96:99], v1, s[8:11], s57 offen offset:3072 sc1
    s_add_u32 s57, s31, 14925824
    buffer_load_dwordx4 v[100:103], v1, s[8:11], s57 offen offset:3072 sc1
    s_add_u32 s57, s31, 14880768
    buffer_load_dwordx4 v[104:107], v1, s[8:11], s57 offen offset:0 sc1
    s_add_u32 s57, s31, 14929920
    buffer_load_dwordx4 v[108:111], v1, s[8:11], s57 offen offset:0 sc1
    s_add_u32 s57, s31, 14880768
    buffer_load_dwordx4 v[112:115], v1, s[8:11], s57 offen offset:1024 sc1
    s_add_u32 s57, s31, 14929920
    buffer_load_dwordx4 v[116:119], v1, s[8:11], s57 offen offset:1024 sc1
    s_add_u32 s57, s31, 14880768
    buffer_load_dwordx4 v[120:123], v1, s[8:11], s57 offen offset:2048 sc1
    s_add_u32 s57, s31, 14929920
    buffer_load_dwordx4 v[124:127], v1, s[8:11], s57 offen offset:2048 sc1
    s_add_u32 s57, s31, 14880768
    buffer_load_dwordx4 v[168:171], v1, s[8:11], s57 offen offset:3072 sc1
    s_add_u32 s57, s31, 14929920
    buffer_load_dwordx4 v[172:175], v1, s[8:11], s57 offen offset:3072 sc1
    s_add_u32 s57, s31, 14884864
    buffer_load_dwordx4 v[216:219], v1, s[8:11], s57 offen offset:0 sc1
    s_add_u32 s57, s31, 14934016
    buffer_load_dwordx4 v[220:223], v1, s[8:11], s57 offen offset:0 sc1
    s_add_u32 s57, s31, 14884864
    buffer_load_dwordx4 v[224:227], v1, s[8:11], s57 offen offset:1024 sc1
    s_add_u32 s57, s31, 14934016
    buffer_load_dwordx4 v[228:231], v1, s[8:11], s57 offen offset:1024 sc1
    s_add_u32 s57, s31, 14884864
    buffer_load_dwordx4 v[232:235], v1, s[8:11], s57 offen offset:2048 sc1
    s_add_u32 s57, s31, 14934016
    buffer_load_dwordx4 v[236:239], v1, s[8:11], s57 offen offset:2048 sc1
    s_waitcnt vmcnt(0)
    s_branch L_fixed_34
L_fix_37:
    s_mov_b32 s68, 0x80000
L_fixp_39:
    buffer_load_dword v3, v25, s[8:11], s38 offen sc1
    s_waitcnt vmcnt(0)
    v_cmp_le_u32 vcc, 8, v3
    s_nop 3
    s_cmp_eq_u64 vcc, -1
    s_cbranch_scc1 L_fixd_40
    s_sub_u32 s68, s68, 1
    s_cmp_lg_u32 s68, 0
    s_cbranch_scc1 L_fixp_39
L_fixd_40:
    s_add_u32 s57, s31, 14876672
    buffer_load_dwordx4 v[96:99], v1, s[8:11], s57 offen offset:3072 sc1
    s_add_u32 s57, s31, 14925824
    buffer_load_dwordx4 v[100:103], v1, s[8:11], s57 offen offset:3072 sc1
    s_add_u32 s57, s31, 14880768
    buffer_load_dwordx4 v[104:107], v1, s[8:11], s57 offen offset:0 sc1
    s_add_u32 s57, s31, 14929920
    buffer_load_dwordx4 v[108:111], v1, s[8:11], s57 offen offset:0 sc1
    s_add_u32 s57, s31, 14880768
    buffer_load_dwordx4 v[112:115], v1, s[8:11], s57 offen offset:1024 sc1
    s_add_u32 s57, s31, 14929920
    buffer_load_dwordx4 v[116:119], v1, s[8:11], s57 offen offset:1024 sc1
    s_add_u32 s57, s31, 14880768
    buffer_load_dwordx4 v[120:123], v1, s[8:11], s57 offen offset:2048 sc1
    s_add_u32 s57, s31, 14929920
    buffer_load_dwordx4 v[124:127], v1, s[8:11], s57 offen offset:2048 sc1
    s_add_u32 s57, s31, 14880768
    buffer_load_dwordx4 v[168:171], v1, s[8:11], s57 offen offset:3072 sc1
    s_add_u32 s57, s31, 14929920
    buffer_load_dwordx4 v[172:175], v1, s[8:11], s57 offen offset:3072 sc1
    s_add_u32 s57, s31, 14884864
    buffer_load_dwordx4 v[216:219], v1, s[8:11], s57 offen offset:0 sc1
    s_add_u32 s57, s31, 14934016
    buffer_load_dwordx4 v[220:223], v1, s[8:11], s57 offen offset:0 sc1
    s_add_u32 s57, s31, 14884864
    buffer_load_dwordx4 v[224:227], v1, s[8:11], s57 offen offset:1024 sc1
    s_add_u32 s57, s31, 14934016
    buffer_load_dwordx4 v[228:231], v1, s[8:11], s57 offen offset:1024 sc1
    s_add_u32 s57, s31, 14884864
    buffer_load_dwordx4 v[232:235], v1, s[8:11], s57 offen offset:2048 sc1
    s_add_u32 s57, s31, 14934016
    buffer_load_dwordx4 v[236:239], v1, s[8:11], s57 offen offset:2048 sc1
    s_add_u32 s57, s31, 14884864
    buffer_load_dwordx4 v[240:243], v1, s[8:11], s57 offen offset:3072 sc1
    s_add_u32 s57, s31, 14934016
    buffer_load_dwordx4 v[244:247], v1, s[8:11], s57 offen offset:3072 sc1
    s_waitcnt vmcnt(0)
    s_branch L_fixed_38
L_fix_41:
    s_mov_b32 s68, 0x80000
L_fixp_43:
    buffer_load_dword v3, v25, s[8:11], s38 offen sc1
    s_waitcnt vmcnt(0)
    v_cmp_le_u32 vcc, 8, v3
    s_nop 3
    s_cmp_eq_u64 vcc, -1
    s_cbranch_scc1 L_fixd_44
    s_sub_u32 s68, s68, 1
    s_cmp_lg_u32 s68, 0
    s_cbranch_scc1 L_fixp_43
L_fixd_44:
    s_add_u32 s57, s31, 14880768
    buffer_load_dwordx4 v[104:107], v1, s[8:11], s57 offen offset:0 sc1
    s_add_u32 s57, s31, 14929920
    buffer_load_dwordx4 v[108:111], v1, s[8:11], s57 offen offset:0 sc1
    s_add_u32 s57, s31, 14880768
    buffer_load_dwordx4 v[112:115], v1, s[8:11], s57 offen offset:1024 sc1
    s_add_u32 s57, s31, 14929920
    buffer_load_dwordx4 v[116:119], v1, s[8:11], s57 offen offset:1024 sc1
    s_add_u32 s57, s31, 14880768
    buffer_load_dwordx4 v[120:123], v1, s[8:11], s57 offen offset:2048 sc1
    s_add_u32 s57, s31, 14929920
    buffer_load_dwordx4 v[124:127], v1, s[8:11], s57 offen offset:2048 sc1
    s_add_u32 s57, s31, 14880768
    buffer_load_dwordx4 v[168:171], v1, s[8:11], s57 offen offset:3072 sc1
    s_add_u32 s57, s31, 14929920
    buffer_load_dwordx4 v[172:175], v1, s[8:11], s57 offen offset:3072 sc1
    s_add_u32 s57, s31, 14884864
    buffer_load_dwordx4 v[216:219], v1, s[8:11], s57 offen offset:0 sc1
    s_add_u32 s57, s31, 14934016
    buffer_load_dwordx4 v[220:223], v1, s[8:11], s57 offen offset:0 sc1
    s_add_u32 s57, s31, 14884864
    buffer_load_dwordx4 v[224:227], v1, s[8:11], s57 offen offset:1024 sc1
    s_add_u32 s57, s31, 14934016
    buffer_load_dwordx4 v[228:231], v1, s[8:11], s57 offen offset:1024 sc1
    s_add_u32 s57, s31, 14884864
    buffer_load_dwordx4 v[232:235], v1, s[8:11], s57 offen offset:2048 sc1
    s_add_u32 s57, s31, 14934016
    buffer_load_dwordx4 v[236:239], v1, s[8:11], s57 offen offset:2048 sc1
    s_add_u32 s57, s31, 14884864
    buffer_load_dwordx4 v[240:243], v1, s[8:11], s57 offen offset:3072 sc1
    s_add_u32 s57, s31, 14934016
    buffer_load_dwordx4 v[244:247], v1, s[8:11], s57 offen offset:3072 sc1
    s_waitcnt vmcnt(0)
    s_branch L_fixed_42
L_fix_45:
    s_mov_b32 s68, 0x80000
L_fixp_47:
    buffer_load_dword v3, v25, s[8:11], s38 offen sc1
    s_waitcnt vmcnt(0)
    v_cmp_le_u32 vcc, 8, v3
    s_nop 3
    s_cmp_eq_u64 vcc, -1
    s_cbranch_scc1 L_fixd_48
    s_sub_u32 s68, s68, 1
    s_cmp_lg_u32 s68, 0
    s_cbranch_scc1 L_fixp_47
L_fixd_48:
    s_add_u32 s57, s31, 14880768
    buffer_load_dwordx4 v[112:115], v1, s[8:11], s57 offen offset:1024 sc1
    s_add_u32 s57, s31, 14929920
    buffer_load_dwordx4 v[116:119], v1, s[8:11], s57 offen offset:1024 sc1
    s_add_u32 s57, s31, 14880768
    buffer_load_dwordx4 v[120:123], v1, s[8:11], s57 offen offset:2048 sc1
    s_add_u32 s57, s31, 14929920
    buffer_load_dwordx4 v[124:127], v1, s[8:11], s57 offen offset:2048 sc1
    s_add_u32 s57, s31, 14880768
    buffer_load_dwordx4 v[168:171], v1, s[8:11], s57 offen offset:3072 sc1
    s_add_u32 s57, s31, 14929920
    buffer_load_dwordx4 v[172:175], v1, s[8:11], s57 offen offset:3072 sc1
    s_add_u32 s57, s31, 14884864
    buffer_load_dwordx4 v[216:219], v1, s[8:11], s57 offen offset:0 sc1
    s_add_u32 s57, s31, 14934016
    buffer_load_dwordx4 v[220:223], v1, s[8:11], s57 offen offset:0 sc1
    s_add_u32 s57, s31, 14884864
    buffer_load_dwordx4 v[224:227], v1, s[8:11], s57 offen offset:1024 sc1
    s_add_u32 s57, s31, 14934016
    buffer_load_dwordx4 v[228:231], v1, s[8:11], s57 offen offset:1024 sc1
    s_add_u32 s57, s31, 14884864
    buffer_load_dwordx4 v[232:235], v1, s[8:11], s57 offen offset:2048 sc1
    s_add_u32 s57, s31, 14934016
    buffer_load_dwordx4 v[236:239], v1, s[8:11], s57 offen offset:2048 sc1
    s_add_u32 s57, s31, 14884864
    buffer_load_dwordx4 v[240:243], v1, s[8:11], s57 offen offset:3072 sc1
    s_add_u32 s57, s31, 14934016
    buffer_load_dwordx4 v[244:247], v1, s[8:11], s57 offen offset:3072 sc1
    s_waitcnt vmcnt(0)
    s_branch L_fixed_46
L_fix_49:
    s_mov_b32 s68, 0x80000
L_fixp_51:
    buffer_load_dword v3, v25, s[8:11], s38 offen sc1
    s_waitcnt vmcnt(0)
    v_cmp_le_u32 vcc, 8, v3
    s_nop 3
    s_cmp_eq_u64 vcc, -1
    s_cbranch_scc1 L_fixd_52
    s_sub_u32 s68, s68, 1
    s_cmp_lg_u32 s68, 0
    s_cbranch_scc1 L_fixp_51
L_fixd_52:
    s_add_u32 s57, s31, 14880768
    buffer_load_dwordx4 v[120:123], v1, s[8:11], s57 offen offset:2048 sc1
    s_add_u32 s57, s31, 14929920
    buffer_load_dwordx4 v[124:127], v1, s[8:11], s57 offen offset:2048 sc1
    s_add_u32 s57, s31, 14880768
    buffer_load_dwordx4 v[168:171], v1, s[8:11], s57 offen offset:3072 sc1
    s_add_u32 s57, s31, 14929920
    buffer_load_dwordx4 v[172:175], v1, s[8:11], s57 offen offset:3072 sc1
    s_add_u32 s57, s31, 14884864
    buffer_load_dwordx4 v[216:219], v1, s[8:11], s57 offen offset:0 sc1
    s_add_u32 s57, s31, 14934016
    buffer_load_dwordx4 v[220:223], v1, s[8:11], s57 offen offset:0 sc1
    s_add_u32 s57, s31, 14884864
    buffer_load_dwordx4 v[224:227], v1, s[8:11], s57 offen offset:1024 sc1
    s_add_u32 s57, s31, 14934016
    buffer_load_dwordx4 v[228:231], v1, s[8:11], s57 offen offset:1024 sc1
    s_add_u32 s57, s31, 14884864
    buffer_load_dwordx4 v[232:235], v1, s[8:11], s57 offen offset:2048 sc1
    s_add_u32 s57, s31, 14934016
    buffer_load_dwordx4 v[236:239], v1, s[8:11], s57 offen offset:2048 sc1
    s_add_u32 s57, s31, 14884864
    buffer_load_dwordx4 v[240:243], v1, s[8:11], s57 offen offset:3072 sc1
    s_add_u32 s57, s31, 14934016
    buffer_load_dwordx4 v[244:247], v1, s[8:11], s57 offen offset:3072 sc1
    s_waitcnt vmcnt(0)
    s_branch L_fixed_50
L_fix_53:
    s_mov_b32 s68, 0x80000
L_fixp_55:
    buffer_load_dword v3, v25, s[8:11], s38 offen sc1
    s_waitcnt vmcnt(0)
    v_cmp_le_u32 vcc, 8, v3
    s_nop 3
    s_cmp_eq_u64 vcc, -1
    s_cbranch_scc1 L_fixd_56
    s_sub_u32 s68, s68, 1
    s_cmp_lg_u32 s68, 0
    s_cbranch_scc1 L_fixp_55
L_fixd_56:
    s_add_u32 s57, s31, 14880768
    buffer_load_dwordx4 v[168:171], v1, s[8:11], s57 offen offset:3072 sc1
    s_add_u32 s57, s31, 14929920
    buffer_load_dwordx4 v[172:175], v1, s[8:11], s57 offen offset:3072 sc1
    s_add_u32 s57, s31, 14884864
    buffer_load_dwordx4 v[216:219], v1, s[8:11], s57 offen offset:0 sc1
    s_add_u32 s57, s31, 14934016
    buffer_load_dwordx4 v[220:223], v1, s[8:11], s57 offen offset:0 sc1
    s_add_u32 s57, s31, 14884864
    buffer_load_dwordx4 v[224:227], v1, s[8:11], s57 offen offset:1024 sc1
    s_add_u32 s57, s31, 14934016
    buffer_load_dwordx4 v[228:231], v1, s[8:11], s57 offen offset:1024 sc1
    s_add_u32 s57, s31, 14884864
    buffer_load_dwordx4 v[232:235], v1, s[8:11], s57 offen offset:2048 sc1
    s_add_u32 s57, s31, 14934016
    buffer_load_dwordx4 v[236:239], v1, s[8:11], s57 offen offset:2048 sc1
    s_add_u32 s57, s31, 14884864
    buffer_load_dwordx4 v[240:243], v1, s[8:11], s57 offen offset:3072 sc1
    s_add_u32 s57, s31, 14934016
    buffer_load_dwordx4 v[244:247], v1, s[8:11], s57 offen offset:3072 sc1
    s_waitcnt vmcnt(0)
    s_branch L_fixed_54
L_fix_57:
    s_mov_b32 s68, 0x80000
L_fixp_59:
    buffer_load_dword v3, v25, s[8:11], s38 offen sc1
    s_waitcnt vmcnt(0)
    v_cmp_le_u32 vcc, 8, v3
    s_nop 3
    s_cmp_eq_u64 vcc, -1
    s_cbranch_scc1 L_fixd_60
    s_sub_u32 s68, s68, 1
    s_cmp_lg_u32 s68, 0
    s_cbranch_scc1 L_fixp_59
L_fixd_60:
    s_add_u32 s57, s31, 14884864
    buffer_load_dwordx4 v[216:219], v1, s[8:11], s57 offen offset:0 sc1
    s_add_u32 s57, s31, 14934016
    buffer_load_dwordx4 v[220:223], v1, s[8:11], s57 offen offset:0 sc1
    s_add_u32 s57, s31, 14884864
    buffer_load_dwordx4 v[224:227], v1, s[8:11], s57 offen offset:1024 sc1
    s_add_u32 s57, s31, 14934016
    buffer_load_dwordx4 v[228:231], v1, s[8:11], s57 offen offset:1024 sc1
    s_add_u32 s57, s31, 14884864
    buffer_load_dwordx4 v[232:235], v1, s[8:11], s57 offen offset:2048 sc1
    s_add_u32 s57, s31, 14934016
    buffer_load_dwordx4 v[236:239], v1, s[8:11], s57 offen offset:2048 sc1
    s_add_u32 s57, s31, 14884864
    buffer_load_dwordx4 v[240:243], v1, s[8:11], s57 offen offset:3072 sc1
    s_add_u32 s57, s31, 14934016
    buffer_load_dwordx4 v[244:247], v1, s[8:11], s57 offen offset:3072 sc1
    s_waitcnt vmcnt(0)
    s_branch L_fixed_58
L_fix_61:
    s_mov_b32 s68, 0x80000
L_fixp_63:
    buffer_load_dword v3, v25, s[8:11], s38 offen sc1
    s_waitcnt vmcnt(0)
    v_cmp_le_u32 vcc, 8, v3
    s_nop 3
    s_cmp_eq_u64 vcc, -1
    s_cbranch_scc1 L_fixd_64
    s_sub_u32 s68, s68, 1
    s_cmp_lg_u32 s68, 0
    s_cbranch_scc1 L_fixp_63
L_fixd_64:
    s_add_u32 s57, s31, 14884864
    buffer_load_dwordx4 v[224:227], v1, s[8:11], s57 offen offset:1024 sc1
    s_add_u32 s57, s31, 14934016
    buffer_load_dwordx4 v[228:231], v1, s[8:11], s57 offen offset:1024 sc1
    s_add_u32 s57, s31, 14884864
    buffer_load_dwordx4 v[232:235], v1, s[8:11], s57 offen offset:2048 sc1
    s_add_u32 s57, s31, 14934016
    buffer_load_dwordx4 v[236:239], v1, s[8:11], s57 offen offset:2048 sc1
    s_add_u32 s57, s31, 14884864
    buffer_load_dwordx4 v[240:243], v1, s[8:11], s57 offen offset:3072 sc1
    s_add_u32 s57, s31, 14934016
    buffer_load_dwordx4 v[244:247], v1, s[8:11], s57 offen offset:3072 sc1
    s_waitcnt vmcnt(0)
    s_branch L_fixed_62
L_fix_67:
    s_mov_b32 s68, 0x80000
L_fixp_69:
    buffer_load_dword v3, v25, s[8:11], s38 offen sc1
    s_waitcnt vmcnt(0)
    v_cmp_le_u32 vcc, 9, v3
    s_nop 3
    s_cmp_eq_u64 vcc, -1
    s_cbranch_scc1 L_fixd_70
    s_sub_u32 s68, s68, 1
    s_cmp_lg_u32 s68, 0
    s_cbranch_scc1 L_fixp_69
L_fixd_70:
    s_add_u32 m0, s28, 44032
    s_add_u32 s57, s48, 32505856
    buffer_load_dwordx4 v1, s[8:11], s57 offen offset:0 sc1 lds
    s_add_u32 m0, s28, 44032
    s_add_u32 s57, s48, 32505856
    buffer_load_dwordx4 v1, s[8:11], s57 offen offset:1024 sc1 lds
    s_add_u32 m0, s28, 50176
    s_add_u32 s57, s48, 32505856
    buffer_load_dwordx4 v1, s[8:11], s57 offen offset:2048 sc1 lds
    s_add_u32 m0, s28, 50176
    s_add_u32 s57, s48, 32505856
    buffer_load_dwordx4 v1, s[8:11], s57 offen offset:3072 sc1 lds
    s_add_u32 m0, s28, 60416
    s_add_u32 s57, s48, 32509952
    buffer_load_dwordx4 v1, s[8:11], s57 offen offset:0 sc1 lds
    s_add_u32 m0, s28, 60416
    s_add_u32 s57, s48, 32509952
    buffer_load_dwordx4 v1, s[8:11], s57 offen offset:1024 sc1 lds
    s_add_u32 m0, s28, 66560
    s_add_u32 s57, s48, 32509952
    buffer_load_dwordx4 v1, s[8:11], s57 offen offset:2048 sc1 lds
    s_add_u32 m0, s28, 66560
    s_add_u32 s57, s48, 32509952
    buffer_load_dwordx4 v1, s[8:11], s57 offen offset:3072 sc1 lds
    s_waitcnt vmcnt(0)
    s_branch L_fixed_68
L_fix_77:
    s_mov_b32 s68, 0x80000
L_fixp_79:
    buffer_load_dword v3, v25, s[8:11], s38 offen sc1
    s_waitcnt vmcnt(0)
    v_cmp_le_u32 vcc, 12, v3
    s_nop 3
    s_cmp_eq_u64 vcc, -1
    s_cbranch_scc1 L_fixd_80
    s_sub_u32 s68, s68, 1
    s_cmp_lg_u32 s68, 0
    s_cbranch_scc1 L_fixp_79
L_fixd_80:
    s_add_u32 s57, s30, 12140544
    buffer_load_dwordx4 v[96:99], v1, s[8:11], s57 offen offset:0 sc1
    s_add_u32 s57, s30, 12161024
    buffer_load_dwordx4 v[100:103], v1, s[8:11], s57 offen offset:0 sc1
    s_add_u32 s57, s30, 12140544
    buffer_load_dwordx4 v[104:107], v1, s[8:11], s57 offen offset:1024 sc1
    s_add_u32 s57, s30, 12161024
    buffer_load_dwordx4 v[108:111], v1, s[8:11], s57 offen offset:1024 sc1
    s_add_u32 s57, s30, 12140544
    buffer_load_dwordx4 v[112:115], v1, s[8:11], s57 offen offset:2048 sc1
    s_add_u32 s57, s30, 12161024
    buffer_load_dwordx4 v[116:119], v1, s[8:11], s57 offen offset:2048 sc1
    s_add_u32 s57, s30, 12140544
    buffer_load_dwordx4 v[120:123], v1, s[8:11], s57 offen offset:3072 sc1
    s_add_u32 s57, s30, 12161024
    buffer_load_dwordx4 v[124:127], v1, s[8:11], s57 offen offset:3072 sc1
    s_add_u32 s57, s30, 12144640
    buffer_load_dwordx4 v[168:171], v1, s[8:11], s57 offen offset:0 sc1
    s_add_u32 s57, s30, 12165120
    buffer_load_dwordx4 v[172:175], v1, s[8:11], s57 offen offset:0 sc1
    s_waitcnt vmcnt(0)
    s_branch L_fixed_78
L_fix_81:
    s_mov_b32 s68, 0x80000
L_fixp_83:
    buffer_load_dword v3, v25, s[8:11], s38 offen sc1
    s_waitcnt vmcnt(0)
    v_cmp_le_u32 vcc, 12, v3
    s_nop 3
    s_cmp_eq_u64 vcc, -1
    s_cbranch_scc1 L_fixd_84
    s_sub_u32 s68, s68, 1
    s_cmp_lg_u32 s68, 0
    s_cbranch_scc1 L_fixp_83
L_fixd_84:
    s_add_u32 s57, s30, 12140544
    buffer_load_dwordx4 v[104:107], v1, s[8:11], s57 offen offset:1024 sc1
    s_add_u32 s57, s30, 12161024
    buffer_load_dwordx4 v[108:111], v1, s[8:11], s57 offen offset:1024 sc1
    s_add_u32 s57, s30, 12140544
    buffer_load_dwordx4 v[112:115], v1, s[8:11], s57 offen offset:2048 sc1
    s_add_u32 s57, s30, 12161024
    buffer_load_dwordx4 v[116:119], v1, s[8:11], s57 offen offset:2048 sc1
    s_add_u32 s57, s30, 12140544
    buffer_load_dwordx4 v[120:123], v1, s[8:11], s57 offen offset:3072 sc1
    s_add_u32 s57, s30, 12161024
    buffer_load_dwordx4 v[124:127], v1, s[8:11], s57 offen offset:3072 sc1
    s_add_u32 s57, s30, 12144640
    buffer_load_dwordx4 v[168:171], v1, s[8:11], s57 offen offset:0 sc1
    s_add_u32 s57, s30, 12165120
    buffer_load_dwordx4 v[172:175], v1, s[8:11], s57 offen offset:0 sc1
    s_waitcnt vmcnt(0)
    s_branch L_fixed_82
L_fix_85:
    s_mov_b32 s68, 0x80000
L_fixp_87:
    buffer_load_dword v3, v25, s[8:11], s38 offen sc1
    s_waitcnt vmcnt(0)
    v_cmp_le_u32 vcc, 12, v3
    s_nop 3
    s_cmp_eq_u64 vcc, -1
    s_cbranch_scc1 L_fixd_88
    s_sub_u32 s68, s68, 1
    s_cmp_lg_u32 s68, 0
    s_cbranch_scc1 L_fixp_87
L_fixd_88:
    s_add_u32 s57, s30, 12140544
    buffer_load_dwordx4 v[112:115], v1, s[8:11], s57 offen offset:2048 sc1
    s_add_u32 s57, s30, 12161024
    buffer_load_dwordx4 v[116:119], v1, s[8:11], s57 offen offset:2048 sc1
    s_add_u32 s57, s30, 12140544
    buffer_load_dwordx4 v[120:123], v1, s[8:11], s57 offen offset:3072 sc1
    s_add_u32 s57, s30, 12161024
    buffer_load_dwordx4 v[124:127], v1, s[8:11], s57 offen offset:3072 sc1
    s_add_u32 s57, s30, 12144640
    buffer_load_dwordx4 v[168:171], v1, s[8:11], s57 offen offset:0 sc1
    s_add_u32 s57, s30, 12165120
    buffer_load_dwordx4 v[172:175], v1, s[8:11], s57 offen offset:0 sc1
    s_waitcnt vmcnt(0)
    s_branch L_fixed_86
L_fix_91:
    s_mov_b32 s68, 0x80000
L_fixp_93:
    buffer_load_dword v3, v25, s[8:11], s38 offen sc1
    s_waitcnt vmcnt(0)
    v_cmp_le_u32 vcc, 13, v3
    s_nop 3
    s_cmp_eq_u64 vcc, -1
    s_cbranch_scc1 L_fixd_94
    s_sub_u32 s68, s68, 1
    s_cmp_lg_u32 s68, 0
    s_cbranch_scc1 L_fixp_93
L_fixd_94:
    s_add_u32 m0, s28, 93184
    s_add_u32 s57, s48, 29884416
    buffer_load_dwordx4 v1, s[8:11], s57 offen offset:0 sc1 lds
    s_add_u32 m0, s28, 93184
    s_add_u32 s57, s48, 29884416
    buffer_load_dwordx4 v1, s[8:11], s57 offen offset:1024 sc1 lds
    s_add_u32 m0, s28, 99328
    s_add_u32 s57, s48, 29884416
    buffer_load_dwordx4 v1, s[8:11], s57 offen offset:2048 sc1 lds
    s_add_u32 m0, s28, 99328
    s_add_u32 s57, s48, 29884416
    buffer_load_dwordx4 v1, s[8:11], s57 offen offset:3072 sc1 lds
    s_add_u32 m0, s28, 109568
    s_add_u32 s57, s48, 29888512
    buffer_load_dwordx4 v1, s[8:11], s57 offen offset:0 sc1 lds
    s_add_u32 m0, s28, 109568
    s_add_u32 s57, s48, 29888512
    buffer_load_dwordx4 v1, s[8:11], s57 offen offset:1024 sc1 lds
    s_add_u32 m0, s28, 1024
    s_add_u32 s57, s48, 29888512
    buffer_load_dwordx4 v1, s[8:11], s57 offen offset:2048 sc1 lds
    s_add_u32 m0, s28, 1024
    s_add_u32 s57, s48, 29888512
    buffer_load_dwordx4 v1, s[8:11], s57 offen offset:3072 sc1 lds
    s_waitcnt vmcnt(0)
    s_branch L_fixed_92
L_fix_99:
    s_mov_b32 s68, 0x80000
L_fixp_101:
    buffer_load_dword v3, v25, s[8:11], s38 offen sc1
    s_waitcnt vmcnt(0)
    v_cmp_le_u32 vcc, 16, v3
    s_nop 3
    s_cmp_eq_u64 vcc, -1
    s_cbranch_scc1 L_fixd_102
    s_sub_u32 s68, s68, 1
    s_cmp_lg_u32 s68, 0
    s_cbranch_scc1 L_fixp_101
L_fixd_102:
    s_add_u32 s57, s31, 21168128
    buffer_load_dwordx4 v[232:235], v1, s[8:11], s57 offen offset:0 sc1
    s_add_u32 s57, s31, 21217280
    buffer_load_dwordx4 v[236:239], v1, s[8:11], s57 offen offset:0 sc1
    s_add_u32 s57, s31, 21168128
    buffer_load_dwordx4 v[240:243], v1, s[8:11], s57 offen offset:1024 sc1
    s_add_u32 s57, s31, 21217280
    buffer_load_dwordx4 v[244:247], v1, s[8:11], s57 offen offset:1024 sc1
    s_add_u32 s57, s31, 21168128
    buffer_load_dwordx4 v[248:251], v1, s[8:11], s57 offen offset:2048 sc1
    s_add_u32 s57, s31, 21217280
    buffer_load_dwordx4 v[252:255], v1, s[8:11], s57 offen offset:2048 sc1
    s_add_u32 s57, s31, 21168128
    buffer_load_dwordx4 v[96:99], v1, s[8:11], s57 offen offset:3072 sc1
    s_add_u32 s57, s31, 21217280
    buffer_load_dwordx4 v[100:103], v1, s[8:11], s57 offen offset:3072 sc1
    s_add_u32 s57, s31, 21172224
    buffer_load_dwordx4 v[104:107], v1, s[8:11], s57 offen offset:0 sc1
    s_add_u32 s57, s31, 21221376
    buffer_load_dwordx4 v[108:111], v1, s[8:11], s57 offen offset:0 sc1
    s_add_u32 s57, s31, 21172224
    buffer_load_dwordx4 v[112:115], v1, s[8:11], s57 offen offset:1024 sc1
    s_add_u32 s57, s31, 21221376
    buffer_load_dwordx4 v[116:119], v1, s[8:11], s57 offen offset:1024 sc1
    s_add_u32 s57, s31, 21172224
    buffer_load_dwordx4 v[120:123], v1, s[8:11], s57 offen offset:2048 sc1
    s_add_u32 s57, s31, 21221376
    buffer_load_dwordx4 v[124:127], v1, s[8:11], s57 offen offset:2048 sc1
    s_add_u32 s57, s31, 21172224
    buffer_load_dwordx4 v[168:171], v1, s[8:11], s57 offen offset:3072 sc1
    s_add_u32 s57, s31, 21221376
    buffer_load_dwordx4 v[172:175], v1, s[8:11], s57 offen offset:3072 sc1
    s_add_u32 s57, s31, 21176320
    buffer_load_dwordx4 v[216:219], v1, s[8:11], s57 offen offset:0 sc1
    s_add_u32 s57, s31, 21225472
    buffer_load_dwordx4 v[220:223], v1, s[8:11], s57 offen offset:0 sc1
    s_add_u32 s57, s31, 21176320
    buffer_load_dwordx4 v[224:227], v1, s[8:11], s57 offen offset:1024 sc1
    s_add_u32 s57, s31, 21225472
    buffer_load_dwordx4 v[228:231], v1, s[8:11], s57 offen offset:1024 sc1
    s_waitcnt vmcnt(0)
    s_branch L_fixed_100
L_fix_103:
    s_mov_b32 s68, 0x80000
L_fixp_105:
    buffer_load_dword v3, v25, s[8:11], s38 offen sc1
    s_waitcnt vmcnt(0)
    v_cmp_le_u32 vcc, 16, v3
    s_nop 3
    s_cmp_eq_u64 vcc, -1
    s_cbranch_scc1 L_fixd_106
    s_sub_u32 s68, s68, 1
    s_cmp_lg_u32 s68, 0
    s_cbranch_scc1 L_fixp_105
L_fixd_106:
    s_add_u32 s57, s31, 21168128
    buffer_load_dwordx4 v[240:243], v1, s[8:11], s57 offen offset:1024 sc1
    s_add_u32 s57, s31, 21217280
    buffer_load_dwordx4 v[244:247], v1, s[8:11], s57 offen offset:1024 sc1
    s_add_u32 s57, s31, 21168128
    buffer_load_dwordx4 v[248:251], v1, s[8:11], s57 offen offset:2048 sc1
    s_add_u32 s57, s31, 21217280
    buffer_load_dwordx4 v[252:255], v1, s[8:11], s57 offen offset:2048 sc1
    s_add_u32 s57, s31, 21168128
    buffer_load_dwordx4 v[96:99], v1, s[8:11], s57 offen offset:3072 sc1
    s_add_u32 s57, s31, 21217280
    buffer_load_dwordx4 v[100:103], v1, s[8:11], s57 offen offset:3072 sc1
    s_add_u32 s57, s31, 21172224
    buffer_load_dwordx4 v[104:107], v1, s[8:11], s57 offen offset:0 sc1
    s_add_u32 s57, s31, 21221376
    buffer_load_dwordx4 v[108:111], v1, s[8:11], s57 offen offset:0 sc1
    s_add_u32 s57, s31, 21172224
    buffer_load_dwordx4 v[112:115], v1, s[8:11], s57 offen offset:1024 sc1
    s_add_u32 s57, s31, 21221376
    buffer_load_dwordx4 v[116:119], v1, s[8:11], s57 offen offset:1024 sc1
    s_add_u32 s57, s31, 21172224
    buffer_load_dwordx4 v[120:123], v1, s[8:11], s57 offen offset:2048 sc1
    s_add_u32 s57, s31, 21221376
    buffer_load_dwordx4 v[124:127], v1, s[8:11], s57 offen offset:2048 sc1
    s_add_u32 s57, s31, 21172224
    buffer_load_dwordx4 v[168:171], v1, s[8:11], s57 offen offset:3072 sc1
    s_add_u32 s57, s31, 21221376
    buffer_load_dwordx4 v[172:175], v1, s[8:11], s57 offen offset:3072 sc1
    s_add_u32 s57, s31, 21176320
    buffer_load_dwordx4 v[216:219], v1, s[8:11], s57 offen offset:0 sc1
    s_add_u32 s57, s31, 21225472
    buffer_load_dwordx4 v[220:223], v1, s[8:11], s57 offen offset:0 sc1
    s_add_u32 s57, s31, 21176320
    buffer_load_dwordx4 v[224:227], v1, s[8:11], s57 offen offset:1024 sc1
    s_add_u32 s57, s31, 21225472
    buffer_load_dwordx4 v[228:231], v1, s[8:11], s57 offen offset:1024 sc1
    s_waitcnt vmcnt(0)
    s_branch L_fixed_104
L_fix_107:
    s_mov_b32 s68, 0x80000
L_fixp_109:
    buffer_load_dword v3, v25, s[8:11], s38 offen sc1
    s_waitcnt vmcnt(0)
    v_cmp_le_u32 vcc, 16, v3
    s_nop 3
    s_cmp_eq_u64 vcc, -1
    s_cbranch_scc1 L_fixd_110
    s_sub_u32 s68, s68, 1
    s_cmp_lg_u32 s68, 0
    s_cbranch_scc1 L_fixp_109
L_fixd_110:
    s_add_u32 s57, s31, 21168128
    buffer_load_dwordx4 v[248:251], v1, s[8:11], s57 offen offset:2048 sc1
    s_add_u32 s57, s31, 21217280
    buffer_load_dwordx4 v[252:255], v1, s[8:11], s57 offen offset:2048 sc1
    s_add_u32 s57, s31, 21168128
    buffer_load_dwordx4 v[96:99], v1, s[8:11], s57 offen offset:3072 sc1
    s_add_u32 s57, s31, 21217280
    buffer_load_dwordx4 v[100:103], v1, s[8:11], s57 offen offset:3072 sc1
    s_add_u32 s57, s31, 21172224
    buffer_load_dwordx4 v[104:107], v1, s[8:11], s57 offen offset:0 sc1
    s_add_u32 s57, s31, 21221376
    buffer_load_dwordx4 v[108:111], v1, s[8:11], s57 offen offset:0 sc1
    s_add_u32 s57, s31, 21172224
    buffer_load_dwordx4 v[112:115], v1, s[8:11], s57 offen offset:1024 sc1
    s_add_u32 s57, s31, 21221376
    buffer_load_dwordx4 v[116:119], v1, s[8:11], s57 offen offset:1024 sc1
    s_add_u32 s57, s31, 21172224
    buffer_load_dwordx4 v[120:123], v1, s[8:11], s57 offen offset:2048 sc1
    s_add_u32 s57, s31, 21221376
    buffer_load_dwordx4 v[124:127], v1, s[8:11], s57 offen offset:2048 sc1
    s_add_u32 s57, s31, 21172224
    buffer_load_dwordx4 v[168:171], v1, s[8:11], s57 offen offset:3072 sc1
    s_add_u32 s57, s31, 21221376
    buffer_load_dwordx4 v[172:175], v1, s[8:11], s57 offen offset:3072 sc1
    s_add_u32 s57, s31, 21176320
    buffer_load_dwordx4 v[216:219], v1, s[8:11], s57 offen offset:0 sc1
    s_add_u32 s57, s31, 21225472
    buffer_load_dwordx4 v[220:223], v1, s[8:11], s57 offen offset:0 sc1
    s_add_u32 s57, s31, 21176320
    buffer_load_dwordx4 v[224:227], v1, s[8:11], s57 offen offset:1024 sc1
    s_add_u32 s57, s31, 21225472
    buffer_load_dwordx4 v[228:231], v1, s[8:11], s57 offen offset:1024 sc1
    s_add_u32 s57, s31, 21176320
    buffer_load_dwordx4 v[232:235], v1, s[8:11], s57 offen offset:2048 sc1
    s_add_u32 s57, s31, 21225472
    buffer_load_dwordx4 v[236:239], v1, s[8:11], s57 offen offset:2048 sc1
    s_waitcnt vmcnt(0)
    s_branch L_fixed_108
L_fix_111:
    s_mov_b32 s68, 0x80000
L_fixp_113:
    buffer_load_dword v3, v25, s[8:11], s38 offen sc1
    s_waitcnt vmcnt(0)
    v_cmp_le_u32 vcc, 16, v3
    s_nop 3
    s_cmp_eq_u64 vcc, -1
    s_cbranch_scc1 L_fixd_114
    s_sub_u32 s68, s68, 1
    s_cmp_lg_u32 s68, 0
    s_cbranch_scc1 L_fixp_113
L_fixd_114:
    s_add_u32 s57, s31, 21168128
    buffer_load_dwordx4 v[96:99], v1, s[8:11], s57 offen offset:3072 sc1
    s_add_u32 s57, s31, 21217280
    buffer_load_dwordx4 v[100:103], v1, s[8:11], s57 offen offset:3072 sc1
    s_add_u32 s57, s31, 21172224
    buffer_load_dwordx4 v[104:107], v1, s[8:11], s57 offen offset:0 sc1
    s_add_u32 s57, s31, 21221376
    buffer_load_dwordx4 v[108:111], v1, s[8:11], s57 offen offset:0 sc1
    s_add_u32 s57, s31, 21172224
    buffer_load_dwordx4 v[112:115], v1, s[8:11], s57 offen offset:1024 sc1
    s_add_u32 s57, s31, 21221376
    buffer_load_dwordx4 v[116:119], v1, s[8:11], s57 offen offset:1024 sc1
    s_add_u32 s57, s31, 21172224
    buffer_load_dwordx4 v[120:123], v1, s[8:11], s57 offen offset:2048 sc1
    s_add_u32 s57, s31, 21221376
    buffer_load_dwordx4 v[124:127], v1, s[8:11], s57 offen offset:2048 sc1
    s_add_u32 s57, s31, 21172224
    buffer_load_dwordx4 v[168:171], v1, s[8:11], s57 offen offset:3072 sc1
    s_add_u32 s57, s31, 21221376
    buffer_load_dwordx4 v[172:175], v1, s[8:11], s57 offen offset:3072 sc1
    s_add_u32 s57, s31, 21176320
    buffer_load_dwordx4 v[216:219], v1, s[8:11], s57 offen offset:0 sc1
    s_add_u32 s57, s31, 21225472
    buffer_load_dwordx4 v[220:223], v1, s[8:11], s57 offen offset:0 sc1
    s_add_u32 s57, s31, 21176320
    buffer_load_dwordx4 v[224:227], v1, s[8:11], s57 offen offset:1024 sc1
    s_add_u32 s57, s31, 21225472
    buffer_load_dwordx4 v[228:231], v1, s[8:11], s57 offen offset:1024 sc1
    s_add_u32 s57, s31, 21176320
    buffer_load_dwordx4 v[232:235], v1, s[8:11], s57 offen offset:2048 sc1
    s_add_u32 s57, s31, 21225472
    buffer_load_dwordx4 v[236:239], v1, s[8:11], s57 offen offset:2048 sc1
    s_add_u32 s57, s31, 21176320
    buffer_load_dwordx4 v[240:243], v1, s[8:11], s57 offen offset:3072 sc1
    s_add_u32 s57, s31, 21225472
    buffer_load_dwordx4 v[244:247], v1, s[8:11], s57 offen offset:3072 sc1
    s_waitcnt vmcnt(0)
    s_branch L_fixed_112
L_fix_115:
    s_mov_b32 s68, 0x80000
L_fixp_117:
    buffer_load_dword v3, v25, s[8:11], s38 offen sc1
    s_waitcnt vmcnt(0)
    v_cmp_le_u32 vcc, 16, v3
    s_nop 3
    s_cmp_eq_u64 vcc, -1
    s_cbranch_scc1 L_fixd_118
    s_sub_u32 s68, s68, 1
    s_cmp_lg_u32 s68, 0
    s_cbranch_scc1 L_fixp_117
L_fixd_118:
    s_add_u32 s57, s31, 21172224
    buffer_load_dwordx4 v[104:107], v1, s[8:11], s57 offen offset:0 sc1
    s_add_u32 s57, s31, 21221376
    buffer_load_dwordx4 v[108:111], v1, s[8:11], s57 offen offset:0 sc1
    s_add_u32 s57, s31, 21172224
    buffer_load_dwordx4 v[112:115], v1, s[8:11], s57 offen offset:1024 sc1
    s_add_u32 s57, s31, 21221376
    buffer_load_dwordx4 v[116:119], v1, s[8:11], s57 offen offset:1024 sc1
    s_add_u32 s57, s31, 21172224
    buffer_load_dwordx4 v[120:123], v1, s[8:11], s57 offen offset:2048 sc1
    s_add_u32 s57, s31, 21221376
    buffer_load_dwordx4 v[124:127], v1, s[8:11], s57 offen offset:2048 sc1
    s_add_u32 s57, s31, 21172224
    buffer_load_dwordx4 v[168:171], v1, s[8:11], s57 offen offset:3072 sc1
    s_add_u32 s57, s31, 21221376
    buffer_load_dwordx4 v[172:175], v1, s[8:11], s57 offen offset:3072 sc1
    s_add_u32 s57, s31, 21176320
    buffer_load_dwordx4 v[216:219], v1, s[8:11], s57 offen offset:0 sc1
    s_add_u32 s57, s31, 21225472
    buffer_load_dwordx4 v[220:223], v1, s[8:11], s57 offen offset:0 sc1
    s_add_u32 s57, s31, 21176320
    buffer_load_dwordx4 v[224:227], v1, s[8:11], s57 offen offset:1024 sc1
    s_add_u32 s57, s31, 21225472
    buffer_load_dwordx4 v[228:231], v1, s[8:11], s57 offen offset:1024 sc1
    s_add_u32 s57, s31, 21176320
    buffer_load_dwordx4 v[232:235], v1, s[8:11], s57 offen offset:2048 sc1
    s_add_u32 s57, s31, 21225472
    buffer_load_dwordx4 v[236:239], v1, s[8:11], s57 offen offset:2048 sc1
    s_add_u32 s57, s31, 21176320
    buffer_load_dwordx4 v[240:243], v1, s[8:11], s57 offen offset:3072 sc1
    s_add_u32 s57, s31, 21225472
    buffer_load_dwordx4 v[244:247], v1, s[8:11], s57 offen offset:3072 sc1
    s_waitcnt vmcnt(0)
    s_branch L_fixed_116
L_fix_119:
    s_mov_b32 s68, 0x80000
L_fixp_121:
    buffer_load_dword v3, v25, s[8:11], s38 offen sc1
    s_waitcnt vmcnt(0)
    v_cmp_le_u32 vcc, 16, v3
    s_nop 3
    s_cmp_eq_u64 vcc, -1
    s_cbranch_scc1 L_fixd_122
    s_sub_u32 s68, s68, 1
    s_cmp_lg_u32 s68, 0
    s_cbranch_scc1 L_fixp_121
L_fixd_122:
    s_add_u32 s57, s31, 21172224
    buffer_load_dwordx4 v[112:115], v1, s[8:11], s57 offen offset:1024 sc1
    s_add_u32 s57, s31, 21221376
    buffer_load_dwordx4 v[116:119], v1, s[8:11], s57 offen offset:1024 sc1
    s_add_u32 s57, s31, 21172224
    buffer_load_dwordx4 v[120:123], v1, s[8:11], s57 offen offset:2048 sc1
    s_add_u32 s57, s31, 21221376
    buffer_load_dwordx4 v[124:127], v1, s[8:11], s57 offen offset:2048 sc1
    s_add_u32 s57, s31, 21172224
    buffer_load_dwordx4 v[168:171], v1, s[8:11], s57 offen offset:3072 sc1
    s_add_u32 s57, s31, 21221376
    buffer_load_dwordx4 v[172:175], v1, s[8:11], s57 offen offset:3072 sc1
    s_add_u32 s57, s31, 21176320
    buffer_load_dwordx4 v[216:219], v1, s[8:11], s57 offen offset:0 sc1
    s_add_u32 s57, s31, 21225472
    buffer_load_dwordx4 v[220:223], v1, s[8:11], s57 offen offset:0 sc1
    s_add_u32 s57, s31, 21176320
    buffer_load_dwordx4 v[224:227], v1, s[8:11], s57 offen offset:1024 sc1
    s_add_u32 s57, s31, 21225472
    buffer_load_dwordx4 v[228:231], v1, s[8:11], s57 offen offset:1024 sc1
    s_add_u32 s57, s31, 21176320
    buffer_load_dwordx4 v[232:235], v1, s[8:11], s57 offen offset:2048 sc1
    s_add_u32 s57, s31, 21225472
    buffer_load_dwordx4 v[236:239], v1, s[8:11], s57 offen offset:2048 sc1
    s_add_u32 s57, s31, 21176320
    buffer_load_dwordx4 v[240:243], v1, s[8:11], s57 offen offset:3072 sc1
    s_add_u32 s57, s31, 21225472
    buffer_load_dwordx4 v[244:247], v1, s[8:11], s57 offen offset:3072 sc1
    s_waitcnt vmcnt(0)
    s_branch L_fixed_120
L_fix_123:
    s_mov_b32 s68, 0x80000
L_fixp_125:
    buffer_load_dword v3, v25, s[8:11], s38 offen sc1
    s_waitcnt vmcnt(0)
    v_cmp_le_u32 vcc, 16, v3
    s_nop 3
    s_cmp_eq_u64 vcc, -1
    s_cbranch_scc1 L_fixd_126
    s_sub_u32 s68, s68, 1
    s_cmp_lg_u32 s68, 0
    s_cbranch_scc1 L_fixp_125
L_fixd_126:
    s_add_u32 s57, s31, 21172224
    buffer_load_dwordx4 v[120:123], v1, s[8:11], s57 offen offset:2048 sc1
    s_add_u32 s57, s31, 21221376
    buffer_load_dwordx4 v[124:127], v1, s[8:11], s57 offen offset:2048 sc1
    s_add_u32 s57, s31, 21172224
    buffer_load_dwordx4 v[168:171], v1, s[8:11], s57 offen offset:3072 sc1
    s_add_u32 s57, s31, 21221376
    buffer_load_dwordx4 v[172:175], v1, s[8:11], s57 offen offset:3072 sc1
    s_add_u32 s57, s31, 21176320
    buffer_load_dwordx4 v[216:219], v1, s[8:11], s57 offen offset:0 sc1
    s_add_u32 s57, s31, 21225472
    buffer_load_dwordx4 v[220:223], v1, s[8:11], s57 offen offset:0 sc1
    s_add_u32 s57, s31, 21176320
    buffer_load_dwordx4 v[224:227], v1, s[8:11], s57 offen offset:1024 sc1
    s_add_u32 s57, s31, 21225472
    buffer_load_dwordx4 v[228:231], v1, s[8:11], s57 offen offset:1024 sc1
    s_add_u32 s57, s31, 21176320
    buffer_load_dwordx4 v[232:235], v1, s[8:11], s57 offen offset:2048 sc1
    s_add_u32 s57, s31, 21225472
    buffer_load_dwordx4 v[236:239], v1, s[8:11], s57 offen offset:2048 sc1
    s_add_u32 s57, s31, 21176320
    buffer_load_dwordx4 v[240:243], v1, s[8:11], s57 offen offset:3072 sc1
    s_add_u32 s57, s31, 21225472
    buffer_load_dwordx4 v[244:247], v1, s[8:11], s57 offen offset:3072 sc1
    s_waitcnt vmcnt(0)
    s_branch L_fixed_124
L_fix_127:
    s_mov_b32 s68, 0x80000
L_fixp_129:
    buffer_load_dword v3, v25, s[8:11], s38 offen sc1
    s_waitcnt vmcnt(0)
    v_cmp_le_u32 vcc, 16, v3
    s_nop 3
    s_cmp_eq_u64 vcc, -1
    s_cbranch_scc1 L_fixd_130
    s_sub_u32 s68, s68, 1
    s_cmp_lg_u32 s68, 0
    s_cbranch_scc1 L_fixp_129
L_fixd_130:
    s_add_u32 s57, s31, 21172224
    buffer_load_dwordx4 v[168:171], v1, s[8:11], s57 offen offset:3072 sc1
    s_add_u32 s57, s31, 21221376
    buffer_load_dwordx4 v[172:175], v1, s[8:11], s57 offen offset:3072 sc1
    s_add_u32 s57, s31, 21176320
    buffer_load_dwordx4 v[216:219], v1, s[8:11], s57 offen offset:0 sc1
    s_add_u32 s57, s31, 21225472
    buffer_load_dwordx4 v[220:223], v1, s[8:11], s57 offen offset:0 sc1
    s_add_u32 s57, s31, 21176320
    buffer_load_dwordx4 v[224:227], v1, s[8:11], s57 offen offset:1024 sc1
    s_add_u32 s57, s31, 21225472
    buffer_load_dwordx4 v[228:231], v1, s[8:11], s57 offen offset:1024 sc1
    s_add_u32 s57, s31, 21176320
    buffer_load_dwordx4 v[232:235], v1, s[8:11], s57 offen offset:2048 sc1
    s_add_u32 s57, s31, 21225472
    buffer_load_dwordx4 v[236:239], v1, s[8:11], s57 offen offset:2048 sc1
    s_add_u32 s57, s31, 21176320
    buffer_load_dwordx4 v[240:243], v1, s[8:11], s57 offen offset:3072 sc1
    s_add_u32 s57, s31, 21225472
    buffer_load_dwordx4 v[244:247], v1, s[8:11], s57 offen offset:3072 sc1
    s_waitcnt vmcnt(0)
    s_branch L_fixed_128
L_fix_131:
    s_mov_b32 s68, 0x80000
L_fixp_133:
    buffer_load_dword v3, v25, s[8:11], s38 offen sc1
    s_waitcnt vmcnt(0)
    v_cmp_le_u32 vcc, 16, v3
    s_nop 3
    s_cmp_eq_u64 vcc, -1
    s_cbranch_scc1 L_fixd_134
    s_sub_u32 s68, s68, 1
    s_cmp_lg_u32 s68, 0
    s_cbranch_scc1 L_fixp_133
L_fixd_134:
    s_add_u32 s57, s31, 21176320
    buffer_load_dwordx4 v[216:219], v1, s[8:11], s57 offen offset:0 sc1
    s_add_u32 s57, s31, 21225472
    buffer_load_dwordx4 v[220:223], v1, s[8:11], s57 offen offset:0 sc1
    s_add_u32 s57, s31, 21176320
    buffer_load_dwordx4 v[224:227], v1, s[8:11], s57 offen offset:1024 sc1
    s_add_u32 s57, s31, 21225472
    buffer_load_dwordx4 v[228:231], v1, s[8:11], s57 offen offset:1024 sc1
    s_add_u32 s57, s31, 21176320
    buffer_load_dwordx4 v[232:235], v1, s[8:11], s57 offen offset:2048 sc1
    s_add_u32 s57, s31, 21225472
    buffer_load_dwordx4 v[236:239], v1, s[8:11], s57 offen offset:2048 sc1
    s_add_u32 s57, s31, 21176320
    buffer_load_dwordx4 v[240:243], v1, s[8:11], s57 offen offset:3072 sc1
    s_add_u32 s57, s31, 21225472
    buffer_load_dwordx4 v[244:247], v1, s[8:11], s57 offen offset:3072 sc1
    s_waitcnt vmcnt(0)
    s_branch L_fixed_132
L_fix_135:
    s_mov_b32 s68, 0x80000
L_fixp_137:
    buffer_load_dword v3, v25, s[8:11], s38 offen sc1
    s_waitcnt vmcnt(0)
    v_cmp_le_u32 vcc, 16, v3
    s_nop 3
    s_cmp_eq_u64 vcc, -1
    s_cbranch_scc1 L_fixd_138
    s_sub_u32 s68, s68, 1
    s_cmp_lg_u32 s68, 0
    s_cbranch_scc1 L_fixp_137
L_fixd_138:
    s_add_u32 s57, s31, 21176320
    buffer_load_dwordx4 v[224:227], v1, s[8:11], s57 offen offset:1024 sc1
    s_add_u32 s57, s31, 21225472
    buffer_load_dwordx4 v[228:231], v1, s[8:11], s57 offen offset:1024 sc1
    s_add_u32 s57, s31, 21176320
    buffer_load_dwordx4 v[232:235], v1, s[8:11], s57 offen offset:2048 sc1
    s_add_u32 s57, s31, 21225472
    buffer_load_dwordx4 v[236:239], v1, s[8:11], s57 offen offset:2048 sc1
    s_add_u32 s57, s31, 21176320
    buffer_load_dwordx4 v[240:243], v1, s[8:11], s57 offen offset:3072 sc1
    s_add_u32 s57, s31, 21225472
    buffer_load_dwordx4 v[244:247], v1, s[8:11], s57 offen offset:3072 sc1
    s_waitcnt vmcnt(0)
    s_branch L_fixed_136
.section .rodata,"a"
.p2align 6
.amdhsa_kernel interleave_layers__sliding_local_dilated__glu_gated_glu__prompt_kernel
  .amdhsa_next_free_vgpr 512
  .amdhsa_next_free_sgpr 102
  .amdhsa_accum_offset 256
  .amdhsa_group_segment_fixed_size 0
  .amdhsa_kernarg_size 80
  .amdhsa_user_sgpr_count 2
  .amdhsa_user_sgpr_kernarg_segment_ptr 1
  .amdhsa_system_sgpr_workgroup_id_x 1
.end_amdhsa_kernel
.p2align 6
.amdhsa_kernel prep_kernel
  .amdhsa_next_free_vgpr 256
  .amdhsa_next_free_sgpr 102
  .amdhsa_accum_offset 256
  .amdhsa_group_segment_fixed_size 0
  .amdhsa_kernarg_size 80
  .amdhsa_user_sgpr_count 2
  .amdhsa_user_sgpr_kernarg_segment_ptr 1
  .amdhsa_system_sgpr_workgroup_id_x 1
.end_amdhsa_kernel
```
